```python
import torch

def _softmax(x, axis=-1):
    return torch.softmax(x, dim=axis)
def _gelu(x):
    return torch.nn.functional.gelu(x, approximate="tanh")
def _silu(x):
    return torch.nn.functional.silu(x)
def _sigmoid(x):
    return torch.sigmoid(x)
def _layernorm(x, axis=-1, eps=1e-5):
    m = x.mean(dim=axis, keepdim=True)
    v = x.var(dim=axis, keepdim=True, unbiased=False)
    return (x - m) / torch.sqrt(v + eps)
def _scatter_add(tgt, idx, src, axis=0):
    return tgt.clone().index_add_(axis, idx, src)
def _segment_sum(src, seg, n):
    out = torch.zeros((n,) + src.shape[1:], dtype=src.dtype)
    return out.index_add_(0, seg, src)
def _pad(x, pw):
    flat = tuple(v for pair in reversed(pw) for v in pair)
    return torch.nn.functional.pad(x, flat)

kernel_name = 'interleave_layers__sliding_block__glu_gated_bilinear__prompt'

def setup_inputs():

    _w = (lambda a: (lambda t: t.to(torch.bfloat16) if t.is_floating_point() else t)(torch.as_tensor(a)))
    def _A_setup():
        B, S, D = 1, 2048, 640
        return {
            "x": _w((lambda *s: torch.randn(*s, dtype=torch.bfloat16) * 0.05)(B, S, D)),
            "wqkv": _w((lambda *s: torch.randn(*s, dtype=torch.bfloat16) * 0.05)(D, 3 * D)),
            "wo": _w((lambda *s: torch.randn(*s, dtype=torch.bfloat16) * 0.05)(D, D)),
        }
    _A_in = _A_setup()

    def _B_setup():
        B, S, D, F = 1, 2048, 640, 1536
        return {
            "x": _w((lambda *s: torch.randn(*s, dtype=torch.bfloat16) * 0.05)(B, S, D)),
            "w_gate": _w((lambda *s: torch.randn(*s, dtype=torch.bfloat16) * 0.8)(D, F) * (D ** -0.5)),
            "w_up": _w((lambda *s: torch.randn(*s, dtype=torch.bfloat16) * 0.8)(D, F) * (D ** -0.5)),
            "w_down": _w((lambda *s: torch.randn(*s, dtype=torch.bfloat16) * 0.8)(F, D) * (F ** -0.5)),
        }
    _B_in = _B_setup()

    return {
        "A_x": _A_in["x"],
        "A_wqkv": _A_in["wqkv"],
        "A_wo": _A_in["wo"],
        "B_x": _B_in["x"],
        "B_w_gate": _B_in["w_gate"],
        "B_w_up": _B_in["w_up"],
        "B_w_down": _B_in["w_down"],
    }

def reference(A_x, A_wqkv, A_wo, B_x, B_w_gate, B_w_up, B_w_down):
    def _A_ref(x, wqkv, wo):
        B, S, D = x.shape
        H = 32; Dh = D // H; W = 256
        qkv = (lambda x, *d: x.permute(*d))((x @ wqkv).reshape(B, S, 3, H, Dh), 2, 0, 3, 1, 4)
        q, k, v = qkv[0], qkv[1], qkv[2]
        scores = torch.einsum("bhqd,bhkd->bhqk", q, k) * (Dh ** -0.5)
        idx = torch.arange(S)
        mask = (idx[:, None] - idx[None, :] >= 0) & (idx[:, None] - idx[None, :] < W)
        scores = torch.where(mask[None, None], scores, -1e9)
        p = _softmax(scores, axis=-1)
        o = torch.einsum("bhqk,bhkd->bhqd", p, v)
        return (lambda x, *d: x.permute(*d))(o, 0, 2, 1, 3).reshape(B, S, D) @ wo

    def _B_ref(x, w_gate, w_up, w_down):
        g = torch.einsum("bsd,df->bsf", x, w_gate)
        u = torch.einsum("bsd,df->bsf", x, w_up)
        h = g * u
        return torch.einsum("bsf,fd->bsd", h, w_down)

    x = A_x
    x = x + _A_ref(_layernorm(x, axis=-1), A_wqkv, A_wo)
    x = x + _B_ref(_layernorm(x, axis=-1), B_w_gate, B_w_up, B_w_down)
    x = x + _A_ref(_layernorm(x, axis=-1), A_wqkv, A_wo)
    x = x + _B_ref(_layernorm(x, axis=-1), B_w_gate, B_w_up, B_w_down)
    return x
```

```asm
; @launch kernel=prep_kernel grid=(182,1,1) block=(640,1,1) lds=81920
; @launch kernel=mega_kernel grid=(256,1,1) block=(256,1,1) lds=146176
.amdgcn_target "amdgcn-amd-amdhsa--gfx950"
.text
.globl prep_kernel
.p2align 8
.type prep_kernel,@function
prep_kernel:
s_cmp_ge_u32 s2, 182
s_cbranch_scc1 prep_end
s_load_dwordx2 s[4:5], s[0:1], 72
s_cmp_ge_u32 s2, 118
s_cbranch_scc1 prep_x
s_cmp_lt_u32 s2, 30
s_cbranch_scc1 prep_w0
s_cmp_lt_u32 s2, 54
s_cbranch_scc1 prep_w1
s_cmp_lt_u32 s2, 78
s_cbranch_scc1 prep_w2
s_cmp_lt_u32 s2, 88
s_cbranch_scc1 prep_w3
s_load_dwordx2 s[6:7], s[0:1], 48
s_sub_u32 s3, s2, 88
s_mul_i32 s22, s3, 205
s_lshr_b32 s22, s22, 11
s_mul_i32 s23, s22, 10
s_sub_u32 s21, s3, s23
s_lshl_b32 s22, s22, 6
s_movk_i32 s20, 1280
s_movk_i32 s23, 64
s_mov_b32 s24, 7208960
s_movk_i32 s25, 80
s_movk_i32 s26, 80
s_mov_b32 s27, 245760
s_mov_b32 s28, 0
s_mov_b32 s29, -1
s_mov_b32 s30, 1966080
s_mov_b32 s40, 0
s_branch prep_wgo
prep_w0:
s_load_dwordx2 s[6:7], s[0:1], 8
s_mov_b32 s21, s2
s_mov_b32 s22, 0
s_movk_i32 s20, 3840
s_movk_i32 s23, 80
s_mov_b32 s24, 0
s_movk_i32 s25, 128
s_movk_i32 s26, 128
s_mov_b32 s27, 163840
s_mov_b32 s28, 0
s_mov_b32 s29, 0
s_mov_b32 s30, 2457600
s_mov_b32 s40, 1
s_branch prep_wgo
prep_w1:
s_load_dwordx2 s[6:7], s[0:1], 32
s_sub_u32 s21, s2, 30
s_mov_b32 s22, 0
s_movk_i32 s20, 3072
s_movk_i32 s23, 80
s_mov_b32 s24, 2457600
s_movk_i32 s25, 96
s_movk_i32 s26, 192
s_mov_b32 s27, 245760
s_mov_b32 s28, 0
s_mov_b32 s29, 7680
s_mov_b32 s30, 1966080
s_mov_b32 s40, 0
s_branch prep_wgo
prep_w2:
s_load_dwordx2 s[6:7], s[0:1], 40
s_sub_u32 s21, s2, 54
s_mov_b32 s22, 0
s_movk_i32 s20, 3072
s_movk_i32 s23, 80
s_mov_b32 s24, 2457600
s_movk_i32 s25, 96
s_movk_i32 s26, 192
s_mov_b32 s27, 245760
s_movk_i32 s28, 96
s_mov_b32 s29, 13824
s_mov_b32 s30, 1966080
s_mov_b32 s40, 0
s_branch prep_wgo
prep_w3:
s_load_dwordx2 s[6:7], s[0:1], 16
s_sub_u32 s21, s2, 78
s_mov_b32 s22, 0
s_movk_i32 s20, 1280
s_movk_i32 s23, 80
s_mov_b32 s24, 6389760
s_movk_i32 s25, 80
s_movk_i32 s26, 80
s_mov_b32 s27, 102400
s_mov_b32 s28, 0
s_mov_b32 s29, -1
s_mov_b32 s30, 819200
s_mov_b32 s40, 2
prep_wgo:
v_lshrrev_b32 v2, 6, v0
v_and_b32 v1, 63, v0
s_nop 0
v_readfirstlane_b32 s31, v2
s_lshl_b32 s33, s31, 3
s_cmp_ge_u32 s33, s23
s_cbranch_scc1 prep_end
v_lshrrev_b32 v3, 3, v1
v_mul_lo_u32 v3, v3, s20
v_and_b32 v4, 7, v1
v_lshl_add_u32 v3, v4, 4, v3
s_add_u32 s34, s22, s33
s_lshl_b32 s35, s34, 3
s_mul_i32 s35, s35, s20
s_lshl_b32 s36, s21, 7
s_add_u32 s35, s35, s36
s_lshl_b32 s36, s20, 3
s_lshl_b32 s37, s31, 13
s_lshl_b32 s38, s21, 6
v_add_u32 v5, s38, v1
s_mov_b32 s41, 52429
v_mul_lo_u32 v6, v5, s41
v_lshrrev_b32 v6, 21, v6
v_mul_u32_u24 v6, 40, v6
v_sub_u32 v6, v5, v6
v_mov_b32 v7, 0
v_cmp_le_u32 vcc, 16, v6
s_nop 0
v_cndmask_b32 v7, v7, 16, vcc
v_cmp_le_u32 vcc, 20, v6
s_nop 0
v_cndmask_b32 v7, v7, -4, vcc
v_cmp_le_u32 vcc, 36, v6
s_nop 0
v_cndmask_b32 v7, v7, 0, vcc
s_cmp_eq_u32 s40, 1
s_cselect_b32 s41, -1, 0
v_and_b32 v7, s41, v7
v_add_u32 v5, v5, v7
v_mov_b32 v14, v5
v_cvt_f32_u32 v6, v5
v_cvt_f32_u32 v7, s25
v_rcp_f32 v7, v7
v_add_f32 v6, 0.5, v6
v_mul_f32 v6, v6, v7
v_cvt_u32_f32 v6, v6
v_mul_lo_u32 v7, v6, s25
v_sub_u32 v7, v5, v7
v_add_u32 v7, s28, v7
v_lshlrev_b32 v7, 4, v7
v_mul_lo_u32 v8, v6, s27
v_add_u32 v7, v7, v8
s_lshl_b32 s39, s26, 4
s_mul_i32 s38, s34, s39
s_add_u32 s38, s38, s24
v_and_b32 v9, 15, v1
v_lshrrev_b32 v10, 2, v9
v_lshlrev_b32 v10, 7, v10
v_and_b32 v9, 3, v9
v_lshl_add_u32 v10, v9, 3, v10
v_lshrrev_b32 v9, 4, v1
v_lshl_add_u32 v10, v9, 5, v10
v_add_u32 v10, s37, v10
s_waitcnt lgkmcnt(0)
s_mov_b32 s8, s6
s_mov_b32 s9, s7
s_mov_b32 s10, s30
s_mov_b32 s11, 0x20000
s_mov_b32 s12, s4
s_mov_b32 s13, s5
s_mov_b32 s14, 57274368
s_mov_b32 s15, 0x20000
s_cmp_eq_u32 s40, 2
s_cbranch_scc1 prep_rowperm
s_add_u32 m0, s37, 0
s_nop 0
buffer_load_dwordx4 v3, s[8:11], s35 offen lds
s_add_u32 s35, s35, s36
s_add_u32 m0, s37, 1024
s_nop 0
buffer_load_dwordx4 v3, s[8:11], s35 offen lds
s_add_u32 s35, s35, s36
s_add_u32 m0, s37, 2048
s_nop 0
buffer_load_dwordx4 v3, s[8:11], s35 offen lds
s_add_u32 s35, s35, s36
s_add_u32 m0, s37, 3072
s_nop 0
buffer_load_dwordx4 v3, s[8:11], s35 offen lds
s_add_u32 s35, s35, s36
s_add_u32 m0, s37, 4096
s_nop 0
buffer_load_dwordx4 v3, s[8:11], s35 offen lds
s_add_u32 s35, s35, s36
s_add_u32 m0, s37, 5120
s_nop 0
buffer_load_dwordx4 v3, s[8:11], s35 offen lds
s_add_u32 s35, s35, s36
s_add_u32 m0, s37, 6144
s_nop 0
buffer_load_dwordx4 v3, s[8:11], s35 offen lds
s_add_u32 s35, s35, s36
s_add_u32 m0, s37, 7168
s_nop 0
buffer_load_dwordx4 v3, s[8:11], s35 offen lds
s_branch prep_loaded
prep_rowperm:
v_lshrrev_b32 v11, 5, v1
v_mul_lo_u32 v11, v11, s36
v_lshlrev_b32 v11, 1, v11
v_add_u32 v11, v11, v3
s_lshl_b32 s42, s21, 7
s_add_u32 s43, s34, 0
s_mul_i32 s44, s43, 205
s_lshr_b32 s44, s44, 10
s_mul_i32 s45, s44, 5
s_sub_u32 s45, s43, s45
s_lshl_b32 s46, s45, 3
s_cmp_ge_u32 s45, 2
s_cselect_b32 s47, 4, 0
s_add_u32 s46, s46, s47
s_cmp_eq_u32 s45, 4
s_cselect_b32 s46, 16, s46
s_mul_i32 s44, s44, 40
s_add_u32 s44, s44, s46
s_mul_i32 s44, s44, s20
s_add_u32 s44, s44, s42
s_cmp_eq_u32 s45, 4
s_cselect_b64 s[48:49], -1, 0
v_cndmask_b32 v15, v3, v11, s[48:49]
s_add_u32 m0, s37, 0
s_nop 0
buffer_load_dwordx4 v15, s[8:11], s44 offen lds
s_add_u32 s43, s34, 1
s_mul_i32 s44, s43, 205
s_lshr_b32 s44, s44, 10
s_mul_i32 s45, s44, 5
s_sub_u32 s45, s43, s45
s_lshl_b32 s46, s45, 3
s_cmp_ge_u32 s45, 2
s_cselect_b32 s47, 4, 0
s_add_u32 s46, s46, s47
s_cmp_eq_u32 s45, 4
s_cselect_b32 s46, 16, s46
s_mul_i32 s44, s44, 40
s_add_u32 s44, s44, s46
s_mul_i32 s44, s44, s20
s_add_u32 s44, s44, s42
s_cmp_eq_u32 s45, 4
s_cselect_b64 s[48:49], -1, 0
v_cndmask_b32 v15, v3, v11, s[48:49]
s_add_u32 m0, s37, 1024
s_nop 0
buffer_load_dwordx4 v15, s[8:11], s44 offen lds
s_add_u32 s43, s34, 2
s_mul_i32 s44, s43, 205
s_lshr_b32 s44, s44, 10
s_mul_i32 s45, s44, 5
s_sub_u32 s45, s43, s45
s_lshl_b32 s46, s45, 3
s_cmp_ge_u32 s45, 2
s_cselect_b32 s47, 4, 0
s_add_u32 s46, s46, s47
s_cmp_eq_u32 s45, 4
s_cselect_b32 s46, 16, s46
s_mul_i32 s44, s44, 40
s_add_u32 s44, s44, s46
s_mul_i32 s44, s44, s20
s_add_u32 s44, s44, s42
s_cmp_eq_u32 s45, 4
s_cselect_b64 s[48:49], -1, 0
v_cndmask_b32 v15, v3, v11, s[48:49]
s_add_u32 m0, s37, 2048
s_nop 0
buffer_load_dwordx4 v15, s[8:11], s44 offen lds
s_add_u32 s43, s34, 3
s_mul_i32 s44, s43, 205
s_lshr_b32 s44, s44, 10
s_mul_i32 s45, s44, 5
s_sub_u32 s45, s43, s45
s_lshl_b32 s46, s45, 3
s_cmp_ge_u32 s45, 2
s_cselect_b32 s47, 4, 0
s_add_u32 s46, s46, s47
s_cmp_eq_u32 s45, 4
s_cselect_b32 s46, 16, s46
s_mul_i32 s44, s44, 40
s_add_u32 s44, s44, s46
s_mul_i32 s44, s44, s20
s_add_u32 s44, s44, s42
s_cmp_eq_u32 s45, 4
s_cselect_b64 s[48:49], -1, 0
v_cndmask_b32 v15, v3, v11, s[48:49]
s_add_u32 m0, s37, 3072
s_nop 0
buffer_load_dwordx4 v15, s[8:11], s44 offen lds
s_add_u32 s43, s34, 4
s_mul_i32 s44, s43, 205
s_lshr_b32 s44, s44, 10
s_mul_i32 s45, s44, 5
s_sub_u32 s45, s43, s45
s_lshl_b32 s46, s45, 3
s_cmp_ge_u32 s45, 2
s_cselect_b32 s47, 4, 0
s_add_u32 s46, s46, s47
s_cmp_eq_u32 s45, 4
s_cselect_b32 s46, 16, s46
s_mul_i32 s44, s44, 40
s_add_u32 s44, s44, s46
s_mul_i32 s44, s44, s20
s_add_u32 s44, s44, s42
s_cmp_eq_u32 s45, 4
s_cselect_b64 s[48:49], -1, 0
v_cndmask_b32 v15, v3, v11, s[48:49]
s_add_u32 m0, s37, 4096
s_nop 0
buffer_load_dwordx4 v15, s[8:11], s44 offen lds
s_add_u32 s43, s34, 5
s_mul_i32 s44, s43, 205
s_lshr_b32 s44, s44, 10
s_mul_i32 s45, s44, 5
s_sub_u32 s45, s43, s45
s_lshl_b32 s46, s45, 3
s_cmp_ge_u32 s45, 2
s_cselect_b32 s47, 4, 0
s_add_u32 s46, s46, s47
s_cmp_eq_u32 s45, 4
s_cselect_b32 s46, 16, s46
s_mul_i32 s44, s44, 40
s_add_u32 s44, s44, s46
s_mul_i32 s44, s44, s20
s_add_u32 s44, s44, s42
s_cmp_eq_u32 s45, 4
s_cselect_b64 s[48:49], -1, 0
v_cndmask_b32 v15, v3, v11, s[48:49]
s_add_u32 m0, s37, 5120
s_nop 0
buffer_load_dwordx4 v15, s[8:11], s44 offen lds
s_add_u32 s43, s34, 6
s_mul_i32 s44, s43, 205
s_lshr_b32 s44, s44, 10
s_mul_i32 s45, s44, 5
s_sub_u32 s45, s43, s45
s_lshl_b32 s46, s45, 3
s_cmp_ge_u32 s45, 2
s_cselect_b32 s47, 4, 0
s_add_u32 s46, s46, s47
s_cmp_eq_u32 s45, 4
s_cselect_b32 s46, 16, s46
s_mul_i32 s44, s44, 40
s_add_u32 s44, s44, s46
s_mul_i32 s44, s44, s20
s_add_u32 s44, s44, s42
s_cmp_eq_u32 s45, 4
s_cselect_b64 s[48:49], -1, 0
v_cndmask_b32 v15, v3, v11, s[48:49]
s_add_u32 m0, s37, 6144
s_nop 0
buffer_load_dwordx4 v15, s[8:11], s44 offen lds
s_add_u32 s43, s34, 7
s_mul_i32 s44, s43, 205
s_lshr_b32 s44, s44, 10
s_mul_i32 s45, s44, 5
s_sub_u32 s45, s43, s45
s_lshl_b32 s46, s45, 3
s_cmp_ge_u32 s45, 2
s_cselect_b32 s47, 4, 0
s_add_u32 s46, s46, s47
s_cmp_eq_u32 s45, 4
s_cselect_b32 s46, 16, s46
s_mul_i32 s44, s44, 40
s_add_u32 s44, s44, s46
s_mul_i32 s44, s44, s20
s_add_u32 s44, s44, s42
s_cmp_eq_u32 s45, 4
s_cselect_b64 s[48:49], -1, 0
v_cndmask_b32 v15, v3, v11, s[48:49]
s_add_u32 m0, s37, 7168
s_nop 0
buffer_load_dwordx4 v15, s[8:11], s44 offen lds
prep_loaded:
v_mov_b32 v12, 0x3f803f80
v_mov_b32 v13, 0
s_waitcnt vmcnt(7)
ds_read_b64_tr_b16 v[16:17], v10 offset:0
ds_read_b64_tr_b16 v[18:19], v10 offset:512
s_waitcnt vmcnt(6)
ds_read_b64_tr_b16 v[20:21], v10 offset:1024
ds_read_b64_tr_b16 v[22:23], v10 offset:1536
s_waitcnt vmcnt(5)
ds_read_b64_tr_b16 v[24:25], v10 offset:2048
ds_read_b64_tr_b16 v[26:27], v10 offset:2560
s_waitcnt vmcnt(4)
ds_read_b64_tr_b16 v[28:29], v10 offset:3072
ds_read_b64_tr_b16 v[30:31], v10 offset:3584
s_waitcnt vmcnt(3)
ds_read_b64_tr_b16 v[32:33], v10 offset:4096
ds_read_b64_tr_b16 v[34:35], v10 offset:4608
s_waitcnt vmcnt(2)
ds_read_b64_tr_b16 v[36:37], v10 offset:5120
ds_read_b64_tr_b16 v[38:39], v10 offset:5632
s_waitcnt vmcnt(1)
ds_read_b64_tr_b16 v[40:41], v10 offset:6144
ds_read_b64_tr_b16 v[42:43], v10 offset:6656
s_waitcnt vmcnt(0)
ds_read_b64_tr_b16 v[44:45], v10 offset:7168
ds_read_b64_tr_b16 v[46:47], v10 offset:7680
s_waitcnt lgkmcnt(14)
buffer_store_dwordx4 v[16:19], v7, s[12:15], s38 offen
s_add_u32 s38, s38, s39
v_dot2_f32_bf16 v13, v16, v12, v13
v_dot2_f32_bf16 v13, v17, v12, v13
v_dot2_f32_bf16 v13, v18, v12, v13
v_dot2_f32_bf16 v13, v19, v12, v13
s_waitcnt lgkmcnt(12)
buffer_store_dwordx4 v[20:23], v7, s[12:15], s38 offen
s_add_u32 s38, s38, s39
v_dot2_f32_bf16 v13, v20, v12, v13
v_dot2_f32_bf16 v13, v21, v12, v13
v_dot2_f32_bf16 v13, v22, v12, v13
v_dot2_f32_bf16 v13, v23, v12, v13
s_waitcnt lgkmcnt(10)
buffer_store_dwordx4 v[24:27], v7, s[12:15], s38 offen
s_add_u32 s38, s38, s39
v_dot2_f32_bf16 v13, v24, v12, v13
v_dot2_f32_bf16 v13, v25, v12, v13
v_dot2_f32_bf16 v13, v26, v12, v13
v_dot2_f32_bf16 v13, v27, v12, v13
s_waitcnt lgkmcnt(8)
buffer_store_dwordx4 v[28:31], v7, s[12:15], s38 offen
s_add_u32 s38, s38, s39
v_dot2_f32_bf16 v13, v28, v12, v13
v_dot2_f32_bf16 v13, v29, v12, v13
v_dot2_f32_bf16 v13, v30, v12, v13
v_dot2_f32_bf16 v13, v31, v12, v13
s_waitcnt lgkmcnt(6)
buffer_store_dwordx4 v[32:35], v7, s[12:15], s38 offen
s_add_u32 s38, s38, s39
v_dot2_f32_bf16 v13, v32, v12, v13
v_dot2_f32_bf16 v13, v33, v12, v13
v_dot2_f32_bf16 v13, v34, v12, v13
v_dot2_f32_bf16 v13, v35, v12, v13
s_waitcnt lgkmcnt(4)
buffer_store_dwordx4 v[36:39], v7, s[12:15], s38 offen
s_add_u32 s38, s38, s39
v_dot2_f32_bf16 v13, v36, v12, v13
v_dot2_f32_bf16 v13, v37, v12, v13
v_dot2_f32_bf16 v13, v38, v12, v13
v_dot2_f32_bf16 v13, v39, v12, v13
s_waitcnt lgkmcnt(2)
buffer_store_dwordx4 v[40:43], v7, s[12:15], s38 offen
s_add_u32 s38, s38, s39
v_dot2_f32_bf16 v13, v40, v12, v13
v_dot2_f32_bf16 v13, v41, v12, v13
v_dot2_f32_bf16 v13, v42, v12, v13
v_dot2_f32_bf16 v13, v43, v12, v13
s_waitcnt lgkmcnt(0)
buffer_store_dwordx4 v[44:47], v7, s[12:15], s38 offen
v_dot2_f32_bf16 v13, v44, v12, v13
v_dot2_f32_bf16 v13, v45, v12, v13
v_dot2_f32_bf16 v13, v46, v12, v13
v_dot2_f32_bf16 v13, v47, v12, v13
s_cmp_eq_u32 s29, -1
s_cbranch_scc1 prep_end
s_nop 3
s_barrier
v_lshlrev_b32 v3, 2, v0
ds_write_b32 v3, v13
s_waitcnt lgkmcnt(0)
s_barrier
s_cmp_lg_u32 s31, 0
s_cbranch_scc1 prep_end
ds_read_b32 v16, v3 offset:0
ds_read_b32 v17, v3 offset:256
ds_read_b32 v18, v3 offset:512
ds_read_b32 v19, v3 offset:768
ds_read_b32 v20, v3 offset:1024
ds_read_b32 v21, v3 offset:1280
ds_read_b32 v22, v3 offset:1536
ds_read_b32 v23, v3 offset:1792
ds_read_b32 v24, v3 offset:2048
ds_read_b32 v25, v3 offset:2304
s_waitcnt lgkmcnt(0)
v_add_f32 v16, v16, v17
v_add_f32 v16, v16, v18
v_add_f32 v16, v16, v19
v_add_f32 v16, v16, v20
v_add_f32 v16, v16, v21
v_add_f32 v16, v16, v22
v_add_f32 v16, v16, v23
v_add_f32 v16, v16, v24
v_add_f32 v16, v16, v25
s_add_u32 s31, s29, 9175040
v_lshlrev_b32 v3, 2, v14
buffer_store_dword v16, v3, s[12:15], s31 offen
s_endpgm
prep_x:
s_load_dwordx2 s[6:7], s[0:1], 0
s_sub_u32 s3, s2, 118
s_waitcnt lgkmcnt(0)
s_mov_b32 s8, s6
s_mov_b32 s9, s7
s_mov_b32 s10, 2621440
s_mov_b32 s11, 0x20000
s_mov_b32 s12, s4
s_mov_b32 s13, s5
s_mov_b32 s14, 57274368
s_mov_b32 s15, 0x20000
v_cmp_gt_u32 vcc, 512, v0
s_and_saveexec_b64 s[32:33], vcc
s_cbranch_execz prep_zero
v_lshrrev_b32 v1, 4, v0
v_and_b32 v2, 15, v0
s_lshl_b32 s21, s3, 5
v_add_u32 v1, s21, v1
s_movk_i32 s20, 1280
v_mul_lo_u32 v3, v1, s20
v_lshl_add_u32 v3, v2, 4, v3
v_lshrrev_b32 v4, 6, v1
s_mov_b32 s20, 81920
v_mul_lo_u32 v4, v4, s20
v_and_b32 v5, 63, v1
v_lshl_add_u32 v4, v5, 4, v4
v_lshl_add_u32 v4, v2, 10, v4
buffer_load_dwordx4 v[8:11], v3, s[8:11], 0 offen offset:0
buffer_load_dwordx4 v[12:15], v3, s[8:11], 0 offen offset:256
buffer_load_dwordx4 v[16:19], v3, s[8:11], 0 offen offset:512
buffer_load_dwordx4 v[20:23], v3, s[8:11], 0 offen offset:768
buffer_load_dwordx4 v[24:27], v3, s[8:11], 0 offen offset:1024
v_mov_b32 v30, 0x3f803f80
v_mov_b32 v32, 0
v_mov_b32 v33, 0
s_mov_b32 s20, 9293824
s_waitcnt vmcnt(4)
buffer_store_dwordx4 v[8:11], v4, s[12:15], s20 offen
v_dot2_f32_bf16 v32, v8, v30, v32
v_dot2_f32_bf16 v33, v8, v8, v33
v_dot2_f32_bf16 v32, v9, v30, v32
v_dot2_f32_bf16 v33, v9, v9, v33
v_dot2_f32_bf16 v32, v10, v30, v32
v_dot2_f32_bf16 v33, v10, v10, v33
v_dot2_f32_bf16 v32, v11, v30, v32
v_dot2_f32_bf16 v33, v11, v11, v33
s_mov_b32 s20, 9310208
s_waitcnt vmcnt(4)
buffer_store_dwordx4 v[12:15], v4, s[12:15], s20 offen
v_dot2_f32_bf16 v32, v12, v30, v32
v_dot2_f32_bf16 v33, v12, v12, v33
v_dot2_f32_bf16 v32, v13, v30, v32
v_dot2_f32_bf16 v33, v13, v13, v33
v_dot2_f32_bf16 v32, v14, v30, v32
v_dot2_f32_bf16 v33, v14, v14, v33
v_dot2_f32_bf16 v32, v15, v30, v32
v_dot2_f32_bf16 v33, v15, v15, v33
s_mov_b32 s20, 9326592
s_waitcnt vmcnt(4)
buffer_store_dwordx4 v[16:19], v4, s[12:15], s20 offen
v_dot2_f32_bf16 v32, v16, v30, v32
v_dot2_f32_bf16 v33, v16, v16, v33
v_dot2_f32_bf16 v32, v17, v30, v32
v_dot2_f32_bf16 v33, v17, v17, v33
v_dot2_f32_bf16 v32, v18, v30, v32
v_dot2_f32_bf16 v33, v18, v18, v33
v_dot2_f32_bf16 v32, v19, v30, v32
v_dot2_f32_bf16 v33, v19, v19, v33
s_mov_b32 s20, 9342976
s_waitcnt vmcnt(4)
buffer_store_dwordx4 v[20:23], v4, s[12:15], s20 offen
v_dot2_f32_bf16 v32, v20, v30, v32
v_dot2_f32_bf16 v33, v20, v20, v33
v_dot2_f32_bf16 v32, v21, v30, v32
v_dot2_f32_bf16 v33, v21, v21, v33
v_dot2_f32_bf16 v32, v22, v30, v32
v_dot2_f32_bf16 v33, v22, v22, v33
v_dot2_f32_bf16 v32, v23, v30, v32
v_dot2_f32_bf16 v33, v23, v23, v33
s_mov_b32 s20, 9359360
s_waitcnt vmcnt(4)
buffer_store_dwordx4 v[24:27], v4, s[12:15], s20 offen
v_dot2_f32_bf16 v32, v24, v30, v32
v_dot2_f32_bf16 v33, v24, v24, v33
v_dot2_f32_bf16 v32, v25, v30, v32
v_dot2_f32_bf16 v33, v25, v25, v33
v_dot2_f32_bf16 v32, v26, v30, v32
v_dot2_f32_bf16 v33, v26, v26, v33
v_dot2_f32_bf16 v32, v27, v30, v32
v_dot2_f32_bf16 v33, v27, v27, v33
s_nop 3
v_add_f32_dpp v32, v32, v32 row_ror:1 row_mask:0xf bank_mask:0xf
v_add_f32_dpp v33, v33, v33 row_ror:1 row_mask:0xf bank_mask:0xf
s_nop 1
v_add_f32_dpp v32, v32, v32 row_ror:2 row_mask:0xf bank_mask:0xf
v_add_f32_dpp v33, v33, v33 row_ror:2 row_mask:0xf bank_mask:0xf
s_nop 1
v_add_f32_dpp v32, v32, v32 row_ror:4 row_mask:0xf bank_mask:0xf
v_add_f32_dpp v33, v33, v33 row_ror:4 row_mask:0xf bank_mask:0xf
s_nop 1
v_add_f32_dpp v32, v32, v32 row_ror:8 row_mask:0xf bank_mask:0xf
v_add_f32_dpp v33, v33, v33 row_ror:8 row_mask:0xf bank_mask:0xf
s_nop 1
v_cmp_eq_u32 vcc, 0, v2
s_nop 1
v_cndmask_b32 v32, 0, v32, vcc
v_cndmask_b32 v33, 0, v33, vcc
v_lshlrev_b32 v5, 15, v2
v_lshl_add_u32 v5, v1, 4, v5
v_mov_b32 v34, 0
v_mov_b32 v35, 0
s_mov_b32 s20, 14536704
v_cmp_gt_u32 vcc, 8, v2
s_and_saveexec_b64 s[22:23], vcc
buffer_store_dwordx4 v[32:35], v5, s[12:15], s20 offen
s_endpgm
prep_zero:
s_mov_b64 exec, s[32:33]
v_subrev_u32 v1, 512, v0
v_cmp_gt_u32 vcc, 96, v1
s_and_saveexec_b64 s[32:33], vcc
s_cbranch_execz prep_end
s_mul_i32 s20, s3, 1536
s_add_u32 s20, s20, 9195520
v_lshlrev_b32 v1, 4, v1
v_mov_b32 v4, 0
v_mov_b32 v5, 0
v_mov_b32 v6, 0
v_mov_b32 v7, 0
buffer_store_dwordx4 v[4:7], v1, s[12:15], s20 offen
prep_end:
s_endpgm
.text
.globl mega_kernel
.p2align 8
.type mega_kernel,@function
mega_kernel:
s_cmp_ge_u32 s2, 256
s_cbranch_scc1 mega_end
s_load_dwordx2 s[4:5], s[0:1], 72
s_load_dwordx2 s[6:7], s[0:1], 56
v_lshrrev_b32 v1, 6, v0
v_and_b32 v0, 63, v0
s_and_b32 s17, s2, 7
s_lshr_b32 s18, s2, 3
v_readfirstlane_b32 s16, v1
v_lshlrev_b32 v1, 4, v0
v_and_b32 v2, 31, v0
v_lshrrev_b32 v3, 5, v0
v_and_b32 v4, 15, v0
v_lshrrev_b32 v5, 4, v0
v_mov_b32 v6, 0
v_mov_b32 v7, 1
s_lshr_b32 s19, s17, 2
s_lshl_b32 s19, s19, 3
s_and_b32 s28, s18, 7
s_add_u32 s19, s19, s28
s_and_b32 s21, s17, 3
s_lshl_b32 s21, s21, 2
s_lshr_b32 s28, s18, 3
s_add_u32 s21, s21, s28
s_min_u32 s20, s21, 14
s_lshl_b32 s22, s17, 2
s_and_b32 s28, s18, 3
s_add_u32 s22, s22, s28
s_lshr_b32 s23, s18, 2
s_lshr_b32 s24, s17, 1
s_lshl_b32 s24, s24, 3
s_and_b32 s28, s18, 7
s_add_u32 s24, s24, s28
s_and_b32 s25, s17, 1
s_lshl_b32 s25, s25, 2
s_lshr_b32 s28, s18, 3
s_add_u32 s25, s25, s28
s_lshl_b32 s30, s16, 11
s_mov_b32 s76, 0
v_lshlrev_b32 v8, 10, v3
v_lshl_add_u32 v8, v2, 4, v8
v_lshlrev_b32 v9, 11, v3
v_lshl_add_u32 v9, v2, 4, v9
v_lshlrev_b32 v10, 10, v5
v_lshl_add_u32 v10, v4, 4, v10
v_mul_u32_u24 v11, 1280, v5
v_lshl_add_u32 v11, v4, 4, v11
v_mul_u32_u24 v12, 3072, v5
v_lshl_add_u32 v12, v4, 4, v12
s_waitcnt lgkmcnt(0)
s_mov_b32 s8, s4
s_mov_b32 s9, s5
s_mov_b32 s10, 57274368
s_mov_b32 s11, 0x20000
s_mov_b32 s12, s6
s_mov_b32 s13, s7
s_mov_b32 s14, 2621440
s_mov_b32 s15, 0x20000
s_add_u32 s26, s19, 0
s_mul_i32 s26, s26, 81920
s_add_u32 s26, s26, 9293824
s_add_u32 s26, s26, s30
s_add_u32 m0, s30, 0
s_nop 0
buffer_load_dwordx4 v1, s[8:11], s26 offen sc1 lds
buffer_load_dwordx4 v1, s[8:11], s26 offen offset:1024 sc1 lds
s_add_u32 s26, s26, 8192
s_add_u32 m0, s30, 8192
s_nop 0
buffer_load_dwordx4 v1, s[8:11], s26 offen sc1 lds
buffer_load_dwordx4 v1, s[8:11], s26 offen offset:1024 sc1 lds
s_add_u32 s26, s26, 8192
s_add_u32 s28, s19, 0
s_lshl_b32 s28, s28, 6
v_add_u32 v29, s28, v0
v_lshlrev_b32 v29, 4, v29
s_mov_b32 s29, 14536704
buffer_load_dwordx4 v[140:143], v29, s[8:11], s29 offen sc1
s_add_u32 s29, s29, 32768
buffer_load_dwordx4 v[144:147], v29, s[8:11], s29 offen sc1
s_add_u32 s29, s29, 32768
buffer_load_dwordx4 v[148:151], v29, s[8:11], s29 offen sc1
s_add_u32 s29, s29, 32768
buffer_load_dwordx4 v[152:155], v29, s[8:11], s29 offen sc1
s_add_u32 s29, s29, 32768
buffer_load_dwordx4 v[156:159], v29, s[8:11], s29 offen sc1
s_add_u32 s29, s29, 32768
buffer_load_dwordx4 v[160:163], v29, s[8:11], s29 offen sc1
s_add_u32 s29, s29, 32768
buffer_load_dwordx4 v[164:167], v29, s[8:11], s29 offen sc1
s_add_u32 s29, s29, 32768
buffer_load_dwordx4 v[168:171], v29, s[8:11], s29 offen sc1
s_lshl_b32 s28, s20, 7
s_lshl_b32 s29, s16, 5
s_add_u32 s28, s28, s29
s_lshl_b32 s28, s28, 2
s_add_u32 s28, s28, 9175040
v_lshlrev_b32 v29, 4, v3
buffer_load_dwordx4 v[124:127], v29, s[8:11], s28 offen offset:0
buffer_load_dwordx4 v[128:131], v29, s[8:11], s28 offen offset:32
buffer_load_dwordx4 v[132:135], v29, s[8:11], s28 offen offset:64
buffer_load_dwordx4 v[136:139], v29, s[8:11], s28 offen offset:96
s_mul_i32 s33, s20, 163840
s_lshl_b32 s28, s16, 9
s_add_u32 s33, s33, s28
s_add_u32 s33, s33, 0
buffer_load_dwordx4 a[0:3], v9, s[8:11], s33 offen offset:0
s_add_u32 s33, s33, 4096
buffer_load_dwordx4 a[4:7], v9, s[8:11], s33 offen offset:0
s_add_u32 s33, s33, 4096
buffer_load_dwordx4 a[8:11], v9, s[8:11], s33 offen offset:0
s_add_u32 s33, s33, 4096
buffer_load_dwordx4 a[12:15], v9, s[8:11], s33 offen offset:0
s_add_u32 s33, s33, 4096
buffer_load_dwordx4 a[16:19], v9, s[8:11], s33 offen offset:0
s_add_u32 s33, s33, 4096
buffer_load_dwordx4 a[20:23], v9, s[8:11], s33 offen offset:0
s_add_u32 s33, s33, 4096
buffer_load_dwordx4 a[24:27], v9, s[8:11], s33 offen offset:0
s_add_u32 s33, s33, 4096
buffer_load_dwordx4 a[28:31], v9, s[8:11], s33 offen offset:0
s_add_u32 s33, s33, 4096
buffer_load_dwordx4 a[32:35], v9, s[8:11], s33 offen offset:0
s_add_u32 s33, s33, 4096
buffer_load_dwordx4 a[36:39], v9, s[8:11], s33 offen offset:0
s_add_u32 m0, s30, 16384
s_nop 0
buffer_load_dwordx4 v1, s[8:11], s26 offen sc1 lds
buffer_load_dwordx4 v1, s[8:11], s26 offen offset:1024 sc1 lds
s_add_u32 s26, s26, 8192
s_add_u32 m0, s30, 24576
s_nop 0
buffer_load_dwordx4 v1, s[8:11], s26 offen sc1 lds
buffer_load_dwordx4 v1, s[8:11], s26 offen offset:1024 sc1 lds
s_add_u32 s26, s26, 8192
s_lshr_b32 s38, s22, 1
s_mul_i32 s38, s38, 5
s_and_b32 s31, s22, 1
s_lshl_b32 s39, s31, 1
s_add_u32 s39, s39, s38
s_lshl_b32 s31, s31, 3
v_lshlrev_b32 v16, 2, v3
v_sub_u32 v16, v2, v16
v_cmp_le_i32 s[40:41], 0, v16
v_cmp_le_i32 s[42:43], 1, v16
v_cmp_le_i32 s[44:45], 2, v16
v_cmp_le_i32 s[46:47], 3, v16
v_cmp_le_i32 s[48:49], 8, v16
v_cmp_le_i32 s[50:51], 9, v16
v_cmp_le_i32 s[52:53], 10, v16
v_cmp_le_i32 s[54:55], 11, v16
v_cmp_le_i32 s[56:57], 16, v16
v_cmp_le_i32 s[58:59], 17, v16
v_cmp_le_i32 s[60:61], 18, v16
v_cmp_le_i32 s[62:63], 19, v16
v_cmp_le_i32 s[64:65], 24, v16
v_cmp_le_i32 s[66:67], 25, v16
v_cmp_le_i32 s[68:69], 26, v16
v_cmp_le_i32 s[70:71], 27, v16
v_cmp_eq_u32 s[74:75], 0, v3
s_lshl_b32 s28, s16, 9
v_mul_u32_u24 v13, 6208, v3
v_lshl_add_u32 v13, v2, 4, v13
v_add_u32 v13, s28, v13
v_add_u32 v13, 65536, v13
s_add_u32 s28, s28, 77952
s_add_u32 s28, s28, s31
v_lshl_add_u32 v14, v2, 4, s28
v_and_b32 v16, 3, v0
v_lshrrev_b32 v17, 2, v4
v_lshl_add_u32 v17, v3, 2, v17
s_lshl_b32 s28, s16, 5
v_add_u32 v17, s28, v17
v_lshlrev_b32 v17, 4, v17
v_lshrrev_b32 v18, 1, v16
v_mul_u32_u24 v18, 6208, v18
v_and_b32 v19, 1, v16
v_lshl_add_u32 v18, v19, 3, v18
v_add_u32 v18, 18624, v18
s_add_u32 s28, s31, 31040
v_mov_b32 v19, s28
v_and_b32 v20, 1, v5
v_cmp_eq_u32 vcc, 1, v20
s_nop 0
v_cndmask_b32 v18, v18, v19, vcc
v_cmp_ne_u32 s[72:73], 0, v16
s_and_b64 s[72:73], s[72:73], vcc
v_add_u32 v15, 65536, v18
v_add_u32 v224, 102784, v18
v_mov_b32 v19, 140032
s_nop 0
v_cndmask_b32 v15, v15, v19, s[72:73]
v_cndmask_b32 v224, v224, v19, s[72:73]
v_add_u32 v15, v15, v17
v_add_u32 v224, v224, v17
v_mov_b32 v16, 0x3f803f80
v_mov_b32 v17, 0x3f803f80
v_mov_b32 v18, 0x3f803f80
v_mov_b32 v19, 0x3f803f80
s_lshl_b32 s28, s16, 10
s_add_u32 s28, s28, 140032
v_add_u32 v20, s28, v1
ds_write_b128 v20, v[16:19]
s_cmp_ge_u32 s16, 2
s_cbranch_scc1 L1
ds_write_b128 v20, v[16:19] offset:4096
L1:
s_waitcnt lgkmcnt(0)
s_add_u32 s33, s33, 4096
buffer_load_dwordx4 a[40:43], v9, s[8:11], s33 offen offset:0
s_add_u32 s33, s33, 4096
buffer_load_dwordx4 a[44:47], v9, s[8:11], s33 offen offset:0
s_add_u32 s33, s33, 4096
buffer_load_dwordx4 a[48:51], v9, s[8:11], s33 offen offset:0
s_add_u32 s33, s33, 4096
buffer_load_dwordx4 a[52:55], v9, s[8:11], s33 offen offset:0
s_add_u32 s33, s33, 4096
buffer_load_dwordx4 a[56:59], v9, s[8:11], s33 offen offset:0
s_add_u32 s33, s33, 4096
buffer_load_dwordx4 a[60:63], v9, s[8:11], s33 offen offset:0
s_add_u32 s33, s33, 4096
buffer_load_dwordx4 a[64:67], v9, s[8:11], s33 offen offset:0
s_add_u32 s33, s33, 4096
buffer_load_dwordx4 a[68:71], v9, s[8:11], s33 offen offset:0
s_add_u32 m0, s30, 32768
s_nop 0
buffer_load_dwordx4 v1, s[8:11], s26 offen sc1 lds
buffer_load_dwordx4 v1, s[8:11], s26 offen offset:1024 sc1 lds
s_add_u32 s26, s26, 8192
s_add_u32 m0, s30, 40960
s_nop 0
buffer_load_dwordx4 v1, s[8:11], s26 offen sc1 lds
buffer_load_dwordx4 v1, s[8:11], s26 offen offset:1024 sc1 lds
s_add_u32 s26, s26, 8192
s_waitcnt vmcnt(30)
v_add_f32 v140, v140, v156
v_add_f32 v141, v141, v157
v_add_f32 v142, v142, v158
v_add_f32 v143, v143, v159
v_add_f32 v144, v144, v160
v_add_f32 v145, v145, v161
v_add_f32 v146, v146, v162
v_add_f32 v147, v147, v163
v_add_f32 v148, v148, v164
v_add_f32 v149, v149, v165
v_add_f32 v150, v150, v166
v_add_f32 v151, v151, v167
v_add_f32 v152, v152, v168
v_add_f32 v153, v153, v169
v_add_f32 v154, v154, v170
v_add_f32 v155, v155, v171
v_add_f32 v140, v140, v148
v_add_f32 v141, v141, v149
v_add_f32 v142, v142, v150
v_add_f32 v143, v143, v151
v_add_f32 v144, v144, v152
v_add_f32 v145, v145, v153
v_add_f32 v146, v146, v154
v_add_f32 v147, v147, v155
v_add_f32 v140, v140, v144
v_add_f32 v141, v141, v145
v_add_f32 v142, v142, v146
v_add_f32 v143, v143, v147
v_add_f32 v140, v140, v142
v_add_f32 v141, v141, v143
v_mul_f32 v28, 0x3acccccd, v140
v_mul_f32 v26, 0x3acccccd, v141
v_fma_f32 v26, -v28, v28, v26
v_max_f32 v26, 0, v26
v_add_f32 v26, 0x3727c5ac, v26
v_rsq_f32 v27, v26
s_nop 0
v_mov_b32 v172, v28
v_mov_b32 v173, v28
v_mov_b32 v176, v27
v_mov_b32 v177, v27
s_nop 1
v_permlane32_swap_b32 v172, v173
v_permlane32_swap_b32 v176, v177
s_waitcnt vmcnt(26)
v_mul_f32_e64 v32, -v172, v124
v_mul_f32_e64 v33, -v172, v125
v_mul_f32_e64 v34, -v172, v126
v_mul_f32_e64 v35, -v172, v127
v_mul_f32_e64 v36, -v172, v128
v_mul_f32_e64 v37, -v172, v129
v_mul_f32_e64 v38, -v172, v130
v_mul_f32_e64 v39, -v172, v131
v_mul_f32_e64 v40, -v172, v132
v_mul_f32_e64 v41, -v172, v133
v_mul_f32_e64 v42, -v172, v134
v_mul_f32_e64 v43, -v172, v135
v_mul_f32_e64 v44, -v172, v136
v_mul_f32_e64 v45, -v172, v137
v_mul_f32_e64 v46, -v172, v138
v_mul_f32_e64 v47, -v172, v139
v_mul_f32_e64 v48, -v173, v124
v_mul_f32_e64 v49, -v173, v125
v_mul_f32_e64 v50, -v173, v126
v_mul_f32_e64 v51, -v173, v127
v_mul_f32_e64 v52, -v173, v128
v_mul_f32_e64 v53, -v173, v129
v_mul_f32_e64 v54, -v173, v130
v_mul_f32_e64 v55, -v173, v131
v_mul_f32_e64 v56, -v173, v132
v_mul_f32_e64 v57, -v173, v133
v_mul_f32_e64 v58, -v173, v134
v_mul_f32_e64 v59, -v173, v135
v_mul_f32_e64 v60, -v173, v136
v_mul_f32_e64 v61, -v173, v137
v_mul_f32_e64 v62, -v173, v138
v_mul_f32_e64 v63, -v173, v139
s_barrier
ds_read_b128 v[96:99], v8 offset:0
ds_read_b128 v[100:103], v8 offset:512
ds_read_b128 v[104:107], v8 offset:2048
ds_read_b128 v[108:111], v8 offset:2560
s_waitcnt lgkmcnt(2)
s_waitcnt vmcnt(25)
v_mfma_f32_32x32x16_bf16 v[32:47], a[0:3], v[96:99], v[32:47]
ds_read_b128 v[112:115], v8 offset:4096
s_add_u32 m0, s30, 49152
s_nop 0
buffer_load_dwordx4 v1, s[8:11], s26 offen sc1 lds
buffer_load_dwordx4 v1, s[8:11], s26 offen offset:1024 sc1 lds
s_add_u32 s26, s26, 8192
s_add_u32 s33, s33, 4096
buffer_load_dwordx4 a[72:75], v9, s[8:11], s33 offen offset:0
v_mfma_f32_32x32x16_bf16 v[48:63], a[0:3], v[100:103], v[48:63]
ds_read_b128 v[116:119], v8 offset:4608
s_add_u32 m0, s30, 57344
s_nop 0
buffer_load_dwordx4 v1, s[8:11], s26 offen sc1 lds
buffer_load_dwordx4 v1, s[8:11], s26 offen offset:1024 sc1 lds
s_add_u32 s26, s26, 8192
s_add_u32 s33, s33, 4096
buffer_load_dwordx4 a[76:79], v9, s[8:11], s33 offen offset:0
s_waitcnt lgkmcnt(2)
s_waitcnt vmcnt(30)
v_mfma_f32_32x32x16_bf16 v[32:47], a[4:7], v[104:107], v[32:47]
ds_read_b128 v[96:99], v8 offset:6144
s_add_u32 s33, s33, 4096
buffer_load_dwordx4 a[80:83], v9, s[8:11], s33 offen offset:0
v_mfma_f32_32x32x16_bf16 v[48:63], a[4:7], v[108:111], v[48:63]
ds_read_b128 v[100:103], v8 offset:6656
s_add_u32 s33, s33, 4096
buffer_load_dwordx4 a[84:87], v9, s[8:11], s33 offen offset:0
s_waitcnt lgkmcnt(2)
s_waitcnt vmcnt(31)
v_mfma_f32_32x32x16_bf16 v[32:47], a[8:11], v[112:115], v[32:47]
ds_read_b128 v[104:107], v8 offset:8192
s_add_u32 s33, s33, 4096
buffer_load_dwordx4 a[88:91], v9, s[8:11], s33 offen offset:0
v_mfma_f32_32x32x16_bf16 v[48:63], a[8:11], v[116:119], v[48:63]
ds_read_b128 v[108:111], v8 offset:8704
s_add_u32 s33, s33, 4096
buffer_load_dwordx4 a[92:95], v9, s[8:11], s33 offen offset:0
s_waitcnt lgkmcnt(2)
s_waitcnt vmcnt(32)
v_mfma_f32_32x32x16_bf16 v[32:47], a[12:15], v[96:99], v[32:47]
ds_read_b128 v[112:115], v8 offset:10240
s_add_u32 s33, s33, 4096
buffer_load_dwordx4 a[96:99], v9, s[8:11], s33 offen offset:0
v_mfma_f32_32x32x16_bf16 v[48:63], a[12:15], v[100:103], v[48:63]
ds_read_b128 v[116:119], v8 offset:10752
s_add_u32 s33, s33, 4096
buffer_load_dwordx4 a[100:103], v9, s[8:11], s33 offen offset:0
s_add_u32 s28, s19, 16
s_lshl_b32 s28, s28, 6
v_add_u32 v29, s28, v0
v_lshlrev_b32 v29, 4, v29
s_mov_b32 s29, 14536704
buffer_load_dwordx4 v[140:143], v29, s[8:11], s29 offen sc1
s_add_u32 s29, s29, 32768
buffer_load_dwordx4 v[144:147], v29, s[8:11], s29 offen sc1
s_add_u32 s29, s29, 32768
buffer_load_dwordx4 v[148:151], v29, s[8:11], s29 offen sc1
s_add_u32 s29, s29, 32768
buffer_load_dwordx4 v[152:155], v29, s[8:11], s29 offen sc1
s_add_u32 s29, s29, 32768
buffer_load_dwordx4 v[156:159], v29, s[8:11], s29 offen sc1
s_add_u32 s29, s29, 32768
buffer_load_dwordx4 v[160:163], v29, s[8:11], s29 offen sc1
s_add_u32 s29, s29, 32768
buffer_load_dwordx4 v[164:167], v29, s[8:11], s29 offen sc1
s_add_u32 s29, s29, 32768
buffer_load_dwordx4 v[168:171], v29, s[8:11], s29 offen sc1
s_waitcnt lgkmcnt(2)
s_waitcnt vmcnt(41)
v_mfma_f32_32x32x16_bf16 v[32:47], a[16:19], v[104:107], v[32:47]
ds_read_b128 v[96:99], v8 offset:12288
s_add_u32 s33, s33, 4096
buffer_load_dwordx4 a[104:107], v9, s[8:11], s33 offen offset:0
v_mfma_f32_32x32x16_bf16 v[48:63], a[16:19], v[108:111], v[48:63]
ds_read_b128 v[100:103], v8 offset:12800
s_add_u32 s33, s33, 4096
buffer_load_dwordx4 a[108:111], v9, s[8:11], s33 offen offset:0
s_waitcnt lgkmcnt(2)
s_waitcnt vmcnt(42)
v_mfma_f32_32x32x16_bf16 v[32:47], a[20:23], v[112:115], v[32:47]
ds_read_b128 v[104:107], v8 offset:14336
s_add_u32 s33, s33, 4096
buffer_load_dwordx4 a[112:115], v9, s[8:11], s33 offen offset:0
v_mfma_f32_32x32x16_bf16 v[48:63], a[20:23], v[116:119], v[48:63]
ds_read_b128 v[108:111], v8 offset:14848
s_add_u32 s33, s33, 4096
buffer_load_dwordx4 a[116:119], v9, s[8:11], s33 offen offset:0
s_waitcnt vmcnt(36)
s_barrier
s_waitcnt lgkmcnt(2)
v_mfma_f32_32x32x16_bf16 v[32:47], a[24:27], v[96:99], v[32:47]
ds_read_b128 v[112:115], v8 offset:16384
s_add_u32 m0, s30, 0
s_nop 0
buffer_load_dwordx4 v1, s[8:11], s26 offen sc1 lds
buffer_load_dwordx4 v1, s[8:11], s26 offen offset:1024 sc1 lds
s_add_u32 s26, s26, 8192
s_add_u32 s33, s33, 4096
buffer_load_dwordx4 a[120:123], v9, s[8:11], s33 offen offset:0
v_mfma_f32_32x32x16_bf16 v[48:63], a[24:27], v[100:103], v[48:63]
ds_read_b128 v[116:119], v8 offset:16896
s_add_u32 s33, s33, 4096
buffer_load_dwordx4 a[124:127], v9, s[8:11], s33 offen offset:0
s_waitcnt lgkmcnt(2)
v_mfma_f32_32x32x16_bf16 v[32:47], a[28:31], v[104:107], v[32:47]
ds_read_b128 v[96:99], v8 offset:18432
s_add_u32 s33, s33, 4096
buffer_load_dwordx4 a[128:131], v9, s[8:11], s33 offen offset:0
v_mfma_f32_32x32x16_bf16 v[48:63], a[28:31], v[108:111], v[48:63]
ds_read_b128 v[100:103], v8 offset:18944
s_add_u32 s33, s33, 4096
buffer_load_dwordx4 a[132:135], v9, s[8:11], s33 offen offset:0
s_waitcnt lgkmcnt(2)
v_mfma_f32_32x32x16_bf16 v[32:47], a[32:35], v[112:115], v[32:47]
ds_read_b128 v[104:107], v8 offset:20480
s_add_u32 s33, s33, 4096
buffer_load_dwordx4 a[136:139], v9, s[8:11], s33 offen offset:0
v_mfma_f32_32x32x16_bf16 v[48:63], a[32:35], v[116:119], v[48:63]
ds_read_b128 v[108:111], v8 offset:20992
s_add_u32 s33, s33, 4096
buffer_load_dwordx4 a[140:143], v9, s[8:11], s33 offen offset:0
s_waitcnt lgkmcnt(2)
v_mfma_f32_32x32x16_bf16 v[32:47], a[36:39], v[96:99], v[32:47]
ds_read_b128 v[112:115], v8 offset:22528
s_add_u32 s33, s33, 4096
buffer_load_dwordx4 a[144:147], v9, s[8:11], s33 offen offset:0
v_mfma_f32_32x32x16_bf16 v[48:63], a[36:39], v[100:103], v[48:63]
ds_read_b128 v[116:119], v8 offset:23040
s_add_u32 s33, s33, 4096
buffer_load_dwordx4 a[148:151], v9, s[8:11], s33 offen offset:0
s_waitcnt lgkmcnt(2)
s_waitcnt vmcnt(45)
v_mfma_f32_32x32x16_bf16 v[32:47], a[40:43], v[104:107], v[32:47]
ds_read_b128 v[96:99], v8 offset:24576
s_add_u32 s33, s33, 4096
buffer_load_dwordx4 a[152:155], v9, s[8:11], s33 offen offset:0
v_mfma_f32_32x32x16_bf16 v[48:63], a[40:43], v[108:111], v[48:63]
ds_read_b128 v[100:103], v8 offset:25088
s_add_u32 s33, s33, 4096
buffer_load_dwordx4 a[156:159], v9, s[8:11], s33 offen offset:0
s_waitcnt lgkmcnt(2)
s_waitcnt vmcnt(46)
v_mfma_f32_32x32x16_bf16 v[32:47], a[44:47], v[112:115], v[32:47]
ds_read_b128 v[104:107], v8 offset:26624
v_mfma_f32_32x32x16_bf16 v[48:63], a[44:47], v[116:119], v[48:63]
ds_read_b128 v[108:111], v8 offset:27136
s_waitcnt lgkmcnt(2)
s_waitcnt vmcnt(45)
v_mfma_f32_32x32x16_bf16 v[32:47], a[48:51], v[96:99], v[32:47]
ds_read_b128 v[112:115], v8 offset:28672
v_mfma_f32_32x32x16_bf16 v[48:63], a[48:51], v[100:103], v[48:63]
ds_read_b128 v[116:119], v8 offset:29184
s_waitcnt lgkmcnt(2)
s_waitcnt vmcnt(44)
v_mfma_f32_32x32x16_bf16 v[32:47], a[52:55], v[104:107], v[32:47]
ds_read_b128 v[96:99], v8 offset:30720
v_mfma_f32_32x32x16_bf16 v[48:63], a[52:55], v[108:111], v[48:63]
ds_read_b128 v[100:103], v8 offset:31232
s_waitcnt vmcnt(36)
s_barrier
s_waitcnt lgkmcnt(2)
v_mfma_f32_32x32x16_bf16 v[32:47], a[56:59], v[112:115], v[32:47]
ds_read_b128 v[104:107], v8 offset:32768
s_add_u32 m0, s30, 8192
s_nop 0
buffer_load_dwordx4 v1, s[8:11], s26 offen sc1 lds
buffer_load_dwordx4 v1, s[8:11], s26 offen offset:1024 sc1 lds
s_add_u32 s26, s26, 8192
v_mfma_f32_32x32x16_bf16 v[48:63], a[56:59], v[116:119], v[48:63]
ds_read_b128 v[108:111], v8 offset:33280
s_add_u32 s26, s19, 16
s_mul_i32 s26, s26, 81920
s_add_u32 s26, s26, 9293824
s_add_u32 s26, s26, s30
s_add_u32 m0, s30, 16384
s_nop 0
buffer_load_dwordx4 v1, s[8:11], s26 offen sc1 lds
buffer_load_dwordx4 v1, s[8:11], s26 offen offset:1024 sc1 lds
s_add_u32 s26, s26, 8192
s_waitcnt lgkmcnt(2)
v_mfma_f32_32x32x16_bf16 v[32:47], a[60:63], v[96:99], v[32:47]
ds_read_b128 v[112:115], v8 offset:34816
v_mfma_f32_32x32x16_bf16 v[48:63], a[60:63], v[100:103], v[48:63]
ds_read_b128 v[116:119], v8 offset:35328
s_waitcnt lgkmcnt(2)
v_mfma_f32_32x32x16_bf16 v[32:47], a[64:67], v[104:107], v[32:47]
ds_read_b128 v[96:99], v8 offset:36864
v_mfma_f32_32x32x16_bf16 v[48:63], a[64:67], v[108:111], v[48:63]
ds_read_b128 v[100:103], v8 offset:37376
s_waitcnt lgkmcnt(2)
v_mfma_f32_32x32x16_bf16 v[32:47], a[68:71], v[112:115], v[32:47]
ds_read_b128 v[104:107], v8 offset:38912
v_mfma_f32_32x32x16_bf16 v[48:63], a[68:71], v[116:119], v[48:63]
ds_read_b128 v[108:111], v8 offset:39424
s_waitcnt lgkmcnt(2)
s_waitcnt vmcnt(37)
v_mfma_f32_32x32x16_bf16 v[32:47], a[72:75], v[96:99], v[32:47]
ds_read_b128 v[112:115], v8 offset:40960
v_mfma_f32_32x32x16_bf16 v[48:63], a[72:75], v[100:103], v[48:63]
ds_read_b128 v[116:119], v8 offset:41472
s_waitcnt lgkmcnt(2)
s_waitcnt vmcnt(34)
v_mfma_f32_32x32x16_bf16 v[32:47], a[76:79], v[104:107], v[32:47]
ds_read_b128 v[96:99], v8 offset:43008
v_mfma_f32_32x32x16_bf16 v[48:63], a[76:79], v[108:111], v[48:63]
ds_read_b128 v[100:103], v8 offset:43520
s_waitcnt lgkmcnt(2)
s_waitcnt vmcnt(33)
v_mfma_f32_32x32x16_bf16 v[32:47], a[80:83], v[112:115], v[32:47]
ds_read_b128 v[104:107], v8 offset:45056
v_mfma_f32_32x32x16_bf16 v[48:63], a[80:83], v[116:119], v[48:63]
ds_read_b128 v[108:111], v8 offset:45568
s_waitcnt lgkmcnt(2)
s_waitcnt vmcnt(32)
v_mfma_f32_32x32x16_bf16 v[32:47], a[84:87], v[96:99], v[32:47]
ds_read_b128 v[112:115], v8 offset:47104
v_mfma_f32_32x32x16_bf16 v[48:63], a[84:87], v[100:103], v[48:63]
ds_read_b128 v[116:119], v8 offset:47616
s_barrier
s_waitcnt lgkmcnt(2)
s_waitcnt vmcnt(31)
v_mfma_f32_32x32x16_bf16 v[32:47], a[88:91], v[104:107], v[32:47]
ds_read_b128 v[96:99], v8 offset:49152
s_add_u32 m0, s30, 24576
s_nop 0
buffer_load_dwordx4 v1, s[8:11], s26 offen sc1 lds
buffer_load_dwordx4 v1, s[8:11], s26 offen offset:1024 sc1 lds
s_add_u32 s26, s26, 8192
v_mfma_f32_32x32x16_bf16 v[48:63], a[88:91], v[108:111], v[48:63]
ds_read_b128 v[100:103], v8 offset:49664
s_add_u32 m0, s30, 32768
s_nop 0
buffer_load_dwordx4 v1, s[8:11], s26 offen sc1 lds
buffer_load_dwordx4 v1, s[8:11], s26 offen offset:1024 sc1 lds
s_add_u32 s26, s26, 8192
s_waitcnt lgkmcnt(2)
s_waitcnt vmcnt(34)
v_mfma_f32_32x32x16_bf16 v[32:47], a[92:95], v[112:115], v[32:47]
ds_read_b128 v[104:107], v8 offset:51200
v_mfma_f32_32x32x16_bf16 v[48:63], a[92:95], v[116:119], v[48:63]
ds_read_b128 v[108:111], v8 offset:51712
s_waitcnt lgkmcnt(2)
s_waitcnt vmcnt(33)
v_mfma_f32_32x32x16_bf16 v[32:47], a[96:99], v[96:99], v[32:47]
ds_read_b128 v[112:115], v8 offset:53248
v_mfma_f32_32x32x16_bf16 v[48:63], a[96:99], v[100:103], v[48:63]
ds_read_b128 v[116:119], v8 offset:53760
s_waitcnt lgkmcnt(2)
s_waitcnt vmcnt(32)
v_mfma_f32_32x32x16_bf16 v[32:47], a[100:103], v[104:107], v[32:47]
ds_read_b128 v[96:99], v8 offset:55296
v_mfma_f32_32x32x16_bf16 v[48:63], a[100:103], v[108:111], v[48:63]
ds_read_b128 v[100:103], v8 offset:55808
s_waitcnt lgkmcnt(2)
s_waitcnt vmcnt(23)
v_mfma_f32_32x32x16_bf16 v[32:47], a[104:107], v[112:115], v[32:47]
ds_read_b128 v[104:107], v8 offset:57344
v_mfma_f32_32x32x16_bf16 v[48:63], a[104:107], v[116:119], v[48:63]
ds_read_b128 v[108:111], v8 offset:57856
s_waitcnt lgkmcnt(2)
s_waitcnt vmcnt(22)
v_mfma_f32_32x32x16_bf16 v[32:47], a[108:111], v[96:99], v[32:47]
ds_read_b128 v[112:115], v8 offset:59392
v_mfma_f32_32x32x16_bf16 v[48:63], a[108:111], v[100:103], v[48:63]
ds_read_b128 v[116:119], v8 offset:59904
s_waitcnt lgkmcnt(2)
s_waitcnt vmcnt(21)
v_mfma_f32_32x32x16_bf16 v[32:47], a[112:115], v[104:107], v[32:47]
ds_read_b128 v[96:99], v8 offset:61440
v_mfma_f32_32x32x16_bf16 v[48:63], a[112:115], v[108:111], v[48:63]
ds_read_b128 v[100:103], v8 offset:61952
s_waitcnt lgkmcnt(2)
s_waitcnt vmcnt(20)
v_mfma_f32_32x32x16_bf16 v[32:47], a[116:119], v[112:115], v[32:47]
ds_read_b128 v[104:107], v8 offset:63488
v_mfma_f32_32x32x16_bf16 v[48:63], a[116:119], v[116:119], v[48:63]
ds_read_b128 v[108:111], v8 offset:64000
s_waitcnt vmcnt(6)
s_barrier
s_waitcnt lgkmcnt(2)
v_mfma_f32_32x32x16_bf16 v[32:47], a[120:123], v[96:99], v[32:47]
ds_read_b128 v[112:115], v8 offset:0
s_add_u32 m0, s30, 40960
s_nop 0
buffer_load_dwordx4 v1, s[8:11], s26 offen sc1 lds
buffer_load_dwordx4 v1, s[8:11], s26 offen offset:1024 sc1 lds
s_add_u32 s26, s26, 8192
v_add_f32 v140, v140, v156
v_mfma_f32_32x32x16_bf16 v[48:63], a[120:123], v[100:103], v[48:63]
ds_read_b128 v[116:119], v8 offset:512
s_add_u32 m0, s30, 49152
s_nop 0
buffer_load_dwordx4 v1, s[8:11], s26 offen sc1 lds
buffer_load_dwordx4 v1, s[8:11], s26 offen offset:1024 sc1 lds
s_add_u32 s26, s26, 8192
v_add_f32 v141, v141, v157
v_add_f32 v142, v142, v158
s_waitcnt lgkmcnt(2)
v_mfma_f32_32x32x16_bf16 v[32:47], a[124:127], v[104:107], v[32:47]
ds_read_b128 v[96:99], v8 offset:2048
v_add_f32 v143, v143, v159
v_add_f32 v144, v144, v160
v_mfma_f32_32x32x16_bf16 v[48:63], a[124:127], v[108:111], v[48:63]
ds_read_b128 v[100:103], v8 offset:2560
v_add_f32 v145, v145, v161
v_add_f32 v146, v146, v162
s_waitcnt lgkmcnt(2)
v_mfma_f32_32x32x16_bf16 v[32:47], a[128:131], v[112:115], v[32:47]
ds_read_b128 v[104:107], v8 offset:4096
v_add_f32 v147, v147, v163
v_add_f32 v148, v148, v164
v_mfma_f32_32x32x16_bf16 v[48:63], a[128:131], v[116:119], v[48:63]
ds_read_b128 v[108:111], v8 offset:4608
v_add_f32 v149, v149, v165
v_add_f32 v150, v150, v166
s_waitcnt lgkmcnt(2)
v_mfma_f32_32x32x16_bf16 v[32:47], a[132:135], v[96:99], v[32:47]
ds_read_b128 v[112:115], v8 offset:6144
v_add_f32 v151, v151, v167
v_add_f32 v152, v152, v168
v_mfma_f32_32x32x16_bf16 v[48:63], a[132:135], v[100:103], v[48:63]
ds_read_b128 v[116:119], v8 offset:6656
v_add_f32 v153, v153, v169
v_add_f32 v154, v154, v170
s_waitcnt lgkmcnt(2)
v_mfma_f32_32x32x16_bf16 v[32:47], a[136:139], v[104:107], v[32:47]
ds_read_b128 v[96:99], v8 offset:8192
v_add_f32 v155, v155, v171
v_add_f32 v140, v140, v148
v_mfma_f32_32x32x16_bf16 v[48:63], a[136:139], v[108:111], v[48:63]
ds_read_b128 v[100:103], v8 offset:8704
v_add_f32 v141, v141, v149
v_add_f32 v142, v142, v150
s_waitcnt lgkmcnt(2)
v_mfma_f32_32x32x16_bf16 v[32:47], a[140:143], v[112:115], v[32:47]
ds_read_b128 v[104:107], v8 offset:10240
v_add_f32 v143, v143, v151
v_add_f32 v144, v144, v152
v_mfma_f32_32x32x16_bf16 v[48:63], a[140:143], v[116:119], v[48:63]
ds_read_b128 v[108:111], v8 offset:10752
v_add_f32 v145, v145, v153
v_add_f32 v146, v146, v154
s_waitcnt lgkmcnt(2)
v_mfma_f32_32x32x16_bf16 v[32:47], a[144:147], v[96:99], v[32:47]
ds_read_b128 v[112:115], v8 offset:12288
v_add_f32 v147, v147, v155
v_add_f32 v140, v140, v144
v_mfma_f32_32x32x16_bf16 v[48:63], a[144:147], v[100:103], v[48:63]
ds_read_b128 v[116:119], v8 offset:12800
v_add_f32 v141, v141, v145
v_add_f32 v142, v142, v146
s_waitcnt lgkmcnt(2)
v_mfma_f32_32x32x16_bf16 v[32:47], a[148:151], v[104:107], v[32:47]
ds_read_b128 v[96:99], v8 offset:14336
v_add_f32 v143, v143, v147
v_add_f32 v140, v140, v142
v_mfma_f32_32x32x16_bf16 v[48:63], a[148:151], v[108:111], v[48:63]
ds_read_b128 v[100:103], v8 offset:14848
v_add_f32 v141, v141, v143
v_mul_f32 v28, 0x3acccccd, v140
s_waitcnt vmcnt(6)
s_barrier
s_waitcnt lgkmcnt(2)
v_mfma_f32_32x32x16_bf16 v[32:47], a[152:155], v[112:115], v[32:47]
ds_read_b128 v[104:107], v8 offset:16384
s_add_u32 m0, s30, 57344
s_nop 0
buffer_load_dwordx4 v1, s[8:11], s26 offen sc1 lds
buffer_load_dwordx4 v1, s[8:11], s26 offen offset:1024 sc1 lds
s_add_u32 s26, s26, 8192
v_mul_f32 v26, 0x3acccccd, v141
v_fma_f32 v26, -v28, v28, v26
v_mfma_f32_32x32x16_bf16 v[48:63], a[152:155], v[116:119], v[48:63]
ds_read_b128 v[108:111], v8 offset:16896
s_add_u32 m0, s30, 0
s_nop 0
buffer_load_dwordx4 v1, s[8:11], s26 offen sc1 lds
buffer_load_dwordx4 v1, s[8:11], s26 offen offset:1024 sc1 lds
s_add_u32 s26, s26, 8192
v_max_f32 v26, 0, v26
v_add_f32 v26, 0x3727c5ac, v26
s_waitcnt lgkmcnt(2)
v_mfma_f32_32x32x16_bf16 v[32:47], a[156:159], v[96:99], v[32:47]
ds_read_b128 v[112:115], v8 offset:18432
v_rsq_f32 v27, v26
s_nop 0
v_mfma_f32_32x32x16_bf16 v[48:63], a[156:159], v[100:103], v[48:63]
ds_read_b128 v[116:119], v8 offset:18944
v_mov_b32 v174, v28
v_mov_b32 v175, v28
v_mov_b32 v178, v27
v_mov_b32 v179, v27
s_nop 1
v_permlane32_swap_b32 v174, v175
v_permlane32_swap_b32 v178, v179
v_mul_f32_e64 v64, -v174, v124
v_mul_f32_e64 v65, -v174, v125
v_mul_f32_e64 v66, -v174, v126
v_mul_f32_e64 v67, -v174, v127
v_mul_f32_e64 v68, -v174, v128
v_mul_f32_e64 v69, -v174, v129
v_mul_f32_e64 v70, -v174, v130
v_mul_f32_e64 v71, -v174, v131
v_mul_f32_e64 v72, -v174, v132
v_mul_f32_e64 v73, -v174, v133
v_mul_f32_e64 v74, -v174, v134
v_mul_f32_e64 v75, -v174, v135
v_mul_f32_e64 v76, -v174, v136
v_mul_f32_e64 v77, -v174, v137
v_mul_f32_e64 v78, -v174, v138
v_mul_f32_e64 v79, -v174, v139
v_mul_f32_e64 v80, -v175, v124
v_mul_f32_e64 v81, -v175, v125
v_mul_f32_e64 v82, -v175, v126
v_mul_f32_e64 v83, -v175, v127
v_mul_f32_e64 v84, -v175, v128
v_mul_f32_e64 v85, -v175, v129
v_mul_f32_e64 v86, -v175, v130
v_mul_f32_e64 v87, -v175, v131
v_mul_f32_e64 v88, -v175, v132
v_mul_f32_e64 v89, -v175, v133
v_mul_f32_e64 v90, -v175, v134
v_mul_f32_e64 v91, -v175, v135
v_mul_f32_e64 v92, -v175, v136
v_mul_f32_e64 v93, -v175, v137
v_mul_f32_e64 v94, -v175, v138
v_mul_f32_e64 v95, -v175, v139
s_waitcnt lgkmcnt(2)
v_mfma_f32_32x32x16_bf16 v[64:79], a[0:3], v[104:107], v[64:79]
ds_read_b128 v[96:99], v8 offset:20480
s_lshl_b32 s37, s20, 4
s_lshl_b32 s28, s16, 2
s_add_u32 s37, s37, s28
s_lshl_b32 s37, s37, 15
s_add_u32 s37, s37, 15060992
s_add_u32 s28, s19, 0
s_lshl_b32 s28, s28, 6
v_add_u32 v25, s28, v2
v_lshlrev_b32 v25, 4, v25
v_lshl_add_u32 v25, v3, 15, v25
v_mul_f32 v32, v32, v176
v_mfma_f32_32x32x16_bf16 v[80:95], a[0:3], v[108:111], v[80:95]
ds_read_b128 v[100:103], v8 offset:20992
v_mul_f32 v33, v33, v176
v_mul_f32 v34, v34, v176
s_waitcnt lgkmcnt(2)
v_mfma_f32_32x32x16_bf16 v[64:79], a[4:7], v[112:115], v[64:79]
ds_read_b128 v[104:107], v8 offset:22528
v_mul_f32 v35, v35, v176
v_cvt_pk_bf16_f32 v16, v32, v33
v_mfma_f32_32x32x16_bf16 v[80:95], a[4:7], v[116:119], v[80:95]
ds_read_b128 v[108:111], v8 offset:23040
v_cvt_pk_bf16_f32 v17, v34, v35
v_mul_f32 v36, v36, v176
s_waitcnt lgkmcnt(2)
v_mfma_f32_32x32x16_bf16 v[64:79], a[8:11], v[96:99], v[64:79]
ds_read_b128 v[112:115], v8 offset:24576
v_mul_f32 v37, v37, v176
v_mul_f32 v38, v38, v176
v_mfma_f32_32x32x16_bf16 v[80:95], a[8:11], v[100:103], v[80:95]
ds_read_b128 v[116:119], v8 offset:25088
v_mul_f32 v39, v39, v176
v_cvt_pk_bf16_f32 v18, v36, v37
s_waitcnt lgkmcnt(2)
v_mfma_f32_32x32x16_bf16 v[64:79], a[12:15], v[104:107], v[64:79]
ds_read_b128 v[96:99], v8 offset:26624
v_cvt_pk_bf16_f32 v19, v38, v39
s_add_u32 s28, s37, 0
s_nop 0
v_permlane32_swap_b32 v16, v18
v_permlane32_swap_b32 v17, v19
s_nop 0
buffer_store_dwordx4 v[16:19], v25, s[8:11], s28 offen offset:0 sc1
s_nop 0
v_mfma_f32_32x32x16_bf16 v[80:95], a[12:15], v[108:111], v[80:95]
ds_read_b128 v[100:103], v8 offset:27136
v_mul_f32 v40, v40, v176
v_mul_f32 v41, v41, v176
s_waitcnt lgkmcnt(2)
v_mfma_f32_32x32x16_bf16 v[64:79], a[16:19], v[112:115], v[64:79]
ds_read_b128 v[104:107], v8 offset:28672
v_mul_f32 v42, v42, v176
v_mul_f32 v43, v43, v176
v_mfma_f32_32x32x16_bf16 v[80:95], a[16:19], v[116:119], v[80:95]
ds_read_b128 v[108:111], v8 offset:29184
v_cvt_pk_bf16_f32 v20, v40, v41
v_cvt_pk_bf16_f32 v21, v42, v43
s_waitcnt lgkmcnt(2)
v_mfma_f32_32x32x16_bf16 v[64:79], a[20:23], v[96:99], v[64:79]
ds_read_b128 v[112:115], v8 offset:30720
v_mul_f32 v44, v44, v176
v_mul_f32 v45, v45, v176
v_mfma_f32_32x32x16_bf16 v[80:95], a[20:23], v[100:103], v[80:95]
ds_read_b128 v[116:119], v8 offset:31232
v_mul_f32 v46, v46, v176
v_mul_f32 v47, v47, v176
s_waitcnt vmcnt(7)
s_barrier
s_waitcnt lgkmcnt(2)
v_mfma_f32_32x32x16_bf16 v[64:79], a[24:27], v[104:107], v[64:79]
ds_read_b128 v[96:99], v8 offset:32768
s_add_u32 m0, s30, 8192
s_nop 0
buffer_load_dwordx4 v1, s[8:11], s26 offen sc1 lds
buffer_load_dwordx4 v1, s[8:11], s26 offen offset:1024 sc1 lds
s_add_u32 s26, s26, 8192
v_cvt_pk_bf16_f32 v22, v44, v45
v_cvt_pk_bf16_f32 v23, v46, v47
v_mfma_f32_32x32x16_bf16 v[80:95], a[24:27], v[108:111], v[80:95]
ds_read_b128 v[100:103], v8 offset:33280
s_add_u32 m0, s30, 16384
s_nop 0
buffer_load_dwordx4 v1, s[8:11], s26 offen sc1 lds
buffer_load_dwordx4 v1, s[8:11], s26 offen offset:1024 sc1 lds
s_add_u32 s26, s26, 8192
s_add_u32 s28, s37, 65536
s_nop 0
v_permlane32_swap_b32 v20, v22
v_permlane32_swap_b32 v21, v23
s_nop 0
buffer_store_dwordx4 v[20:23], v25, s[8:11], s28 offen offset:0 sc1
s_nop 0
v_mul_f32 v48, v48, v177
s_waitcnt lgkmcnt(2)
v_mfma_f32_32x32x16_bf16 v[64:79], a[28:31], v[112:115], v[64:79]
ds_read_b128 v[104:107], v8 offset:34816
v_mul_f32 v49, v49, v177
v_mul_f32 v50, v50, v177
v_mfma_f32_32x32x16_bf16 v[80:95], a[28:31], v[116:119], v[80:95]
ds_read_b128 v[108:111], v8 offset:35328
v_mul_f32 v51, v51, v177
v_cvt_pk_bf16_f32 v16, v48, v49
s_waitcnt lgkmcnt(2)
v_mfma_f32_32x32x16_bf16 v[64:79], a[32:35], v[96:99], v[64:79]
ds_read_b128 v[112:115], v8 offset:36864
v_cvt_pk_bf16_f32 v17, v50, v51
v_mul_f32 v52, v52, v177
v_mfma_f32_32x32x16_bf16 v[80:95], a[32:35], v[100:103], v[80:95]
ds_read_b128 v[116:119], v8 offset:37376
v_mul_f32 v53, v53, v177
v_mul_f32 v54, v54, v177
s_waitcnt lgkmcnt(2)
v_mfma_f32_32x32x16_bf16 v[64:79], a[36:39], v[104:107], v[64:79]
ds_read_b128 v[96:99], v8 offset:38912
v_mul_f32 v55, v55, v177
v_cvt_pk_bf16_f32 v18, v52, v53
v_mfma_f32_32x32x16_bf16 v[80:95], a[36:39], v[108:111], v[80:95]
ds_read_b128 v[100:103], v8 offset:39424
v_cvt_pk_bf16_f32 v19, v54, v55
s_add_u32 s28, s37, 0
s_nop 0
v_permlane32_swap_b32 v16, v18
v_permlane32_swap_b32 v17, v19
s_nop 0
buffer_store_dwordx4 v[16:19], v25, s[8:11], s28 offen offset:512 sc1
s_nop 0
s_waitcnt lgkmcnt(2)
v_mfma_f32_32x32x16_bf16 v[64:79], a[40:43], v[112:115], v[64:79]
ds_read_b128 v[104:107], v8 offset:40960
v_mul_f32 v56, v56, v177
v_mul_f32 v57, v57, v177
v_mfma_f32_32x32x16_bf16 v[80:95], a[40:43], v[116:119], v[80:95]
ds_read_b128 v[108:111], v8 offset:41472
v_mul_f32 v58, v58, v177
v_mul_f32 v59, v59, v177
s_waitcnt lgkmcnt(2)
v_mfma_f32_32x32x16_bf16 v[64:79], a[44:47], v[96:99], v[64:79]
ds_read_b128 v[112:115], v8 offset:43008
v_cvt_pk_bf16_f32 v20, v56, v57
v_cvt_pk_bf16_f32 v21, v58, v59
v_mfma_f32_32x32x16_bf16 v[80:95], a[44:47], v[100:103], v[80:95]
ds_read_b128 v[116:119], v8 offset:43520
v_mul_f32 v60, v60, v177
v_mul_f32 v61, v61, v177
v_mul_f32 v62, v62, v177
v_mul_f32 v63, v63, v177
v_cvt_pk_bf16_f32 v22, v60, v61
v_cvt_pk_bf16_f32 v23, v62, v63
s_add_u32 s28, s37, 65536
s_nop 0
v_permlane32_swap_b32 v20, v22
v_permlane32_swap_b32 v21, v23
s_nop 0
buffer_store_dwordx4 v[20:23], v25, s[8:11], s28 offen offset:512 sc1
s_nop 0
s_waitcnt lgkmcnt(2)
v_mfma_f32_32x32x16_bf16 v[64:79], a[48:51], v[104:107], v[64:79]
ds_read_b128 v[96:99], v8 offset:45056
v_mfma_f32_32x32x16_bf16 v[80:95], a[48:51], v[108:111], v[80:95]
ds_read_b128 v[100:103], v8 offset:45568
s_waitcnt lgkmcnt(2)
v_mfma_f32_32x32x16_bf16 v[64:79], a[52:55], v[112:115], v[64:79]
ds_read_b128 v[104:107], v8 offset:47104
v_mfma_f32_32x32x16_bf16 v[80:95], a[52:55], v[116:119], v[80:95]
ds_read_b128 v[108:111], v8 offset:47616
s_waitcnt vmcnt(10)
s_barrier
s_waitcnt lgkmcnt(2)
v_mfma_f32_32x32x16_bf16 v[64:79], a[56:59], v[96:99], v[64:79]
ds_read_b128 v[112:115], v8 offset:49152
s_add_u32 m0, s30, 24576
s_nop 0
buffer_load_dwordx4 v1, s[8:11], s26 offen sc1 lds
buffer_load_dwordx4 v1, s[8:11], s26 offen offset:1024 sc1 lds
s_add_u32 s26, s26, 8192
v_mfma_f32_32x32x16_bf16 v[80:95], a[56:59], v[100:103], v[80:95]
ds_read_b128 v[116:119], v8 offset:49664
s_waitcnt lgkmcnt(2)
v_mfma_f32_32x32x16_bf16 v[64:79], a[60:63], v[104:107], v[64:79]
ds_read_b128 v[96:99], v8 offset:51200
v_mfma_f32_32x32x16_bf16 v[80:95], a[60:63], v[108:111], v[80:95]
ds_read_b128 v[100:103], v8 offset:51712
s_waitcnt lgkmcnt(2)
v_mfma_f32_32x32x16_bf16 v[64:79], a[64:67], v[112:115], v[64:79]
ds_read_b128 v[104:107], v8 offset:53248
v_mfma_f32_32x32x16_bf16 v[80:95], a[64:67], v[116:119], v[80:95]
ds_read_b128 v[108:111], v8 offset:53760
s_waitcnt lgkmcnt(2)
v_mfma_f32_32x32x16_bf16 v[64:79], a[68:71], v[96:99], v[64:79]
ds_read_b128 v[112:115], v8 offset:55296
v_mfma_f32_32x32x16_bf16 v[80:95], a[68:71], v[100:103], v[80:95]
ds_read_b128 v[116:119], v8 offset:55808
s_add_u32 s28, s19, 0
s_lshl_b32 s28, s28, 7
s_add_u32 s28, s28, 9211904
s_waitcnt vmcnt(2)
s_barrier
s_cmp_lg_u32 s16, 0
s_cbranch_scc1 S2
v_lshlrev_b32 v29, 12, v0
s_mov_b64 exec, 0xff
buffer_atomic_add v7, v29, s[8:11], s28 offen sc1
s_mov_b64 exec, -1
S2:
s_waitcnt lgkmcnt(2)
v_mfma_f32_32x32x16_bf16 v[64:79], a[72:75], v[104:107], v[64:79]
ds_read_b128 v[96:99], v8 offset:57344
v_mfma_f32_32x32x16_bf16 v[80:95], a[72:75], v[108:111], v[80:95]
ds_read_b128 v[100:103], v8 offset:57856
s_waitcnt lgkmcnt(2)
v_mfma_f32_32x32x16_bf16 v[64:79], a[76:79], v[112:115], v[64:79]
ds_read_b128 v[104:107], v8 offset:59392
v_mfma_f32_32x32x16_bf16 v[80:95], a[76:79], v[116:119], v[80:95]
ds_read_b128 v[108:111], v8 offset:59904
s_waitcnt lgkmcnt(2)
v_mfma_f32_32x32x16_bf16 v[64:79], a[80:83], v[96:99], v[64:79]
ds_read_b128 v[112:115], v8 offset:61440
v_mfma_f32_32x32x16_bf16 v[80:95], a[80:83], v[100:103], v[80:95]
ds_read_b128 v[116:119], v8 offset:61952
s_waitcnt lgkmcnt(2)
v_mfma_f32_32x32x16_bf16 v[64:79], a[84:87], v[104:107], v[64:79]
ds_read_b128 v[96:99], v8 offset:63488
v_mfma_f32_32x32x16_bf16 v[80:95], a[84:87], v[108:111], v[80:95]
ds_read_b128 v[100:103], v8 offset:64000
s_barrier
s_waitcnt lgkmcnt(2)
v_mfma_f32_32x32x16_bf16 v[64:79], a[88:91], v[112:115], v[64:79]
ds_read_b128 v[104:107], v8 offset:0
v_mfma_f32_32x32x16_bf16 v[80:95], a[88:91], v[116:119], v[80:95]
ds_read_b128 v[108:111], v8 offset:512
s_waitcnt lgkmcnt(2)
v_mfma_f32_32x32x16_bf16 v[64:79], a[92:95], v[96:99], v[64:79]
ds_read_b128 v[112:115], v8 offset:2048
v_mfma_f32_32x32x16_bf16 v[80:95], a[92:95], v[100:103], v[80:95]
ds_read_b128 v[116:119], v8 offset:2560
s_waitcnt lgkmcnt(2)
v_mfma_f32_32x32x16_bf16 v[64:79], a[96:99], v[104:107], v[64:79]
ds_read_b128 v[96:99], v8 offset:4096
v_mfma_f32_32x32x16_bf16 v[80:95], a[96:99], v[108:111], v[80:95]
ds_read_b128 v[100:103], v8 offset:4608
s_waitcnt lgkmcnt(2)
v_mfma_f32_32x32x16_bf16 v[64:79], a[100:103], v[112:115], v[64:79]
ds_read_b128 v[104:107], v8 offset:6144
v_mfma_f32_32x32x16_bf16 v[80:95], a[100:103], v[116:119], v[80:95]
ds_read_b128 v[108:111], v8 offset:6656
s_waitcnt lgkmcnt(2)
v_mfma_f32_32x32x16_bf16 v[64:79], a[104:107], v[96:99], v[64:79]
ds_read_b128 v[112:115], v8 offset:8192
v_mfma_f32_32x32x16_bf16 v[80:95], a[104:107], v[100:103], v[80:95]
ds_read_b128 v[116:119], v8 offset:8704
s_waitcnt lgkmcnt(2)
v_mfma_f32_32x32x16_bf16 v[64:79], a[108:111], v[104:107], v[64:79]
ds_read_b128 v[96:99], v8 offset:10240
v_mfma_f32_32x32x16_bf16 v[80:95], a[108:111], v[108:111], v[80:95]
ds_read_b128 v[100:103], v8 offset:10752
s_waitcnt lgkmcnt(2)
v_mfma_f32_32x32x16_bf16 v[64:79], a[112:115], v[112:115], v[64:79]
ds_read_b128 v[104:107], v8 offset:12288
v_mfma_f32_32x32x16_bf16 v[80:95], a[112:115], v[116:119], v[80:95]
ds_read_b128 v[108:111], v8 offset:12800
s_waitcnt lgkmcnt(2)
v_mfma_f32_32x32x16_bf16 v[64:79], a[116:119], v[96:99], v[64:79]
ds_read_b128 v[112:115], v8 offset:14336
v_mfma_f32_32x32x16_bf16 v[80:95], a[116:119], v[100:103], v[80:95]
ds_read_b128 v[116:119], v8 offset:14848
s_lshl_b32 s28, s23, 1
s_add_u32 s28, s28, 0
s_sub_u32 s28, s28, 4
v_min_u32 v30, 5, v0
v_add_u32 v30, s28, v30
v_max_i32 v30, 0, v30
v_lshlrev_b32 v30, 7, v30
s_lshl_b32 s95, s17, 12
s_add_u32 s95, s95, 9211904
buffer_load_dword v31, v30, s[8:11], s95 offen sc1
s_waitcnt vmcnt(1)
s_barrier
s_waitcnt lgkmcnt(2)
v_mfma_f32_32x32x16_bf16 v[64:79], a[120:123], v[104:107], v[64:79]
ds_read_b128 v[96:99], v8 offset:16384
v_mfma_f32_32x32x16_bf16 v[80:95], a[120:123], v[108:111], v[80:95]
ds_read_b128 v[100:103], v8 offset:16896
s_waitcnt lgkmcnt(2)
v_mfma_f32_32x32x16_bf16 v[64:79], a[124:127], v[112:115], v[64:79]
ds_read_b128 v[104:107], v8 offset:18432
v_mfma_f32_32x32x16_bf16 v[80:95], a[124:127], v[116:119], v[80:95]
ds_read_b128 v[108:111], v8 offset:18944
s_waitcnt lgkmcnt(2)
v_mfma_f32_32x32x16_bf16 v[64:79], a[128:131], v[96:99], v[64:79]
ds_read_b128 v[112:115], v8 offset:20480
v_mfma_f32_32x32x16_bf16 v[80:95], a[128:131], v[100:103], v[80:95]
ds_read_b128 v[116:119], v8 offset:20992
s_waitcnt lgkmcnt(2)
v_mfma_f32_32x32x16_bf16 v[64:79], a[132:135], v[104:107], v[64:79]
ds_read_b128 v[96:99], v8 offset:22528
v_mfma_f32_32x32x16_bf16 v[80:95], a[132:135], v[108:111], v[80:95]
ds_read_b128 v[100:103], v8 offset:23040
s_waitcnt lgkmcnt(2)
v_mfma_f32_32x32x16_bf16 v[64:79], a[136:139], v[112:115], v[64:79]
ds_read_b128 v[104:107], v8 offset:24576
v_mfma_f32_32x32x16_bf16 v[80:95], a[136:139], v[116:119], v[80:95]
ds_read_b128 v[108:111], v8 offset:25088
s_waitcnt lgkmcnt(2)
v_mfma_f32_32x32x16_bf16 v[64:79], a[140:143], v[96:99], v[64:79]
ds_read_b128 v[112:115], v8 offset:26624
v_mfma_f32_32x32x16_bf16 v[80:95], a[140:143], v[100:103], v[80:95]
ds_read_b128 v[116:119], v8 offset:27136
s_waitcnt lgkmcnt(2)
v_mfma_f32_32x32x16_bf16 v[64:79], a[144:147], v[104:107], v[64:79]
ds_read_b128 v[96:99], v8 offset:28672
v_mfma_f32_32x32x16_bf16 v[80:95], a[144:147], v[108:111], v[80:95]
ds_read_b128 v[100:103], v8 offset:29184
s_waitcnt vmcnt(0)
s_cmp_lg_u32 s16, 0
s_cbranch_scc1 P3
s_movk_i32 s77, 16
P4:
v_cmp_gt_u32 vcc, s77, v31
s_nop 1
s_cbranch_vccz P3
s_add_u32 s76, s76, 1
s_cmp_gt_u32 s76, 400000
s_cbranch_scc1 P3
s_sleep 4
buffer_load_dword v31, v30, s[8:11], s95 offen sc1
s_waitcnt vmcnt(0)
s_branch P4
P3:
s_barrier
s_lshl_b32 s78, s23, 7
s_add_u32 s78, s78, 0
s_lshl_b32 s28, s16, 6
s_add_u32 s79, s78, s28
s_sub_u32 s79, s79, 256
s_max_i32 s79, s79, 0
s_lshl_b32 s79, s79, 4
s_add_u32 s28, s16, 4
s_min_u32 s28, s28, 5
s_lshl_b32 s81, s28, 10
s_lshl_b32 s28, s28, 6
s_add_u32 s80, s78, s28
s_sub_u32 s80, s80, 256
s_max_i32 s80, s80, 0
s_lshl_b32 s80, s80, 4
s_lshl_b32 s82, s16, 10
s_lshl_b32 s83, s39, 15
s_add_u32 s84, s38, 4
s_lshl_b32 s84, s84, 15
s_add_u32 s28, s83, 17682432
s_add_u32 s28, s28, s79
s_add_u32 m0, s82, 65536
s_nop 0
buffer_load_dwordx4 v1, s[8:11], s28 offen sc1 lds
s_add_u32 s28, s83, 17682432
s_add_u32 s28, s28, s80
s_add_u32 m0, s81, 65536
s_nop 0
buffer_load_dwordx4 v1, s[8:11], s28 offen sc1 lds
s_add_u32 s28, s83, 17715200
s_add_u32 s28, s28, s79
s_add_u32 m0, s82, 71744
s_nop 0
buffer_load_dwordx4 v1, s[8:11], s28 offen sc1 lds
s_add_u32 s28, s83, 17715200
s_add_u32 s28, s28, s80
s_add_u32 m0, s81, 71744
s_nop 0
buffer_load_dwordx4 v1, s[8:11], s28 offen sc1 lds
s_add_u32 s28, s84, 17682432
s_add_u32 s28, s28, s79
s_add_u32 m0, s82, 77952
s_nop 0
buffer_load_dwordx4 v1, s[8:11], s28 offen sc1 lds
s_add_u32 s28, s84, 17682432
s_add_u32 s28, s28, s80
s_add_u32 m0, s81, 77952
s_nop 0
buffer_load_dwordx4 v1, s[8:11], s28 offen sc1 lds
s_add_u32 s28, s83, 20303872
s_add_u32 s28, s28, s79
s_add_u32 m0, s82, 84160
s_nop 0
buffer_load_dwordx4 v1, s[8:11], s28 offen sc1 lds
s_add_u32 s28, s83, 20303872
s_add_u32 s28, s28, s80
s_add_u32 m0, s81, 84160
s_nop 0
buffer_load_dwordx4 v1, s[8:11], s28 offen sc1 lds
s_add_u32 s28, s83, 20336640
s_add_u32 s28, s28, s79
s_add_u32 m0, s82, 90368
s_nop 0
buffer_load_dwordx4 v1, s[8:11], s28 offen sc1 lds
s_add_u32 s28, s83, 20336640
s_add_u32 s28, s28, s80
s_add_u32 m0, s81, 90368
s_nop 0
buffer_load_dwordx4 v1, s[8:11], s28 offen sc1 lds
s_add_u32 s28, s84, 20303872
s_add_u32 s28, s28, s79
s_add_u32 m0, s82, 96576
s_nop 0
buffer_load_dwordx4 v1, s[8:11], s28 offen sc1 lds
s_add_u32 s28, s84, 20303872
s_add_u32 s28, s28, s80
s_add_u32 m0, s81, 96576
s_nop 0
buffer_load_dwordx4 v1, s[8:11], s28 offen sc1 lds
s_lshl_b32 s28, s16, 5
s_add_u32 s28, s28, s78
v_add_u32 v29, s28, v2
v_lshlrev_b32 v29, 4, v29
v_lshl_add_u32 v28, v3, 15, v29
s_add_u32 s28, s83, 15060992
buffer_load_dwordx4 v[200:203], v28, s[8:11], s28 offen sc1
v_add_u32 v29, s31, v29
s_add_u32 s28, s84, 15060992
buffer_load_dwordx2 v[204:205], v29, s[8:11], s28 offen sc1
s_waitcnt lgkmcnt(2)
v_mfma_f32_32x32x16_bf16 v[64:79], a[148:151], v[112:115], v[64:79]
ds_read_b128 v[104:107], v8 offset:30720
v_mfma_f32_32x32x16_bf16 v[80:95], a[148:151], v[116:119], v[80:95]
ds_read_b128 v[108:111], v8 offset:31232
s_waitcnt lgkmcnt(2)
v_mfma_f32_32x32x16_bf16 v[64:79], a[152:155], v[96:99], v[64:79]
v_mfma_f32_32x32x16_bf16 v[80:95], a[152:155], v[100:103], v[80:95]
s_waitcnt lgkmcnt(0)
v_mfma_f32_32x32x16_bf16 v[64:79], a[156:159], v[104:107], v[64:79]
v_mfma_f32_32x32x16_bf16 v[80:95], a[156:159], v[108:111], v[80:95]
s_nop 7
s_lshl_b32 s37, s20, 4
s_lshl_b32 s28, s16, 2
s_add_u32 s37, s37, s28
s_lshl_b32 s37, s37, 15
s_add_u32 s37, s37, 15060992
s_add_u32 s28, s19, 16
s_lshl_b32 s28, s28, 6
v_add_u32 v25, s28, v2
v_lshlrev_b32 v25, 4, v25
v_lshl_add_u32 v25, v3, 15, v25
v_mul_f32 v64, v64, v178
v_mul_f32 v65, v65, v178
v_mul_f32 v66, v66, v178
v_mul_f32 v67, v67, v178
v_cvt_pk_bf16_f32 v16, v64, v65
v_cvt_pk_bf16_f32 v17, v66, v67
v_mul_f32 v68, v68, v178
v_mul_f32 v69, v69, v178
v_mul_f32 v70, v70, v178
v_mul_f32 v71, v71, v178
v_cvt_pk_bf16_f32 v18, v68, v69
v_cvt_pk_bf16_f32 v19, v70, v71
s_add_u32 s28, s37, 0
s_nop 0
v_permlane32_swap_b32 v16, v18
v_permlane32_swap_b32 v17, v19
s_nop 0
buffer_store_dwordx4 v[16:19], v25, s[8:11], s28 offen offset:0 sc1
s_nop 0
v_mul_f32 v72, v72, v178
v_mul_f32 v73, v73, v178
v_mul_f32 v74, v74, v178
v_mul_f32 v75, v75, v178
v_cvt_pk_bf16_f32 v20, v72, v73
v_cvt_pk_bf16_f32 v21, v74, v75
v_mul_f32 v76, v76, v178
v_mul_f32 v77, v77, v178
v_mul_f32 v78, v78, v178
v_mul_f32 v79, v79, v178
v_cvt_pk_bf16_f32 v22, v76, v77
v_cvt_pk_bf16_f32 v23, v78, v79
s_add_u32 s28, s37, 65536
s_nop 0
v_permlane32_swap_b32 v20, v22
v_permlane32_swap_b32 v21, v23
s_nop 0
buffer_store_dwordx4 v[20:23], v25, s[8:11], s28 offen offset:0 sc1
s_nop 0
v_mul_f32 v80, v80, v179
v_mul_f32 v81, v81, v179
v_mul_f32 v82, v82, v179
v_mul_f32 v83, v83, v179
v_cvt_pk_bf16_f32 v16, v80, v81
v_cvt_pk_bf16_f32 v17, v82, v83
v_mul_f32 v84, v84, v179
v_mul_f32 v85, v85, v179
v_mul_f32 v86, v86, v179
v_mul_f32 v87, v87, v179
v_cvt_pk_bf16_f32 v18, v84, v85
v_cvt_pk_bf16_f32 v19, v86, v87
s_add_u32 s28, s37, 0
s_nop 0
v_permlane32_swap_b32 v16, v18
v_permlane32_swap_b32 v17, v19
s_nop 0
buffer_store_dwordx4 v[16:19], v25, s[8:11], s28 offen offset:512 sc1
s_nop 0
v_mul_f32 v88, v88, v179
v_mul_f32 v89, v89, v179
v_mul_f32 v90, v90, v179
v_mul_f32 v91, v91, v179
v_cvt_pk_bf16_f32 v20, v88, v89
v_cvt_pk_bf16_f32 v21, v90, v91
v_mul_f32 v92, v92, v179
v_mul_f32 v93, v93, v179
v_mul_f32 v94, v94, v179
v_mul_f32 v95, v95, v179
v_cvt_pk_bf16_f32 v22, v92, v93
v_cvt_pk_bf16_f32 v23, v94, v95
s_add_u32 s28, s37, 65536
s_nop 0
v_permlane32_swap_b32 v20, v22
v_permlane32_swap_b32 v21, v23
s_nop 0
buffer_store_dwordx4 v[20:23], v25, s[8:11], s28 offen offset:512 sc1
s_nop 0
s_lshl_b32 s85, s23, 2
s_add_u32 s85, s85, s16
s_sub_u32 s85, 8, s85
s_max_i32 s85, s85, 0
s_waitcnt vmcnt(4)
v_cndmask_b32 v204, 0, v204, s[74:75]
v_cndmask_b32 v205, 0, v205, s[74:75]
v_mov_b32 v16, 0x3f80
v_cndmask_b32 v206, 0, v16, s[74:75]
v_mov_b32 v207, 0
v_mov_b32 v183, 0
v_mov_b32 v191, 0
v_mov_b32 v199, 0
s_barrier
ds_read_b128 v[176:179], v13 offset:0
ds_read_b64 v[180:181], v14 offset:0
s_cmp_gt_u32 s85, 0
s_cselect_b32 s28, 0xff7f, 0
v_mov_b32 v182, s28
ds_read_b128 v[184:187], v13 offset:4096
ds_read_b64 v[188:189], v14 offset:4096
s_cmp_gt_u32 s85, 8
s_cselect_b32 s28, 0xff7f, 0
v_mov_b32 v190, s28
ds_read_b128 v[192:195], v13 offset:512
ds_read_b64 v[196:197], v14 offset:512
s_cmp_gt_u32 s85, 1
s_cselect_b32 s28, 0xff7f, 0
v_mov_b32 v198, s28
s_waitcnt lgkmcnt(4)
s_nop 0
v_mfma_f32_32x32x16_bf16 v[32:47], v[180:183], v[204:207], 0
s_mul_i32 s34, s25, 102400
s_mul_i32 s28, s16, 25600
s_add_u32 s34, s34, s28
s_add_u32 s34, s34, 6389760
buffer_load_dwordx4 a[160:163], v11, s[8:11], s34 offen offset:0
v_mfma_f32_32x32x16_bf16 v[32:47], v[176:179], v[200:203], v[32:47]
ds_read_b128 v[176:179], v13 offset:1024
ds_read_b64 v[180:181], v14 offset:1024
s_cmp_gt_u32 s85, 2
s_cselect_b32 s28, 0xff7f, 0
v_mov_b32 v182, s28
s_waitcnt lgkmcnt(4)
s_nop 0
v_mfma_f32_32x32x16_bf16 v[160:175], v[188:191], v[204:207], 0
buffer_load_dwordx4 a[164:167], v11, s[8:11], s34 offen offset:256
v_mfma_f32_32x32x16_bf16 v[160:175], v[184:187], v[200:203], v[160:175]
ds_read_b128 v[184:187], v13 offset:1536
ds_read_b64 v[188:189], v14 offset:1536
s_cmp_gt_u32 s85, 3
s_cselect_b32 s28, 0xff7f, 0
v_mov_b32 v190, s28
s_waitcnt lgkmcnt(4)
s_nop 0
v_mfma_f32_32x32x16_bf16 v[48:63], v[196:199], v[204:207], 0
buffer_load_dwordx4 a[168:171], v11, s[8:11], s34 offen offset:512
v_mfma_f32_32x32x16_bf16 v[48:63], v[192:195], v[200:203], v[48:63]
ds_read_b128 v[192:195], v13 offset:2048
ds_read_b64 v[196:197], v14 offset:2048
s_cmp_gt_u32 s85, 4
s_cselect_b32 s28, 0xff7f, 0
v_mov_b32 v198, s28
s_waitcnt lgkmcnt(4)
s_nop 0
v_mfma_f32_32x32x16_bf16 v[64:79], v[180:183], v[204:207], 0
buffer_load_dwordx4 a[172:175], v11, s[8:11], s34 offen offset:768
v_mfma_f32_32x32x16_bf16 v[64:79], v[176:179], v[200:203], v[64:79]
ds_read_b128 v[176:179], v13 offset:2560
ds_read_b64 v[180:181], v14 offset:2560
s_cmp_gt_u32 s85, 5
s_cselect_b32 s28, 0xff7f, 0
v_mov_b32 v182, s28
s_waitcnt lgkmcnt(4)
s_nop 0
v_mfma_f32_32x32x16_bf16 v[80:95], v[188:191], v[204:207], 0
v_cndmask_b32 v32, v32, v160, s[40:41]
v_cndmask_b32 v33, v33, v161, s[42:43]
v_cndmask_b32 v34, v34, v162, s[44:45]
v_cndmask_b32 v35, v35, v163, s[46:47]
buffer_load_dwordx4 a[176:179], v11, s[8:11], s34 offen offset:1024
v_mfma_f32_32x32x16_bf16 v[80:95], v[184:187], v[200:203], v[80:95]
v_cndmask_b32 v36, v36, v164, s[48:49]
v_cndmask_b32 v37, v37, v165, s[50:51]
v_cndmask_b32 v38, v38, v166, s[52:53]
v_cndmask_b32 v39, v39, v167, s[54:55]
ds_read_b128 v[184:187], v13 offset:3072
ds_read_b64 v[188:189], v14 offset:3072
s_cmp_gt_u32 s85, 6
s_cselect_b32 s28, 0xff7f, 0
v_mov_b32 v190, s28
s_waitcnt lgkmcnt(4)
s_nop 0
v_mfma_f32_32x32x16_bf16 v[96:111], v[196:199], v[204:207], 0
v_cndmask_b32 v40, v40, v168, s[56:57]
v_cndmask_b32 v41, v41, v169, s[58:59]
v_cndmask_b32 v42, v42, v170, s[60:61]
v_cndmask_b32 v43, v43, v171, s[62:63]
s_add_u32 s34, s34, 5120
buffer_load_dwordx4 a[180:183], v11, s[8:11], s34 offen offset:0
v_mfma_f32_32x32x16_bf16 v[96:111], v[192:195], v[200:203], v[96:111]
v_cndmask_b32 v44, v44, v172, s[64:65]
v_cndmask_b32 v45, v45, v173, s[66:67]
v_cndmask_b32 v46, v46, v174, s[68:69]
v_cndmask_b32 v47, v47, v175, s[70:71]
ds_read_b128 v[192:195], v13 offset:3584
ds_read_b64 v[196:197], v14 offset:3584
s_cmp_gt_u32 s85, 7
s_cselect_b32 s28, 0xff7f, 0
v_mov_b32 v198, s28
s_waitcnt lgkmcnt(4)
s_nop 0
v_mfma_f32_32x32x16_bf16 v[112:127], v[180:183], v[204:207], 0
v_max_f32 v16, v32, v33
v_max_f32 v17, v34, v35
v_max3_f32 v16, v16, v36, v37
v_max3_f32 v17, v17, v38, v39
buffer_load_dwordx4 a[184:187], v11, s[8:11], s34 offen offset:256
v_mfma_f32_32x32x16_bf16 v[112:127], v[176:179], v[200:203], v[112:127]
v_max3_f32 v16, v16, v40, v41
v_max3_f32 v17, v17, v42, v43
v_max3_f32 v16, v16, v44, v45
v_max3_f32 v17, v17, v46, v47
s_waitcnt lgkmcnt(2)
s_nop 0
v_mfma_f32_32x32x16_bf16 v[128:143], v[188:191], v[204:207], 0
v_max3_f32 v16, v16, v48, v49
v_max3_f32 v17, v17, v50, v51
v_max3_f32 v16, v16, v52, v53
v_max3_f32 v17, v17, v54, v55
buffer_load_dwordx4 a[188:191], v11, s[8:11], s34 offen offset:512
v_mfma_f32_32x32x16_bf16 v[128:143], v[184:187], v[200:203], v[128:143]
v_max3_f32 v16, v16, v56, v57
v_max3_f32 v17, v17, v58, v59
v_max3_f32 v16, v16, v60, v61
v_max3_f32 v17, v17, v62, v63
s_waitcnt lgkmcnt(0)
s_nop 0
v_mfma_f32_32x32x16_bf16 v[144:159], v[196:199], v[204:207], 0
v_max3_f32 v16, v16, v64, v65
v_max3_f32 v17, v17, v66, v67
v_max3_f32 v16, v16, v68, v69
v_max3_f32 v17, v17, v70, v71
buffer_load_dwordx4 a[192:195], v11, s[8:11], s34 offen offset:768
v_mfma_f32_32x32x16_bf16 v[144:159], v[192:195], v[200:203], v[144:159]
v_max3_f32 v16, v16, v72, v73
v_max3_f32 v17, v17, v74, v75
v_max3_f32 v16, v16, v76, v77
v_max3_f32 v17, v17, v78, v79
s_add_u32 s28, s19, 16
s_lshl_b32 s28, s28, 7
s_add_u32 s28, s28, 9211904
s_waitcnt vmcnt(9)
s_barrier
s_cmp_lg_u32 s16, 0
s_cbranch_scc1 S5
v_lshlrev_b32 v29, 12, v0
s_mov_b64 exec, 0xff
buffer_atomic_add v7, v29, s[8:11], s28 offen sc1
s_mov_b64 exec, -1
S5:
s_barrier
ds_read_b64_tr_b16 v[176:177], v15 offset:0
ds_read_b64_tr_b16 v[178:179], v15 offset:128
ds_read_b64_tr_b16 v[180:181], v15 offset:256
ds_read_b64_tr_b16 v[182:183], v15 offset:384
ds_read_b64_tr_b16 v[184:185], v15 offset:4096
ds_read_b64_tr_b16 v[186:187], v15 offset:4224
v_max3_f32 v16, v16, v80, v81
v_max3_f32 v17, v17, v82, v83
v_max3_f32 v16, v16, v84, v85
v_max3_f32 v17, v17, v86, v87
v_max3_f32 v16, v16, v88, v89
v_max3_f32 v17, v17, v90, v91
v_max3_f32 v16, v16, v92, v93
v_max3_f32 v17, v17, v94, v95
v_max3_f32 v16, v16, v96, v97
v_max3_f32 v17, v17, v98, v99
v_max3_f32 v16, v16, v100, v101
v_max3_f32 v17, v17, v102, v103
v_max3_f32 v16, v16, v104, v105
v_max3_f32 v17, v17, v106, v107
v_max3_f32 v16, v16, v108, v109
v_max3_f32 v17, v17, v110, v111
v_max3_f32 v16, v16, v112, v113
v_max3_f32 v17, v17, v114, v115
v_max3_f32 v16, v16, v116, v117
v_max3_f32 v17, v17, v118, v119
v_max3_f32 v16, v16, v120, v121
v_max3_f32 v17, v17, v122, v123
v_max3_f32 v16, v16, v124, v125
v_max3_f32 v17, v17, v126, v127
v_max3_f32 v16, v16, v128, v129
v_max3_f32 v17, v17, v130, v131
v_max3_f32 v16, v16, v132, v133
v_max3_f32 v17, v17, v134, v135
v_max3_f32 v16, v16, v136, v137
v_max3_f32 v17, v17, v138, v139
v_max3_f32 v16, v16, v140, v141
v_max3_f32 v17, v17, v142, v143
v_max3_f32 v16, v16, v144, v145
v_max3_f32 v17, v17, v146, v147
v_max3_f32 v16, v16, v148, v149
v_max3_f32 v17, v17, v150, v151
v_max3_f32 v16, v16, v152, v153
v_max3_f32 v17, v17, v154, v155
v_max3_f32 v16, v16, v156, v157
v_max3_f32 v17, v17, v158, v159
v_max_f32 v16, v16, v17
v_mov_b32 v17, v16
s_nop 1
v_permlane32_swap_b32 v16, v17
s_nop 0
v_max_f32 v16, v16, v17
s_mov_b32 s90, 0x3ea52b5c
s_mov_b32 s91, 0x3ea52b5c
v_mul_f32_e64 v16, s90, -v16
v_mov_b32 v17, v16
v_pk_fma_f32 v[32:33], v[32:33], s[90:91], v[16:17]
v_pk_fma_f32 v[34:35], v[34:35], s[90:91], v[16:17]
v_pk_fma_f32 v[36:37], v[36:37], s[90:91], v[16:17]
v_pk_fma_f32 v[38:39], v[38:39], s[90:91], v[16:17]
v_pk_fma_f32 v[40:41], v[40:41], s[90:91], v[16:17]
v_pk_fma_f32 v[42:43], v[42:43], s[90:91], v[16:17]
v_pk_fma_f32 v[44:45], v[44:45], s[90:91], v[16:17]
v_pk_fma_f32 v[46:47], v[46:47], s[90:91], v[16:17]
buffer_load_dwordx4 a[196:199], v11, s[8:11], s34 offen offset:1024
v_exp_f32 v32, v32
v_exp_f32 v33, v33
v_exp_f32 v34, v34
v_exp_f32 v35, v35
v_exp_f32 v36, v36
v_exp_f32 v37, v37
v_exp_f32 v38, v38
v_exp_f32 v39, v39
v_exp_f32 v40, v40
v_exp_f32 v41, v41
v_exp_f32 v42, v42
v_exp_f32 v43, v43
v_exp_f32 v44, v44
v_exp_f32 v45, v45
v_exp_f32 v46, v46
v_exp_f32 v47, v47
s_add_u32 s34, s34, 5120
buffer_load_dwordx4 a[200:203], v11, s[8:11], s34 offen offset:0
s_nop 0
v_cndmask_b32 v160, 0, v32, s[40:41]
v_cndmask_b32 v32, v32, 0, s[40:41]
v_cndmask_b32 v161, 0, v33, s[42:43]
v_cndmask_b32 v33, v33, 0, s[42:43]
v_cndmask_b32 v162, 0, v34, s[44:45]
v_cndmask_b32 v34, v34, 0, s[44:45]
v_cndmask_b32 v163, 0, v35, s[46:47]
v_cndmask_b32 v35, v35, 0, s[46:47]
v_cndmask_b32 v164, 0, v36, s[48:49]
v_cndmask_b32 v36, v36, 0, s[48:49]
v_cndmask_b32 v165, 0, v37, s[50:51]
v_cndmask_b32 v37, v37, 0, s[50:51]
v_cndmask_b32 v166, 0, v38, s[52:53]
v_cndmask_b32 v38, v38, 0, s[52:53]
v_cndmask_b32 v167, 0, v39, s[54:55]
v_cndmask_b32 v39, v39, 0, s[54:55]
v_cndmask_b32 v168, 0, v40, s[56:57]
v_cndmask_b32 v40, v40, 0, s[56:57]
v_cndmask_b32 v169, 0, v41, s[58:59]
v_cndmask_b32 v41, v41, 0, s[58:59]
v_cndmask_b32 v170, 0, v42, s[60:61]
v_cndmask_b32 v42, v42, 0, s[60:61]
v_cndmask_b32 v171, 0, v43, s[62:63]
v_cndmask_b32 v43, v43, 0, s[62:63]
v_cndmask_b32 v172, 0, v44, s[64:65]
v_cndmask_b32 v44, v44, 0, s[64:65]
v_cndmask_b32 v173, 0, v45, s[66:67]
v_cndmask_b32 v45, v45, 0, s[66:67]
v_cndmask_b32 v174, 0, v46, s[68:69]
v_cndmask_b32 v46, v46, 0, s[68:69]
v_cndmask_b32 v175, 0, v47, s[70:71]
v_cndmask_b32 v47, v47, 0, s[70:71]
v_cvt_pk_bf16_f32 v32, v32, v33
v_cvt_pk_bf16_f32 v33, v34, v35
v_cvt_pk_bf16_f32 v34, v36, v37
v_cvt_pk_bf16_f32 v35, v38, v39
v_cvt_pk_bf16_f32 v36, v40, v41
v_cvt_pk_bf16_f32 v37, v42, v43
v_cvt_pk_bf16_f32 v38, v44, v45
v_cvt_pk_bf16_f32 v39, v46, v47
v_cvt_pk_bf16_f32 v160, v160, v161
v_cvt_pk_bf16_f32 v161, v162, v163
v_cvt_pk_bf16_f32 v162, v164, v165
v_cvt_pk_bf16_f32 v163, v166, v167
v_cvt_pk_bf16_f32 v164, v168, v169
v_cvt_pk_bf16_f32 v165, v170, v171
v_cvt_pk_bf16_f32 v166, v172, v173
v_cvt_pk_bf16_f32 v167, v174, v175
s_nop 1
ds_read_b64_tr_b16 v[188:189], v15 offset:4352
ds_read_b64_tr_b16 v[190:191], v15 offset:4480
s_waitcnt lgkmcnt(6)
v_mfma_f32_32x32x16_bf16 v[208:223], v[176:179], v[32:35], 0
ds_read_b64_tr_b16 v[176:177], v15 offset:512
ds_read_b64_tr_b16 v[178:179], v15 offset:640
s_waitcnt lgkmcnt(6)
v_mfma_f32_32x32x16_bf16 v[208:223], v[180:183], v[36:39], v[208:223]
buffer_load_dwordx4 a[204:207], v11, s[8:11], s34 offen offset:256
s_nop 1
ds_read_b64_tr_b16 v[180:181], v15 offset:768
ds_read_b64_tr_b16 v[182:183], v15 offset:896
s_waitcnt lgkmcnt(6)
v_mfma_f32_32x32x16_bf16 v[208:223], v[184:187], v[160:163], v[208:223]
ds_read_b64_tr_b16 v[184:185], v15 offset:1024
ds_read_b64_tr_b16 v[186:187], v15 offset:1152
s_waitcnt lgkmcnt(6)
v_mfma_f32_32x32x16_bf16 v[208:223], v[188:191], v[164:167], v[208:223]
buffer_load_dwordx4 a[208:211], v11, s[8:11], s34 offen offset:512
v_pk_fma_f32 v[48:49], v[48:49], s[90:91], v[16:17]
v_pk_fma_f32 v[50:51], v[50:51], s[90:91], v[16:17]
v_pk_fma_f32 v[52:53], v[52:53], s[90:91], v[16:17]
v_pk_fma_f32 v[54:55], v[54:55], s[90:91], v[16:17]
v_pk_fma_f32 v[56:57], v[56:57], s[90:91], v[16:17]
v_pk_fma_f32 v[58:59], v[58:59], s[90:91], v[16:17]
v_pk_fma_f32 v[60:61], v[60:61], s[90:91], v[16:17]
v_pk_fma_f32 v[62:63], v[62:63], s[90:91], v[16:17]
buffer_load_dwordx4 a[212:215], v11, s[8:11], s34 offen offset:768
v_exp_f32 v48, v48
v_exp_f32 v49, v49
v_exp_f32 v50, v50
v_exp_f32 v51, v51
v_exp_f32 v52, v52
v_exp_f32 v53, v53
v_exp_f32 v54, v54
v_exp_f32 v55, v55
v_exp_f32 v56, v56
v_exp_f32 v57, v57
v_exp_f32 v58, v58
v_exp_f32 v59, v59
v_exp_f32 v60, v60
v_exp_f32 v61, v61
v_exp_f32 v62, v62
v_exp_f32 v63, v63
buffer_load_dwordx4 a[216:219], v11, s[8:11], s34 offen offset:1024
s_nop 0
v_cvt_pk_bf16_f32 v48, v48, v49
v_cvt_pk_bf16_f32 v49, v50, v51
v_cvt_pk_bf16_f32 v50, v52, v53
v_cvt_pk_bf16_f32 v51, v54, v55
v_cvt_pk_bf16_f32 v52, v56, v57
v_cvt_pk_bf16_f32 v53, v58, v59
v_cvt_pk_bf16_f32 v54, v60, v61
v_cvt_pk_bf16_f32 v55, v62, v63
s_nop 1
ds_read_b64_tr_b16 v[188:189], v15 offset:1280
ds_read_b64_tr_b16 v[190:191], v15 offset:1408
s_waitcnt lgkmcnt(6)
v_mfma_f32_32x32x16_bf16 v[208:223], v[176:179], v[48:51], v[208:223]
ds_read_b64_tr_b16 v[176:177], v15 offset:1536
ds_read_b64_tr_b16 v[178:179], v15 offset:1664
s_waitcnt lgkmcnt(6)
v_mfma_f32_32x32x16_bf16 v[208:223], v[180:183], v[52:55], v[208:223]
s_add_u32 s34, s34, 5120
buffer_load_dwordx4 a[220:223], v11, s[8:11], s34 offen offset:0
s_lshl_b32 s28, s23, 1
s_add_u32 s28, s28, 16
s_sub_u32 s28, s28, 4
v_min_u32 v30, 5, v0
v_add_u32 v30, s28, v30
v_max_i32 v30, 0, v30
v_lshlrev_b32 v30, 7, v30
buffer_load_dword v31, v30, s[8:11], s95 offen sc1
v_pk_fma_f32 v[64:65], v[64:65], s[90:91], v[16:17]
v_pk_fma_f32 v[66:67], v[66:67], s[90:91], v[16:17]
v_pk_fma_f32 v[68:69], v[68:69], s[90:91], v[16:17]
v_pk_fma_f32 v[70:71], v[70:71], s[90:91], v[16:17]
v_pk_fma_f32 v[72:73], v[72:73], s[90:91], v[16:17]
v_pk_fma_f32 v[74:75], v[74:75], s[90:91], v[16:17]
v_pk_fma_f32 v[76:77], v[76:77], s[90:91], v[16:17]
v_pk_fma_f32 v[78:79], v[78:79], s[90:91], v[16:17]
buffer_load_dwordx4 a[224:227], v11, s[8:11], s34 offen offset:256
v_exp_f32 v64, v64
v_exp_f32 v65, v65
v_exp_f32 v66, v66
v_exp_f32 v67, v67
v_exp_f32 v68, v68
v_exp_f32 v69, v69
v_exp_f32 v70, v70
v_exp_f32 v71, v71
v_exp_f32 v72, v72
v_exp_f32 v73, v73
v_exp_f32 v74, v74
v_exp_f32 v75, v75
v_exp_f32 v76, v76
v_exp_f32 v77, v77
v_exp_f32 v78, v78
v_exp_f32 v79, v79
buffer_load_dwordx4 a[228:231], v11, s[8:11], s34 offen offset:512
s_nop 0
v_cvt_pk_bf16_f32 v64, v64, v65
v_cvt_pk_bf16_f32 v65, v66, v67
v_cvt_pk_bf16_f32 v66, v68, v69
v_cvt_pk_bf16_f32 v67, v70, v71
v_cvt_pk_bf16_f32 v68, v72, v73
v_cvt_pk_bf16_f32 v69, v74, v75
v_cvt_pk_bf16_f32 v70, v76, v77
v_cvt_pk_bf16_f32 v71, v78, v79
s_nop 1
ds_read_b64_tr_b16 v[180:181], v15 offset:1792
ds_read_b64_tr_b16 v[182:183], v15 offset:1920
s_waitcnt lgkmcnt(6)
v_mfma_f32_32x32x16_bf16 v[208:223], v[184:187], v[64:67], v[208:223]
ds_read_b64_tr_b16 v[184:185], v15 offset:2048
ds_read_b64_tr_b16 v[186:187], v15 offset:2176
s_waitcnt lgkmcnt(6)
v_mfma_f32_32x32x16_bf16 v[208:223], v[188:191], v[68:71], v[208:223]
buffer_load_dwordx4 a[232:235], v11, s[8:11], s34 offen offset:768
v_pk_fma_f32 v[80:81], v[80:81], s[90:91], v[16:17]
v_pk_fma_f32 v[82:83], v[82:83], s[90:91], v[16:17]
v_pk_fma_f32 v[84:85], v[84:85], s[90:91], v[16:17]
v_pk_fma_f32 v[86:87], v[86:87], s[90:91], v[16:17]
v_pk_fma_f32 v[88:89], v[88:89], s[90:91], v[16:17]
v_pk_fma_f32 v[90:91], v[90:91], s[90:91], v[16:17]
v_pk_fma_f32 v[92:93], v[92:93], s[90:91], v[16:17]
v_pk_fma_f32 v[94:95], v[94:95], s[90:91], v[16:17]
buffer_load_dwordx4 a[236:239], v11, s[8:11], s34 offen offset:1024
v_exp_f32 v80, v80
v_exp_f32 v81, v81
v_exp_f32 v82, v82
v_exp_f32 v83, v83
v_exp_f32 v84, v84
v_exp_f32 v85, v85
v_exp_f32 v86, v86
v_exp_f32 v87, v87
v_exp_f32 v88, v88
v_exp_f32 v89, v89
v_exp_f32 v90, v90
v_exp_f32 v91, v91
v_exp_f32 v92, v92
v_exp_f32 v93, v93
v_exp_f32 v94, v94
v_exp_f32 v95, v95
s_add_u32 s34, s34, 5120
buffer_load_dwordx4 a[240:243], v11, s[8:11], s34 offen offset:0
s_nop 0
v_cvt_pk_bf16_f32 v80, v80, v81
v_cvt_pk_bf16_f32 v81, v82, v83
v_cvt_pk_bf16_f32 v82, v84, v85
v_cvt_pk_bf16_f32 v83, v86, v87
v_cvt_pk_bf16_f32 v84, v88, v89
v_cvt_pk_bf16_f32 v85, v90, v91
v_cvt_pk_bf16_f32 v86, v92, v93
v_cvt_pk_bf16_f32 v87, v94, v95
s_nop 1
ds_read_b64_tr_b16 v[188:189], v15 offset:2304
ds_read_b64_tr_b16 v[190:191], v15 offset:2432
s_waitcnt lgkmcnt(6)
v_mfma_f32_32x32x16_bf16 v[208:223], v[176:179], v[80:83], v[208:223]
ds_read_b64_tr_b16 v[176:177], v15 offset:2560
ds_read_b64_tr_b16 v[178:179], v15 offset:2688
s_waitcnt lgkmcnt(6)
v_mfma_f32_32x32x16_bf16 v[208:223], v[180:183], v[84:87], v[208:223]
buffer_load_dwordx4 a[244:247], v11, s[8:11], s34 offen offset:256
v_pk_fma_f32 v[96:97], v[96:97], s[90:91], v[16:17]
v_pk_fma_f32 v[98:99], v[98:99], s[90:91], v[16:17]
v_pk_fma_f32 v[100:101], v[100:101], s[90:91], v[16:17]
v_pk_fma_f32 v[102:103], v[102:103], s[90:91], v[16:17]
v_pk_fma_f32 v[104:105], v[104:105], s[90:91], v[16:17]
v_pk_fma_f32 v[106:107], v[106:107], s[90:91], v[16:17]
v_pk_fma_f32 v[108:109], v[108:109], s[90:91], v[16:17]
v_pk_fma_f32 v[110:111], v[110:111], s[90:91], v[16:17]
buffer_load_dwordx4 a[248:251], v11, s[8:11], s34 offen offset:512
v_exp_f32 v96, v96
v_exp_f32 v97, v97
v_exp_f32 v98, v98
v_exp_f32 v99, v99
v_exp_f32 v100, v100
v_exp_f32 v101, v101
v_exp_f32 v102, v102
v_exp_f32 v103, v103
v_exp_f32 v104, v104
v_exp_f32 v105, v105
v_exp_f32 v106, v106
v_exp_f32 v107, v107
v_exp_f32 v108, v108
v_exp_f32 v109, v109
v_exp_f32 v110, v110
v_exp_f32 v111, v111
buffer_load_dwordx4 a[252:255], v11, s[8:11], s34 offen offset:768
s_nop 0
v_cvt_pk_bf16_f32 v96, v96, v97
v_cvt_pk_bf16_f32 v97, v98, v99
v_cvt_pk_bf16_f32 v98, v100, v101
v_cvt_pk_bf16_f32 v99, v102, v103
v_cvt_pk_bf16_f32 v100, v104, v105
v_cvt_pk_bf16_f32 v101, v106, v107
v_cvt_pk_bf16_f32 v102, v108, v109
v_cvt_pk_bf16_f32 v103, v110, v111
s_nop 1
ds_read_b64_tr_b16 v[180:181], v15 offset:2816
ds_read_b64_tr_b16 v[182:183], v15 offset:2944
s_waitcnt lgkmcnt(6)
v_mfma_f32_32x32x16_bf16 v[208:223], v[184:187], v[96:99], v[208:223]
ds_read_b64_tr_b16 v[184:185], v15 offset:3072
ds_read_b64_tr_b16 v[186:187], v15 offset:3200
s_waitcnt lgkmcnt(6)
v_mfma_f32_32x32x16_bf16 v[208:223], v[188:191], v[100:103], v[208:223]
buffer_load_dwordx4 v[228:231], v11, s[8:11], s34 offen offset:1024
s_waitcnt vmcnt(9)
s_cmp_lg_u32 s16, 0
s_cbranch_scc1 P6
s_movk_i32 s77, 16
P7:
v_cmp_gt_u32 vcc, s77, v31
s_nop 1
s_cbranch_vccz P6
s_add_u32 s76, s76, 1
s_cmp_gt_u32 s76, 400000
s_cbranch_scc1 P6
s_sleep 4
buffer_load_dword v31, v30, s[8:11], s95 offen sc1
s_waitcnt vmcnt(0)
s_branch P7
P6:
s_barrier
s_lshl_b32 s78, s23, 7
s_add_u32 s78, s78, 1024
s_lshl_b32 s28, s16, 6
s_add_u32 s79, s78, s28
s_sub_u32 s79, s79, 256
s_max_i32 s79, s79, 0
s_lshl_b32 s79, s79, 4
s_add_u32 s28, s16, 4
s_min_u32 s28, s28, 5
s_lshl_b32 s81, s28, 10
s_lshl_b32 s28, s28, 6
s_add_u32 s80, s78, s28
s_sub_u32 s80, s80, 256
s_max_i32 s80, s80, 0
s_lshl_b32 s80, s80, 4
s_lshl_b32 s82, s16, 10
s_lshl_b32 s83, s39, 15
s_add_u32 s84, s38, 4
s_lshl_b32 s84, s84, 15
s_add_u32 s28, s83, 17682432
s_add_u32 s28, s28, s79
s_add_u32 m0, s82, 102784
s_nop 0
buffer_load_dwordx4 v1, s[8:11], s28 offen sc1 lds
s_add_u32 s28, s83, 17682432
s_add_u32 s28, s28, s80
s_add_u32 m0, s81, 102784
s_nop 0
buffer_load_dwordx4 v1, s[8:11], s28 offen sc1 lds
s_add_u32 s28, s83, 17715200
s_add_u32 s28, s28, s79
s_add_u32 m0, s82, 108992
s_nop 0
buffer_load_dwordx4 v1, s[8:11], s28 offen sc1 lds
s_add_u32 s28, s83, 17715200
s_add_u32 s28, s28, s80
s_add_u32 m0, s81, 108992
s_nop 0
buffer_load_dwordx4 v1, s[8:11], s28 offen sc1 lds
s_add_u32 s28, s84, 17682432
s_add_u32 s28, s28, s79
s_add_u32 m0, s82, 115200
s_nop 0
buffer_load_dwordx4 v1, s[8:11], s28 offen sc1 lds
s_add_u32 s28, s84, 17682432
s_add_u32 s28, s28, s80
s_add_u32 m0, s81, 115200
s_nop 0
buffer_load_dwordx4 v1, s[8:11], s28 offen sc1 lds
s_add_u32 s28, s83, 20303872
s_add_u32 s28, s28, s79
s_add_u32 m0, s82, 121408
s_nop 0
buffer_load_dwordx4 v1, s[8:11], s28 offen sc1 lds
s_add_u32 s28, s83, 20303872
s_add_u32 s28, s28, s80
s_add_u32 m0, s81, 121408
s_nop 0
buffer_load_dwordx4 v1, s[8:11], s28 offen sc1 lds
s_add_u32 s28, s83, 20336640
s_add_u32 s28, s28, s79
s_add_u32 m0, s82, 127616
s_nop 0
buffer_load_dwordx4 v1, s[8:11], s28 offen sc1 lds
s_add_u32 s28, s83, 20336640
s_add_u32 s28, s28, s80
s_add_u32 m0, s81, 127616
s_nop 0
buffer_load_dwordx4 v1, s[8:11], s28 offen sc1 lds
s_add_u32 s28, s84, 20303872
s_add_u32 s28, s28, s79
s_add_u32 m0, s82, 133824
s_nop 0
buffer_load_dwordx4 v1, s[8:11], s28 offen sc1 lds
s_add_u32 s28, s84, 20303872
s_add_u32 s28, s28, s80
s_add_u32 m0, s81, 133824
s_nop 0
buffer_load_dwordx4 v1, s[8:11], s28 offen sc1 lds
s_lshl_b32 s28, s16, 5
s_add_u32 s28, s28, s78
v_add_u32 v29, s28, v2
v_lshlrev_b32 v29, 4, v29
v_lshl_add_u32 v28, v3, 15, v29
s_add_u32 s28, s83, 15060992
buffer_load_dwordx4 v[232:235], v28, s[8:11], s28 offen sc1
v_add_u32 v29, s31, v29
s_add_u32 s28, s84, 15060992
buffer_load_dwordx2 v[236:237], v29, s[8:11], s28 offen sc1
v_pk_fma_f32 v[112:113], v[112:113], s[90:91], v[16:17]
v_pk_fma_f32 v[114:115], v[114:115], s[90:91], v[16:17]
v_pk_fma_f32 v[116:117], v[116:117], s[90:91], v[16:17]
v_pk_fma_f32 v[118:119], v[118:119], s[90:91], v[16:17]
v_pk_fma_f32 v[120:121], v[120:121], s[90:91], v[16:17]
v_pk_fma_f32 v[122:123], v[122:123], s[90:91], v[16:17]
v_pk_fma_f32 v[124:125], v[124:125], s[90:91], v[16:17]
v_pk_fma_f32 v[126:127], v[126:127], s[90:91], v[16:17]
s_mul_i32 s35, s21, 245760
s_lshr_b32 s28, s16, 1
s_mul_i32 s28, s28, 1536
s_add_u32 s35, s35, s28
s_and_b32 s28, s16, 1
s_mul_i32 s28, s28, 768
s_add_u32 s35, s35, s28
s_add_u32 s35, s35, 2457600
buffer_load_dwordx4 a[0:3], v12, s[8:11], s35 offen offset:0
v_exp_f32 v112, v112
v_exp_f32 v113, v113
v_exp_f32 v114, v114
v_exp_f32 v115, v115
v_exp_f32 v116, v116
v_exp_f32 v117, v117
v_exp_f32 v118, v118
v_exp_f32 v119, v119
v_exp_f32 v120, v120
v_exp_f32 v121, v121
v_exp_f32 v122, v122
v_exp_f32 v123, v123
v_exp_f32 v124, v124
v_exp_f32 v125, v125
v_exp_f32 v126, v126
v_exp_f32 v127, v127
buffer_load_dwordx4 a[4:7], v12, s[8:11], s35 offen offset:256
s_nop 0
v_cvt_pk_bf16_f32 v112, v112, v113
v_cvt_pk_bf16_f32 v113, v114, v115
v_cvt_pk_bf16_f32 v114, v116, v117
v_cvt_pk_bf16_f32 v115, v118, v119
v_cvt_pk_bf16_f32 v116, v120, v121
v_cvt_pk_bf16_f32 v117, v122, v123
v_cvt_pk_bf16_f32 v118, v124, v125
v_cvt_pk_bf16_f32 v119, v126, v127
s_nop 1
ds_read_b64_tr_b16 v[188:189], v15 offset:3328
ds_read_b64_tr_b16 v[190:191], v15 offset:3456
s_waitcnt lgkmcnt(6)
v_mfma_f32_32x32x16_bf16 v[208:223], v[176:179], v[112:115], v[208:223]
ds_read_b64_tr_b16 v[176:177], v15 offset:3584
ds_read_b64_tr_b16 v[178:179], v15 offset:3712
s_waitcnt lgkmcnt(6)
v_mfma_f32_32x32x16_bf16 v[208:223], v[180:183], v[116:119], v[208:223]
buffer_load_dwordx4 a[8:11], v12, s[8:11], s35 offen offset:512
v_pk_fma_f32 v[128:129], v[128:129], s[90:91], v[16:17]
v_pk_fma_f32 v[130:131], v[130:131], s[90:91], v[16:17]
v_pk_fma_f32 v[132:133], v[132:133], s[90:91], v[16:17]
v_pk_fma_f32 v[134:135], v[134:135], s[90:91], v[16:17]
v_pk_fma_f32 v[136:137], v[136:137], s[90:91], v[16:17]
v_pk_fma_f32 v[138:139], v[138:139], s[90:91], v[16:17]
v_pk_fma_f32 v[140:141], v[140:141], s[90:91], v[16:17]
v_pk_fma_f32 v[142:143], v[142:143], s[90:91], v[16:17]
s_add_u32 s35, s35, 12288
buffer_load_dwordx4 a[12:15], v12, s[8:11], s35 offen offset:0
v_exp_f32 v128, v128
v_exp_f32 v129, v129
v_exp_f32 v130, v130
v_exp_f32 v131, v131
v_exp_f32 v132, v132
v_exp_f32 v133, v133
v_exp_f32 v134, v134
v_exp_f32 v135, v135
v_exp_f32 v136, v136
v_exp_f32 v137, v137
v_exp_f32 v138, v138
v_exp_f32 v139, v139
v_exp_f32 v140, v140
v_exp_f32 v141, v141
v_exp_f32 v142, v142
v_exp_f32 v143, v143
buffer_load_dwordx4 a[16:19], v12, s[8:11], s35 offen offset:256
s_nop 0
v_cvt_pk_bf16_f32 v128, v128, v129
v_cvt_pk_bf16_f32 v129, v130, v131
v_cvt_pk_bf16_f32 v130, v132, v133
v_cvt_pk_bf16_f32 v131, v134, v135
v_cvt_pk_bf16_f32 v132, v136, v137
v_cvt_pk_bf16_f32 v133, v138, v139
v_cvt_pk_bf16_f32 v134, v140, v141
v_cvt_pk_bf16_f32 v135, v142, v143
s_nop 1
ds_read_b64_tr_b16 v[180:181], v15 offset:3840
ds_read_b64_tr_b16 v[182:183], v15 offset:3968
s_waitcnt lgkmcnt(6)
v_mfma_f32_32x32x16_bf16 v[208:223], v[184:187], v[128:131], v[208:223]
s_waitcnt lgkmcnt(4)
v_mfma_f32_32x32x16_bf16 v[208:223], v[188:191], v[132:135], v[208:223]
buffer_load_dwordx4 a[20:23], v12, s[8:11], s35 offen offset:512
v_pk_fma_f32 v[144:145], v[144:145], s[90:91], v[16:17]
v_pk_fma_f32 v[146:147], v[146:147], s[90:91], v[16:17]
v_pk_fma_f32 v[148:149], v[148:149], s[90:91], v[16:17]
v_pk_fma_f32 v[150:151], v[150:151], s[90:91], v[16:17]
v_pk_fma_f32 v[152:153], v[152:153], s[90:91], v[16:17]
v_pk_fma_f32 v[154:155], v[154:155], s[90:91], v[16:17]
v_pk_fma_f32 v[156:157], v[156:157], s[90:91], v[16:17]
v_pk_fma_f32 v[158:159], v[158:159], s[90:91], v[16:17]
s_add_u32 s35, s35, 12288
buffer_load_dwordx4 a[24:27], v12, s[8:11], s35 offen offset:0
v_exp_f32 v144, v144
v_exp_f32 v145, v145
v_exp_f32 v146, v146
v_exp_f32 v147, v147
v_exp_f32 v148, v148
v_exp_f32 v149, v149
v_exp_f32 v150, v150
v_exp_f32 v151, v151
v_exp_f32 v152, v152
v_exp_f32 v153, v153
v_exp_f32 v154, v154
v_exp_f32 v155, v155
v_exp_f32 v156, v156
v_exp_f32 v157, v157
v_exp_f32 v158, v158
v_exp_f32 v159, v159
buffer_load_dwordx4 a[28:31], v12, s[8:11], s35 offen offset:256
s_nop 0
v_cvt_pk_bf16_f32 v144, v144, v145
v_cvt_pk_bf16_f32 v145, v146, v147
v_cvt_pk_bf16_f32 v146, v148, v149
v_cvt_pk_bf16_f32 v147, v150, v151
v_cvt_pk_bf16_f32 v148, v152, v153
v_cvt_pk_bf16_f32 v149, v154, v155
v_cvt_pk_bf16_f32 v150, v156, v157
v_cvt_pk_bf16_f32 v151, v158, v159
s_nop 1
s_waitcnt lgkmcnt(2)
v_mfma_f32_32x32x16_bf16 v[208:223], v[176:179], v[144:147], v[208:223]
s_waitcnt lgkmcnt(0)
v_mfma_f32_32x32x16_bf16 v[208:223], v[180:183], v[148:151], v[208:223]
buffer_load_dwordx4 a[32:35], v12, s[8:11], s35 offen offset:512
s_lshl_b32 s28, s23, 7
s_add_u32 s28, s28, 0
s_lshl_b32 s29, s16, 5
s_add_u32 s28, s28, s29
v_add_u32 v18, s28, v2
v_lshrrev_b32 v19, 6, v18
s_mov_b32 s29, 81920
v_mul_lo_u32 v19, v19, s29
v_and_b32 v18, 63, v18
v_lshl_add_u32 v19, v18, 4, v19
v_add_u32 v18, s39, v3
v_lshl_add_u32 v26, v18, 10, v19
s_add_u32 s29, s38, 4
s_lshl_b32 s29, s29, 10
s_add_u32 s29, s29, s31
v_add_u32 v27, s29, v19
s_nop 5
v_mov_b32 v16, v216
v_mov_b32 v17, v216
s_nop 1
v_permlane32_swap_b32 v16, v17
s_nop 0
v_rcp_f32 v17, v17
s_nop 0
v_mul_f32 v208, v208, v17
v_mul_f32 v209, v209, v17
v_mul_f32 v210, v210, v17
v_mul_f32 v211, v211, v17
v_mul_f32 v212, v212, v17
v_mul_f32 v213, v213, v17
v_mul_f32 v214, v214, v17
v_mul_f32 v215, v215, v17
v_mul_f32 v216, v216, v17
v_mul_f32 v217, v217, v17
v_mul_f32 v218, v218, v17
v_mul_f32 v219, v219, v17
v_cvt_pk_bf16_f32 v20, v208, v209
v_cvt_pk_bf16_f32 v21, v210, v211
v_cvt_pk_bf16_f32 v22, v212, v213
v_cvt_pk_bf16_f32 v23, v214, v215
v_cvt_pk_bf16_f32 v24, v216, v217
v_cvt_pk_bf16_f32 v25, v218, v219
s_mov_b32 s28, 22925312
v_permlane32_swap_b32 v20, v22
v_permlane32_swap_b32 v21, v23
s_nop 0
buffer_store_dwordx4 v[20:23], v26, s[8:11], s28 offen sc1
s_mov_b64 exec, s[74:75]
buffer_store_dwordx2 v[24:25], v27, s[8:11], s28 offen sc1
s_mov_b64 exec, -1
s_mul_i32 s98, s16, 10240
s_mul_i32 s99, s16, 10240
s_add_u32 s99, s99, 40960
s_mul_i32 s28, s16, 10240
s_add_u32 s28, s28, 86400
s_cmp_ge_u32 s16, 2
s_cselect_b32 s99, s28, s99
s_mul_i32 s97, s16, 12288
s_add_u32 s97, s97, 90112
v_lshlrev_b32 v226, 9, v5
v_lshl_add_u32 v226, v4, 4, v226
s_and_b32 s28, s16, 1
s_lshl_b32 s28, s28, 8
v_add_u32 v227, s28, v226
s_xor_b32 s28, s28, 256
v_add_u32 v226, s28, v226
s_mov_b32 s85, 0
s_waitcnt vmcnt(11)
v_cndmask_b32 v236, 0, v236, s[74:75]
v_cndmask_b32 v237, 0, v237, s[74:75]
v_mov_b32 v16, 0x3f80
v_cndmask_b32 v238, 0, v16, s[74:75]
v_mov_b32 v239, 0
v_mov_b32 v183, 0
v_mov_b32 v191, 0
v_mov_b32 v199, 0
s_barrier
ds_read_b128 v[176:179], v13 offset:37248
ds_read_b64 v[180:181], v14 offset:37248
s_cmp_gt_u32 s85, 0
s_cselect_b32 s28, 0xff7f, 0
v_mov_b32 v182, s28
ds_read_b128 v[184:187], v13 offset:41344
ds_read_b64 v[188:189], v14 offset:41344
s_cmp_gt_u32 s85, 8
s_cselect_b32 s28, 0xff7f, 0
v_mov_b32 v190, s28
ds_read_b128 v[192:195], v13 offset:37760
ds_read_b64 v[196:197], v14 offset:37760
s_cmp_gt_u32 s85, 1
s_cselect_b32 s28, 0xff7f, 0
v_mov_b32 v198, s28
s_waitcnt lgkmcnt(4)
s_nop 0
v_mfma_f32_32x32x16_bf16 v[32:47], v[180:183], v[236:239], 0
s_add_u32 s35, s35, 12288
buffer_load_dwordx4 a[36:39], v12, s[8:11], s35 offen offset:0
v_mfma_f32_32x32x16_bf16 v[32:47], v[176:179], v[232:235], v[32:47]
ds_read_b128 v[176:179], v13 offset:38272
ds_read_b64 v[180:181], v14 offset:38272
s_cmp_gt_u32 s85, 2
s_cselect_b32 s28, 0xff7f, 0
v_mov_b32 v182, s28
s_waitcnt lgkmcnt(4)
s_nop 0
v_mfma_f32_32x32x16_bf16 v[160:175], v[188:191], v[236:239], 0
buffer_load_dwordx4 a[40:43], v12, s[8:11], s35 offen offset:256
v_mfma_f32_32x32x16_bf16 v[160:175], v[184:187], v[232:235], v[160:175]
ds_read_b128 v[184:187], v13 offset:38784
ds_read_b64 v[188:189], v14 offset:38784
s_cmp_gt_u32 s85, 3
s_cselect_b32 s28, 0xff7f, 0
v_mov_b32 v190, s28
s_waitcnt lgkmcnt(4)
s_nop 0
v_mfma_f32_32x32x16_bf16 v[48:63], v[196:199], v[236:239], 0
buffer_load_dwordx4 a[44:47], v12, s[8:11], s35 offen offset:512
v_mfma_f32_32x32x16_bf16 v[48:63], v[192:195], v[232:235], v[48:63]
ds_read_b128 v[192:195], v13 offset:39296
ds_read_b64 v[196:197], v14 offset:39296
s_cmp_gt_u32 s85, 4
s_cselect_b32 s28, 0xff7f, 0
v_mov_b32 v198, s28
s_waitcnt lgkmcnt(4)
s_nop 0
v_mfma_f32_32x32x16_bf16 v[64:79], v[180:183], v[236:239], 0
s_add_u32 s35, s35, 12288
buffer_load_dwordx4 a[48:51], v12, s[8:11], s35 offen offset:0
v_mfma_f32_32x32x16_bf16 v[64:79], v[176:179], v[232:235], v[64:79]
ds_read_b128 v[176:179], v13 offset:39808
ds_read_b64 v[180:181], v14 offset:39808
s_cmp_gt_u32 s85, 5
s_cselect_b32 s28, 0xff7f, 0
v_mov_b32 v182, s28
s_waitcnt lgkmcnt(4)
s_nop 0
v_mfma_f32_32x32x16_bf16 v[80:95], v[188:191], v[236:239], 0
v_cndmask_b32 v32, v32, v160, s[40:41]
v_cndmask_b32 v33, v33, v161, s[42:43]
v_cndmask_b32 v34, v34, v162, s[44:45]
v_cndmask_b32 v35, v35, v163, s[46:47]
buffer_load_dwordx4 a[52:55], v12, s[8:11], s35 offen offset:256
v_mfma_f32_32x32x16_bf16 v[80:95], v[184:187], v[232:235], v[80:95]
v_cndmask_b32 v36, v36, v164, s[48:49]
v_cndmask_b32 v37, v37, v165, s[50:51]
v_cndmask_b32 v38, v38, v166, s[52:53]
v_cndmask_b32 v39, v39, v167, s[54:55]
ds_read_b128 v[184:187], v13 offset:40320
ds_read_b64 v[188:189], v14 offset:40320
s_cmp_gt_u32 s85, 6
s_cselect_b32 s28, 0xff7f, 0
v_mov_b32 v190, s28
s_waitcnt lgkmcnt(4)
s_nop 0
v_mfma_f32_32x32x16_bf16 v[96:111], v[196:199], v[236:239], 0
v_cndmask_b32 v40, v40, v168, s[56:57]
v_cndmask_b32 v41, v41, v169, s[58:59]
v_cndmask_b32 v42, v42, v170, s[60:61]
v_cndmask_b32 v43, v43, v171, s[62:63]
buffer_load_dwordx4 a[56:59], v12, s[8:11], s35 offen offset:512
v_mfma_f32_32x32x16_bf16 v[96:111], v[192:195], v[232:235], v[96:111]
v_cndmask_b32 v44, v44, v172, s[64:65]
v_cndmask_b32 v45, v45, v173, s[66:67]
v_cndmask_b32 v46, v46, v174, s[68:69]
v_cndmask_b32 v47, v47, v175, s[70:71]
ds_read_b128 v[192:195], v13 offset:40832
ds_read_b64 v[196:197], v14 offset:40832
s_cmp_gt_u32 s85, 7
s_cselect_b32 s28, 0xff7f, 0
v_mov_b32 v198, s28
s_waitcnt lgkmcnt(4)
s_nop 0
v_mfma_f32_32x32x16_bf16 v[112:127], v[180:183], v[236:239], 0
v_max_f32 v16, v32, v33
v_max_f32 v17, v34, v35
v_max3_f32 v16, v16, v36, v37
v_max3_f32 v17, v17, v38, v39
s_add_u32 s35, s35, 12288
buffer_load_dwordx4 a[60:63], v12, s[8:11], s35 offen offset:0
v_mfma_f32_32x32x16_bf16 v[112:127], v[176:179], v[232:235], v[112:127]
v_max3_f32 v16, v16, v40, v41
v_max3_f32 v17, v17, v42, v43
v_max3_f32 v16, v16, v44, v45
v_max3_f32 v17, v17, v46, v47
s_waitcnt lgkmcnt(2)
s_nop 0
v_mfma_f32_32x32x16_bf16 v[128:143], v[188:191], v[236:239], 0
v_max3_f32 v16, v16, v48, v49
v_max3_f32 v17, v17, v50, v51
v_max3_f32 v16, v16, v52, v53
v_max3_f32 v17, v17, v54, v55
buffer_load_dwordx4 a[64:67], v12, s[8:11], s35 offen offset:256
v_mfma_f32_32x32x16_bf16 v[128:143], v[184:187], v[232:235], v[128:143]
v_max3_f32 v16, v16, v56, v57
v_max3_f32 v17, v17, v58, v59
v_max3_f32 v16, v16, v60, v61
v_max3_f32 v17, v17, v62, v63
s_waitcnt lgkmcnt(0)
s_nop 0
v_mfma_f32_32x32x16_bf16 v[144:159], v[196:199], v[236:239], 0
v_max3_f32 v16, v16, v64, v65
v_max3_f32 v17, v17, v66, v67
v_max3_f32 v16, v16, v68, v69
v_max3_f32 v17, v17, v70, v71
buffer_load_dwordx4 a[68:71], v12, s[8:11], s35 offen offset:512
v_mfma_f32_32x32x16_bf16 v[144:159], v[192:195], v[232:235], v[144:159]
v_max3_f32 v16, v16, v72, v73
v_max3_f32 v17, v17, v74, v75
v_max3_f32 v16, v16, v76, v77
v_max3_f32 v17, v17, v78, v79
s_lshl_b32 s28, s23, 7
s_add_u32 s28, s28, 9195520
s_waitcnt vmcnt(9)
s_barrier
s_cmp_lg_u32 s16, 0
s_cbranch_scc1 S8
s_mov_b64 exec, 1
buffer_atomic_add v7, v6, s[8:11], s28 offen sc1
s_mov_b64 exec, -1
S8:
s_barrier
ds_read_b64_tr_b16 v[176:177], v224 offset:0
ds_read_b64_tr_b16 v[178:179], v224 offset:128
ds_read_b64_tr_b16 v[180:181], v224 offset:256
ds_read_b64_tr_b16 v[182:183], v224 offset:384
ds_read_b64_tr_b16 v[184:185], v224 offset:4096
ds_read_b64_tr_b16 v[186:187], v224 offset:4224
v_max3_f32 v16, v16, v80, v81
v_max3_f32 v17, v17, v82, v83
v_max3_f32 v16, v16, v84, v85
v_max3_f32 v17, v17, v86, v87
v_max3_f32 v16, v16, v88, v89
v_max3_f32 v17, v17, v90, v91
v_max3_f32 v16, v16, v92, v93
v_max3_f32 v17, v17, v94, v95
v_max3_f32 v16, v16, v96, v97
v_max3_f32 v17, v17, v98, v99
v_max3_f32 v16, v16, v100, v101
v_max3_f32 v17, v17, v102, v103
v_max3_f32 v16, v16, v104, v105
v_max3_f32 v17, v17, v106, v107
v_max3_f32 v16, v16, v108, v109
v_max3_f32 v17, v17, v110, v111
v_max3_f32 v16, v16, v112, v113
v_max3_f32 v17, v17, v114, v115
v_max3_f32 v16, v16, v116, v117
v_max3_f32 v17, v17, v118, v119
v_max3_f32 v16, v16, v120, v121
v_max3_f32 v17, v17, v122, v123
v_max3_f32 v16, v16, v124, v125
v_max3_f32 v17, v17, v126, v127
v_max3_f32 v16, v16, v128, v129
v_max3_f32 v17, v17, v130, v131
v_max3_f32 v16, v16, v132, v133
v_max3_f32 v17, v17, v134, v135
v_max3_f32 v16, v16, v136, v137
v_max3_f32 v17, v17, v138, v139
v_max3_f32 v16, v16, v140, v141
v_max3_f32 v17, v17, v142, v143
v_max3_f32 v16, v16, v144, v145
v_max3_f32 v17, v17, v146, v147
v_max3_f32 v16, v16, v148, v149
v_max3_f32 v17, v17, v150, v151
v_max3_f32 v16, v16, v152, v153
v_max3_f32 v17, v17, v154, v155
v_max3_f32 v16, v16, v156, v157
v_max3_f32 v17, v17, v158, v159
v_max_f32 v16, v16, v17
v_mov_b32 v17, v16
s_nop 1
v_permlane32_swap_b32 v16, v17
s_nop 0
v_max_f32 v16, v16, v17
s_mov_b32 s90, 0x3ea52b5c
s_mov_b32 s91, 0x3ea52b5c
v_mul_f32_e64 v16, s90, -v16
v_mov_b32 v17, v16
v_pk_fma_f32 v[32:33], v[32:33], s[90:91], v[16:17]
v_pk_fma_f32 v[34:35], v[34:35], s[90:91], v[16:17]
v_pk_fma_f32 v[36:37], v[36:37], s[90:91], v[16:17]
v_pk_fma_f32 v[38:39], v[38:39], s[90:91], v[16:17]
v_pk_fma_f32 v[40:41], v[40:41], s[90:91], v[16:17]
v_pk_fma_f32 v[42:43], v[42:43], s[90:91], v[16:17]
v_pk_fma_f32 v[44:45], v[44:45], s[90:91], v[16:17]
v_pk_fma_f32 v[46:47], v[46:47], s[90:91], v[16:17]
s_add_u32 s35, s35, 12288
buffer_load_dwordx4 a[72:75], v12, s[8:11], s35 offen offset:0
v_exp_f32 v32, v32
v_exp_f32 v33, v33
v_exp_f32 v34, v34
v_exp_f32 v35, v35
v_exp_f32 v36, v36
v_exp_f32 v37, v37
v_exp_f32 v38, v38
v_exp_f32 v39, v39
v_exp_f32 v40, v40
v_exp_f32 v41, v41
v_exp_f32 v42, v42
v_exp_f32 v43, v43
v_exp_f32 v44, v44
v_exp_f32 v45, v45
v_exp_f32 v46, v46
v_exp_f32 v47, v47
buffer_load_dwordx4 a[76:79], v12, s[8:11], s35 offen offset:256
s_nop 0
v_cndmask_b32 v160, 0, v32, s[40:41]
v_cndmask_b32 v32, v32, 0, s[40:41]
v_cndmask_b32 v161, 0, v33, s[42:43]
v_cndmask_b32 v33, v33, 0, s[42:43]
v_cndmask_b32 v162, 0, v34, s[44:45]
v_cndmask_b32 v34, v34, 0, s[44:45]
v_cndmask_b32 v163, 0, v35, s[46:47]
v_cndmask_b32 v35, v35, 0, s[46:47]
v_cndmask_b32 v164, 0, v36, s[48:49]
v_cndmask_b32 v36, v36, 0, s[48:49]
v_cndmask_b32 v165, 0, v37, s[50:51]
v_cndmask_b32 v37, v37, 0, s[50:51]
v_cndmask_b32 v166, 0, v38, s[52:53]
v_cndmask_b32 v38, v38, 0, s[52:53]
v_cndmask_b32 v167, 0, v39, s[54:55]
v_cndmask_b32 v39, v39, 0, s[54:55]
v_cndmask_b32 v168, 0, v40, s[56:57]
v_cndmask_b32 v40, v40, 0, s[56:57]
v_cndmask_b32 v169, 0, v41, s[58:59]
v_cndmask_b32 v41, v41, 0, s[58:59]
v_cndmask_b32 v170, 0, v42, s[60:61]
v_cndmask_b32 v42, v42, 0, s[60:61]
v_cndmask_b32 v171, 0, v43, s[62:63]
v_cndmask_b32 v43, v43, 0, s[62:63]
v_cndmask_b32 v172, 0, v44, s[64:65]
v_cndmask_b32 v44, v44, 0, s[64:65]
v_cndmask_b32 v173, 0, v45, s[66:67]
v_cndmask_b32 v45, v45, 0, s[66:67]
v_cndmask_b32 v174, 0, v46, s[68:69]
v_cndmask_b32 v46, v46, 0, s[68:69]
v_cndmask_b32 v175, 0, v47, s[70:71]
v_cndmask_b32 v47, v47, 0, s[70:71]
v_cvt_pk_bf16_f32 v32, v32, v33
v_cvt_pk_bf16_f32 v33, v34, v35
v_cvt_pk_bf16_f32 v34, v36, v37
v_cvt_pk_bf16_f32 v35, v38, v39
v_cvt_pk_bf16_f32 v36, v40, v41
v_cvt_pk_bf16_f32 v37, v42, v43
v_cvt_pk_bf16_f32 v38, v44, v45
v_cvt_pk_bf16_f32 v39, v46, v47
v_cvt_pk_bf16_f32 v160, v160, v161
v_cvt_pk_bf16_f32 v161, v162, v163
v_cvt_pk_bf16_f32 v162, v164, v165
v_cvt_pk_bf16_f32 v163, v166, v167
v_cvt_pk_bf16_f32 v164, v168, v169
v_cvt_pk_bf16_f32 v165, v170, v171
v_cvt_pk_bf16_f32 v166, v172, v173
v_cvt_pk_bf16_f32 v167, v174, v175
s_nop 1
ds_read_b64_tr_b16 v[188:189], v224 offset:4352
ds_read_b64_tr_b16 v[190:191], v224 offset:4480
s_waitcnt lgkmcnt(6)
v_mfma_f32_32x32x16_bf16 v[208:223], v[176:179], v[32:35], 0
ds_read_b64_tr_b16 v[176:177], v224 offset:512
ds_read_b64_tr_b16 v[178:179], v224 offset:640
s_waitcnt lgkmcnt(6)
v_mfma_f32_32x32x16_bf16 v[208:223], v[180:183], v[36:39], v[208:223]
buffer_load_dwordx4 a[80:83], v12, s[8:11], s35 offen offset:512
s_and_b32 s28, s24, 1
s_lshl_b32 s28, s28, 5
s_and_b32 s29, s16, 1
s_lshl_b32 s29, s29, 4
s_add_u32 s28, s28, s29
v_add_u32 v225, s28, v4
s_lshr_b32 s28, s24, 1
s_add_u32 s28, s28, 0
s_mul_i32 s28, s28, 81920
s_mul_i32 s29, s25, 10240
s_add_u32 s28, s28, s29
s_add_u32 s28, s28, 9293824
v_lshrrev_b32 v28, 1, v5
v_lshlrev_b32 v28, 10, v28
v_and_b32 v29, 1, v5
v_lshl_add_u32 v28, v29, 3, v28
v_lshl_add_u32 v245, v225, 4, v28
s_lshr_b32 s29, s16, 1
s_mul_i32 s29, s29, 6144
s_add_u32 s28, s28, s29
buffer_load_dwordx2 v[248:249], v245, s[8:11], s28 offen sc1
buffer_load_dwordx2 v[250:251], v245, s[8:11], s28 offen offset:2048 sc1
s_lshr_b32 s29, s16, 1
s_lshl_b32 s29, s29, 11
s_sub_u32 s28, s28, s29
s_add_u32 s28, s28, 4096
buffer_load_dwordx2 v[252:253], v245, s[8:11], s28 offen sc1
s_nop 1
ds_read_b64_tr_b16 v[180:181], v224 offset:768
ds_read_b64_tr_b16 v[182:183], v224 offset:896
s_waitcnt lgkmcnt(6)
v_mfma_f32_32x32x16_bf16 v[208:223], v[184:187], v[160:163], v[208:223]
ds_read_b64_tr_b16 v[184:185], v224 offset:1024
ds_read_b64_tr_b16 v[186:187], v224 offset:1152
s_waitcnt lgkmcnt(6)
v_mfma_f32_32x32x16_bf16 v[208:223], v[188:191], v[164:167], v[208:223]
s_add_u32 s35, s35, 12288
buffer_load_dwordx4 a[84:87], v12, s[8:11], s35 offen offset:0
v_pk_fma_f32 v[48:49], v[48:49], s[90:91], v[16:17]
v_pk_fma_f32 v[50:51], v[50:51], s[90:91], v[16:17]
v_pk_fma_f32 v[52:53], v[52:53], s[90:91], v[16:17]
v_pk_fma_f32 v[54:55], v[54:55], s[90:91], v[16:17]
v_pk_fma_f32 v[56:57], v[56:57], s[90:91], v[16:17]
v_pk_fma_f32 v[58:59], v[58:59], s[90:91], v[16:17]
v_pk_fma_f32 v[60:61], v[60:61], s[90:91], v[16:17]
v_pk_fma_f32 v[62:63], v[62:63], s[90:91], v[16:17]
buffer_load_dwordx4 a[88:91], v12, s[8:11], s35 offen offset:256
v_exp_f32 v48, v48
v_exp_f32 v49, v49
v_exp_f32 v50, v50
v_exp_f32 v51, v51
v_exp_f32 v52, v52
v_exp_f32 v53, v53
v_exp_f32 v54, v54
v_exp_f32 v55, v55
v_exp_f32 v56, v56
v_exp_f32 v57, v57
v_exp_f32 v58, v58
v_exp_f32 v59, v59
v_exp_f32 v60, v60
v_exp_f32 v61, v61
v_exp_f32 v62, v62
v_exp_f32 v63, v63
buffer_load_dwordx4 a[92:95], v12, s[8:11], s35 offen offset:512
s_nop 0
v_cvt_pk_bf16_f32 v48, v48, v49
v_cvt_pk_bf16_f32 v49, v50, v51
v_cvt_pk_bf16_f32 v50, v52, v53
v_cvt_pk_bf16_f32 v51, v54, v55
v_cvt_pk_bf16_f32 v52, v56, v57
v_cvt_pk_bf16_f32 v53, v58, v59
v_cvt_pk_bf16_f32 v54, v60, v61
v_cvt_pk_bf16_f32 v55, v62, v63
s_nop 1
ds_read_b64_tr_b16 v[188:189], v224 offset:1280
ds_read_b64_tr_b16 v[190:191], v224 offset:1408
s_waitcnt lgkmcnt(6)
v_mfma_f32_32x32x16_bf16 v[208:223], v[176:179], v[48:51], v[208:223]
ds_read_b64_tr_b16 v[176:177], v224 offset:1536
ds_read_b64_tr_b16 v[178:179], v224 offset:1664
s_waitcnt lgkmcnt(6)
v_mfma_f32_32x32x16_bf16 v[208:223], v[180:183], v[52:55], v[208:223]
s_add_u32 s35, s35, 12288
buffer_load_dwordx4 a[96:99], v12, s[8:11], s35 offen offset:0
v_pk_fma_f32 v[64:65], v[64:65], s[90:91], v[16:17]
v_pk_fma_f32 v[66:67], v[66:67], s[90:91], v[16:17]
v_pk_fma_f32 v[68:69], v[68:69], s[90:91], v[16:17]
v_pk_fma_f32 v[70:71], v[70:71], s[90:91], v[16:17]
v_pk_fma_f32 v[72:73], v[72:73], s[90:91], v[16:17]
v_pk_fma_f32 v[74:75], v[74:75], s[90:91], v[16:17]
v_pk_fma_f32 v[76:77], v[76:77], s[90:91], v[16:17]
v_pk_fma_f32 v[78:79], v[78:79], s[90:91], v[16:17]
buffer_load_dwordx4 a[100:103], v12, s[8:11], s35 offen offset:256
v_exp_f32 v64, v64
v_exp_f32 v65, v65
v_exp_f32 v66, v66
v_exp_f32 v67, v67
v_exp_f32 v68, v68
v_exp_f32 v69, v69
v_exp_f32 v70, v70
v_exp_f32 v71, v71
v_exp_f32 v72, v72
v_exp_f32 v73, v73
v_exp_f32 v74, v74
v_exp_f32 v75, v75
v_exp_f32 v76, v76
v_exp_f32 v77, v77
v_exp_f32 v78, v78
v_exp_f32 v79, v79
buffer_load_dwordx4 a[104:107], v12, s[8:11], s35 offen offset:512
s_nop 0
v_cvt_pk_bf16_f32 v64, v64, v65
v_cvt_pk_bf16_f32 v65, v66, v67
v_cvt_pk_bf16_f32 v66, v68, v69
v_cvt_pk_bf16_f32 v67, v70, v71
v_cvt_pk_bf16_f32 v68, v72, v73
v_cvt_pk_bf16_f32 v69, v74, v75
v_cvt_pk_bf16_f32 v70, v76, v77
v_cvt_pk_bf16_f32 v71, v78, v79
s_nop 1
ds_read_b64_tr_b16 v[180:181], v224 offset:1792
ds_read_b64_tr_b16 v[182:183], v224 offset:1920
s_waitcnt lgkmcnt(6)
v_mfma_f32_32x32x16_bf16 v[208:223], v[184:187], v[64:67], v[208:223]
ds_read_b64_tr_b16 v[184:185], v224 offset:2048
ds_read_b64_tr_b16 v[186:187], v224 offset:2176
s_waitcnt lgkmcnt(6)
v_mfma_f32_32x32x16_bf16 v[208:223], v[188:191], v[68:71], v[208:223]
s_add_u32 s35, s35, 12288
buffer_load_dwordx4 a[108:111], v12, s[8:11], s35 offen offset:0
s_lshr_b32 s29, s24, 2
s_lshl_b32 s29, s29, 7
s_add_u32 s94, s29, 9195520
buffer_load_dword v31, v6, s[8:11], s94 offen sc1
v_pk_fma_f32 v[80:81], v[80:81], s[90:91], v[16:17]
v_pk_fma_f32 v[82:83], v[82:83], s[90:91], v[16:17]
v_pk_fma_f32 v[84:85], v[84:85], s[90:91], v[16:17]
v_pk_fma_f32 v[86:87], v[86:87], s[90:91], v[16:17]
v_pk_fma_f32 v[88:89], v[88:89], s[90:91], v[16:17]
v_pk_fma_f32 v[90:91], v[90:91], s[90:91], v[16:17]
v_pk_fma_f32 v[92:93], v[92:93], s[90:91], v[16:17]
v_pk_fma_f32 v[94:95], v[94:95], s[90:91], v[16:17]
buffer_load_dwordx4 a[112:115], v12, s[8:11], s35 offen offset:256
v_exp_f32 v80, v80
v_exp_f32 v81, v81
v_exp_f32 v82, v82
v_exp_f32 v83, v83
v_exp_f32 v84, v84
v_exp_f32 v85, v85
v_exp_f32 v86, v86
v_exp_f32 v87, v87
v_exp_f32 v88, v88
v_exp_f32 v89, v89
v_exp_f32 v90, v90
v_exp_f32 v91, v91
v_exp_f32 v92, v92
v_exp_f32 v93, v93
v_exp_f32 v94, v94
v_exp_f32 v95, v95
buffer_load_dwordx4 a[116:119], v12, s[8:11], s35 offen offset:512
s_nop 0
v_cvt_pk_bf16_f32 v80, v80, v81
v_cvt_pk_bf16_f32 v81, v82, v83
v_cvt_pk_bf16_f32 v82, v84, v85
v_cvt_pk_bf16_f32 v83, v86, v87
v_cvt_pk_bf16_f32 v84, v88, v89
v_cvt_pk_bf16_f32 v85, v90, v91
v_cvt_pk_bf16_f32 v86, v92, v93
v_cvt_pk_bf16_f32 v87, v94, v95
s_nop 1
ds_read_b64_tr_b16 v[188:189], v224 offset:2304
ds_read_b64_tr_b16 v[190:191], v224 offset:2432
s_waitcnt lgkmcnt(6)
v_mfma_f32_32x32x16_bf16 v[208:223], v[176:179], v[80:83], v[208:223]
ds_read_b64_tr_b16 v[176:177], v224 offset:2560
ds_read_b64_tr_b16 v[178:179], v224 offset:2688
s_waitcnt lgkmcnt(6)
v_mfma_f32_32x32x16_bf16 v[208:223], v[180:183], v[84:87], v[208:223]
s_add_u32 s35, s35, 12288
buffer_load_dwordx4 a[120:123], v12, s[8:11], s35 offen offset:0
v_pk_fma_f32 v[96:97], v[96:97], s[90:91], v[16:17]
v_pk_fma_f32 v[98:99], v[98:99], s[90:91], v[16:17]
v_pk_fma_f32 v[100:101], v[100:101], s[90:91], v[16:17]
v_pk_fma_f32 v[102:103], v[102:103], s[90:91], v[16:17]
v_pk_fma_f32 v[104:105], v[104:105], s[90:91], v[16:17]
v_pk_fma_f32 v[106:107], v[106:107], s[90:91], v[16:17]
v_pk_fma_f32 v[108:109], v[108:109], s[90:91], v[16:17]
v_pk_fma_f32 v[110:111], v[110:111], s[90:91], v[16:17]
buffer_load_dwordx4 a[124:127], v12, s[8:11], s35 offen offset:256
v_exp_f32 v96, v96
v_exp_f32 v97, v97
v_exp_f32 v98, v98
v_exp_f32 v99, v99
v_exp_f32 v100, v100
v_exp_f32 v101, v101
v_exp_f32 v102, v102
v_exp_f32 v103, v103
v_exp_f32 v104, v104
v_exp_f32 v105, v105
v_exp_f32 v106, v106
v_exp_f32 v107, v107
v_exp_f32 v108, v108
v_exp_f32 v109, v109
v_exp_f32 v110, v110
v_exp_f32 v111, v111
buffer_load_dwordx4 a[128:131], v12, s[8:11], s35 offen offset:512
s_nop 0
v_cvt_pk_bf16_f32 v96, v96, v97
v_cvt_pk_bf16_f32 v97, v98, v99
v_cvt_pk_bf16_f32 v98, v100, v101
v_cvt_pk_bf16_f32 v99, v102, v103
v_cvt_pk_bf16_f32 v100, v104, v105
v_cvt_pk_bf16_f32 v101, v106, v107
v_cvt_pk_bf16_f32 v102, v108, v109
v_cvt_pk_bf16_f32 v103, v110, v111
s_nop 1
ds_read_b64_tr_b16 v[180:181], v224 offset:2816
ds_read_b64_tr_b16 v[182:183], v224 offset:2944
s_waitcnt lgkmcnt(6)
v_mfma_f32_32x32x16_bf16 v[208:223], v[184:187], v[96:99], v[208:223]
ds_read_b64_tr_b16 v[184:185], v224 offset:3072
ds_read_b64_tr_b16 v[186:187], v224 offset:3200
s_waitcnt lgkmcnt(6)
v_mfma_f32_32x32x16_bf16 v[208:223], v[188:191], v[100:103], v[208:223]
s_add_u32 s35, s35, 12288
buffer_load_dwordx4 a[132:135], v12, s[8:11], s35 offen offset:0
v_pk_fma_f32 v[112:113], v[112:113], s[90:91], v[16:17]
v_pk_fma_f32 v[114:115], v[114:115], s[90:91], v[16:17]
v_pk_fma_f32 v[116:117], v[116:117], s[90:91], v[16:17]
v_pk_fma_f32 v[118:119], v[118:119], s[90:91], v[16:17]
v_pk_fma_f32 v[120:121], v[120:121], s[90:91], v[16:17]
v_pk_fma_f32 v[122:123], v[122:123], s[90:91], v[16:17]
v_pk_fma_f32 v[124:125], v[124:125], s[90:91], v[16:17]
v_pk_fma_f32 v[126:127], v[126:127], s[90:91], v[16:17]
buffer_load_dwordx4 a[136:139], v12, s[8:11], s35 offen offset:256
v_exp_f32 v112, v112
v_exp_f32 v113, v113
v_exp_f32 v114, v114
v_exp_f32 v115, v115
v_exp_f32 v116, v116
v_exp_f32 v117, v117
v_exp_f32 v118, v118
v_exp_f32 v119, v119
v_exp_f32 v120, v120
v_exp_f32 v121, v121
v_exp_f32 v122, v122
v_exp_f32 v123, v123
v_exp_f32 v124, v124
v_exp_f32 v125, v125
v_exp_f32 v126, v126
v_exp_f32 v127, v127
buffer_load_dwordx4 a[140:143], v12, s[8:11], s35 offen offset:512
s_nop 0
v_cvt_pk_bf16_f32 v112, v112, v113
v_cvt_pk_bf16_f32 v113, v114, v115
v_cvt_pk_bf16_f32 v114, v116, v117
v_cvt_pk_bf16_f32 v115, v118, v119
v_cvt_pk_bf16_f32 v116, v120, v121
v_cvt_pk_bf16_f32 v117, v122, v123
v_cvt_pk_bf16_f32 v118, v124, v125
v_cvt_pk_bf16_f32 v119, v126, v127
s_nop 1
ds_read_b64_tr_b16 v[188:189], v224 offset:3328
ds_read_b64_tr_b16 v[190:191], v224 offset:3456
s_waitcnt lgkmcnt(6)
v_mfma_f32_32x32x16_bf16 v[208:223], v[176:179], v[112:115], v[208:223]
ds_read_b64_tr_b16 v[176:177], v224 offset:3584
ds_read_b64_tr_b16 v[178:179], v224 offset:3712
s_waitcnt lgkmcnt(6)
v_mfma_f32_32x32x16_bf16 v[208:223], v[180:183], v[116:119], v[208:223]
s_add_u32 s35, s35, 12288
buffer_load_dwordx4 a[144:147], v12, s[8:11], s35 offen offset:0
s_waitcnt vmcnt(9)
s_cmp_lg_u32 s16, 0
s_cbranch_scc1 P9
s_movk_i32 s77, 32
P10:
v_cmp_gt_u32 vcc, s77, v31
s_nop 1
s_cbranch_vccz P9
s_add_u32 s76, s76, 1
s_cmp_gt_u32 s76, 400000
s_cbranch_scc1 P9
s_sleep 4
buffer_load_dword v31, v6, s[8:11], s94 offen sc1
s_waitcnt vmcnt(0)
s_branch P10
P9:
s_barrier
s_lshr_b32 s28, s24, 1
s_add_u32 s28, s28, 0
s_mul_i32 s87, s28, 81920
s_add_u32 s87, s87, 22925312
s_mul_i32 s28, s16, 20480
s_add_u32 s87, s87, s28
s_and_b32 s28, s24, 1
s_lshl_b32 s28, s28, 9
s_add_u32 s87, s87, s28
s_add_u32 m0, s98, 0
s_add_u32 s28, s87, 1024
buffer_load_dwordx4 v8, s[8:11], s87 offen sc1 lds
buffer_load_dwordx4 v8, s[8:11], s28 offen offset:1024 sc1 lds
s_add_u32 s87, s87, 4096
s_add_u32 m0, s98, 2048
s_add_u32 s28, s87, 1024
buffer_load_dwordx4 v8, s[8:11], s87 offen sc1 lds
buffer_load_dwordx4 v8, s[8:11], s28 offen offset:1024 sc1 lds
s_add_u32 s87, s87, 4096
s_add_u32 m0, s98, 4096
s_add_u32 s28, s87, 1024
buffer_load_dwordx4 v8, s[8:11], s87 offen sc1 lds
buffer_load_dwordx4 v8, s[8:11], s28 offen offset:1024 sc1 lds
s_add_u32 s87, s87, 4096
s_add_u32 m0, s98, 6144
s_add_u32 s28, s87, 1024
buffer_load_dwordx4 v8, s[8:11], s87 offen sc1 lds
buffer_load_dwordx4 v8, s[8:11], s28 offen offset:1024 sc1 lds
s_add_u32 s87, s87, 4096
s_add_u32 m0, s98, 8192
s_add_u32 s28, s87, 1024
buffer_load_dwordx4 v8, s[8:11], s87 offen sc1 lds
buffer_load_dwordx4 v8, s[8:11], s28 offen offset:1024 sc1 lds
s_add_u32 s87, s87, 4096
v_pk_fma_f32 v[128:129], v[128:129], s[90:91], v[16:17]
v_pk_fma_f32 v[130:131], v[130:131], s[90:91], v[16:17]
v_pk_fma_f32 v[132:133], v[132:133], s[90:91], v[16:17]
v_pk_fma_f32 v[134:135], v[134:135], s[90:91], v[16:17]
v_pk_fma_f32 v[136:137], v[136:137], s[90:91], v[16:17]
v_pk_fma_f32 v[138:139], v[138:139], s[90:91], v[16:17]
v_pk_fma_f32 v[140:141], v[140:141], s[90:91], v[16:17]
v_pk_fma_f32 v[142:143], v[142:143], s[90:91], v[16:17]
buffer_load_dwordx4 a[148:151], v12, s[8:11], s35 offen offset:256
v_exp_f32 v128, v128
v_exp_f32 v129, v129
v_exp_f32 v130, v130
v_exp_f32 v131, v131
v_exp_f32 v132, v132
v_exp_f32 v133, v133
v_exp_f32 v134, v134
v_exp_f32 v135, v135
v_exp_f32 v136, v136
v_exp_f32 v137, v137
v_exp_f32 v138, v138
v_exp_f32 v139, v139
v_exp_f32 v140, v140
v_exp_f32 v141, v141
v_exp_f32 v142, v142
v_exp_f32 v143, v143
buffer_load_dwordx4 a[152:155], v12, s[8:11], s35 offen offset:512
s_nop 0
v_cvt_pk_bf16_f32 v128, v128, v129
v_cvt_pk_bf16_f32 v129, v130, v131
v_cvt_pk_bf16_f32 v130, v132, v133
v_cvt_pk_bf16_f32 v131, v134, v135
v_cvt_pk_bf16_f32 v132, v136, v137
v_cvt_pk_bf16_f32 v133, v138, v139
v_cvt_pk_bf16_f32 v134, v140, v141
v_cvt_pk_bf16_f32 v135, v142, v143
s_nop 1
ds_read_b64_tr_b16 v[180:181], v224 offset:3840
ds_read_b64_tr_b16 v[182:183], v224 offset:3968
s_waitcnt lgkmcnt(6)
v_mfma_f32_32x32x16_bf16 v[208:223], v[184:187], v[128:131], v[208:223]
s_waitcnt lgkmcnt(4)
v_mfma_f32_32x32x16_bf16 v[208:223], v[188:191], v[132:135], v[208:223]
s_add_u32 s35, s35, 12288
buffer_load_dwordx4 a[156:159], v12, s[8:11], s35 offen offset:0
v_pk_fma_f32 v[144:145], v[144:145], s[90:91], v[16:17]
v_pk_fma_f32 v[146:147], v[146:147], s[90:91], v[16:17]
v_pk_fma_f32 v[148:149], v[148:149], s[90:91], v[16:17]
v_pk_fma_f32 v[150:151], v[150:151], s[90:91], v[16:17]
v_pk_fma_f32 v[152:153], v[152:153], s[90:91], v[16:17]
v_pk_fma_f32 v[154:155], v[154:155], s[90:91], v[16:17]
v_pk_fma_f32 v[156:157], v[156:157], s[90:91], v[16:17]
v_pk_fma_f32 v[158:159], v[158:159], s[90:91], v[16:17]
v_exp_f32 v144, v144
v_exp_f32 v145, v145
v_exp_f32 v146, v146
v_exp_f32 v147, v147
v_exp_f32 v148, v148
v_exp_f32 v149, v149
v_exp_f32 v150, v150
v_exp_f32 v151, v151
v_exp_f32 v152, v152
v_exp_f32 v153, v153
v_exp_f32 v154, v154
v_exp_f32 v155, v155
v_exp_f32 v156, v156
v_exp_f32 v157, v157
v_exp_f32 v158, v158
v_exp_f32 v159, v159
s_nop 0
v_cvt_pk_bf16_f32 v144, v144, v145
v_cvt_pk_bf16_f32 v145, v146, v147
v_cvt_pk_bf16_f32 v146, v148, v149
v_cvt_pk_bf16_f32 v147, v150, v151
v_cvt_pk_bf16_f32 v148, v152, v153
v_cvt_pk_bf16_f32 v149, v154, v155
v_cvt_pk_bf16_f32 v150, v156, v157
v_cvt_pk_bf16_f32 v151, v158, v159
s_nop 1
s_waitcnt lgkmcnt(2)
v_mfma_f32_32x32x16_bf16 v[208:223], v[176:179], v[144:147], v[208:223]
s_waitcnt lgkmcnt(0)
v_mfma_f32_32x32x16_bf16 v[208:223], v[180:183], v[148:151], v[208:223]
s_lshl_b32 s28, s23, 7
s_add_u32 s28, s28, 1024
s_lshl_b32 s29, s16, 5
s_add_u32 s28, s28, s29
v_add_u32 v18, s28, v2
v_lshrrev_b32 v19, 6, v18
s_mov_b32 s29, 81920
v_mul_lo_u32 v19, v19, s29
v_and_b32 v18, 63, v18
v_lshl_add_u32 v19, v18, 4, v19
v_add_u32 v18, s39, v3
v_lshl_add_u32 v26, v18, 10, v19
s_add_u32 s29, s38, 4
s_lshl_b32 s29, s29, 10
s_add_u32 s29, s29, s31
v_add_u32 v27, s29, v19
s_nop 5
v_mov_b32 v16, v216
v_mov_b32 v17, v216
s_nop 1
v_permlane32_swap_b32 v16, v17
s_nop 0
v_rcp_f32 v17, v17
s_nop 0
v_mul_f32 v208, v208, v17
v_mul_f32 v209, v209, v17
v_mul_f32 v210, v210, v17
v_mul_f32 v211, v211, v17
v_mul_f32 v212, v212, v17
v_mul_f32 v213, v213, v17
v_mul_f32 v214, v214, v17
v_mul_f32 v215, v215, v17
v_mul_f32 v216, v216, v17
v_mul_f32 v217, v217, v17
v_mul_f32 v218, v218, v17
v_mul_f32 v219, v219, v17
v_cvt_pk_bf16_f32 v20, v208, v209
v_cvt_pk_bf16_f32 v21, v210, v211
v_cvt_pk_bf16_f32 v22, v212, v213
v_cvt_pk_bf16_f32 v23, v214, v215
v_cvt_pk_bf16_f32 v24, v216, v217
v_cvt_pk_bf16_f32 v25, v218, v219
s_mov_b32 s28, 22925312
v_permlane32_swap_b32 v20, v22
v_permlane32_swap_b32 v21, v23
s_nop 0
buffer_store_dwordx4 v[20:23], v26, s[8:11], s28 offen sc1
s_mov_b64 exec, s[74:75]
buffer_store_dwordx2 v[24:25], v27, s[8:11], s28 offen sc1
s_mov_b64 exec, -1
s_barrier
s_and_b32 s28, s24, 1
s_lshl_b32 s28, s28, 5
s_and_b32 s29, s16, 1
s_lshl_b32 s29, s29, 4
s_add_u32 s28, s28, s29
v_add_u32 v244, s28, v4
s_lshr_b32 s28, s24, 1
s_add_u32 s28, s28, 16
s_mul_i32 s28, s28, 81920
s_mul_i32 s29, s25, 10240
s_add_u32 s28, s28, s29
s_add_u32 s28, s28, 9293824
v_lshrrev_b32 v28, 1, v5
v_lshlrev_b32 v28, 10, v28
v_and_b32 v29, 1, v5
v_lshl_add_u32 v28, v29, 3, v28
v_lshl_add_u32 v246, v244, 4, v28
s_lshr_b32 s29, s16, 1
s_mul_i32 s29, s29, 6144
s_add_u32 s28, s28, s29
buffer_load_dwordx2 v[232:233], v246, s[8:11], s28 offen sc1
buffer_load_dwordx2 v[234:235], v246, s[8:11], s28 offen offset:2048 sc1
s_lshr_b32 s29, s16, 1
s_lshl_b32 s29, s29, 11
s_sub_u32 s28, s28, s29
s_add_u32 s28, s28, 4096
buffer_load_dwordx2 v[236:237], v246, s[8:11], s28 offen sc1
v_add_u32 v238, s98, v227
v_add_u32 v239, s98, v226
s_waitcnt vmcnt(16)
ds_read_b128 v[32:35], v238 offset:0
ds_read_b128 v[36:39], v239 offset:0
s_waitcnt vmcnt(14)
ds_read_b128 v[40:43], v238 offset:2048
ds_read_b128 v[44:47], v239 offset:2048
s_waitcnt lgkmcnt(2)
v_mfma_f32_16x16x32_bf16 v[48:51], a[160:163], v[32:35], 0
v_mfma_f32_16x16x32_bf16 v[68:71], a[160:163], v[36:39], 0
v_mfma_f32_16x16x32_bf16 v[52:55], a[164:167], v[32:35], 0
v_mfma_f32_16x16x32_bf16 v[72:75], a[164:167], v[36:39], 0
v_mfma_f32_16x16x32_bf16 v[56:59], a[168:171], v[32:35], 0
v_mfma_f32_16x16x32_bf16 v[76:79], a[168:171], v[36:39], 0
v_mfma_f32_16x16x32_bf16 v[60:63], a[172:175], v[32:35], 0
v_mfma_f32_16x16x32_bf16 v[80:83], a[172:175], v[36:39], 0
v_mfma_f32_16x16x32_bf16 v[64:67], a[176:179], v[32:35], 0
v_mfma_f32_16x16x32_bf16 v[84:87], a[176:179], v[36:39], 0
s_lshl_b32 s28, s23, 7
s_add_u32 s28, s28, 9196544
s_waitcnt vmcnt(3)
s_barrier
s_cmp_lg_u32 s16, 0
s_cbranch_scc1 S11
s_mov_b64 exec, 1
buffer_atomic_add v7, v6, s[8:11], s28 offen sc1
s_mov_b64 exec, -1
S11:
ds_read_b128 v[32:35], v238 offset:4096
ds_read_b128 v[36:39], v239 offset:4096
s_waitcnt lgkmcnt(2)
v_mfma_f32_16x16x32_bf16 v[48:51], a[180:183], v[40:43], v[48:51]
v_mfma_f32_16x16x32_bf16 v[68:71], a[180:183], v[44:47], v[68:71]
v_mfma_f32_16x16x32_bf16 v[52:55], a[184:187], v[40:43], v[52:55]
v_mfma_f32_16x16x32_bf16 v[72:75], a[184:187], v[44:47], v[72:75]
v_mfma_f32_16x16x32_bf16 v[56:59], a[188:191], v[40:43], v[56:59]
v_mfma_f32_16x16x32_bf16 v[76:79], a[188:191], v[44:47], v[76:79]
v_mfma_f32_16x16x32_bf16 v[60:63], a[192:195], v[40:43], v[60:63]
v_mfma_f32_16x16x32_bf16 v[80:83], a[192:195], v[44:47], v[80:83]
v_mfma_f32_16x16x32_bf16 v[64:67], a[196:199], v[40:43], v[64:67]
v_mfma_f32_16x16x32_bf16 v[84:87], a[196:199], v[44:47], v[84:87]
ds_read_b128 v[40:43], v238 offset:6144
ds_read_b128 v[44:47], v239 offset:6144
s_waitcnt lgkmcnt(2)
v_mfma_f32_16x16x32_bf16 v[48:51], a[200:203], v[32:35], v[48:51]
v_mfma_f32_16x16x32_bf16 v[68:71], a[200:203], v[36:39], v[68:71]
v_mfma_f32_16x16x32_bf16 v[52:55], a[204:207], v[32:35], v[52:55]
v_mfma_f32_16x16x32_bf16 v[72:75], a[204:207], v[36:39], v[72:75]
v_mfma_f32_16x16x32_bf16 v[56:59], a[208:211], v[32:35], v[56:59]
v_mfma_f32_16x16x32_bf16 v[76:79], a[208:211], v[36:39], v[76:79]
v_mfma_f32_16x16x32_bf16 v[60:63], a[212:215], v[32:35], v[60:63]
v_mfma_f32_16x16x32_bf16 v[80:83], a[212:215], v[36:39], v[80:83]
v_mfma_f32_16x16x32_bf16 v[64:67], a[216:219], v[32:35], v[64:67]
v_mfma_f32_16x16x32_bf16 v[84:87], a[216:219], v[36:39], v[84:87]
ds_read_b128 v[32:35], v238 offset:8192
ds_read_b128 v[36:39], v239 offset:8192
s_waitcnt lgkmcnt(2)
v_mfma_f32_16x16x32_bf16 v[48:51], a[220:223], v[40:43], v[48:51]
v_mfma_f32_16x16x32_bf16 v[68:71], a[220:223], v[44:47], v[68:71]
v_mfma_f32_16x16x32_bf16 v[52:55], a[224:227], v[40:43], v[52:55]
v_mfma_f32_16x16x32_bf16 v[72:75], a[224:227], v[44:47], v[72:75]
v_mfma_f32_16x16x32_bf16 v[56:59], a[228:231], v[40:43], v[56:59]
v_mfma_f32_16x16x32_bf16 v[76:79], a[228:231], v[44:47], v[76:79]
v_mfma_f32_16x16x32_bf16 v[60:63], a[232:235], v[40:43], v[60:63]
v_mfma_f32_16x16x32_bf16 v[80:83], a[232:235], v[44:47], v[80:83]
v_mfma_f32_16x16x32_bf16 v[64:67], a[236:239], v[40:43], v[64:67]
v_mfma_f32_16x16x32_bf16 v[84:87], a[236:239], v[44:47], v[84:87]
s_waitcnt lgkmcnt(0)
v_mfma_f32_16x16x32_bf16 v[48:51], a[240:243], v[32:35], v[48:51]
v_mfma_f32_16x16x32_bf16 v[68:71], a[240:243], v[36:39], v[68:71]
v_mfma_f32_16x16x32_bf16 v[52:55], a[244:247], v[32:35], v[52:55]
v_mfma_f32_16x16x32_bf16 v[72:75], a[244:247], v[36:39], v[72:75]
v_mfma_f32_16x16x32_bf16 v[56:59], a[248:251], v[32:35], v[56:59]
v_mfma_f32_16x16x32_bf16 v[76:79], a[248:251], v[36:39], v[76:79]
v_mfma_f32_16x16x32_bf16 v[60:63], a[252:255], v[32:35], v[60:63]
v_mfma_f32_16x16x32_bf16 v[80:83], a[252:255], v[36:39], v[80:83]
v_mfma_f32_16x16x32_bf16 v[64:67], v[228:231], v[32:35], v[64:67]
v_mfma_f32_16x16x32_bf16 v[84:87], v[228:231], v[36:39], v[84:87]
s_lshr_b32 s28, s24, 1
s_add_u32 s28, s28, 0
s_mul_i32 s88, s28, 81920
s_mul_i32 s29, s25, 10240
s_add_u32 s88, s88, s29
s_barrier
s_mul_i32 s28, s16, 10240
s_add_u32 s28, s28, 65536
s_and_b32 s29, s16, 1
s_mul_i32 s29, s29, 5120
s_add_u32 s90, s28, s29
v_add_u32 v24, s90, v1
s_xor_b32 s29, s29, 5120
s_add_u32 s90, s28, s29
v_add_u32 v25, s90, v1
s_cmp_ge_u32 s16, 2
s_cbranch_scc1 V13
s_nop 1
ds_write_b128 v25, v[68:71] offset:0
ds_write_b128 v25, v[72:75] offset:1024
ds_write_b128 v25, v[76:79] offset:2048
ds_write_b128 v24, v[60:63] offset:3072
ds_write_b128 v25, v[80:83] offset:3072
ds_write_b128 v24, v[64:67] offset:4096
ds_write_b128 v25, v[84:87] offset:4096
s_waitcnt lgkmcnt(0)
s_barrier
s_add_u32 s28, s16, 1
s_and_b32 s28, s28, 3
s_mul_i32 s28, s28, 10240
s_and_b32 s29, s16, 1
s_mul_i32 s29, s29, 5120
s_add_u32 s28, s28, s29
s_add_u32 s28, s28, 65536
v_add_u32 v26, s28, v1
ds_read_b128 v[88:91], v26 offset:0
ds_read_b128 v[92:95], v26 offset:1024
ds_read_b128 v[96:99], v26 offset:2048
s_add_u32 s28, s16, 2
s_and_b32 s28, s28, 3
s_mul_i32 s28, s28, 10240
s_and_b32 s29, s16, 1
s_mul_i32 s29, s29, 5120
s_add_u32 s28, s28, s29
s_add_u32 s28, s28, 65536
v_add_u32 v26, s28, v1
ds_read_b128 v[100:103], v26 offset:0
ds_read_b128 v[104:107], v26 offset:1024
ds_read_b128 v[108:111], v26 offset:2048
s_add_u32 s28, s16, 3
s_and_b32 s28, s28, 3
s_mul_i32 s28, s28, 10240
s_and_b32 s29, s16, 1
s_mul_i32 s29, s29, 5120
s_add_u32 s28, s28, s29
s_add_u32 s28, s28, 65536
v_add_u32 v26, s28, v1
ds_read_b128 v[112:115], v26 offset:0
ds_read_b128 v[116:119], v26 offset:1024
ds_read_b128 v[120:123], v26 offset:2048
s_waitcnt lgkmcnt(6)
v_add_f32 v48, v48, v88
v_add_f32 v49, v49, v89
v_add_f32 v50, v50, v90
v_add_f32 v51, v51, v91
v_add_f32 v52, v52, v92
v_add_f32 v53, v53, v93
v_add_f32 v54, v54, v94
v_add_f32 v55, v55, v95
v_add_f32 v56, v56, v96
v_add_f32 v57, v57, v97
v_add_f32 v58, v58, v98
v_add_f32 v59, v59, v99
s_waitcnt lgkmcnt(3)
v_add_f32 v48, v48, v100
v_add_f32 v49, v49, v101
v_add_f32 v50, v50, v102
v_add_f32 v51, v51, v103
v_add_f32 v52, v52, v104
v_add_f32 v53, v53, v105
v_add_f32 v54, v54, v106
v_add_f32 v55, v55, v107
v_add_f32 v56, v56, v108
v_add_f32 v57, v57, v109
v_add_f32 v58, v58, v110
v_add_f32 v59, v59, v111
s_waitcnt lgkmcnt(0)
v_add_f32 v48, v48, v112
v_add_f32 v49, v49, v113
v_add_f32 v50, v50, v114
v_add_f32 v51, v51, v115
v_add_f32 v52, v52, v116
v_add_f32 v53, v53, v117
v_add_f32 v54, v54, v118
v_add_f32 v55, v55, v119
v_add_f32 v56, v56, v120
v_add_f32 v57, v57, v121
v_add_f32 v58, v58, v122
v_add_f32 v59, v59, v123
v_lshlrev_b32 v26, 16, v248
v_and_b32 v27, 0xffff0000, v248
v_add_f32 v48, v48, v26
v_add_f32 v49, v49, v27
v_cvt_pk_bf16_f32 v248, v48, v49
v_lshlrev_b32 v26, 16, v249
v_and_b32 v27, 0xffff0000, v249
v_add_f32 v50, v50, v26
v_add_f32 v51, v51, v27
v_cvt_pk_bf16_f32 v249, v50, v51
v_lshlrev_b32 v26, 16, v250
v_and_b32 v27, 0xffff0000, v250
v_add_f32 v52, v52, v26
v_add_f32 v53, v53, v27
v_cvt_pk_bf16_f32 v250, v52, v53
v_lshlrev_b32 v26, 16, v251
v_and_b32 v27, 0xffff0000, v251
v_add_f32 v54, v54, v26
v_add_f32 v55, v55, v27
v_cvt_pk_bf16_f32 v251, v54, v55
v_lshlrev_b32 v26, 16, v252
v_and_b32 v27, 0xffff0000, v252
v_add_f32 v56, v56, v26
v_add_f32 v57, v57, v27
v_cvt_pk_bf16_f32 v252, v56, v57
v_lshlrev_b32 v26, 16, v253
v_and_b32 v27, 0xffff0000, v253
v_add_f32 v58, v58, v26
v_add_f32 v59, v59, v27
v_cvt_pk_bf16_f32 v253, v58, v59
v_mov_b32 v28, 0x3f803f80
v_mov_b32 v26, 0
v_mov_b32 v27, 0
v_dot2_f32_bf16 v26, v248, v28, v26
v_dot2_f32_bf16 v27, v248, v248, v27
v_dot2_f32_bf16 v26, v249, v28, v26
v_dot2_f32_bf16 v27, v249, v249, v27
v_dot2_f32_bf16 v26, v250, v28, v26
v_dot2_f32_bf16 v27, v250, v250, v27
v_dot2_f32_bf16 v26, v251, v28, v26
v_dot2_f32_bf16 v27, v251, v251, v27
v_dot2_f32_bf16 v26, v252, v28, v26
v_dot2_f32_bf16 v27, v252, v252, v27
v_dot2_f32_bf16 v26, v253, v28, v26
v_dot2_f32_bf16 v27, v253, v253, v27
s_add_u32 s89, s88, 11915264
s_add_u32 s91, s89, 4096
buffer_store_dwordx2 v[252:253], v245, s[8:11], s91 offen sc1
v_and_b32 v29, 1, v5
v_lshlrev_b32 v29, 1, v29
v_lshrrev_b32 v30, 1, v5
v_add_u32 v29, v29, v30
v_lshlrev_b32 v29, 10, v29
v_lshl_add_u32 v29, v225, 4, v29
v_permlane16_swap_b32 v248, v250
v_permlane16_swap_b32 v249, v251
s_nop 0
buffer_store_dwordx4 v[248:251], v29, s[8:11], s89 offen offset:0 sc1
v_mov_b32 v28, v26
v_mov_b32 v30, v27
s_nop 1
v_permlane16_swap_b32 v26, v28
v_permlane16_swap_b32 v27, v30
s_nop 0
v_add_f32 v26, v26, v28
v_add_f32 v27, v27, v30
v_mov_b32 v28, v26
v_mov_b32 v30, v27
s_nop 1
v_permlane32_swap_b32 v26, v28
v_permlane32_swap_b32 v27, v30
s_nop 0
v_add_f32 v26, v26, v28
v_add_f32 v27, v27, v30
s_lshr_b32 s28, s24, 1
s_add_u32 s28, s28, 0
s_lshl_b32 s28, s28, 6
v_add_u32 v28, s28, v225
v_lshlrev_b32 v28, 4, v28
s_lshl_b32 s28, s25, 15
s_add_u32 s28, s28, 14798848
v_cmp_gt_u32 vcc, 16, v0
s_and_saveexec_b64 s[92:93], vcc
buffer_store_dwordx2 v[26:27], v28, s[8:11], s28 offen sc1
s_mov_b64 exec, -1
s_branch V12
V13:
s_nop 1
ds_write_b128 v24, v[48:51] offset:0
ds_write_b128 v25, v[68:71] offset:0
ds_write_b128 v24, v[52:55] offset:1024
ds_write_b128 v25, v[72:75] offset:1024
ds_write_b128 v24, v[56:59] offset:2048
ds_write_b128 v25, v[76:79] offset:2048
ds_write_b128 v25, v[80:83] offset:3072
ds_write_b128 v25, v[84:87] offset:4096
s_waitcnt lgkmcnt(0)
s_barrier
s_add_u32 s28, s16, 1
s_and_b32 s28, s28, 3
s_mul_i32 s28, s28, 10240
s_and_b32 s29, s16, 1
s_mul_i32 s29, s29, 5120
s_add_u32 s28, s28, s29
s_add_u32 s28, s28, 65536
v_add_u32 v26, s28, v1
ds_read_b128 v[88:91], v26 offset:3072
ds_read_b128 v[92:95], v26 offset:4096
s_add_u32 s28, s16, 2
s_and_b32 s28, s28, 3
s_mul_i32 s28, s28, 10240
s_and_b32 s29, s16, 1
s_mul_i32 s29, s29, 5120
s_add_u32 s28, s28, s29
s_add_u32 s28, s28, 65536
v_add_u32 v26, s28, v1
ds_read_b128 v[100:103], v26 offset:3072
ds_read_b128 v[104:107], v26 offset:4096
s_add_u32 s28, s16, 3
s_and_b32 s28, s28, 3
s_mul_i32 s28, s28, 10240
s_and_b32 s29, s16, 1
s_mul_i32 s29, s29, 5120
s_add_u32 s28, s28, s29
s_add_u32 s28, s28, 65536
v_add_u32 v26, s28, v1
ds_read_b128 v[112:115], v26 offset:3072
ds_read_b128 v[116:119], v26 offset:4096
s_waitcnt lgkmcnt(4)
v_add_f32 v60, v60, v88
v_add_f32 v61, v61, v89
v_add_f32 v62, v62, v90
v_add_f32 v63, v63, v91
v_add_f32 v64, v64, v92
v_add_f32 v65, v65, v93
v_add_f32 v66, v66, v94
v_add_f32 v67, v67, v95
s_waitcnt lgkmcnt(2)
v_add_f32 v60, v60, v100
v_add_f32 v61, v61, v101
v_add_f32 v62, v62, v102
v_add_f32 v63, v63, v103
v_add_f32 v64, v64, v104
v_add_f32 v65, v65, v105
v_add_f32 v66, v66, v106
v_add_f32 v67, v67, v107
s_waitcnt lgkmcnt(0)
v_add_f32 v60, v60, v112
v_add_f32 v61, v61, v113
v_add_f32 v62, v62, v114
v_add_f32 v63, v63, v115
v_add_f32 v64, v64, v116
v_add_f32 v65, v65, v117
v_add_f32 v66, v66, v118
v_add_f32 v67, v67, v119
v_lshlrev_b32 v26, 16, v248
v_and_b32 v27, 0xffff0000, v248
v_add_f32 v60, v60, v26
v_add_f32 v61, v61, v27
v_cvt_pk_bf16_f32 v248, v60, v61
v_lshlrev_b32 v26, 16, v249
v_and_b32 v27, 0xffff0000, v249
v_add_f32 v62, v62, v26
v_add_f32 v63, v63, v27
v_cvt_pk_bf16_f32 v249, v62, v63
v_lshlrev_b32 v26, 16, v250
v_and_b32 v27, 0xffff0000, v250
v_add_f32 v64, v64, v26
v_add_f32 v65, v65, v27
v_cvt_pk_bf16_f32 v250, v64, v65
v_lshlrev_b32 v26, 16, v251
v_and_b32 v27, 0xffff0000, v251
v_add_f32 v66, v66, v26
v_add_f32 v67, v67, v27
v_cvt_pk_bf16_f32 v251, v66, v67
v_mov_b32 v28, 0x3f803f80
v_mov_b32 v26, 0
v_mov_b32 v27, 0
v_dot2_f32_bf16 v26, v248, v28, v26
v_dot2_f32_bf16 v27, v248, v248, v27
v_dot2_f32_bf16 v26, v249, v28, v26
v_dot2_f32_bf16 v27, v249, v249, v27
v_dot2_f32_bf16 v26, v250, v28, v26
v_dot2_f32_bf16 v27, v250, v250, v27
v_dot2_f32_bf16 v26, v251, v28, v26
v_dot2_f32_bf16 v27, v251, v251, v27
s_add_u32 s89, s88, 11915264
v_and_b32 v29, 1, v5
v_lshlrev_b32 v29, 1, v29
v_lshrrev_b32 v30, 1, v5
v_add_u32 v29, v29, v30
v_lshlrev_b32 v29, 10, v29
v_lshl_add_u32 v29, v225, 4, v29
v_permlane16_swap_b32 v248, v250
v_permlane16_swap_b32 v249, v251
s_add_u32 s91, s89, 4096
s_nop 0
buffer_store_dwordx4 v[248:251], v29, s[8:11], s91 offen offset:2048 sc1
v_mov_b32 v28, v26
v_mov_b32 v30, v27
s_nop 1
v_permlane16_swap_b32 v26, v28
v_permlane16_swap_b32 v27, v30
s_nop 0
v_add_f32 v26, v26, v28
v_add_f32 v27, v27, v30
v_mov_b32 v28, v26
v_mov_b32 v30, v27
s_nop 1
v_permlane32_swap_b32 v26, v28
v_permlane32_swap_b32 v27, v30
s_nop 0
v_add_f32 v26, v26, v28
v_add_f32 v27, v27, v30
s_lshr_b32 s28, s24, 1
s_add_u32 s28, s28, 0
s_lshl_b32 s28, s28, 6
v_add_u32 v28, s28, v225
v_lshlrev_b32 v28, 4, v28
s_lshl_b32 s28, s25, 15
s_add_u32 s28, s28, 14798856
v_cmp_gt_u32 vcc, 16, v0
s_and_saveexec_b64 s[92:93], vcc
buffer_store_dwordx2 v[26:27], v28, s[8:11], s28 offen sc1
s_mov_b64 exec, -1
V12:
s_lshr_b32 s29, s24, 2
s_lshl_b32 s29, s29, 7
s_add_u32 s94, s29, 9196544
buffer_load_dword v31, v6, s[8:11], s94 offen sc1
s_waitcnt vmcnt(0)
s_cmp_lg_u32 s16, 0
s_cbranch_scc1 P14
s_movk_i32 s77, 32
P15:
v_cmp_gt_u32 vcc, s77, v31
s_nop 1
s_cbranch_vccz P14
s_add_u32 s76, s76, 1
s_cmp_gt_u32 s76, 400000
s_cbranch_scc1 P14
s_sleep 4
buffer_load_dword v31, v6, s[8:11], s94 offen sc1
s_waitcnt vmcnt(0)
s_branch P15
P14:
s_barrier
s_lshr_b32 s28, s24, 1
s_add_u32 s28, s28, 16
s_mul_i32 s87, s28, 81920
s_add_u32 s87, s87, 22925312
s_mul_i32 s28, s16, 20480
s_add_u32 s87, s87, s28
s_and_b32 s28, s24, 1
s_lshl_b32 s28, s28, 9
s_add_u32 s87, s87, s28
s_add_u32 m0, s99, 0
s_add_u32 s28, s87, 1024
buffer_load_dwordx4 v8, s[8:11], s87 offen sc1 lds
buffer_load_dwordx4 v8, s[8:11], s28 offen offset:1024 sc1 lds
s_add_u32 s87, s87, 4096
s_add_u32 m0, s99, 2048
s_add_u32 s28, s87, 1024
buffer_load_dwordx4 v8, s[8:11], s87 offen sc1 lds
buffer_load_dwordx4 v8, s[8:11], s28 offen offset:1024 sc1 lds
s_add_u32 s87, s87, 4096
s_add_u32 m0, s99, 4096
s_add_u32 s28, s87, 1024
buffer_load_dwordx4 v8, s[8:11], s87 offen sc1 lds
buffer_load_dwordx4 v8, s[8:11], s28 offen offset:1024 sc1 lds
s_add_u32 s87, s87, 4096
s_add_u32 m0, s99, 6144
s_add_u32 s28, s87, 1024
buffer_load_dwordx4 v8, s[8:11], s87 offen sc1 lds
buffer_load_dwordx4 v8, s[8:11], s28 offen offset:1024 sc1 lds
s_add_u32 s87, s87, 4096
s_add_u32 m0, s99, 8192
s_add_u32 s28, s87, 1024
buffer_load_dwordx4 v8, s[8:11], s87 offen sc1 lds
buffer_load_dwordx4 v8, s[8:11], s28 offen offset:1024 sc1 lds
s_add_u32 s87, s87, 4096
v_add_u32 v238, s99, v227
v_add_u32 v239, s99, v226
s_waitcnt vmcnt(8)
ds_read_b128 v[32:35], v238 offset:0
ds_read_b128 v[36:39], v239 offset:0
s_lshr_b32 s28, s24, 1
s_lshl_b32 s28, s28, 7
s_add_u32 s28, s28, 9197568
s_barrier
s_cmp_lg_u32 s16, 0
s_cbranch_scc1 S16
s_mov_b64 exec, 1
buffer_atomic_add v7, v6, s[8:11], s28 offen sc1
s_mov_b64 exec, -1
S16:
s_waitcnt vmcnt(6)
ds_read_b128 v[40:43], v238 offset:2048
ds_read_b128 v[44:47], v239 offset:2048
s_waitcnt lgkmcnt(2)
v_mfma_f32_16x16x32_bf16 v[48:51], a[160:163], v[32:35], 0
v_mfma_f32_16x16x32_bf16 v[68:71], a[160:163], v[36:39], 0
buffer_load_dwordx4 a[160:163], v12, s[8:11], s35 offen offset:256
v_mfma_f32_16x16x32_bf16 v[52:55], a[164:167], v[32:35], 0
v_mfma_f32_16x16x32_bf16 v[72:75], a[164:167], v[36:39], 0
buffer_load_dwordx4 a[164:167], v12, s[8:11], s35 offen offset:512
v_mfma_f32_16x16x32_bf16 v[56:59], a[168:171], v[32:35], 0
v_mfma_f32_16x16x32_bf16 v[76:79], a[168:171], v[36:39], 0
s_add_u32 s35, s35, 12288
buffer_load_dwordx4 a[168:171], v12, s[8:11], s35 offen offset:0
v_mfma_f32_16x16x32_bf16 v[60:63], a[172:175], v[32:35], 0
v_mfma_f32_16x16x32_bf16 v[80:83], a[172:175], v[36:39], 0
buffer_load_dwordx4 a[172:175], v12, s[8:11], s35 offen offset:256
v_mfma_f32_16x16x32_bf16 v[64:67], a[176:179], v[32:35], 0
v_mfma_f32_16x16x32_bf16 v[84:87], a[176:179], v[36:39], 0
buffer_load_dwordx4 a[176:179], v12, s[8:11], s35 offen offset:512
s_waitcnt vmcnt(9)
ds_read_b128 v[32:35], v238 offset:4096
ds_read_b128 v[36:39], v239 offset:4096
s_waitcnt lgkmcnt(2)
v_mfma_f32_16x16x32_bf16 v[48:51], a[180:183], v[40:43], v[48:51]
v_mfma_f32_16x16x32_bf16 v[68:71], a[180:183], v[44:47], v[68:71]
s_add_u32 s35, s35, 12288
buffer_load_dwordx4 a[180:183], v12, s[8:11], s35 offen offset:0
v_mfma_f32_16x16x32_bf16 v[52:55], a[184:187], v[40:43], v[52:55]
v_mfma_f32_16x16x32_bf16 v[72:75], a[184:187], v[44:47], v[72:75]
buffer_load_dwordx4 a[184:187], v12, s[8:11], s35 offen offset:256
v_mfma_f32_16x16x32_bf16 v[56:59], a[188:191], v[40:43], v[56:59]
v_mfma_f32_16x16x32_bf16 v[76:79], a[188:191], v[44:47], v[76:79]
buffer_load_dwordx4 a[188:191], v12, s[8:11], s35 offen offset:512
v_mfma_f32_16x16x32_bf16 v[60:63], a[192:195], v[40:43], v[60:63]
v_mfma_f32_16x16x32_bf16 v[80:83], a[192:195], v[44:47], v[80:83]
s_add_u32 s35, s35, 12288
buffer_load_dwordx4 a[192:195], v12, s[8:11], s35 offen offset:0
v_mfma_f32_16x16x32_bf16 v[64:67], a[196:199], v[40:43], v[64:67]
v_mfma_f32_16x16x32_bf16 v[84:87], a[196:199], v[44:47], v[84:87]
buffer_load_dwordx4 a[196:199], v12, s[8:11], s35 offen offset:256
s_waitcnt vmcnt(12)
ds_read_b128 v[40:43], v238 offset:6144
ds_read_b128 v[44:47], v239 offset:6144
s_waitcnt lgkmcnt(2)
v_mfma_f32_16x16x32_bf16 v[48:51], a[200:203], v[32:35], v[48:51]
v_mfma_f32_16x16x32_bf16 v[68:71], a[200:203], v[36:39], v[68:71]
buffer_load_dwordx4 a[200:203], v12, s[8:11], s35 offen offset:512
v_mfma_f32_16x16x32_bf16 v[52:55], a[204:207], v[32:35], v[52:55]
v_mfma_f32_16x16x32_bf16 v[72:75], a[204:207], v[36:39], v[72:75]
s_add_u32 s35, s35, 12288
buffer_load_dwordx4 a[204:207], v12, s[8:11], s35 offen offset:0
v_mfma_f32_16x16x32_bf16 v[56:59], a[208:211], v[32:35], v[56:59]
v_mfma_f32_16x16x32_bf16 v[76:79], a[208:211], v[36:39], v[76:79]
buffer_load_dwordx4 a[208:211], v12, s[8:11], s35 offen offset:256
v_mfma_f32_16x16x32_bf16 v[60:63], a[212:215], v[32:35], v[60:63]
v_mfma_f32_16x16x32_bf16 v[80:83], a[212:215], v[36:39], v[80:83]
buffer_load_dwordx4 a[212:215], v12, s[8:11], s35 offen offset:512
v_mfma_f32_16x16x32_bf16 v[64:67], a[216:219], v[32:35], v[64:67]
v_mfma_f32_16x16x32_bf16 v[84:87], a[216:219], v[36:39], v[84:87]
s_add_u32 s35, s35, 12288
buffer_load_dwordx4 a[216:219], v12, s[8:11], s35 offen offset:0
s_waitcnt vmcnt(15)
ds_read_b128 v[32:35], v238 offset:8192
ds_read_b128 v[36:39], v239 offset:8192
s_waitcnt lgkmcnt(2)
v_mfma_f32_16x16x32_bf16 v[48:51], a[220:223], v[40:43], v[48:51]
v_mfma_f32_16x16x32_bf16 v[68:71], a[220:223], v[44:47], v[68:71]
buffer_load_dwordx4 a[220:223], v12, s[8:11], s35 offen offset:256
v_mfma_f32_16x16x32_bf16 v[52:55], a[224:227], v[40:43], v[52:55]
v_mfma_f32_16x16x32_bf16 v[72:75], a[224:227], v[44:47], v[72:75]
buffer_load_dwordx4 a[224:227], v12, s[8:11], s35 offen offset:512
v_mfma_f32_16x16x32_bf16 v[56:59], a[228:231], v[40:43], v[56:59]
v_mfma_f32_16x16x32_bf16 v[76:79], a[228:231], v[44:47], v[76:79]
s_add_u32 s35, s35, 12288
buffer_load_dwordx4 a[228:231], v12, s[8:11], s35 offen offset:0
v_mfma_f32_16x16x32_bf16 v[60:63], a[232:235], v[40:43], v[60:63]
v_mfma_f32_16x16x32_bf16 v[80:83], a[232:235], v[44:47], v[80:83]
buffer_load_dwordx4 a[232:235], v12, s[8:11], s35 offen offset:256
v_mfma_f32_16x16x32_bf16 v[64:67], a[236:239], v[40:43], v[64:67]
v_mfma_f32_16x16x32_bf16 v[84:87], a[236:239], v[44:47], v[84:87]
buffer_load_dwordx4 a[236:239], v12, s[8:11], s35 offen offset:512
s_waitcnt lgkmcnt(0)
v_mfma_f32_16x16x32_bf16 v[48:51], a[240:243], v[32:35], v[48:51]
v_mfma_f32_16x16x32_bf16 v[68:71], a[240:243], v[36:39], v[68:71]
v_mfma_f32_16x16x32_bf16 v[52:55], a[244:247], v[32:35], v[52:55]
v_mfma_f32_16x16x32_bf16 v[72:75], a[244:247], v[36:39], v[72:75]
v_mfma_f32_16x16x32_bf16 v[56:59], a[248:251], v[32:35], v[56:59]
v_mfma_f32_16x16x32_bf16 v[76:79], a[248:251], v[36:39], v[76:79]
v_mfma_f32_16x16x32_bf16 v[60:63], a[252:255], v[32:35], v[60:63]
v_mfma_f32_16x16x32_bf16 v[80:83], a[252:255], v[36:39], v[80:83]
v_mfma_f32_16x16x32_bf16 v[64:67], v[228:231], v[32:35], v[64:67]
v_mfma_f32_16x16x32_bf16 v[84:87], v[228:231], v[36:39], v[84:87]
s_mov_b32 s29, s19
s_lshl_b32 s29, s29, 7
s_add_u32 s94, s29, 9197568
buffer_load_dword v31, v6, s[8:11], s94 offen sc1
s_lshr_b32 s28, s16, 1
s_lshl_b32 s28, s28, 9
v_add_u32 v188, s28, v10
s_sub_u32 s28, 512, s28
v_add_u32 v189, s28, v10
s_lshr_b32 s29, s16, 1
s_lshl_b32 s29, s29, 7
s_xor_b32 s28, s29, 0
v_lshl_add_u32 v240, v4, 2, s28
s_xor_b32 s28, s29, 64
v_lshl_add_u32 v241, v4, 2, s28
s_xor_b32 s28, s29, 128
v_lshl_add_u32 v242, v4, 2, s28
s_xor_b32 s28, s29, 192
v_lshl_add_u32 v243, v4, 2, s28
s_lshr_b32 s28, s16, 1
s_mul_i32 s28, s28, 1536
s_mul_i32 s29, s21, 96
s_add_u32 s28, s28, s29
s_and_b32 s29, s16, 1
s_mul_i32 s29, s29, 48
s_add_u32 s28, s28, s29
s_lshl_b32 s28, s28, 2
s_add_u32 s28, s28, 9182720
v_lshlrev_b32 v29, 4, v5
buffer_load_dwordx4 v[176:179], v29, s[8:11], s28 offen offset:0
buffer_load_dwordx4 v[180:183], v29, s[8:11], s28 offen offset:64
buffer_load_dwordx4 v[184:187], v29, s[8:11], s28 offen offset:128
s_waitcnt vmcnt(3)
s_cmp_lg_u32 s16, 0
s_cbranch_scc1 P17
s_movk_i32 s77, 16
P18:
v_cmp_gt_u32 vcc, s77, v31
s_nop 1
s_cbranch_vccz P17
s_add_u32 s76, s76, 1
s_cmp_gt_u32 s76, 400000
s_cbranch_scc1 P17
s_sleep 4
buffer_load_dword v31, v6, s[8:11], s94 offen sc1
s_waitcnt vmcnt(0)
s_branch P18
P17:
s_barrier
s_add_u32 s28, s19, 0
s_lshl_b32 s28, s28, 6
v_add_u32 v29, s28, v0
v_lshlrev_b32 v29, 4, v29
s_mov_b32 s29, 14798848
buffer_load_dwordx4 v[192:195], v29, s[8:11], s29 offen sc1
s_add_u32 s29, s29, 32768
buffer_load_dwordx4 v[196:199], v29, s[8:11], s29 offen sc1
s_add_u32 s29, s29, 32768
buffer_load_dwordx4 v[200:203], v29, s[8:11], s29 offen sc1
s_add_u32 s29, s29, 32768
buffer_load_dwordx4 v[204:207], v29, s[8:11], s29 offen sc1
s_add_u32 s29, s29, 32768
buffer_load_dwordx4 v[208:211], v29, s[8:11], s29 offen sc1
s_add_u32 s29, s29, 32768
buffer_load_dwordx4 v[212:215], v29, s[8:11], s29 offen sc1
s_add_u32 s29, s29, 32768
buffer_load_dwordx4 v[216:219], v29, s[8:11], s29 offen sc1
s_add_u32 s29, s29, 32768
buffer_load_dwordx4 v[220:223], v29, s[8:11], s29 offen sc1
s_add_u32 s26, s19, 0
s_mul_i32 s26, s26, 81920
s_add_u32 s26, s26, 11915264
s_add_u32 s26, s26, s30
s_add_u32 m0, s30, 0
s_nop 0
buffer_load_dwordx4 v1, s[8:11], s26 offen sc1 lds
buffer_load_dwordx4 v1, s[8:11], s26 offen offset:1024 sc1 lds
s_add_u32 s26, s26, 8192
s_add_u32 m0, s30, 8192
s_nop 0
buffer_load_dwordx4 v1, s[8:11], s26 offen sc1 lds
buffer_load_dwordx4 v1, s[8:11], s26 offen offset:1024 sc1 lds
s_add_u32 s26, s26, 8192
s_add_u32 m0, s30, 16384
s_nop 0
buffer_load_dwordx4 v1, s[8:11], s26 offen sc1 lds
buffer_load_dwordx4 v1, s[8:11], s26 offen offset:1024 sc1 lds
s_add_u32 s26, s26, 8192
s_add_u32 m0, s30, 24576
s_nop 0
buffer_load_dwordx4 v1, s[8:11], s26 offen sc1 lds
buffer_load_dwordx4 v1, s[8:11], s26 offen offset:1024 sc1 lds
s_add_u32 s26, s26, 8192
s_add_u32 m0, s30, 32768
s_nop 0
buffer_load_dwordx4 v1, s[8:11], s26 offen sc1 lds
buffer_load_dwordx4 v1, s[8:11], s26 offen offset:1024 sc1 lds
s_add_u32 s26, s26, 8192
s_lshr_b32 s28, s24, 1
s_add_u32 s28, s28, 16
s_mul_i32 s88, s28, 81920
s_mul_i32 s29, s25, 10240
s_add_u32 s88, s88, s29
s_barrier
s_mul_i32 s28, s16, 10240
s_add_u32 s28, s28, 65536
s_and_b32 s29, s16, 1
s_mul_i32 s29, s29, 5120
s_add_u32 s90, s28, s29
v_add_u32 v24, s90, v1
s_xor_b32 s29, s29, 5120
s_add_u32 s90, s28, s29
v_add_u32 v25, s90, v1
s_cmp_ge_u32 s16, 2
s_cbranch_scc1 V20
s_nop 1
ds_write_b128 v25, v[68:71] offset:0
ds_write_b128 v25, v[72:75] offset:1024
ds_write_b128 v25, v[76:79] offset:2048
ds_write_b128 v24, v[60:63] offset:3072
ds_write_b128 v25, v[80:83] offset:3072
ds_write_b128 v24, v[64:67] offset:4096
ds_write_b128 v25, v[84:87] offset:4096
s_waitcnt lgkmcnt(0)
s_barrier
s_add_u32 s28, s16, 1
s_and_b32 s28, s28, 3
s_mul_i32 s28, s28, 10240
s_and_b32 s29, s16, 1
s_mul_i32 s29, s29, 5120
s_add_u32 s28, s28, s29
s_add_u32 s28, s28, 65536
v_add_u32 v26, s28, v1
ds_read_b128 v[88:91], v26 offset:0
ds_read_b128 v[92:95], v26 offset:1024
ds_read_b128 v[96:99], v26 offset:2048
s_add_u32 s28, s16, 2
s_and_b32 s28, s28, 3
s_mul_i32 s28, s28, 10240
s_and_b32 s29, s16, 1
s_mul_i32 s29, s29, 5120
s_add_u32 s28, s28, s29
s_add_u32 s28, s28, 65536
v_add_u32 v26, s28, v1
ds_read_b128 v[100:103], v26 offset:0
ds_read_b128 v[104:107], v26 offset:1024
ds_read_b128 v[108:111], v26 offset:2048
s_add_u32 s28, s16, 3
s_and_b32 s28, s28, 3
s_mul_i32 s28, s28, 10240
s_and_b32 s29, s16, 1
s_mul_i32 s29, s29, 5120
s_add_u32 s28, s28, s29
s_add_u32 s28, s28, 65536
v_add_u32 v26, s28, v1
ds_read_b128 v[112:115], v26 offset:0
ds_read_b128 v[116:119], v26 offset:1024
ds_read_b128 v[120:123], v26 offset:2048
s_waitcnt lgkmcnt(6)
v_add_f32 v48, v48, v88
v_add_f32 v49, v49, v89
v_add_f32 v50, v50, v90
v_add_f32 v51, v51, v91
v_add_f32 v52, v52, v92
v_add_f32 v53, v53, v93
v_add_f32 v54, v54, v94
v_add_f32 v55, v55, v95
v_add_f32 v56, v56, v96
v_add_f32 v57, v57, v97
v_add_f32 v58, v58, v98
v_add_f32 v59, v59, v99
s_waitcnt lgkmcnt(3)
v_add_f32 v48, v48, v100
v_add_f32 v49, v49, v101
v_add_f32 v50, v50, v102
v_add_f32 v51, v51, v103
v_add_f32 v52, v52, v104
v_add_f32 v53, v53, v105
v_add_f32 v54, v54, v106
v_add_f32 v55, v55, v107
v_add_f32 v56, v56, v108
v_add_f32 v57, v57, v109
v_add_f32 v58, v58, v110
v_add_f32 v59, v59, v111
s_waitcnt lgkmcnt(0)
v_add_f32 v48, v48, v112
v_add_f32 v49, v49, v113
v_add_f32 v50, v50, v114
v_add_f32 v51, v51, v115
v_add_f32 v52, v52, v116
v_add_f32 v53, v53, v117
v_add_f32 v54, v54, v118
v_add_f32 v55, v55, v119
v_add_f32 v56, v56, v120
v_add_f32 v57, v57, v121
v_add_f32 v58, v58, v122
v_add_f32 v59, v59, v123
v_lshlrev_b32 v26, 16, v232
v_and_b32 v27, 0xffff0000, v232
v_add_f32 v48, v48, v26
v_add_f32 v49, v49, v27
v_cvt_pk_bf16_f32 v232, v48, v49
v_lshlrev_b32 v26, 16, v233
v_and_b32 v27, 0xffff0000, v233
v_add_f32 v50, v50, v26
v_add_f32 v51, v51, v27
v_cvt_pk_bf16_f32 v233, v50, v51
v_lshlrev_b32 v26, 16, v234
v_and_b32 v27, 0xffff0000, v234
v_add_f32 v52, v52, v26
v_add_f32 v53, v53, v27
v_cvt_pk_bf16_f32 v234, v52, v53
v_lshlrev_b32 v26, 16, v235
v_and_b32 v27, 0xffff0000, v235
v_add_f32 v54, v54, v26
v_add_f32 v55, v55, v27
v_cvt_pk_bf16_f32 v235, v54, v55
v_lshlrev_b32 v26, 16, v236
v_and_b32 v27, 0xffff0000, v236
v_add_f32 v56, v56, v26
v_add_f32 v57, v57, v27
v_cvt_pk_bf16_f32 v236, v56, v57
v_lshlrev_b32 v26, 16, v237
v_and_b32 v27, 0xffff0000, v237
v_add_f32 v58, v58, v26
v_add_f32 v59, v59, v27
v_cvt_pk_bf16_f32 v237, v58, v59
v_mov_b32 v28, 0x3f803f80
v_mov_b32 v26, 0
v_mov_b32 v27, 0
v_dot2_f32_bf16 v26, v232, v28, v26
v_dot2_f32_bf16 v27, v232, v232, v27
v_dot2_f32_bf16 v26, v233, v28, v26
v_dot2_f32_bf16 v27, v233, v233, v27
v_dot2_f32_bf16 v26, v234, v28, v26
v_dot2_f32_bf16 v27, v234, v234, v27
v_dot2_f32_bf16 v26, v235, v28, v26
v_dot2_f32_bf16 v27, v235, v235, v27
v_dot2_f32_bf16 v26, v236, v28, v26
v_dot2_f32_bf16 v27, v236, v236, v27
v_dot2_f32_bf16 v26, v237, v28, v26
v_dot2_f32_bf16 v27, v237, v237, v27
s_add_u32 s89, s88, 11915264
s_add_u32 s91, s89, 4096
buffer_store_dwordx2 v[236:237], v246, s[8:11], s91 offen sc1
v_and_b32 v29, 1, v5
v_lshlrev_b32 v29, 1, v29
v_lshrrev_b32 v30, 1, v5
v_add_u32 v29, v29, v30
v_lshlrev_b32 v29, 10, v29
v_lshl_add_u32 v29, v244, 4, v29
v_permlane16_swap_b32 v232, v234
v_permlane16_swap_b32 v233, v235
s_nop 0
buffer_store_dwordx4 v[232:235], v29, s[8:11], s89 offen offset:0 sc1
v_mov_b32 v28, v26
v_mov_b32 v30, v27
s_nop 1
v_permlane16_swap_b32 v26, v28
v_permlane16_swap_b32 v27, v30
s_nop 0
v_add_f32 v26, v26, v28
v_add_f32 v27, v27, v30
v_mov_b32 v28, v26
v_mov_b32 v30, v27
s_nop 1
v_permlane32_swap_b32 v26, v28
v_permlane32_swap_b32 v27, v30
s_nop 0
v_add_f32 v26, v26, v28
v_add_f32 v27, v27, v30
s_lshr_b32 s28, s24, 1
s_add_u32 s28, s28, 16
s_lshl_b32 s28, s28, 6
v_add_u32 v28, s28, v244
v_lshlrev_b32 v28, 4, v28
s_lshl_b32 s28, s25, 15
s_add_u32 s28, s28, 14798848
v_cmp_gt_u32 vcc, 16, v0
s_and_saveexec_b64 s[92:93], vcc
buffer_store_dwordx2 v[26:27], v28, s[8:11], s28 offen sc1
s_mov_b64 exec, -1
s_branch V19
V20:
s_nop 1
ds_write_b128 v24, v[48:51] offset:0
ds_write_b128 v25, v[68:71] offset:0
ds_write_b128 v24, v[52:55] offset:1024
ds_write_b128 v25, v[72:75] offset:1024
ds_write_b128 v24, v[56:59] offset:2048
ds_write_b128 v25, v[76:79] offset:2048
ds_write_b128 v25, v[80:83] offset:3072
ds_write_b128 v25, v[84:87] offset:4096
s_waitcnt lgkmcnt(0)
s_barrier
s_add_u32 s28, s16, 1
s_and_b32 s28, s28, 3
s_mul_i32 s28, s28, 10240
s_and_b32 s29, s16, 1
s_mul_i32 s29, s29, 5120
s_add_u32 s28, s28, s29
s_add_u32 s28, s28, 65536
v_add_u32 v26, s28, v1
ds_read_b128 v[88:91], v26 offset:3072
ds_read_b128 v[92:95], v26 offset:4096
s_add_u32 s28, s16, 2
s_and_b32 s28, s28, 3
s_mul_i32 s28, s28, 10240
s_and_b32 s29, s16, 1
s_mul_i32 s29, s29, 5120
s_add_u32 s28, s28, s29
s_add_u32 s28, s28, 65536
v_add_u32 v26, s28, v1
ds_read_b128 v[100:103], v26 offset:3072
ds_read_b128 v[104:107], v26 offset:4096
s_add_u32 s28, s16, 3
s_and_b32 s28, s28, 3
s_mul_i32 s28, s28, 10240
s_and_b32 s29, s16, 1
s_mul_i32 s29, s29, 5120
s_add_u32 s28, s28, s29
s_add_u32 s28, s28, 65536
v_add_u32 v26, s28, v1
ds_read_b128 v[112:115], v26 offset:3072
ds_read_b128 v[116:119], v26 offset:4096
s_waitcnt lgkmcnt(4)
v_add_f32 v60, v60, v88
v_add_f32 v61, v61, v89
v_add_f32 v62, v62, v90
v_add_f32 v63, v63, v91
v_add_f32 v64, v64, v92
v_add_f32 v65, v65, v93
v_add_f32 v66, v66, v94
v_add_f32 v67, v67, v95
s_waitcnt lgkmcnt(2)
v_add_f32 v60, v60, v100
v_add_f32 v61, v61, v101
v_add_f32 v62, v62, v102
v_add_f32 v63, v63, v103
v_add_f32 v64, v64, v104
v_add_f32 v65, v65, v105
v_add_f32 v66, v66, v106
v_add_f32 v67, v67, v107
s_waitcnt lgkmcnt(0)
v_add_f32 v60, v60, v112
v_add_f32 v61, v61, v113
v_add_f32 v62, v62, v114
v_add_f32 v63, v63, v115
v_add_f32 v64, v64, v116
v_add_f32 v65, v65, v117
v_add_f32 v66, v66, v118
v_add_f32 v67, v67, v119
v_lshlrev_b32 v26, 16, v232
v_and_b32 v27, 0xffff0000, v232
v_add_f32 v60, v60, v26
v_add_f32 v61, v61, v27
v_cvt_pk_bf16_f32 v232, v60, v61
v_lshlrev_b32 v26, 16, v233
v_and_b32 v27, 0xffff0000, v233
v_add_f32 v62, v62, v26
v_add_f32 v63, v63, v27
v_cvt_pk_bf16_f32 v233, v62, v63
v_lshlrev_b32 v26, 16, v234
v_and_b32 v27, 0xffff0000, v234
v_add_f32 v64, v64, v26
v_add_f32 v65, v65, v27
v_cvt_pk_bf16_f32 v234, v64, v65
v_lshlrev_b32 v26, 16, v235
v_and_b32 v27, 0xffff0000, v235
v_add_f32 v66, v66, v26
v_add_f32 v67, v67, v27
v_cvt_pk_bf16_f32 v235, v66, v67
v_mov_b32 v28, 0x3f803f80
v_mov_b32 v26, 0
v_mov_b32 v27, 0
v_dot2_f32_bf16 v26, v232, v28, v26
v_dot2_f32_bf16 v27, v232, v232, v27
v_dot2_f32_bf16 v26, v233, v28, v26
v_dot2_f32_bf16 v27, v233, v233, v27
v_dot2_f32_bf16 v26, v234, v28, v26
v_dot2_f32_bf16 v27, v234, v234, v27
v_dot2_f32_bf16 v26, v235, v28, v26
v_dot2_f32_bf16 v27, v235, v235, v27
s_add_u32 s89, s88, 11915264
v_and_b32 v29, 1, v5
v_lshlrev_b32 v29, 1, v29
v_lshrrev_b32 v30, 1, v5
v_add_u32 v29, v29, v30
v_lshlrev_b32 v29, 10, v29
v_lshl_add_u32 v29, v244, 4, v29
v_permlane16_swap_b32 v232, v234
v_permlane16_swap_b32 v233, v235
s_add_u32 s91, s89, 4096
s_nop 0
buffer_store_dwordx4 v[232:235], v29, s[8:11], s91 offen offset:2048 sc1
v_mov_b32 v28, v26
v_mov_b32 v30, v27
s_nop 1
v_permlane16_swap_b32 v26, v28
v_permlane16_swap_b32 v27, v30
s_nop 0
v_add_f32 v26, v26, v28
v_add_f32 v27, v27, v30
v_mov_b32 v28, v26
v_mov_b32 v30, v27
s_nop 1
v_permlane32_swap_b32 v26, v28
v_permlane32_swap_b32 v27, v30
s_nop 0
v_add_f32 v26, v26, v28
v_add_f32 v27, v27, v30
s_lshr_b32 s28, s24, 1
s_add_u32 s28, s28, 16
s_lshl_b32 s28, s28, 6
v_add_u32 v28, s28, v244
v_lshlrev_b32 v28, 4, v28
s_lshl_b32 s28, s25, 15
s_add_u32 s28, s28, 14798856
v_cmp_gt_u32 vcc, 16, v0
s_and_saveexec_b64 s[92:93], vcc
buffer_store_dwordx2 v[26:27], v28, s[8:11], s28 offen sc1
s_mov_b64 exec, -1
V19:
s_waitcnt vmcnt(12)
v_add_f32 v192, v192, v208
v_add_f32 v193, v193, v209
v_add_f32 v194, v194, v210
v_add_f32 v195, v195, v211
v_add_f32 v196, v196, v212
v_add_f32 v197, v197, v213
v_add_f32 v198, v198, v214
v_add_f32 v199, v199, v215
v_add_f32 v200, v200, v216
v_add_f32 v201, v201, v217
v_add_f32 v202, v202, v218
v_add_f32 v203, v203, v219
v_add_f32 v204, v204, v220
v_add_f32 v205, v205, v221
v_add_f32 v206, v206, v222
v_add_f32 v207, v207, v223
v_add_f32 v192, v192, v200
v_add_f32 v193, v193, v201
v_add_f32 v194, v194, v202
v_add_f32 v195, v195, v203
v_add_f32 v196, v196, v204
v_add_f32 v197, v197, v205
v_add_f32 v198, v198, v206
v_add_f32 v199, v199, v207
v_add_f32 v192, v192, v196
v_add_f32 v193, v193, v197
v_add_f32 v194, v194, v198
v_add_f32 v195, v195, v199
v_add_f32 v192, v192, v194
v_add_f32 v193, v193, v195
v_mul_f32 v28, 0x3acccccd, v192
v_mul_f32 v26, 0x3acccccd, v193
v_fma_f32 v26, -v28, v28, v26
v_max_f32 v26, 0, v26
v_add_f32 v26, 0x3727c5ac, v26
v_rsq_f32 v27, v26
s_nop 0
ds_bpermute_b32 v160, v240, v27
ds_bpermute_b32 v168, v240, v28
ds_bpermute_b32 v161, v241, v27
ds_bpermute_b32 v169, v241, v28
ds_bpermute_b32 v162, v242, v27
ds_bpermute_b32 v170, v242, v28
ds_bpermute_b32 v163, v243, v27
ds_bpermute_b32 v171, v243, v28
s_waitcnt lgkmcnt(0)
v_mul_f32_e64 v32, -v168, v176
v_mul_f32_e64 v33, -v168, v177
v_mul_f32_e64 v34, -v168, v178
v_mul_f32_e64 v35, -v168, v179
v_mul_f32_e64 v36, -v169, v176
v_mul_f32_e64 v37, -v169, v177
v_mul_f32_e64 v38, -v169, v178
v_mul_f32_e64 v39, -v169, v179
v_mul_f32_e64 v40, -v170, v176
v_mul_f32_e64 v41, -v170, v177
v_mul_f32_e64 v42, -v170, v178
v_mul_f32_e64 v43, -v170, v179
v_mul_f32_e64 v44, -v171, v176
v_mul_f32_e64 v45, -v171, v177
v_mul_f32_e64 v46, -v171, v178
v_mul_f32_e64 v47, -v171, v179
v_mul_f32_e64 v48, -v168, v180
v_mul_f32_e64 v49, -v168, v181
v_mul_f32_e64 v50, -v168, v182
v_mul_f32_e64 v51, -v168, v183
v_mul_f32_e64 v52, -v169, v180
v_mul_f32_e64 v53, -v169, v181
v_mul_f32_e64 v54, -v169, v182
v_mul_f32_e64 v55, -v169, v183
v_mul_f32_e64 v56, -v170, v180
v_mul_f32_e64 v57, -v170, v181
v_mul_f32_e64 v58, -v170, v182
v_mul_f32_e64 v59, -v170, v183
v_mul_f32_e64 v60, -v171, v180
v_mul_f32_e64 v61, -v171, v181
v_mul_f32_e64 v62, -v171, v182
v_mul_f32_e64 v63, -v171, v183
v_mul_f32_e64 v64, -v168, v184
v_mul_f32_e64 v65, -v168, v185
v_mul_f32_e64 v66, -v168, v186
v_mul_f32_e64 v67, -v168, v187
v_mul_f32_e64 v68, -v169, v184
v_mul_f32_e64 v69, -v169, v185
v_mul_f32_e64 v70, -v169, v186
v_mul_f32_e64 v71, -v169, v187
v_mul_f32_e64 v72, -v170, v184
v_mul_f32_e64 v73, -v170, v185
v_mul_f32_e64 v74, -v170, v186
v_mul_f32_e64 v75, -v170, v187
v_mul_f32_e64 v76, -v171, v184
v_mul_f32_e64 v77, -v171, v185
v_mul_f32_e64 v78, -v171, v186
v_mul_f32_e64 v79, -v171, v187
s_waitcnt vmcnt(10)
s_barrier
ds_read_b128 v[128:131], v188 offset:0
ds_read_b128 v[132:135], v188 offset:256
ds_read_b128 v[136:139], v189 offset:0
ds_read_b128 v[140:143], v189 offset:256
s_waitcnt lgkmcnt(0)
v_mfma_f32_16x16x32_bf16 v[32:35], a[0:3], v[128:131], v[32:35]
ds_read_b128 v[144:147], v188 offset:4096
v_mfma_f32_16x16x32_bf16 v[36:39], a[0:3], v[132:135], v[36:39]
ds_read_b128 v[148:151], v188 offset:4352
v_mfma_f32_16x16x32_bf16 v[40:43], a[0:3], v[136:139], v[40:43]
ds_read_b128 v[152:155], v189 offset:4096
v_mfma_f32_16x16x32_bf16 v[44:47], a[0:3], v[140:143], v[44:47]
ds_read_b128 v[156:159], v189 offset:4352
v_mfma_f32_16x16x32_bf16 v[48:51], a[4:7], v[128:131], v[48:51]
s_add_u32 m0, s30, 40960
s_nop 0
buffer_load_dwordx4 v1, s[8:11], s26 offen sc1 lds
buffer_load_dwordx4 v1, s[8:11], s26 offen offset:1024 sc1 lds
s_add_u32 s26, s26, 8192
v_mfma_f32_16x16x32_bf16 v[52:55], a[4:7], v[132:135], v[52:55]
v_mfma_f32_16x16x32_bf16 v[56:59], a[4:7], v[136:139], v[56:59]
v_mfma_f32_16x16x32_bf16 v[60:63], a[4:7], v[140:143], v[60:63]
s_add_u32 m0, s30, 49152
s_nop 0
buffer_load_dwordx4 v1, s[8:11], s26 offen sc1 lds
buffer_load_dwordx4 v1, s[8:11], s26 offen offset:1024 sc1 lds
s_add_u32 s26, s26, 8192
v_mfma_f32_16x16x32_bf16 v[64:67], a[8:11], v[128:131], v[64:67]
v_mfma_f32_16x16x32_bf16 v[68:71], a[8:11], v[132:135], v[68:71]
v_mfma_f32_16x16x32_bf16 v[72:75], a[8:11], v[136:139], v[72:75]
s_add_u32 m0, s30, 57344
s_nop 0
buffer_load_dwordx4 v1, s[8:11], s26 offen sc1 lds
buffer_load_dwordx4 v1, s[8:11], s26 offen offset:1024 sc1 lds
s_add_u32 s26, s26, 8192
v_mfma_f32_16x16x32_bf16 v[76:79], a[8:11], v[140:143], v[76:79]
s_waitcnt vmcnt(14)
s_barrier
s_waitcnt lgkmcnt(0)
v_mfma_f32_16x16x32_bf16 v[32:35], a[12:15], v[144:147], v[32:35]
ds_read_b128 v[128:131], v188 offset:8192
v_mfma_f32_16x16x32_bf16 v[36:39], a[12:15], v[148:151], v[36:39]
ds_read_b128 v[132:135], v188 offset:8448
v_mfma_f32_16x16x32_bf16 v[40:43], a[12:15], v[152:155], v[40:43]
ds_read_b128 v[136:139], v189 offset:8192
v_mfma_f32_16x16x32_bf16 v[44:47], a[12:15], v[156:159], v[44:47]
ds_read_b128 v[140:143], v189 offset:8448
v_mfma_f32_16x16x32_bf16 v[48:51], a[16:19], v[144:147], v[48:51]
v_mfma_f32_16x16x32_bf16 v[52:55], a[16:19], v[148:151], v[52:55]
v_mfma_f32_16x16x32_bf16 v[56:59], a[16:19], v[152:155], v[56:59]
v_mfma_f32_16x16x32_bf16 v[60:63], a[16:19], v[156:159], v[60:63]
v_mfma_f32_16x16x32_bf16 v[64:67], a[20:23], v[144:147], v[64:67]
v_mfma_f32_16x16x32_bf16 v[68:71], a[20:23], v[148:151], v[68:71]
v_mfma_f32_16x16x32_bf16 v[72:75], a[20:23], v[152:155], v[72:75]
v_mfma_f32_16x16x32_bf16 v[76:79], a[20:23], v[156:159], v[76:79]
s_lshr_b32 s28, s24, 1
s_lshl_b32 s28, s28, 7
s_add_u32 s28, s28, 9199616
s_waitcnt vmcnt(6)
s_barrier
s_cmp_lg_u32 s16, 0
s_cbranch_scc1 S21
s_mov_b64 exec, 1
buffer_atomic_add v7, v6, s[8:11], s28 offen sc1
s_mov_b64 exec, -1
S21:
s_waitcnt lgkmcnt(0)
v_mfma_f32_16x16x32_bf16 v[32:35], a[24:27], v[128:131], v[32:35]
ds_read_b128 v[144:147], v188 offset:12288
v_mfma_f32_16x16x32_bf16 v[36:39], a[24:27], v[132:135], v[36:39]
ds_read_b128 v[148:151], v188 offset:12544
v_mfma_f32_16x16x32_bf16 v[40:43], a[24:27], v[136:139], v[40:43]
ds_read_b128 v[152:155], v189 offset:12288
v_mfma_f32_16x16x32_bf16 v[44:47], a[24:27], v[140:143], v[44:47]
ds_read_b128 v[156:159], v189 offset:12544
v_mfma_f32_16x16x32_bf16 v[48:51], a[28:31], v[128:131], v[48:51]
v_mfma_f32_16x16x32_bf16 v[52:55], a[28:31], v[132:135], v[52:55]
v_mfma_f32_16x16x32_bf16 v[56:59], a[28:31], v[136:139], v[56:59]
v_mfma_f32_16x16x32_bf16 v[60:63], a[28:31], v[140:143], v[60:63]
v_mfma_f32_16x16x32_bf16 v[64:67], a[32:35], v[128:131], v[64:67]
v_mfma_f32_16x16x32_bf16 v[68:71], a[32:35], v[132:135], v[68:71]
v_mfma_f32_16x16x32_bf16 v[72:75], a[32:35], v[136:139], v[72:75]
v_mfma_f32_16x16x32_bf16 v[76:79], a[32:35], v[140:143], v[76:79]
s_barrier
s_waitcnt lgkmcnt(0)
v_mfma_f32_16x16x32_bf16 v[32:35], a[36:39], v[144:147], v[32:35]
ds_read_b128 v[128:131], v188 offset:16384
v_mfma_f32_16x16x32_bf16 v[36:39], a[36:39], v[148:151], v[36:39]
ds_read_b128 v[132:135], v188 offset:16640
v_mfma_f32_16x16x32_bf16 v[40:43], a[36:39], v[152:155], v[40:43]
ds_read_b128 v[136:139], v189 offset:16384
v_mfma_f32_16x16x32_bf16 v[44:47], a[36:39], v[156:159], v[44:47]
ds_read_b128 v[140:143], v189 offset:16640
v_mfma_f32_16x16x32_bf16 v[48:51], a[40:43], v[144:147], v[48:51]
s_add_u32 m0, s30, 0
s_nop 0
buffer_load_dwordx4 v1, s[8:11], s26 offen sc1 lds
buffer_load_dwordx4 v1, s[8:11], s26 offen offset:1024 sc1 lds
s_add_u32 s26, s26, 8192
v_mfma_f32_16x16x32_bf16 v[52:55], a[40:43], v[148:151], v[52:55]
v_mfma_f32_16x16x32_bf16 v[56:59], a[40:43], v[152:155], v[56:59]
v_mfma_f32_16x16x32_bf16 v[60:63], a[40:43], v[156:159], v[60:63]
v_mfma_f32_16x16x32_bf16 v[64:67], a[44:47], v[144:147], v[64:67]
v_mfma_f32_16x16x32_bf16 v[68:71], a[44:47], v[148:151], v[68:71]
v_mfma_f32_16x16x32_bf16 v[72:75], a[44:47], v[152:155], v[72:75]
v_mfma_f32_16x16x32_bf16 v[76:79], a[44:47], v[156:159], v[76:79]
s_waitcnt lgkmcnt(0)
v_mfma_f32_16x16x32_bf16 v[32:35], a[48:51], v[128:131], v[32:35]
ds_read_b128 v[144:147], v188 offset:20480
v_mfma_f32_16x16x32_bf16 v[36:39], a[48:51], v[132:135], v[36:39]
ds_read_b128 v[148:151], v188 offset:20736
v_mfma_f32_16x16x32_bf16 v[40:43], a[48:51], v[136:139], v[40:43]
ds_read_b128 v[152:155], v189 offset:20480
v_mfma_f32_16x16x32_bf16 v[44:47], a[48:51], v[140:143], v[44:47]
ds_read_b128 v[156:159], v189 offset:20736
v_mfma_f32_16x16x32_bf16 v[48:51], a[52:55], v[128:131], v[48:51]
v_mfma_f32_16x16x32_bf16 v[52:55], a[52:55], v[132:135], v[52:55]
v_mfma_f32_16x16x32_bf16 v[56:59], a[52:55], v[136:139], v[56:59]
v_mfma_f32_16x16x32_bf16 v[60:63], a[52:55], v[140:143], v[60:63]
v_mfma_f32_16x16x32_bf16 v[64:67], a[56:59], v[128:131], v[64:67]
v_mfma_f32_16x16x32_bf16 v[68:71], a[56:59], v[132:135], v[68:71]
v_mfma_f32_16x16x32_bf16 v[72:75], a[56:59], v[136:139], v[72:75]
v_mfma_f32_16x16x32_bf16 v[76:79], a[56:59], v[140:143], v[76:79]
s_barrier
s_waitcnt lgkmcnt(0)
v_mfma_f32_16x16x32_bf16 v[32:35], a[60:63], v[144:147], v[32:35]
ds_read_b128 v[128:131], v188 offset:24576
v_mfma_f32_16x16x32_bf16 v[36:39], a[60:63], v[148:151], v[36:39]
ds_read_b128 v[132:135], v188 offset:24832
v_mfma_f32_16x16x32_bf16 v[40:43], a[60:63], v[152:155], v[40:43]
ds_read_b128 v[136:139], v189 offset:24576
v_mfma_f32_16x16x32_bf16 v[44:47], a[60:63], v[156:159], v[44:47]
ds_read_b128 v[140:143], v189 offset:24832
v_mfma_f32_16x16x32_bf16 v[48:51], a[64:67], v[144:147], v[48:51]
s_add_u32 m0, s30, 8192
s_nop 0
buffer_load_dwordx4 v1, s[8:11], s26 offen sc1 lds
buffer_load_dwordx4 v1, s[8:11], s26 offen offset:1024 sc1 lds
s_add_u32 s26, s26, 8192
v_mfma_f32_16x16x32_bf16 v[52:55], a[64:67], v[148:151], v[52:55]
v_mfma_f32_16x16x32_bf16 v[56:59], a[64:67], v[152:155], v[56:59]
v_mfma_f32_16x16x32_bf16 v[60:63], a[64:67], v[156:159], v[60:63]
v_mfma_f32_16x16x32_bf16 v[64:67], a[68:71], v[144:147], v[64:67]
v_mfma_f32_16x16x32_bf16 v[68:71], a[68:71], v[148:151], v[68:71]
v_mfma_f32_16x16x32_bf16 v[72:75], a[68:71], v[152:155], v[72:75]
v_mfma_f32_16x16x32_bf16 v[76:79], a[68:71], v[156:159], v[76:79]
s_waitcnt lgkmcnt(0)
v_mfma_f32_16x16x32_bf16 v[32:35], a[72:75], v[128:131], v[32:35]
ds_read_b128 v[144:147], v188 offset:28672
v_mfma_f32_16x16x32_bf16 v[36:39], a[72:75], v[132:135], v[36:39]
ds_read_b128 v[148:151], v188 offset:28928
v_mfma_f32_16x16x32_bf16 v[40:43], a[72:75], v[136:139], v[40:43]
ds_read_b128 v[152:155], v189 offset:28672
v_mfma_f32_16x16x32_bf16 v[44:47], a[72:75], v[140:143], v[44:47]
ds_read_b128 v[156:159], v189 offset:28928
v_mfma_f32_16x16x32_bf16 v[48:51], a[76:79], v[128:131], v[48:51]
v_mfma_f32_16x16x32_bf16 v[52:55], a[76:79], v[132:135], v[52:55]
v_mfma_f32_16x16x32_bf16 v[56:59], a[76:79], v[136:139], v[56:59]
v_mfma_f32_16x16x32_bf16 v[60:63], a[76:79], v[140:143], v[60:63]
v_mfma_f32_16x16x32_bf16 v[64:67], a[80:83], v[128:131], v[64:67]
v_mfma_f32_16x16x32_bf16 v[68:71], a[80:83], v[132:135], v[68:71]
v_mfma_f32_16x16x32_bf16 v[72:75], a[80:83], v[136:139], v[72:75]
v_mfma_f32_16x16x32_bf16 v[76:79], a[80:83], v[140:143], v[76:79]
s_barrier
s_waitcnt lgkmcnt(0)
v_mfma_f32_16x16x32_bf16 v[32:35], a[84:87], v[144:147], v[32:35]
ds_read_b128 v[128:131], v188 offset:32768
v_mfma_f32_16x16x32_bf16 v[36:39], a[84:87], v[148:151], v[36:39]
ds_read_b128 v[132:135], v188 offset:33024
v_mfma_f32_16x16x32_bf16 v[40:43], a[84:87], v[152:155], v[40:43]
ds_read_b128 v[136:139], v189 offset:32768
v_mfma_f32_16x16x32_bf16 v[44:47], a[84:87], v[156:159], v[44:47]
ds_read_b128 v[140:143], v189 offset:33024
v_mfma_f32_16x16x32_bf16 v[48:51], a[88:91], v[144:147], v[48:51]
v_mfma_f32_16x16x32_bf16 v[52:55], a[88:91], v[148:151], v[52:55]
v_mfma_f32_16x16x32_bf16 v[56:59], a[88:91], v[152:155], v[56:59]
v_mfma_f32_16x16x32_bf16 v[60:63], a[88:91], v[156:159], v[60:63]
v_mfma_f32_16x16x32_bf16 v[64:67], a[92:95], v[144:147], v[64:67]
v_mfma_f32_16x16x32_bf16 v[68:71], a[92:95], v[148:151], v[68:71]
v_mfma_f32_16x16x32_bf16 v[72:75], a[92:95], v[152:155], v[72:75]
v_mfma_f32_16x16x32_bf16 v[76:79], a[92:95], v[156:159], v[76:79]
s_waitcnt lgkmcnt(0)
v_mfma_f32_16x16x32_bf16 v[32:35], a[96:99], v[128:131], v[32:35]
ds_read_b128 v[144:147], v188 offset:36864
v_mfma_f32_16x16x32_bf16 v[36:39], a[96:99], v[132:135], v[36:39]
ds_read_b128 v[148:151], v188 offset:37120
v_mfma_f32_16x16x32_bf16 v[40:43], a[96:99], v[136:139], v[40:43]
ds_read_b128 v[152:155], v189 offset:36864
v_mfma_f32_16x16x32_bf16 v[44:47], a[96:99], v[140:143], v[44:47]
ds_read_b128 v[156:159], v189 offset:37120
v_mfma_f32_16x16x32_bf16 v[48:51], a[100:103], v[128:131], v[48:51]
v_mfma_f32_16x16x32_bf16 v[52:55], a[100:103], v[132:135], v[52:55]
v_mfma_f32_16x16x32_bf16 v[56:59], a[100:103], v[136:139], v[56:59]
v_mfma_f32_16x16x32_bf16 v[60:63], a[100:103], v[140:143], v[60:63]
v_mfma_f32_16x16x32_bf16 v[64:67], a[104:107], v[128:131], v[64:67]
v_mfma_f32_16x16x32_bf16 v[68:71], a[104:107], v[132:135], v[68:71]
v_mfma_f32_16x16x32_bf16 v[72:75], a[104:107], v[136:139], v[72:75]
v_mfma_f32_16x16x32_bf16 v[76:79], a[104:107], v[140:143], v[76:79]
s_mov_b32 s29, s19
s_add_u32 s29, s29, 16
s_lshl_b32 s29, s29, 7
s_add_u32 s94, s29, 9197568
buffer_load_dword v31, v6, s[8:11], s94 offen sc1
s_waitcnt vmcnt(9)
s_barrier
s_waitcnt lgkmcnt(0)
v_mfma_f32_16x16x32_bf16 v[32:35], a[108:111], v[144:147], v[32:35]
ds_read_b128 v[128:131], v188 offset:40960
v_mfma_f32_16x16x32_bf16 v[36:39], a[108:111], v[148:151], v[36:39]
ds_read_b128 v[132:135], v188 offset:41216
v_mfma_f32_16x16x32_bf16 v[40:43], a[108:111], v[152:155], v[40:43]
ds_read_b128 v[136:139], v189 offset:40960
v_mfma_f32_16x16x32_bf16 v[44:47], a[108:111], v[156:159], v[44:47]
ds_read_b128 v[140:143], v189 offset:41216
v_mfma_f32_16x16x32_bf16 v[48:51], a[112:115], v[144:147], v[48:51]
v_mfma_f32_16x16x32_bf16 v[52:55], a[112:115], v[148:151], v[52:55]
v_mfma_f32_16x16x32_bf16 v[56:59], a[112:115], v[152:155], v[56:59]
v_mfma_f32_16x16x32_bf16 v[60:63], a[112:115], v[156:159], v[60:63]
v_mfma_f32_16x16x32_bf16 v[64:67], a[116:119], v[144:147], v[64:67]
v_mfma_f32_16x16x32_bf16 v[68:71], a[116:119], v[148:151], v[68:71]
v_mfma_f32_16x16x32_bf16 v[72:75], a[116:119], v[152:155], v[72:75]
v_mfma_f32_16x16x32_bf16 v[76:79], a[116:119], v[156:159], v[76:79]
s_waitcnt lgkmcnt(0)
v_mfma_f32_16x16x32_bf16 v[32:35], a[120:123], v[128:131], v[32:35]
ds_read_b128 v[144:147], v188 offset:45056
v_mfma_f32_16x16x32_bf16 v[36:39], a[120:123], v[132:135], v[36:39]
ds_read_b128 v[148:151], v188 offset:45312
v_mfma_f32_16x16x32_bf16 v[40:43], a[120:123], v[136:139], v[40:43]
ds_read_b128 v[152:155], v189 offset:45056
v_mfma_f32_16x16x32_bf16 v[44:47], a[120:123], v[140:143], v[44:47]
ds_read_b128 v[156:159], v189 offset:45312
v_mfma_f32_16x16x32_bf16 v[48:51], a[124:127], v[128:131], v[48:51]
v_mfma_f32_16x16x32_bf16 v[52:55], a[124:127], v[132:135], v[52:55]
v_mfma_f32_16x16x32_bf16 v[56:59], a[124:127], v[136:139], v[56:59]
v_mfma_f32_16x16x32_bf16 v[60:63], a[124:127], v[140:143], v[60:63]
v_mfma_f32_16x16x32_bf16 v[64:67], a[128:131], v[128:131], v[64:67]
v_mfma_f32_16x16x32_bf16 v[68:71], a[128:131], v[132:135], v[68:71]
v_mfma_f32_16x16x32_bf16 v[72:75], a[128:131], v[136:139], v[72:75]
v_mfma_f32_16x16x32_bf16 v[76:79], a[128:131], v[140:143], v[76:79]
s_waitcnt vmcnt(7)
s_barrier
s_waitcnt lgkmcnt(0)
v_mfma_f32_16x16x32_bf16 v[32:35], a[132:135], v[144:147], v[32:35]
ds_read_b128 v[128:131], v188 offset:49152
v_mfma_f32_16x16x32_bf16 v[36:39], a[132:135], v[148:151], v[36:39]
ds_read_b128 v[132:135], v188 offset:49408
v_mfma_f32_16x16x32_bf16 v[40:43], a[132:135], v[152:155], v[40:43]
ds_read_b128 v[136:139], v189 offset:49152
v_mfma_f32_16x16x32_bf16 v[44:47], a[132:135], v[156:159], v[44:47]
ds_read_b128 v[140:143], v189 offset:49408
v_mfma_f32_16x16x32_bf16 v[48:51], a[136:139], v[144:147], v[48:51]
v_mfma_f32_16x16x32_bf16 v[52:55], a[136:139], v[148:151], v[52:55]
v_mfma_f32_16x16x32_bf16 v[56:59], a[136:139], v[152:155], v[56:59]
v_mfma_f32_16x16x32_bf16 v[60:63], a[136:139], v[156:159], v[60:63]
v_mfma_f32_16x16x32_bf16 v[64:67], a[140:143], v[144:147], v[64:67]
v_mfma_f32_16x16x32_bf16 v[68:71], a[140:143], v[148:151], v[68:71]
v_mfma_f32_16x16x32_bf16 v[72:75], a[140:143], v[152:155], v[72:75]
v_mfma_f32_16x16x32_bf16 v[76:79], a[140:143], v[156:159], v[76:79]
s_waitcnt vmcnt(0)
s_cmp_lg_u32 s16, 0
s_cbranch_scc1 P22
s_movk_i32 s77, 16
P23:
v_cmp_gt_u32 vcc, s77, v31
s_nop 1
s_cbranch_vccz P22
s_add_u32 s76, s76, 1
s_cmp_gt_u32 s76, 400000
s_cbranch_scc1 P22
s_sleep 4
buffer_load_dword v31, v6, s[8:11], s94 offen sc1
s_waitcnt vmcnt(0)
s_branch P23
P22:
s_barrier
s_add_u32 s28, s19, 16
s_lshl_b32 s28, s28, 6
v_add_u32 v29, s28, v0
v_lshlrev_b32 v29, 4, v29
s_mov_b32 s29, 14798848
buffer_load_dwordx4 v[192:195], v29, s[8:11], s29 offen sc1
s_add_u32 s29, s29, 32768
buffer_load_dwordx4 v[196:199], v29, s[8:11], s29 offen sc1
s_add_u32 s29, s29, 32768
buffer_load_dwordx4 v[200:203], v29, s[8:11], s29 offen sc1
s_add_u32 s29, s29, 32768
buffer_load_dwordx4 v[204:207], v29, s[8:11], s29 offen sc1
s_add_u32 s29, s29, 32768
buffer_load_dwordx4 v[208:211], v29, s[8:11], s29 offen sc1
s_add_u32 s29, s29, 32768
buffer_load_dwordx4 v[212:215], v29, s[8:11], s29 offen sc1
s_add_u32 s29, s29, 32768
buffer_load_dwordx4 v[216:219], v29, s[8:11], s29 offen sc1
s_add_u32 s29, s29, 32768
buffer_load_dwordx4 v[220:223], v29, s[8:11], s29 offen sc1
s_waitcnt lgkmcnt(0)
v_mfma_f32_16x16x32_bf16 v[32:35], a[144:147], v[128:131], v[32:35]
ds_read_b128 v[144:147], v188 offset:53248
v_mfma_f32_16x16x32_bf16 v[36:39], a[144:147], v[132:135], v[36:39]
ds_read_b128 v[148:151], v188 offset:53504
v_mfma_f32_16x16x32_bf16 v[40:43], a[144:147], v[136:139], v[40:43]
ds_read_b128 v[152:155], v189 offset:53248
v_mfma_f32_16x16x32_bf16 v[44:47], a[144:147], v[140:143], v[44:47]
ds_read_b128 v[156:159], v189 offset:53504
v_mfma_f32_16x16x32_bf16 v[48:51], a[148:151], v[128:131], v[48:51]
s_add_u32 s26, s19, 16
s_mul_i32 s26, s26, 81920
s_add_u32 s26, s26, 11915264
s_add_u32 s26, s26, s30
s_add_u32 m0, s30, 16384
s_nop 0
buffer_load_dwordx4 v1, s[8:11], s26 offen sc1 lds
buffer_load_dwordx4 v1, s[8:11], s26 offen offset:1024 sc1 lds
s_add_u32 s26, s26, 8192
v_mfma_f32_16x16x32_bf16 v[52:55], a[148:151], v[132:135], v[52:55]
v_mfma_f32_16x16x32_bf16 v[56:59], a[148:151], v[136:139], v[56:59]
v_mfma_f32_16x16x32_bf16 v[60:63], a[148:151], v[140:143], v[60:63]
s_add_u32 m0, s30, 24576
s_nop 0
buffer_load_dwordx4 v1, s[8:11], s26 offen sc1 lds
buffer_load_dwordx4 v1, s[8:11], s26 offen offset:1024 sc1 lds
s_add_u32 s26, s26, 8192
v_mfma_f32_16x16x32_bf16 v[64:67], a[152:155], v[128:131], v[64:67]
v_mfma_f32_16x16x32_bf16 v[68:71], a[152:155], v[132:135], v[68:71]
v_mfma_f32_16x16x32_bf16 v[72:75], a[152:155], v[136:139], v[72:75]
s_add_u32 m0, s30, 32768
s_nop 0
buffer_load_dwordx4 v1, s[8:11], s26 offen sc1 lds
buffer_load_dwordx4 v1, s[8:11], s26 offen offset:1024 sc1 lds
s_add_u32 s26, s26, 8192
v_mfma_f32_16x16x32_bf16 v[76:79], a[152:155], v[140:143], v[76:79]
s_barrier
s_waitcnt lgkmcnt(0)
v_mfma_f32_16x16x32_bf16 v[32:35], a[156:159], v[144:147], v[32:35]
ds_read_b128 v[128:131], v188 offset:57344
v_mfma_f32_16x16x32_bf16 v[36:39], a[156:159], v[148:151], v[36:39]
ds_read_b128 v[132:135], v188 offset:57600
v_mfma_f32_16x16x32_bf16 v[40:43], a[156:159], v[152:155], v[40:43]
ds_read_b128 v[136:139], v189 offset:57344
v_mfma_f32_16x16x32_bf16 v[44:47], a[156:159], v[156:159], v[44:47]
ds_read_b128 v[140:143], v189 offset:57600
v_mfma_f32_16x16x32_bf16 v[48:51], a[160:163], v[144:147], v[48:51]
s_add_u32 m0, s30, 40960
s_nop 0
buffer_load_dwordx4 v1, s[8:11], s26 offen sc1 lds
buffer_load_dwordx4 v1, s[8:11], s26 offen offset:1024 sc1 lds
s_add_u32 s26, s26, 8192
v_mfma_f32_16x16x32_bf16 v[52:55], a[160:163], v[148:151], v[52:55]
v_mfma_f32_16x16x32_bf16 v[56:59], a[160:163], v[152:155], v[56:59]
v_mfma_f32_16x16x32_bf16 v[60:63], a[160:163], v[156:159], v[60:63]
v_mfma_f32_16x16x32_bf16 v[64:67], a[164:167], v[144:147], v[64:67]
v_mfma_f32_16x16x32_bf16 v[68:71], a[164:167], v[148:151], v[68:71]
v_mfma_f32_16x16x32_bf16 v[72:75], a[164:167], v[152:155], v[72:75]
v_mfma_f32_16x16x32_bf16 v[76:79], a[164:167], v[156:159], v[76:79]
s_waitcnt lgkmcnt(0)
v_mfma_f32_16x16x32_bf16 v[32:35], a[168:171], v[128:131], v[32:35]
ds_read_b128 v[144:147], v188 offset:61440
v_mfma_f32_16x16x32_bf16 v[36:39], a[168:171], v[132:135], v[36:39]
ds_read_b128 v[148:151], v188 offset:61696
v_mfma_f32_16x16x32_bf16 v[40:43], a[168:171], v[136:139], v[40:43]
ds_read_b128 v[152:155], v189 offset:61440
v_mfma_f32_16x16x32_bf16 v[44:47], a[168:171], v[140:143], v[44:47]
ds_read_b128 v[156:159], v189 offset:61696
v_mfma_f32_16x16x32_bf16 v[48:51], a[172:175], v[128:131], v[48:51]
v_mfma_f32_16x16x32_bf16 v[52:55], a[172:175], v[132:135], v[52:55]
v_mfma_f32_16x16x32_bf16 v[56:59], a[172:175], v[136:139], v[56:59]
v_mfma_f32_16x16x32_bf16 v[60:63], a[172:175], v[140:143], v[60:63]
v_mfma_f32_16x16x32_bf16 v[64:67], a[176:179], v[128:131], v[64:67]
v_mfma_f32_16x16x32_bf16 v[68:71], a[176:179], v[132:135], v[68:71]
v_mfma_f32_16x16x32_bf16 v[72:75], a[176:179], v[136:139], v[72:75]
v_mfma_f32_16x16x32_bf16 v[76:79], a[176:179], v[140:143], v[76:79]
s_barrier
s_waitcnt lgkmcnt(0)
v_mfma_f32_16x16x32_bf16 v[32:35], a[180:183], v[144:147], v[32:35]
ds_read_b128 v[128:131], v188 offset:0
v_mfma_f32_16x16x32_bf16 v[36:39], a[180:183], v[148:151], v[36:39]
ds_read_b128 v[132:135], v188 offset:256
v_mfma_f32_16x16x32_bf16 v[40:43], a[180:183], v[152:155], v[40:43]
ds_read_b128 v[136:139], v189 offset:0
v_mfma_f32_16x16x32_bf16 v[44:47], a[180:183], v[156:159], v[44:47]
ds_read_b128 v[140:143], v189 offset:256
v_mfma_f32_16x16x32_bf16 v[48:51], a[184:187], v[144:147], v[48:51]
s_add_u32 m0, s30, 49152
s_nop 0
buffer_load_dwordx4 v1, s[8:11], s26 offen sc1 lds
buffer_load_dwordx4 v1, s[8:11], s26 offen offset:1024 sc1 lds
s_add_u32 s26, s26, 8192
v_mfma_f32_16x16x32_bf16 v[52:55], a[184:187], v[148:151], v[52:55]
s_waitcnt vmcnt(10)
v_mfma_f32_16x16x32_bf16 v[56:59], a[184:187], v[152:155], v[56:59]
v_add_f32 v192, v192, v208
v_mfma_f32_16x16x32_bf16 v[60:63], a[184:187], v[156:159], v[60:63]
v_mfma_f32_16x16x32_bf16 v[64:67], a[188:191], v[144:147], v[64:67]
v_add_f32 v193, v193, v209
v_mfma_f32_16x16x32_bf16 v[68:71], a[188:191], v[148:151], v[68:71]
v_add_f32 v194, v194, v210
v_mfma_f32_16x16x32_bf16 v[72:75], a[188:191], v[152:155], v[72:75]
v_mfma_f32_16x16x32_bf16 v[76:79], a[188:191], v[156:159], v[76:79]
v_add_f32 v195, v195, v211
s_waitcnt lgkmcnt(0)
v_mfma_f32_16x16x32_bf16 v[32:35], a[192:195], v[128:131], v[32:35]
ds_read_b128 v[144:147], v188 offset:4096
v_mfma_f32_16x16x32_bf16 v[36:39], a[192:195], v[132:135], v[36:39]
ds_read_b128 v[148:151], v188 offset:4352
v_mfma_f32_16x16x32_bf16 v[40:43], a[192:195], v[136:139], v[40:43]
ds_read_b128 v[152:155], v189 offset:4096
v_mfma_f32_16x16x32_bf16 v[44:47], a[192:195], v[140:143], v[44:47]
ds_read_b128 v[156:159], v189 offset:4352
v_mfma_f32_16x16x32_bf16 v[48:51], a[196:199], v[128:131], v[48:51]
v_mfma_f32_16x16x32_bf16 v[52:55], a[196:199], v[132:135], v[52:55]
v_add_f32 v196, v196, v212
v_mfma_f32_16x16x32_bf16 v[56:59], a[196:199], v[136:139], v[56:59]
v_add_f32 v197, v197, v213
v_mfma_f32_16x16x32_bf16 v[60:63], a[196:199], v[140:143], v[60:63]
v_mfma_f32_16x16x32_bf16 v[64:67], a[200:203], v[128:131], v[64:67]
v_add_f32 v198, v198, v214
v_mfma_f32_16x16x32_bf16 v[68:71], a[200:203], v[132:135], v[68:71]
v_add_f32 v199, v199, v215
v_mfma_f32_16x16x32_bf16 v[72:75], a[200:203], v[136:139], v[72:75]
v_mfma_f32_16x16x32_bf16 v[76:79], a[200:203], v[140:143], v[76:79]
v_add_f32 v200, v200, v216
s_barrier
s_waitcnt lgkmcnt(0)
v_mfma_f32_16x16x32_bf16 v[32:35], a[204:207], v[144:147], v[32:35]
ds_read_b128 v[128:131], v188 offset:8192
v_mfma_f32_16x16x32_bf16 v[36:39], a[204:207], v[148:151], v[36:39]
ds_read_b128 v[132:135], v188 offset:8448
v_mfma_f32_16x16x32_bf16 v[40:43], a[204:207], v[152:155], v[40:43]
ds_read_b128 v[136:139], v189 offset:8192
v_mfma_f32_16x16x32_bf16 v[44:47], a[204:207], v[156:159], v[44:47]
ds_read_b128 v[140:143], v189 offset:8448
v_mfma_f32_16x16x32_bf16 v[48:51], a[208:211], v[144:147], v[48:51]
s_add_u32 m0, s30, 57344
s_nop 0
buffer_load_dwordx4 v1, s[8:11], s26 offen sc1 lds
buffer_load_dwordx4 v1, s[8:11], s26 offen offset:1024 sc1 lds
s_add_u32 s26, s26, 8192
v_mfma_f32_16x16x32_bf16 v[52:55], a[208:211], v[148:151], v[52:55]
v_add_f32 v201, v201, v217
v_mfma_f32_16x16x32_bf16 v[56:59], a[208:211], v[152:155], v[56:59]
v_add_f32 v202, v202, v218
v_mfma_f32_16x16x32_bf16 v[60:63], a[208:211], v[156:159], v[60:63]
v_mfma_f32_16x16x32_bf16 v[64:67], a[212:215], v[144:147], v[64:67]
v_add_f32 v203, v203, v219
v_mfma_f32_16x16x32_bf16 v[68:71], a[212:215], v[148:151], v[68:71]
v_add_f32 v204, v204, v220
v_mfma_f32_16x16x32_bf16 v[72:75], a[212:215], v[152:155], v[72:75]
v_mfma_f32_16x16x32_bf16 v[76:79], a[212:215], v[156:159], v[76:79]
v_add_f32 v205, v205, v221
s_waitcnt lgkmcnt(0)
v_mfma_f32_16x16x32_bf16 v[32:35], a[216:219], v[128:131], v[32:35]
ds_read_b128 v[144:147], v188 offset:12288
v_mfma_f32_16x16x32_bf16 v[36:39], a[216:219], v[132:135], v[36:39]
ds_read_b128 v[148:151], v188 offset:12544
v_mfma_f32_16x16x32_bf16 v[40:43], a[216:219], v[136:139], v[40:43]
ds_read_b128 v[152:155], v189 offset:12288
v_mfma_f32_16x16x32_bf16 v[44:47], a[216:219], v[140:143], v[44:47]
ds_read_b128 v[156:159], v189 offset:12544
v_mfma_f32_16x16x32_bf16 v[48:51], a[220:223], v[128:131], v[48:51]
v_mfma_f32_16x16x32_bf16 v[52:55], a[220:223], v[132:135], v[52:55]
v_add_f32 v206, v206, v222
v_mfma_f32_16x16x32_bf16 v[56:59], a[220:223], v[136:139], v[56:59]
v_add_f32 v207, v207, v223
v_mfma_f32_16x16x32_bf16 v[60:63], a[220:223], v[140:143], v[60:63]
v_mfma_f32_16x16x32_bf16 v[64:67], a[224:227], v[128:131], v[64:67]
v_add_f32 v192, v192, v200
v_mfma_f32_16x16x32_bf16 v[68:71], a[224:227], v[132:135], v[68:71]
v_add_f32 v193, v193, v201
v_mfma_f32_16x16x32_bf16 v[72:75], a[224:227], v[136:139], v[72:75]
v_mfma_f32_16x16x32_bf16 v[76:79], a[224:227], v[140:143], v[76:79]
v_add_f32 v194, v194, v202
s_waitcnt vmcnt(10)
s_barrier
s_waitcnt lgkmcnt(0)
v_mfma_f32_16x16x32_bf16 v[32:35], a[228:231], v[144:147], v[32:35]
ds_read_b128 v[128:131], v188 offset:16384
v_mfma_f32_16x16x32_bf16 v[36:39], a[228:231], v[148:151], v[36:39]
ds_read_b128 v[132:135], v188 offset:16640
v_mfma_f32_16x16x32_bf16 v[40:43], a[228:231], v[152:155], v[40:43]
ds_read_b128 v[136:139], v189 offset:16384
v_mfma_f32_16x16x32_bf16 v[44:47], a[228:231], v[156:159], v[44:47]
ds_read_b128 v[140:143], v189 offset:16640
v_mfma_f32_16x16x32_bf16 v[48:51], a[232:235], v[144:147], v[48:51]
s_add_u32 m0, s30, 0
s_nop 0
buffer_load_dwordx4 v1, s[8:11], s26 offen sc1 lds
buffer_load_dwordx4 v1, s[8:11], s26 offen offset:1024 sc1 lds
s_add_u32 s26, s26, 8192
v_mfma_f32_16x16x32_bf16 v[52:55], a[232:235], v[148:151], v[52:55]
v_add_f32 v195, v195, v203
v_mfma_f32_16x16x32_bf16 v[56:59], a[232:235], v[152:155], v[56:59]
v_add_f32 v196, v196, v204
v_mfma_f32_16x16x32_bf16 v[60:63], a[232:235], v[156:159], v[60:63]
v_mfma_f32_16x16x32_bf16 v[64:67], a[236:239], v[144:147], v[64:67]
v_add_f32 v197, v197, v205
v_mfma_f32_16x16x32_bf16 v[68:71], a[236:239], v[148:151], v[68:71]
v_add_f32 v198, v198, v206
v_mfma_f32_16x16x32_bf16 v[72:75], a[236:239], v[152:155], v[72:75]
v_mfma_f32_16x16x32_bf16 v[76:79], a[236:239], v[156:159], v[76:79]
v_add_f32 v199, v199, v207
v_add_f32 v192, v192, v196
v_add_f32 v193, v193, v197
v_add_f32 v194, v194, v198
v_add_f32 v195, v195, v199
v_add_f32 v192, v192, v194
v_add_f32 v193, v193, v195
v_mul_f32 v28, 0x3acccccd, v192
v_mul_f32 v26, 0x3acccccd, v193
v_fma_f32 v26, -v28, v28, v26
v_max_f32 v26, 0, v26
v_add_f32 v26, 0x3727c5ac, v26
v_rsq_f32 v27, v26
s_nop 0
ds_bpermute_b32 v164, v240, v27
ds_bpermute_b32 v172, v240, v28
ds_bpermute_b32 v165, v241, v27
ds_bpermute_b32 v173, v241, v28
ds_bpermute_b32 v166, v242, v27
ds_bpermute_b32 v174, v242, v28
ds_bpermute_b32 v167, v243, v27
ds_bpermute_b32 v175, v243, v28
s_waitcnt lgkmcnt(0)
v_mul_f32_e64 v80, -v172, v176
v_mul_f32_e64 v81, -v172, v177
v_mul_f32_e64 v82, -v172, v178
v_mul_f32_e64 v83, -v172, v179
v_mul_f32_e64 v84, -v173, v176
v_mul_f32_e64 v85, -v173, v177
v_mul_f32_e64 v86, -v173, v178
v_mul_f32_e64 v87, -v173, v179
v_mul_f32_e64 v88, -v174, v176
v_mul_f32_e64 v89, -v174, v177
v_mul_f32_e64 v90, -v174, v178
v_mul_f32_e64 v91, -v174, v179
v_mul_f32_e64 v92, -v175, v176
v_mul_f32_e64 v93, -v175, v177
v_mul_f32_e64 v94, -v175, v178
v_mul_f32_e64 v95, -v175, v179
v_mul_f32_e64 v96, -v172, v180
v_mul_f32_e64 v97, -v172, v181
v_mul_f32_e64 v98, -v172, v182
v_mul_f32_e64 v99, -v172, v183
v_mul_f32_e64 v100, -v173, v180
v_mul_f32_e64 v101, -v173, v181
v_mul_f32_e64 v102, -v173, v182
v_mul_f32_e64 v103, -v173, v183
v_mul_f32_e64 v104, -v174, v180
v_mul_f32_e64 v105, -v174, v181
v_mul_f32_e64 v106, -v174, v182
v_mul_f32_e64 v107, -v174, v183
v_mul_f32_e64 v108, -v175, v180
v_mul_f32_e64 v109, -v175, v181
v_mul_f32_e64 v110, -v175, v182
v_mul_f32_e64 v111, -v175, v183
v_mul_f32_e64 v112, -v172, v184
v_mul_f32_e64 v113, -v172, v185
v_mul_f32_e64 v114, -v172, v186
v_mul_f32_e64 v115, -v172, v187
v_mul_f32_e64 v116, -v173, v184
v_mul_f32_e64 v117, -v173, v185
v_mul_f32_e64 v118, -v173, v186
v_mul_f32_e64 v119, -v173, v187
v_mul_f32_e64 v120, -v174, v184
v_mul_f32_e64 v121, -v174, v185
v_mul_f32_e64 v122, -v174, v186
v_mul_f32_e64 v123, -v174, v187
v_mul_f32_e64 v124, -v175, v184
v_mul_f32_e64 v125, -v175, v185
v_mul_f32_e64 v126, -v175, v186
v_mul_f32_e64 v127, -v175, v187
s_nop 3
v_mfma_f32_16x16x32_bf16 v[80:83], a[0:3], v[128:131], v[80:83]
ds_read_b128 v[144:147], v188 offset:20480
v_mfma_f32_16x16x32_bf16 v[84:87], a[0:3], v[132:135], v[84:87]
ds_read_b128 v[148:151], v188 offset:20736
v_mfma_f32_16x16x32_bf16 v[88:91], a[0:3], v[136:139], v[88:91]
ds_read_b128 v[152:155], v189 offset:20480
v_mfma_f32_16x16x32_bf16 v[92:95], a[0:3], v[140:143], v[92:95]
ds_read_b128 v[156:159], v189 offset:20736
s_mul_i32 s36, s25, 245760
s_mul_i32 s28, s16, 61440
s_add_u32 s36, s36, s28
s_add_u32 s36, s36, 7208960
buffer_load_dwordx4 a[0:3], v11, s[8:11], s36 offen offset:0
v_mfma_f32_16x16x32_bf16 v[96:99], a[4:7], v[128:131], v[96:99]
v_mfma_f32_16x16x32_bf16 v[100:103], a[4:7], v[132:135], v[100:103]
v_mul_f32 v32, v32, v160
v_mfma_f32_16x16x32_bf16 v[104:107], a[4:7], v[136:139], v[104:107]
v_mul_f32 v33, v33, v160
v_mfma_f32_16x16x32_bf16 v[108:111], a[4:7], v[140:143], v[108:111]
buffer_load_dwordx4 a[4:7], v11, s[8:11], s36 offen offset:256
v_mfma_f32_16x16x32_bf16 v[112:115], a[8:11], v[128:131], v[112:115]
v_mul_f32 v34, v34, v160
v_mfma_f32_16x16x32_bf16 v[116:119], a[8:11], v[132:135], v[116:119]
v_mul_f32 v35, v35, v160
v_mfma_f32_16x16x32_bf16 v[120:123], a[8:11], v[136:139], v[120:123]
v_mfma_f32_16x16x32_bf16 v[124:127], a[8:11], v[140:143], v[124:127]
v_mul_f32 v36, v36, v161
buffer_load_dwordx4 a[8:11], v11, s[8:11], s36 offen offset:512
s_waitcnt vmcnt(13)
s_barrier
s_waitcnt lgkmcnt(0)
v_mfma_f32_16x16x32_bf16 v[80:83], a[12:15], v[144:147], v[80:83]
ds_read_b128 v[128:131], v188 offset:24576
v_mfma_f32_16x16x32_bf16 v[84:87], a[12:15], v[148:151], v[84:87]
ds_read_b128 v[132:135], v188 offset:24832
v_mfma_f32_16x16x32_bf16 v[88:91], a[12:15], v[152:155], v[88:91]
ds_read_b128 v[136:139], v189 offset:24576
v_mfma_f32_16x16x32_bf16 v[92:95], a[12:15], v[156:159], v[92:95]
ds_read_b128 v[140:143], v189 offset:24832
buffer_load_dwordx4 a[12:15], v11, s[8:11], s36 offen offset:768
v_mfma_f32_16x16x32_bf16 v[96:99], a[16:19], v[144:147], v[96:99]
s_add_u32 m0, s30, 8192
s_nop 0
buffer_load_dwordx4 v1, s[8:11], s26 offen sc1 lds
buffer_load_dwordx4 v1, s[8:11], s26 offen offset:1024 sc1 lds
s_add_u32 s26, s26, 8192
v_mfma_f32_16x16x32_bf16 v[100:103], a[16:19], v[148:151], v[100:103]
v_mul_f32 v37, v37, v161
v_mfma_f32_16x16x32_bf16 v[104:107], a[16:19], v[152:155], v[104:107]
v_mul_f32 v38, v38, v161
v_mfma_f32_16x16x32_bf16 v[108:111], a[16:19], v[156:159], v[108:111]
buffer_load_dwordx4 a[16:19], v11, s[8:11], s36 offen offset:1024
v_mfma_f32_16x16x32_bf16 v[112:115], a[20:23], v[144:147], v[112:115]
v_mul_f32 v39, v39, v161
v_mfma_f32_16x16x32_bf16 v[116:119], a[20:23], v[148:151], v[116:119]
v_mul_f32 v40, v40, v162
v_mfma_f32_16x16x32_bf16 v[120:123], a[20:23], v[152:155], v[120:123]
v_mfma_f32_16x16x32_bf16 v[124:127], a[20:23], v[156:159], v[124:127]
v_mul_f32 v41, v41, v162
s_add_u32 s36, s36, 5120
buffer_load_dwordx4 a[20:23], v11, s[8:11], s36 offen offset:0
s_waitcnt lgkmcnt(0)
v_mfma_f32_16x16x32_bf16 v[80:83], a[24:27], v[128:131], v[80:83]
ds_read_b128 v[144:147], v188 offset:28672
v_mfma_f32_16x16x32_bf16 v[84:87], a[24:27], v[132:135], v[84:87]
ds_read_b128 v[148:151], v188 offset:28928
v_mfma_f32_16x16x32_bf16 v[88:91], a[24:27], v[136:139], v[88:91]
ds_read_b128 v[152:155], v189 offset:28672
v_mfma_f32_16x16x32_bf16 v[92:95], a[24:27], v[140:143], v[92:95]
ds_read_b128 v[156:159], v189 offset:28928
buffer_load_dwordx4 a[24:27], v11, s[8:11], s36 offen offset:256
v_mfma_f32_16x16x32_bf16 v[96:99], a[28:31], v[128:131], v[96:99]
v_mfma_f32_16x16x32_bf16 v[100:103], a[28:31], v[132:135], v[100:103]
v_mul_f32 v42, v42, v162
v_mfma_f32_16x16x32_bf16 v[104:107], a[28:31], v[136:139], v[104:107]
v_mul_f32 v43, v43, v162
v_mfma_f32_16x16x32_bf16 v[108:111], a[28:31], v[140:143], v[108:111]
buffer_load_dwordx4 a[28:31], v11, s[8:11], s36 offen offset:512
v_mfma_f32_16x16x32_bf16 v[112:115], a[32:35], v[128:131], v[112:115]
v_mul_f32 v44, v44, v163
v_mfma_f32_16x16x32_bf16 v[116:119], a[32:35], v[132:135], v[116:119]
v_mul_f32 v45, v45, v163
v_mfma_f32_16x16x32_bf16 v[120:123], a[32:35], v[136:139], v[120:123]
v_mfma_f32_16x16x32_bf16 v[124:127], a[32:35], v[140:143], v[124:127]
v_mul_f32 v46, v46, v163
buffer_load_dwordx4 a[32:35], v11, s[8:11], s36 offen offset:768
s_waitcnt vmcnt(19)
s_barrier
s_waitcnt lgkmcnt(0)
v_mfma_f32_16x16x32_bf16 v[80:83], a[36:39], v[144:147], v[80:83]
ds_read_b128 v[128:131], v188 offset:32768
v_mfma_f32_16x16x32_bf16 v[84:87], a[36:39], v[148:151], v[84:87]
ds_read_b128 v[132:135], v188 offset:33024
v_mfma_f32_16x16x32_bf16 v[88:91], a[36:39], v[152:155], v[88:91]
ds_read_b128 v[136:139], v189 offset:32768
v_mfma_f32_16x16x32_bf16 v[92:95], a[36:39], v[156:159], v[92:95]
ds_read_b128 v[140:143], v189 offset:33024
buffer_load_dwordx4 a[36:39], v11, s[8:11], s36 offen offset:1024
v_mfma_f32_16x16x32_bf16 v[96:99], a[40:43], v[144:147], v[96:99]
s_add_u32 m0, s30, 16384
s_nop 0
buffer_load_dwordx4 v1, s[8:11], s26 offen sc1 lds
buffer_load_dwordx4 v1, s[8:11], s26 offen offset:1024 sc1 lds
s_add_u32 s26, s26, 8192
v_mfma_f32_16x16x32_bf16 v[100:103], a[40:43], v[148:151], v[100:103]
v_mul_f32 v47, v47, v163
v_mfma_f32_16x16x32_bf16 v[104:107], a[40:43], v[152:155], v[104:107]
v_mul_f32 v48, v48, v160
v_mfma_f32_16x16x32_bf16 v[108:111], a[40:43], v[156:159], v[108:111]
s_add_u32 s36, s36, 5120
buffer_load_dwordx4 a[40:43], v11, s[8:11], s36 offen offset:0
v_mfma_f32_16x16x32_bf16 v[112:115], a[44:47], v[144:147], v[112:115]
v_mul_f32 v49, v49, v160
v_mfma_f32_16x16x32_bf16 v[116:119], a[44:47], v[148:151], v[116:119]
v_mul_f32 v50, v50, v160
v_mfma_f32_16x16x32_bf16 v[120:123], a[44:47], v[152:155], v[120:123]
v_mfma_f32_16x16x32_bf16 v[124:127], a[44:47], v[156:159], v[124:127]
v_mul_f32 v51, v51, v160
buffer_load_dwordx4 a[44:47], v11, s[8:11], s36 offen offset:256
s_waitcnt lgkmcnt(0)
v_mfma_f32_16x16x32_bf16 v[80:83], a[48:51], v[128:131], v[80:83]
ds_read_b128 v[144:147], v188 offset:36864
v_mfma_f32_16x16x32_bf16 v[84:87], a[48:51], v[132:135], v[84:87]
ds_read_b128 v[148:151], v188 offset:37120
v_mfma_f32_16x16x32_bf16 v[88:91], a[48:51], v[136:139], v[88:91]
ds_read_b128 v[152:155], v189 offset:36864
v_mfma_f32_16x16x32_bf16 v[92:95], a[48:51], v[140:143], v[92:95]
ds_read_b128 v[156:159], v189 offset:37120
buffer_load_dwordx4 a[48:51], v11, s[8:11], s36 offen offset:512
v_mfma_f32_16x16x32_bf16 v[96:99], a[52:55], v[128:131], v[96:99]
v_mfma_f32_16x16x32_bf16 v[100:103], a[52:55], v[132:135], v[100:103]
v_mul_f32 v52, v52, v161
v_mfma_f32_16x16x32_bf16 v[104:107], a[52:55], v[136:139], v[104:107]
v_mul_f32 v53, v53, v161
v_mfma_f32_16x16x32_bf16 v[108:111], a[52:55], v[140:143], v[108:111]
buffer_load_dwordx4 a[52:55], v11, s[8:11], s36 offen offset:768
v_mfma_f32_16x16x32_bf16 v[112:115], a[56:59], v[128:131], v[112:115]
v_mul_f32 v54, v54, v161
v_mfma_f32_16x16x32_bf16 v[116:119], a[56:59], v[132:135], v[116:119]
v_mul_f32 v55, v55, v161
v_mfma_f32_16x16x32_bf16 v[120:123], a[56:59], v[136:139], v[120:123]
v_mfma_f32_16x16x32_bf16 v[124:127], a[56:59], v[140:143], v[124:127]
v_mul_f32 v56, v56, v162
buffer_load_dwordx4 a[56:59], v11, s[8:11], s36 offen offset:1024
v_mul_f32 v57, v57, v162
v_mul_f32 v58, v58, v162
v_mul_f32 v59, v59, v162
v_mul_f32 v60, v60, v163
v_mul_f32 v61, v61, v163
v_mul_f32 v62, v62, v163
v_mul_f32 v63, v63, v163
v_mul_f32 v64, v64, v160
v_mul_f32 v65, v65, v160
v_mul_f32 v66, v66, v160
v_mul_f32 v67, v67, v160
v_mul_f32 v68, v68, v161
v_mul_f32 v69, v69, v161
v_mul_f32 v70, v70, v161
v_mul_f32 v71, v71, v161
v_mul_f32 v72, v72, v162
v_mul_f32 v73, v73, v162
v_mul_f32 v74, v74, v162
v_mul_f32 v75, v75, v162
v_mul_f32 v76, v76, v163
v_mul_f32 v77, v77, v163
v_mul_f32 v78, v78, v163
v_mul_f32 v79, v79, v163
s_mul_i32 s28, s16, 6144
s_add_u32 s28, s28, 65536
v_add_u32 v29, s28, v1
s_nop 0
ds_write_b128 v29, v[40:43] offset:0
ds_write_b128 v29, v[44:47] offset:1024
ds_write_b128 v29, v[56:59] offset:2048
ds_write_b128 v29, v[60:63] offset:3072
ds_write_b128 v29, v[72:75] offset:4096
ds_write_b128 v29, v[76:79] offset:5120
s_waitcnt lgkmcnt(0)
s_waitcnt vmcnt(25)
s_barrier
v_mfma_f32_16x16x32_bf16 v[80:83], a[60:63], v[144:147], v[80:83]
ds_read_b128 v[128:131], v188 offset:40960
v_mfma_f32_16x16x32_bf16 v[84:87], a[60:63], v[148:151], v[84:87]
ds_read_b128 v[132:135], v188 offset:41216
v_mfma_f32_16x16x32_bf16 v[88:91], a[60:63], v[152:155], v[88:91]
ds_read_b128 v[136:139], v189 offset:40960
v_mfma_f32_16x16x32_bf16 v[92:95], a[60:63], v[156:159], v[92:95]
ds_read_b128 v[140:143], v189 offset:41216
s_add_u32 s36, s36, 5120
buffer_load_dwordx4 a[60:63], v11, s[8:11], s36 offen offset:0
v_mfma_f32_16x16x32_bf16 v[96:99], a[64:67], v[144:147], v[96:99]
s_add_u32 m0, s30, 24576
s_nop 0
buffer_load_dwordx4 v1, s[8:11], s26 offen sc1 lds
buffer_load_dwordx4 v1, s[8:11], s26 offen offset:1024 sc1 lds
s_add_u32 s26, s26, 8192
v_mfma_f32_16x16x32_bf16 v[100:103], a[64:67], v[148:151], v[100:103]
s_xor_b32 s28, s16, 2
s_mul_i32 s28, s28, 6144
s_add_u32 s28, s28, 65536
v_add_u32 v29, s28, v1
s_nop 0
ds_read_b128 v[192:195], v29 offset:0
ds_read_b128 v[196:199], v29 offset:1024
ds_read_b128 v[200:203], v29 offset:2048
ds_read_b128 v[204:207], v29 offset:3072
ds_read_b128 v[208:211], v29 offset:4096
ds_read_b128 v[212:215], v29 offset:5120
v_lshrrev_b32 v28, 1, v5
v_lshlrev_b32 v28, 10, v28
v_and_b32 v27, 1, v5
v_lshl_add_u32 v28, v27, 8, v28
v_lshl_add_u32 v28, v4, 4, v28
s_lshr_b32 s28, s16, 1
s_lshl_b32 s28, s28, 9
v_add_u32 v28, s28, v28
s_add_u32 s28, s19, 0
s_mul_i32 s37, s28, 196608
s_mul_i32 s28, s21, 96
s_and_b32 s29, s16, 1
s_mul_i32 s29, s29, 48
s_add_u32 s28, s28, s29
s_lshl_b32 s28, s28, 7
s_add_u32 s37, s37, s28
s_add_u32 s37, s37, 25546752
s_waitcnt lgkmcnt(0)
v_mfma_f32_16x16x32_bf16 v[104:107], a[64:67], v[152:155], v[104:107]
v_mul_f32 v32, v32, v192
v_mfma_f32_16x16x32_bf16 v[108:111], a[64:67], v[156:159], v[108:111]
buffer_load_dwordx4 a[64:67], v11, s[8:11], s36 offen offset:256
v_mfma_f32_16x16x32_bf16 v[112:115], a[68:71], v[144:147], v[112:115]
v_mul_f32 v33, v33, v193
v_mfma_f32_16x16x32_bf16 v[116:119], a[68:71], v[148:151], v[116:119]
v_mul_f32 v34, v34, v194
v_mfma_f32_16x16x32_bf16 v[120:123], a[68:71], v[152:155], v[120:123]
v_mfma_f32_16x16x32_bf16 v[124:127], a[68:71], v[156:159], v[124:127]
v_mul_f32 v35, v35, v195
buffer_load_dwordx4 a[68:71], v11, s[8:11], s36 offen offset:512
v_mfma_f32_16x16x32_bf16 v[80:83], a[72:75], v[128:131], v[80:83]
ds_read_b128 v[144:147], v188 offset:45056
v_mfma_f32_16x16x32_bf16 v[84:87], a[72:75], v[132:135], v[84:87]
ds_read_b128 v[148:151], v188 offset:45312
v_mfma_f32_16x16x32_bf16 v[88:91], a[72:75], v[136:139], v[88:91]
ds_read_b128 v[152:155], v189 offset:45056
v_mfma_f32_16x16x32_bf16 v[92:95], a[72:75], v[140:143], v[92:95]
ds_read_b128 v[156:159], v189 offset:45312
buffer_load_dwordx4 a[72:75], v11, s[8:11], s36 offen offset:768
v_mfma_f32_16x16x32_bf16 v[96:99], a[76:79], v[128:131], v[96:99]
v_mfma_f32_16x16x32_bf16 v[100:103], a[76:79], v[132:135], v[100:103]
v_cvt_pk_bf16_f32 v16, v32, v33
v_mfma_f32_16x16x32_bf16 v[104:107], a[76:79], v[136:139], v[104:107]
v_cvt_pk_bf16_f32 v17, v34, v35
v_mfma_f32_16x16x32_bf16 v[108:111], a[76:79], v[140:143], v[108:111]
buffer_load_dwordx4 a[76:79], v11, s[8:11], s36 offen offset:1024
v_mfma_f32_16x16x32_bf16 v[112:115], a[80:83], v[128:131], v[112:115]
v_mul_f32 v36, v36, v196
v_mfma_f32_16x16x32_bf16 v[116:119], a[80:83], v[132:135], v[116:119]
v_mul_f32 v37, v37, v197
v_mfma_f32_16x16x32_bf16 v[120:123], a[80:83], v[136:139], v[120:123]
v_mfma_f32_16x16x32_bf16 v[124:127], a[80:83], v[140:143], v[124:127]
v_mul_f32 v38, v38, v198
s_add_u32 s36, s36, 5120
buffer_load_dwordx4 a[80:83], v11, s[8:11], s36 offen offset:0
s_waitcnt vmcnt(31)
s_barrier
s_waitcnt lgkmcnt(0)
v_mfma_f32_16x16x32_bf16 v[80:83], a[84:87], v[144:147], v[80:83]
ds_read_b128 v[128:131], v188 offset:49152
v_mfma_f32_16x16x32_bf16 v[84:87], a[84:87], v[148:151], v[84:87]
ds_read_b128 v[132:135], v188 offset:49408
v_mfma_f32_16x16x32_bf16 v[88:91], a[84:87], v[152:155], v[88:91]
ds_read_b128 v[136:139], v189 offset:49152
v_mfma_f32_16x16x32_bf16 v[92:95], a[84:87], v[156:159], v[92:95]
ds_read_b128 v[140:143], v189 offset:49408
buffer_load_dwordx4 a[84:87], v11, s[8:11], s36 offen offset:256
v_mfma_f32_16x16x32_bf16 v[96:99], a[88:91], v[144:147], v[96:99]
v_mfma_f32_16x16x32_bf16 v[100:103], a[88:91], v[148:151], v[100:103]
v_mul_f32 v39, v39, v199
v_mfma_f32_16x16x32_bf16 v[104:107], a[88:91], v[152:155], v[104:107]
v_cvt_pk_bf16_f32 v18, v36, v37
v_mfma_f32_16x16x32_bf16 v[108:111], a[88:91], v[156:159], v[108:111]
buffer_load_dwordx4 a[88:91], v11, s[8:11], s36 offen offset:512
v_mfma_f32_16x16x32_bf16 v[112:115], a[92:95], v[144:147], v[112:115]
v_cvt_pk_bf16_f32 v19, v38, v39
v_mfma_f32_16x16x32_bf16 v[116:119], a[92:95], v[148:151], v[116:119]
s_nop 0
s_nop 0
v_permlane16_swap_b32 v16, v18
v_permlane16_swap_b32 v17, v19
s_nop 0
buffer_store_dwordx4 v[16:19], v28, s[8:11], s37 offen offset:0 sc1
s_nop 0
v_mfma_f32_16x16x32_bf16 v[120:123], a[92:95], v[152:155], v[120:123]
v_mfma_f32_16x16x32_bf16 v[124:127], a[92:95], v[156:159], v[124:127]
v_mul_f32 v48, v48, v200
buffer_load_dwordx4 a[92:95], v11, s[8:11], s36 offen offset:768
s_waitcnt lgkmcnt(0)
v_mfma_f32_16x16x32_bf16 v[80:83], a[96:99], v[128:131], v[80:83]
ds_read_b128 v[144:147], v188 offset:53248
v_mfma_f32_16x16x32_bf16 v[84:87], a[96:99], v[132:135], v[84:87]
ds_read_b128 v[148:151], v188 offset:53504
v_mfma_f32_16x16x32_bf16 v[88:91], a[96:99], v[136:139], v[88:91]
ds_read_b128 v[152:155], v189 offset:53248
v_mfma_f32_16x16x32_bf16 v[92:95], a[96:99], v[140:143], v[92:95]
ds_read_b128 v[156:159], v189 offset:53504
buffer_load_dwordx4 a[96:99], v11, s[8:11], s36 offen offset:1024
v_mfma_f32_16x16x32_bf16 v[96:99], a[100:103], v[128:131], v[96:99]
v_mfma_f32_16x16x32_bf16 v[100:103], a[100:103], v[132:135], v[100:103]
v_mul_f32 v49, v49, v201
v_mfma_f32_16x16x32_bf16 v[104:107], a[100:103], v[136:139], v[104:107]
v_mul_f32 v50, v50, v202
v_mfma_f32_16x16x32_bf16 v[108:111], a[100:103], v[140:143], v[108:111]
s_add_u32 s36, s36, 5120
buffer_load_dwordx4 a[100:103], v11, s[8:11], s36 offen offset:0
v_mfma_f32_16x16x32_bf16 v[112:115], a[104:107], v[128:131], v[112:115]
v_mul_f32 v51, v51, v203
v_mfma_f32_16x16x32_bf16 v[116:119], a[104:107], v[132:135], v[116:119]
v_cvt_pk_bf16_f32 v20, v48, v49
v_mfma_f32_16x16x32_bf16 v[120:123], a[104:107], v[136:139], v[120:123]
v_mfma_f32_16x16x32_bf16 v[124:127], a[104:107], v[140:143], v[124:127]
v_cvt_pk_bf16_f32 v21, v50, v51
buffer_load_dwordx4 a[104:107], v11, s[8:11], s36 offen offset:256
v_mul_f32 v52, v52, v204
v_mul_f32 v53, v53, v205
v_mul_f32 v54, v54, v206
v_mul_f32 v55, v55, v207
v_cvt_pk_bf16_f32 v22, v52, v53
v_cvt_pk_bf16_f32 v23, v54, v55
s_nop 0
s_nop 0
v_permlane16_swap_b32 v20, v22
v_permlane16_swap_b32 v21, v23
s_nop 0
buffer_store_dwordx4 v[20:23], v28, s[8:11], s37 offen offset:2048 sc1
s_nop 0
v_mul_f32 v64, v64, v208
v_mul_f32 v65, v65, v209
v_mul_f32 v66, v66, v210
v_mul_f32 v67, v67, v211
v_cvt_pk_bf16_f32 v16, v64, v65
v_cvt_pk_bf16_f32 v17, v66, v67
v_mul_f32 v68, v68, v212
v_mul_f32 v69, v69, v213
v_mul_f32 v70, v70, v214
v_mul_f32 v71, v71, v215
v_cvt_pk_bf16_f32 v18, v68, v69
v_cvt_pk_bf16_f32 v19, v70, v71
s_add_u32 s37, s37, 4096
s_nop 0
v_permlane16_swap_b32 v16, v18
v_permlane16_swap_b32 v17, v19
s_nop 0
buffer_store_dwordx4 v[16:19], v28, s[8:11], s37 offen offset:0 sc1
s_nop 0
s_waitcnt vmcnt(38)
s_barrier
s_waitcnt lgkmcnt(0)
v_mfma_f32_16x16x32_bf16 v[80:83], a[108:111], v[144:147], v[80:83]
ds_read_b128 v[128:131], v188 offset:57344
v_mfma_f32_16x16x32_bf16 v[84:87], a[108:111], v[148:151], v[84:87]
ds_read_b128 v[132:135], v188 offset:57600
v_mfma_f32_16x16x32_bf16 v[88:91], a[108:111], v[152:155], v[88:91]
ds_read_b128 v[136:139], v189 offset:57344
v_mfma_f32_16x16x32_bf16 v[92:95], a[108:111], v[156:159], v[92:95]
ds_read_b128 v[140:143], v189 offset:57600
buffer_load_dwordx4 a[108:111], v11, s[8:11], s36 offen offset:512
v_mfma_f32_16x16x32_bf16 v[96:99], a[112:115], v[144:147], v[96:99]
v_mfma_f32_16x16x32_bf16 v[100:103], a[112:115], v[148:151], v[100:103]
v_mfma_f32_16x16x32_bf16 v[104:107], a[112:115], v[152:155], v[104:107]
v_mfma_f32_16x16x32_bf16 v[108:111], a[112:115], v[156:159], v[108:111]
buffer_load_dwordx4 a[112:115], v11, s[8:11], s36 offen offset:768
v_mfma_f32_16x16x32_bf16 v[112:115], a[116:119], v[144:147], v[112:115]
v_mfma_f32_16x16x32_bf16 v[116:119], a[116:119], v[148:151], v[116:119]
v_mfma_f32_16x16x32_bf16 v[120:123], a[116:119], v[152:155], v[120:123]
v_mfma_f32_16x16x32_bf16 v[124:127], a[116:119], v[156:159], v[124:127]
buffer_load_dwordx4 a[116:119], v11, s[8:11], s36 offen offset:1024
s_waitcnt lgkmcnt(0)
v_mfma_f32_16x16x32_bf16 v[80:83], a[120:123], v[128:131], v[80:83]
ds_read_b128 v[144:147], v188 offset:61440
v_mfma_f32_16x16x32_bf16 v[84:87], a[120:123], v[132:135], v[84:87]
ds_read_b128 v[148:151], v188 offset:61696
v_mfma_f32_16x16x32_bf16 v[88:91], a[120:123], v[136:139], v[88:91]
ds_read_b128 v[152:155], v189 offset:61440
v_mfma_f32_16x16x32_bf16 v[92:95], a[120:123], v[140:143], v[92:95]
ds_read_b128 v[156:159], v189 offset:61696
s_add_u32 s36, s36, 5120
buffer_load_dwordx4 a[120:123], v11, s[8:11], s36 offen offset:0
v_mfma_f32_16x16x32_bf16 v[96:99], a[124:127], v[128:131], v[96:99]
v_mfma_f32_16x16x32_bf16 v[100:103], a[124:127], v[132:135], v[100:103]
v_mfma_f32_16x16x32_bf16 v[104:107], a[124:127], v[136:139], v[104:107]
v_mfma_f32_16x16x32_bf16 v[108:111], a[124:127], v[140:143], v[108:111]
buffer_load_dwordx4 a[124:127], v11, s[8:11], s36 offen offset:256
v_mfma_f32_16x16x32_bf16 v[112:115], a[128:131], v[128:131], v[112:115]
v_mfma_f32_16x16x32_bf16 v[116:119], a[128:131], v[132:135], v[116:119]
v_mfma_f32_16x16x32_bf16 v[120:123], a[128:131], v[136:139], v[120:123]
v_mfma_f32_16x16x32_bf16 v[124:127], a[128:131], v[140:143], v[124:127]
buffer_load_dwordx4 a[128:131], v11, s[8:11], s36 offen offset:512
s_add_u32 s28, s19, 0
s_lshl_b32 s28, s28, 7
s_add_u32 s28, s28, 9201664
s_waitcnt vmcnt(6)
s_barrier
s_cmp_lg_u32 s16, 0
s_cbranch_scc1 S24
s_mov_b64 exec, 1
buffer_atomic_add v7, v6, s[8:11], s28 offen sc1
s_mov_b64 exec, -1
S24:
s_barrier
s_waitcnt lgkmcnt(0)
v_mfma_f32_16x16x32_bf16 v[80:83], a[132:135], v[144:147], v[80:83]
ds_read_b128 v[128:131], v188 offset:0
v_mfma_f32_16x16x32_bf16 v[84:87], a[132:135], v[148:151], v[84:87]
ds_read_b128 v[132:135], v188 offset:256
v_mfma_f32_16x16x32_bf16 v[88:91], a[132:135], v[152:155], v[88:91]
ds_read_b128 v[136:139], v189 offset:0
v_mfma_f32_16x16x32_bf16 v[92:95], a[132:135], v[156:159], v[92:95]
ds_read_b128 v[140:143], v189 offset:256
buffer_load_dwordx4 a[132:135], v11, s[8:11], s36 offen offset:768
v_mfma_f32_16x16x32_bf16 v[96:99], a[136:139], v[144:147], v[96:99]
v_mfma_f32_16x16x32_bf16 v[100:103], a[136:139], v[148:151], v[100:103]
v_mfma_f32_16x16x32_bf16 v[104:107], a[136:139], v[152:155], v[104:107]
v_mfma_f32_16x16x32_bf16 v[108:111], a[136:139], v[156:159], v[108:111]
buffer_load_dwordx4 a[136:139], v11, s[8:11], s36 offen offset:1024
v_mfma_f32_16x16x32_bf16 v[112:115], a[140:143], v[144:147], v[112:115]
v_mfma_f32_16x16x32_bf16 v[116:119], a[140:143], v[148:151], v[116:119]
v_mfma_f32_16x16x32_bf16 v[120:123], a[140:143], v[152:155], v[120:123]
v_mfma_f32_16x16x32_bf16 v[124:127], a[140:143], v[156:159], v[124:127]
s_add_u32 s36, s36, 5120
buffer_load_dwordx4 a[140:143], v11, s[8:11], s36 offen offset:0
s_waitcnt lgkmcnt(0)
v_mfma_f32_16x16x32_bf16 v[80:83], a[144:147], v[128:131], v[80:83]
ds_read_b128 v[144:147], v188 offset:4096
v_mfma_f32_16x16x32_bf16 v[84:87], a[144:147], v[132:135], v[84:87]
ds_read_b128 v[148:151], v188 offset:4352
v_mfma_f32_16x16x32_bf16 v[88:91], a[144:147], v[136:139], v[88:91]
ds_read_b128 v[152:155], v189 offset:4096
v_mfma_f32_16x16x32_bf16 v[92:95], a[144:147], v[140:143], v[92:95]
ds_read_b128 v[156:159], v189 offset:4352
buffer_load_dwordx4 a[144:147], v11, s[8:11], s36 offen offset:256
v_mfma_f32_16x16x32_bf16 v[96:99], a[148:151], v[128:131], v[96:99]
v_mfma_f32_16x16x32_bf16 v[100:103], a[148:151], v[132:135], v[100:103]
v_mfma_f32_16x16x32_bf16 v[104:107], a[148:151], v[136:139], v[104:107]
v_mfma_f32_16x16x32_bf16 v[108:111], a[148:151], v[140:143], v[108:111]
buffer_load_dwordx4 a[148:151], v11, s[8:11], s36 offen offset:512
v_mfma_f32_16x16x32_bf16 v[112:115], a[152:155], v[128:131], v[112:115]
v_mfma_f32_16x16x32_bf16 v[116:119], a[152:155], v[132:135], v[116:119]
v_mfma_f32_16x16x32_bf16 v[120:123], a[152:155], v[136:139], v[120:123]
v_mfma_f32_16x16x32_bf16 v[124:127], a[152:155], v[140:143], v[124:127]
buffer_load_dwordx4 a[152:155], v11, s[8:11], s36 offen offset:768
s_barrier
s_waitcnt lgkmcnt(0)
v_mfma_f32_16x16x32_bf16 v[80:83], a[156:159], v[144:147], v[80:83]
ds_read_b128 v[128:131], v188 offset:8192
v_mfma_f32_16x16x32_bf16 v[84:87], a[156:159], v[148:151], v[84:87]
ds_read_b128 v[132:135], v188 offset:8448
v_mfma_f32_16x16x32_bf16 v[88:91], a[156:159], v[152:155], v[88:91]
ds_read_b128 v[136:139], v189 offset:8192
v_mfma_f32_16x16x32_bf16 v[92:95], a[156:159], v[156:159], v[92:95]
ds_read_b128 v[140:143], v189 offset:8448
buffer_load_dwordx4 a[156:159], v11, s[8:11], s36 offen offset:1024
v_mfma_f32_16x16x32_bf16 v[96:99], a[160:163], v[144:147], v[96:99]
v_mfma_f32_16x16x32_bf16 v[100:103], a[160:163], v[148:151], v[100:103]
v_mfma_f32_16x16x32_bf16 v[104:107], a[160:163], v[152:155], v[104:107]
v_mfma_f32_16x16x32_bf16 v[108:111], a[160:163], v[156:159], v[108:111]
s_add_u32 s36, s36, 5120
buffer_load_dwordx4 a[160:163], v11, s[8:11], s36 offen offset:0
v_mfma_f32_16x16x32_bf16 v[112:115], a[164:167], v[144:147], v[112:115]
v_mfma_f32_16x16x32_bf16 v[116:119], a[164:167], v[148:151], v[116:119]
v_mfma_f32_16x16x32_bf16 v[120:123], a[164:167], v[152:155], v[120:123]
v_mfma_f32_16x16x32_bf16 v[124:127], a[164:167], v[156:159], v[124:127]
buffer_load_dwordx4 a[164:167], v11, s[8:11], s36 offen offset:256
s_and_b32 s28, s24, 1
s_lshl_b32 s28, s28, 5
s_and_b32 s29, s16, 1
s_lshl_b32 s29, s29, 4
s_add_u32 s28, s28, s29
v_add_u32 v225, s28, v4
s_lshr_b32 s28, s24, 1
s_add_u32 s28, s28, 0
s_mul_i32 s28, s28, 81920
s_mul_i32 s29, s25, 10240
s_add_u32 s28, s28, s29
s_add_u32 s28, s28, 11915264
v_lshrrev_b32 v28, 1, v5
v_lshlrev_b32 v28, 10, v28
v_and_b32 v29, 1, v5
v_lshl_add_u32 v28, v29, 3, v28
v_lshl_add_u32 v245, v225, 4, v28
s_lshr_b32 s29, s16, 1
s_mul_i32 s29, s29, 6144
s_add_u32 s28, s28, s29
buffer_load_dwordx2 v[248:249], v245, s[8:11], s28 offen sc1
buffer_load_dwordx2 v[250:251], v245, s[8:11], s28 offen offset:2048 sc1
s_lshr_b32 s29, s16, 1
s_lshl_b32 s29, s29, 11
s_sub_u32 s28, s28, s29
s_add_u32 s28, s28, 4096
buffer_load_dwordx2 v[252:253], v245, s[8:11], s28 offen sc1
s_waitcnt lgkmcnt(0)
v_mfma_f32_16x16x32_bf16 v[80:83], a[168:171], v[128:131], v[80:83]
ds_read_b128 v[144:147], v188 offset:12288
v_mfma_f32_16x16x32_bf16 v[84:87], a[168:171], v[132:135], v[84:87]
ds_read_b128 v[148:151], v188 offset:12544
v_mfma_f32_16x16x32_bf16 v[88:91], a[168:171], v[136:139], v[88:91]
ds_read_b128 v[152:155], v189 offset:12288
v_mfma_f32_16x16x32_bf16 v[92:95], a[168:171], v[140:143], v[92:95]
ds_read_b128 v[156:159], v189 offset:12544
buffer_load_dwordx4 a[168:171], v11, s[8:11], s36 offen offset:512
v_mfma_f32_16x16x32_bf16 v[96:99], a[172:175], v[128:131], v[96:99]
v_mfma_f32_16x16x32_bf16 v[100:103], a[172:175], v[132:135], v[100:103]
v_mfma_f32_16x16x32_bf16 v[104:107], a[172:175], v[136:139], v[104:107]
v_mfma_f32_16x16x32_bf16 v[108:111], a[172:175], v[140:143], v[108:111]
buffer_load_dwordx4 a[172:175], v11, s[8:11], s36 offen offset:768
v_mfma_f32_16x16x32_bf16 v[112:115], a[176:179], v[128:131], v[112:115]
v_mfma_f32_16x16x32_bf16 v[116:119], a[176:179], v[132:135], v[116:119]
v_mfma_f32_16x16x32_bf16 v[120:123], a[176:179], v[136:139], v[120:123]
v_mfma_f32_16x16x32_bf16 v[124:127], a[176:179], v[140:143], v[124:127]
buffer_load_dwordx4 a[176:179], v11, s[8:11], s36 offen offset:1024
s_barrier
s_waitcnt lgkmcnt(0)
v_mfma_f32_16x16x32_bf16 v[80:83], a[180:183], v[144:147], v[80:83]
ds_read_b128 v[128:131], v188 offset:16384
v_mfma_f32_16x16x32_bf16 v[84:87], a[180:183], v[148:151], v[84:87]
ds_read_b128 v[132:135], v188 offset:16640
v_mfma_f32_16x16x32_bf16 v[88:91], a[180:183], v[152:155], v[88:91]
ds_read_b128 v[136:139], v189 offset:16384
v_mfma_f32_16x16x32_bf16 v[92:95], a[180:183], v[156:159], v[92:95]
ds_read_b128 v[140:143], v189 offset:16640
s_add_u32 s36, s36, 5120
buffer_load_dwordx4 a[180:183], v11, s[8:11], s36 offen offset:0
v_mfma_f32_16x16x32_bf16 v[96:99], a[184:187], v[144:147], v[96:99]
v_mfma_f32_16x16x32_bf16 v[100:103], a[184:187], v[148:151], v[100:103]
v_mfma_f32_16x16x32_bf16 v[104:107], a[184:187], v[152:155], v[104:107]
v_mfma_f32_16x16x32_bf16 v[108:111], a[184:187], v[156:159], v[108:111]
buffer_load_dwordx4 a[184:187], v11, s[8:11], s36 offen offset:256
v_mfma_f32_16x16x32_bf16 v[112:115], a[188:191], v[144:147], v[112:115]
v_mfma_f32_16x16x32_bf16 v[116:119], a[188:191], v[148:151], v[116:119]
v_mfma_f32_16x16x32_bf16 v[120:123], a[188:191], v[152:155], v[120:123]
v_mfma_f32_16x16x32_bf16 v[124:127], a[188:191], v[156:159], v[124:127]
buffer_load_dwordx4 a[188:191], v11, s[8:11], s36 offen offset:512
s_lshr_b32 s29, s24, 1
s_lshl_b32 s29, s29, 7
s_add_u32 s94, s29, 9201664
buffer_load_dword v31, v6, s[8:11], s94 offen sc1
s_waitcnt lgkmcnt(0)
v_mfma_f32_16x16x32_bf16 v[80:83], a[192:195], v[128:131], v[80:83]
ds_read_b128 v[144:147], v188 offset:20480
v_mfma_f32_16x16x32_bf16 v[84:87], a[192:195], v[132:135], v[84:87]
ds_read_b128 v[148:151], v188 offset:20736
v_mfma_f32_16x16x32_bf16 v[88:91], a[192:195], v[136:139], v[88:91]
ds_read_b128 v[152:155], v189 offset:20480
v_mfma_f32_16x16x32_bf16 v[92:95], a[192:195], v[140:143], v[92:95]
ds_read_b128 v[156:159], v189 offset:20736
buffer_load_dwordx4 a[192:195], v11, s[8:11], s36 offen offset:768
v_mfma_f32_16x16x32_bf16 v[96:99], a[196:199], v[128:131], v[96:99]
v_mfma_f32_16x16x32_bf16 v[100:103], a[196:199], v[132:135], v[100:103]
v_mfma_f32_16x16x32_bf16 v[104:107], a[196:199], v[136:139], v[104:107]
v_mfma_f32_16x16x32_bf16 v[108:111], a[196:199], v[140:143], v[108:111]
buffer_load_dwordx4 a[196:199], v11, s[8:11], s36 offen offset:1024
v_mfma_f32_16x16x32_bf16 v[112:115], a[200:203], v[128:131], v[112:115]
v_mfma_f32_16x16x32_bf16 v[116:119], a[200:203], v[132:135], v[116:119]
v_mfma_f32_16x16x32_bf16 v[120:123], a[200:203], v[136:139], v[120:123]
v_mfma_f32_16x16x32_bf16 v[124:127], a[200:203], v[140:143], v[124:127]
s_add_u32 s36, s36, 5120
buffer_load_dwordx4 a[200:203], v11, s[8:11], s36 offen offset:0
s_barrier
s_waitcnt lgkmcnt(0)
v_mfma_f32_16x16x32_bf16 v[80:83], a[204:207], v[144:147], v[80:83]
ds_read_b128 v[128:131], v188 offset:24576
v_mfma_f32_16x16x32_bf16 v[84:87], a[204:207], v[148:151], v[84:87]
ds_read_b128 v[132:135], v188 offset:24832
v_mfma_f32_16x16x32_bf16 v[88:91], a[204:207], v[152:155], v[88:91]
ds_read_b128 v[136:139], v189 offset:24576
v_mfma_f32_16x16x32_bf16 v[92:95], a[204:207], v[156:159], v[92:95]
ds_read_b128 v[140:143], v189 offset:24832
buffer_load_dwordx4 a[204:207], v11, s[8:11], s36 offen offset:256
v_mfma_f32_16x16x32_bf16 v[96:99], a[208:211], v[144:147], v[96:99]
v_mfma_f32_16x16x32_bf16 v[100:103], a[208:211], v[148:151], v[100:103]
v_mfma_f32_16x16x32_bf16 v[104:107], a[208:211], v[152:155], v[104:107]
v_mfma_f32_16x16x32_bf16 v[108:111], a[208:211], v[156:159], v[108:111]
buffer_load_dwordx4 a[208:211], v11, s[8:11], s36 offen offset:512
v_mfma_f32_16x16x32_bf16 v[112:115], a[212:215], v[144:147], v[112:115]
v_mfma_f32_16x16x32_bf16 v[116:119], a[212:215], v[148:151], v[116:119]
v_mfma_f32_16x16x32_bf16 v[120:123], a[212:215], v[152:155], v[120:123]
v_mfma_f32_16x16x32_bf16 v[124:127], a[212:215], v[156:159], v[124:127]
buffer_load_dwordx4 a[212:215], v11, s[8:11], s36 offen offset:768
s_waitcnt lgkmcnt(0)
v_mfma_f32_16x16x32_bf16 v[80:83], a[216:219], v[128:131], v[80:83]
ds_read_b128 v[144:147], v188 offset:28672
v_mfma_f32_16x16x32_bf16 v[84:87], a[216:219], v[132:135], v[84:87]
ds_read_b128 v[148:151], v188 offset:28928
v_mfma_f32_16x16x32_bf16 v[88:91], a[216:219], v[136:139], v[88:91]
ds_read_b128 v[152:155], v189 offset:28672
v_mfma_f32_16x16x32_bf16 v[92:95], a[216:219], v[140:143], v[92:95]
ds_read_b128 v[156:159], v189 offset:28928
buffer_load_dwordx4 a[216:219], v11, s[8:11], s36 offen offset:1024
v_mfma_f32_16x16x32_bf16 v[96:99], a[220:223], v[128:131], v[96:99]
v_mfma_f32_16x16x32_bf16 v[100:103], a[220:223], v[132:135], v[100:103]
v_mfma_f32_16x16x32_bf16 v[104:107], a[220:223], v[136:139], v[104:107]
v_mfma_f32_16x16x32_bf16 v[108:111], a[220:223], v[140:143], v[108:111]
s_add_u32 s36, s36, 5120
buffer_load_dwordx4 a[220:223], v11, s[8:11], s36 offen offset:0
v_mfma_f32_16x16x32_bf16 v[112:115], a[224:227], v[128:131], v[112:115]
v_mfma_f32_16x16x32_bf16 v[116:119], a[224:227], v[132:135], v[116:119]
v_mfma_f32_16x16x32_bf16 v[120:123], a[224:227], v[136:139], v[120:123]
v_mfma_f32_16x16x32_bf16 v[124:127], a[224:227], v[140:143], v[124:127]
buffer_load_dwordx4 a[224:227], v11, s[8:11], s36 offen offset:256
s_waitcnt vmcnt(9)
s_cmp_lg_u32 s16, 0
s_cbranch_scc1 P25
s_movk_i32 s77, 16
P26:
v_cmp_gt_u32 vcc, s77, v31
s_nop 1
s_cbranch_vccz P25
s_add_u32 s76, s76, 1
s_cmp_gt_u32 s76, 400000
s_cbranch_scc1 P25
s_sleep 4
buffer_load_dword v31, v6, s[8:11], s94 offen sc1
s_waitcnt vmcnt(0)
s_branch P26
P25:
s_barrier
s_lshr_b32 s28, s24, 1
s_add_u32 s28, s28, 0
s_mul_i32 s87, s28, 196608
s_add_u32 s87, s87, 25546752
s_mul_i32 s28, s16, 49152
s_add_u32 s87, s87, s28
s_and_b32 s28, s24, 1
s_lshl_b32 s28, s28, 9
s_add_u32 s87, s87, s28
s_and_b32 s28, s16, 1
s_lshl_b32 s28, s28, 8
v_add_u32 v254, s28, v10
s_xor_b32 s28, s28, 256
v_add_u32 v247, s28, v10
buffer_load_dwordx4 v[32:35], v254, s[8:11], s87 offen sc1
buffer_load_dwordx4 v[36:39], v247, s[8:11], s87 offen sc1
s_add_u32 s87, s87, 4096
buffer_load_dwordx4 v[40:43], v254, s[8:11], s87 offen sc1
buffer_load_dwordx4 v[44:47], v247, s[8:11], s87 offen sc1
s_add_u32 s87, s87, 4096
buffer_load_dwordx4 v[48:51], v254, s[8:11], s87 offen sc1
buffer_load_dwordx4 v[52:55], v247, s[8:11], s87 offen sc1
s_add_u32 s87, s87, 4096
buffer_load_dwordx4 v[56:59], v254, s[8:11], s87 offen sc1
buffer_load_dwordx4 v[60:63], v247, s[8:11], s87 offen sc1
s_add_u32 s87, s87, 4096
buffer_load_dwordx4 v[64:67], v254, s[8:11], s87 offen sc1
buffer_load_dwordx4 v[68:71], v247, s[8:11], s87 offen sc1
s_add_u32 s87, s87, 4096
buffer_load_dwordx4 v[72:75], v254, s[8:11], s87 offen sc1
buffer_load_dwordx4 v[76:79], v247, s[8:11], s87 offen sc1
s_add_u32 s87, s87, 4096
s_waitcnt lgkmcnt(0)
v_mfma_f32_16x16x32_bf16 v[80:83], a[228:231], v[144:147], v[80:83]
v_mfma_f32_16x16x32_bf16 v[84:87], a[228:231], v[148:151], v[84:87]
v_mfma_f32_16x16x32_bf16 v[88:91], a[228:231], v[152:155], v[88:91]
v_mfma_f32_16x16x32_bf16 v[92:95], a[228:231], v[156:159], v[92:95]
buffer_load_dwordx4 a[228:231], v11, s[8:11], s36 offen offset:512
v_mfma_f32_16x16x32_bf16 v[96:99], a[232:235], v[144:147], v[96:99]
v_mfma_f32_16x16x32_bf16 v[100:103], a[232:235], v[148:151], v[100:103]
v_mfma_f32_16x16x32_bf16 v[104:107], a[232:235], v[152:155], v[104:107]
v_mfma_f32_16x16x32_bf16 v[108:111], a[232:235], v[156:159], v[108:111]
buffer_load_dwordx4 a[232:235], v11, s[8:11], s36 offen offset:768
v_mfma_f32_16x16x32_bf16 v[112:115], a[236:239], v[144:147], v[112:115]
v_mfma_f32_16x16x32_bf16 v[116:119], a[236:239], v[148:151], v[116:119]
v_mfma_f32_16x16x32_bf16 v[120:123], a[236:239], v[152:155], v[120:123]
v_mfma_f32_16x16x32_bf16 v[124:127], a[236:239], v[156:159], v[124:127]
buffer_load_dwordx4 a[236:239], v11, s[8:11], s36 offen offset:1024
s_nop 5
v_mul_f32 v80, v80, v164
v_mul_f32 v81, v81, v164
v_mul_f32 v82, v82, v164
v_mul_f32 v83, v83, v164
v_mul_f32 v84, v84, v165
v_mul_f32 v85, v85, v165
v_mul_f32 v86, v86, v165
v_mul_f32 v87, v87, v165
v_mul_f32 v88, v88, v166
v_mul_f32 v89, v89, v166
v_mul_f32 v90, v90, v166
v_mul_f32 v91, v91, v166
v_mul_f32 v92, v92, v167
v_mul_f32 v93, v93, v167
v_mul_f32 v94, v94, v167
v_mul_f32 v95, v95, v167
v_mul_f32 v96, v96, v164
v_mul_f32 v97, v97, v164
v_mul_f32 v98, v98, v164
v_mul_f32 v99, v99, v164
v_mul_f32 v100, v100, v165
v_mul_f32 v101, v101, v165
v_mul_f32 v102, v102, v165
v_mul_f32 v103, v103, v165
v_mul_f32 v104, v104, v166
v_mul_f32 v105, v105, v166
v_mul_f32 v106, v106, v166
v_mul_f32 v107, v107, v166
v_mul_f32 v108, v108, v167
v_mul_f32 v109, v109, v167
v_mul_f32 v110, v110, v167
v_mul_f32 v111, v111, v167
v_mul_f32 v112, v112, v164
v_mul_f32 v113, v113, v164
v_mul_f32 v114, v114, v164
v_mul_f32 v115, v115, v164
v_mul_f32 v116, v116, v165
v_mul_f32 v117, v117, v165
v_mul_f32 v118, v118, v165
v_mul_f32 v119, v119, v165
v_mul_f32 v120, v120, v166
v_mul_f32 v121, v121, v166
v_mul_f32 v122, v122, v166
v_mul_f32 v123, v123, v166
v_mul_f32 v124, v124, v167
v_mul_f32 v125, v125, v167
v_mul_f32 v126, v126, v167
v_mul_f32 v127, v127, v167
s_mul_i32 s28, s16, 6144
s_add_u32 s28, s28, 65536
v_add_u32 v29, s28, v1
s_nop 0
ds_write_b128 v29, v[88:91] offset:0
ds_write_b128 v29, v[92:95] offset:1024
ds_write_b128 v29, v[104:107] offset:2048
ds_write_b128 v29, v[108:111] offset:3072
ds_write_b128 v29, v[120:123] offset:4096
ds_write_b128 v29, v[124:127] offset:5120
s_waitcnt lgkmcnt(0)
s_barrier
s_xor_b32 s28, s16, 2
s_mul_i32 s28, s28, 6144
s_add_u32 s28, s28, 65536
v_add_u32 v29, s28, v1
s_nop 0
ds_read_b128 v[192:195], v29 offset:0
ds_read_b128 v[196:199], v29 offset:1024
ds_read_b128 v[200:203], v29 offset:2048
ds_read_b128 v[204:207], v29 offset:3072
ds_read_b128 v[208:211], v29 offset:4096
ds_read_b128 v[212:215], v29 offset:5120
v_lshrrev_b32 v28, 1, v5
v_lshlrev_b32 v28, 10, v28
v_and_b32 v27, 1, v5
v_lshl_add_u32 v28, v27, 8, v28
v_lshl_add_u32 v28, v4, 4, v28
s_lshr_b32 s28, s16, 1
s_lshl_b32 s28, s28, 9
v_add_u32 v28, s28, v28
s_add_u32 s28, s19, 16
s_mul_i32 s37, s28, 196608
s_mul_i32 s28, s21, 96
s_and_b32 s29, s16, 1
s_mul_i32 s29, s29, 48
s_add_u32 s28, s28, s29
s_lshl_b32 s28, s28, 7
s_add_u32 s37, s37, s28
s_add_u32 s37, s37, 25546752
s_waitcnt lgkmcnt(0)
v_mul_f32 v80, v80, v192
v_mul_f32 v81, v81, v193
v_mul_f32 v82, v82, v194
v_mul_f32 v83, v83, v195
v_cvt_pk_bf16_f32 v16, v80, v81
v_cvt_pk_bf16_f32 v17, v82, v83
v_mul_f32 v84, v84, v196
v_mul_f32 v85, v85, v197
v_mul_f32 v86, v86, v198
v_mul_f32 v87, v87, v199
v_cvt_pk_bf16_f32 v18, v84, v85
v_cvt_pk_bf16_f32 v19, v86, v87
s_nop 0
s_nop 0
v_permlane16_swap_b32 v16, v18
v_permlane16_swap_b32 v17, v19
s_nop 0
buffer_store_dwordx4 v[16:19], v28, s[8:11], s37 offen offset:0 sc1
s_nop 0
v_mul_f32 v96, v96, v200
v_mul_f32 v97, v97, v201
v_mul_f32 v98, v98, v202
v_mul_f32 v99, v99, v203
v_cvt_pk_bf16_f32 v20, v96, v97
v_cvt_pk_bf16_f32 v21, v98, v99
v_mul_f32 v100, v100, v204
v_mul_f32 v101, v101, v205
v_mul_f32 v102, v102, v206
v_mul_f32 v103, v103, v207
v_cvt_pk_bf16_f32 v22, v100, v101
v_cvt_pk_bf16_f32 v23, v102, v103
s_nop 0
s_nop 0
v_permlane16_swap_b32 v20, v22
v_permlane16_swap_b32 v21, v23
s_nop 0
buffer_store_dwordx4 v[20:23], v28, s[8:11], s37 offen offset:2048 sc1
s_nop 0
v_mul_f32 v112, v112, v208
v_mul_f32 v113, v113, v209
v_mul_f32 v114, v114, v210
v_mul_f32 v115, v115, v211
v_cvt_pk_bf16_f32 v16, v112, v113
v_cvt_pk_bf16_f32 v17, v114, v115
v_mul_f32 v116, v116, v212
v_mul_f32 v117, v117, v213
v_mul_f32 v118, v118, v214
v_mul_f32 v119, v119, v215
v_cvt_pk_bf16_f32 v18, v116, v117
v_cvt_pk_bf16_f32 v19, v118, v119
s_add_u32 s37, s37, 4096
s_nop 0
v_permlane16_swap_b32 v16, v18
v_permlane16_swap_b32 v17, v19
s_nop 0
buffer_store_dwordx4 v[16:19], v28, s[8:11], s37 offen offset:0 sc1
s_nop 0
buffer_load_dwordx4 v[80:83], v254, s[8:11], s87 offen sc1
buffer_load_dwordx4 v[84:87], v247, s[8:11], s87 offen sc1
s_add_u32 s87, s87, 4096
buffer_load_dwordx4 v[88:91], v254, s[8:11], s87 offen sc1
buffer_load_dwordx4 v[92:95], v247, s[8:11], s87 offen sc1
s_add_u32 s87, s87, 4096
buffer_load_dwordx4 v[96:99], v254, s[8:11], s87 offen sc1
buffer_load_dwordx4 v[100:103], v247, s[8:11], s87 offen sc1
s_add_u32 s87, s87, 4096
buffer_load_dwordx4 v[104:107], v254, s[8:11], s87 offen sc1
buffer_load_dwordx4 v[108:111], v247, s[8:11], s87 offen sc1
s_add_u32 s87, s87, 4096
buffer_load_dwordx4 v[112:115], v254, s[8:11], s87 offen sc1
buffer_load_dwordx4 v[116:119], v247, s[8:11], s87 offen sc1
s_add_u32 s87, s87, 4096
buffer_load_dwordx4 v[120:123], v254, s[8:11], s87 offen sc1
buffer_load_dwordx4 v[124:127], v247, s[8:11], s87 offen sc1
s_add_u32 s87, s87, 4096
s_and_b32 s28, s24, 1
s_lshl_b32 s28, s28, 5
s_and_b32 s29, s16, 1
s_lshl_b32 s29, s29, 4
s_add_u32 s28, s28, s29
v_add_u32 v244, s28, v4
s_lshr_b32 s28, s24, 1
s_add_u32 s28, s28, 16
s_mul_i32 s28, s28, 81920
s_mul_i32 s29, s25, 10240
s_add_u32 s28, s28, s29
s_add_u32 s28, s28, 11915264
v_lshrrev_b32 v28, 1, v5
v_lshlrev_b32 v28, 10, v28
v_and_b32 v29, 1, v5
v_lshl_add_u32 v28, v29, 3, v28
v_lshl_add_u32 v246, v244, 4, v28
s_lshr_b32 s29, s16, 1
s_mul_i32 s29, s29, 6144
s_add_u32 s28, s28, s29
buffer_load_dwordx2 v[232:233], v246, s[8:11], s28 offen sc1
buffer_load_dwordx2 v[234:235], v246, s[8:11], s28 offen offset:2048 sc1
s_lshr_b32 s29, s16, 1
s_lshl_b32 s29, s29, 11
s_sub_u32 s28, s28, s29
s_add_u32 s28, s28, 4096
buffer_load_dwordx2 v[236:237], v246, s[8:11], s28 offen sc1
s_waitcnt vmcnt(31)
v_mfma_f32_16x16x32_bf16 v[184:187], a[0:3], v[32:35], 0
v_mfma_f32_16x16x32_bf16 v[204:207], a[0:3], v[36:39], 0
v_mfma_f32_16x16x32_bf16 v[188:191], a[4:7], v[32:35], 0
v_mfma_f32_16x16x32_bf16 v[208:211], a[4:7], v[36:39], 0
v_mfma_f32_16x16x32_bf16 v[192:195], a[8:11], v[32:35], 0
v_mfma_f32_16x16x32_bf16 v[212:215], a[8:11], v[36:39], 0
v_mfma_f32_16x16x32_bf16 v[196:199], a[12:15], v[32:35], 0
v_mfma_f32_16x16x32_bf16 v[216:219], a[12:15], v[36:39], 0
v_mfma_f32_16x16x32_bf16 v[200:203], a[16:19], v[32:35], 0
v_mfma_f32_16x16x32_bf16 v[220:223], a[16:19], v[36:39], 0
s_add_u32 s28, s19, 16
s_lshl_b32 s28, s28, 7
s_add_u32 s28, s28, 9201664
s_waitcnt vmcnt(15)
s_barrier
s_cmp_lg_u32 s16, 0
s_cbranch_scc1 S27
s_mov_b64 exec, 1
buffer_atomic_add v7, v6, s[8:11], s28 offen sc1
s_mov_b64 exec, -1
S27:
v_mfma_f32_16x16x32_bf16 v[184:187], a[20:23], v[40:43], v[184:187]
v_mfma_f32_16x16x32_bf16 v[204:207], a[20:23], v[44:47], v[204:207]
v_mfma_f32_16x16x32_bf16 v[188:191], a[24:27], v[40:43], v[188:191]
v_mfma_f32_16x16x32_bf16 v[208:211], a[24:27], v[44:47], v[208:211]
v_mfma_f32_16x16x32_bf16 v[192:195], a[28:31], v[40:43], v[192:195]
v_mfma_f32_16x16x32_bf16 v[212:215], a[28:31], v[44:47], v[212:215]
v_mfma_f32_16x16x32_bf16 v[196:199], a[32:35], v[40:43], v[196:199]
v_mfma_f32_16x16x32_bf16 v[216:219], a[32:35], v[44:47], v[216:219]
v_mfma_f32_16x16x32_bf16 v[200:203], a[36:39], v[40:43], v[200:203]
v_mfma_f32_16x16x32_bf16 v[220:223], a[36:39], v[44:47], v[220:223]
v_mfma_f32_16x16x32_bf16 v[184:187], a[40:43], v[48:51], v[184:187]
v_mfma_f32_16x16x32_bf16 v[204:207], a[40:43], v[52:55], v[204:207]
v_mfma_f32_16x16x32_bf16 v[188:191], a[44:47], v[48:51], v[188:191]
v_mfma_f32_16x16x32_bf16 v[208:211], a[44:47], v[52:55], v[208:211]
v_mfma_f32_16x16x32_bf16 v[192:195], a[48:51], v[48:51], v[192:195]
v_mfma_f32_16x16x32_bf16 v[212:215], a[48:51], v[52:55], v[212:215]
v_mfma_f32_16x16x32_bf16 v[196:199], a[52:55], v[48:51], v[196:199]
v_mfma_f32_16x16x32_bf16 v[216:219], a[52:55], v[52:55], v[216:219]
v_mfma_f32_16x16x32_bf16 v[200:203], a[56:59], v[48:51], v[200:203]
v_mfma_f32_16x16x32_bf16 v[220:223], a[56:59], v[52:55], v[220:223]
v_mfma_f32_16x16x32_bf16 v[184:187], a[60:63], v[56:59], v[184:187]
v_mfma_f32_16x16x32_bf16 v[204:207], a[60:63], v[60:63], v[204:207]
v_mfma_f32_16x16x32_bf16 v[188:191], a[64:67], v[56:59], v[188:191]
v_mfma_f32_16x16x32_bf16 v[208:211], a[64:67], v[60:63], v[208:211]
v_mfma_f32_16x16x32_bf16 v[192:195], a[68:71], v[56:59], v[192:195]
v_mfma_f32_16x16x32_bf16 v[212:215], a[68:71], v[60:63], v[212:215]
v_mfma_f32_16x16x32_bf16 v[196:199], a[72:75], v[56:59], v[196:199]
v_mfma_f32_16x16x32_bf16 v[216:219], a[72:75], v[60:63], v[216:219]
v_mfma_f32_16x16x32_bf16 v[200:203], a[76:79], v[56:59], v[200:203]
v_mfma_f32_16x16x32_bf16 v[220:223], a[76:79], v[60:63], v[220:223]
v_mfma_f32_16x16x32_bf16 v[184:187], a[80:83], v[64:67], v[184:187]
v_mfma_f32_16x16x32_bf16 v[204:207], a[80:83], v[68:71], v[204:207]
v_mfma_f32_16x16x32_bf16 v[188:191], a[84:87], v[64:67], v[188:191]
v_mfma_f32_16x16x32_bf16 v[208:211], a[84:87], v[68:71], v[208:211]
v_mfma_f32_16x16x32_bf16 v[192:195], a[88:91], v[64:67], v[192:195]
v_mfma_f32_16x16x32_bf16 v[212:215], a[88:91], v[68:71], v[212:215]
v_mfma_f32_16x16x32_bf16 v[196:199], a[92:95], v[64:67], v[196:199]
v_mfma_f32_16x16x32_bf16 v[216:219], a[92:95], v[68:71], v[216:219]
v_mfma_f32_16x16x32_bf16 v[200:203], a[96:99], v[64:67], v[200:203]
v_mfma_f32_16x16x32_bf16 v[220:223], a[96:99], v[68:71], v[220:223]
v_mfma_f32_16x16x32_bf16 v[184:187], a[100:103], v[72:75], v[184:187]
v_mfma_f32_16x16x32_bf16 v[204:207], a[100:103], v[76:79], v[204:207]
v_mfma_f32_16x16x32_bf16 v[188:191], a[104:107], v[72:75], v[188:191]
v_mfma_f32_16x16x32_bf16 v[208:211], a[104:107], v[76:79], v[208:211]
v_mfma_f32_16x16x32_bf16 v[192:195], a[108:111], v[72:75], v[192:195]
v_mfma_f32_16x16x32_bf16 v[212:215], a[108:111], v[76:79], v[212:215]
v_mfma_f32_16x16x32_bf16 v[196:199], a[112:115], v[72:75], v[196:199]
v_mfma_f32_16x16x32_bf16 v[216:219], a[112:115], v[76:79], v[216:219]
v_mfma_f32_16x16x32_bf16 v[200:203], a[116:119], v[72:75], v[200:203]
v_mfma_f32_16x16x32_bf16 v[220:223], a[116:119], v[76:79], v[220:223]
s_waitcnt vmcnt(13)
v_mfma_f32_16x16x32_bf16 v[184:187], a[120:123], v[80:83], v[184:187]
v_mfma_f32_16x16x32_bf16 v[204:207], a[120:123], v[84:87], v[204:207]
v_mfma_f32_16x16x32_bf16 v[188:191], a[124:127], v[80:83], v[188:191]
v_mfma_f32_16x16x32_bf16 v[208:211], a[124:127], v[84:87], v[208:211]
v_mfma_f32_16x16x32_bf16 v[192:195], a[128:131], v[80:83], v[192:195]
v_mfma_f32_16x16x32_bf16 v[212:215], a[128:131], v[84:87], v[212:215]
v_mfma_f32_16x16x32_bf16 v[196:199], a[132:135], v[80:83], v[196:199]
v_mfma_f32_16x16x32_bf16 v[216:219], a[132:135], v[84:87], v[216:219]
v_mfma_f32_16x16x32_bf16 v[200:203], a[136:139], v[80:83], v[200:203]
v_mfma_f32_16x16x32_bf16 v[220:223], a[136:139], v[84:87], v[220:223]
s_waitcnt vmcnt(11)
v_mfma_f32_16x16x32_bf16 v[184:187], a[140:143], v[88:91], v[184:187]
v_mfma_f32_16x16x32_bf16 v[204:207], a[140:143], v[92:95], v[204:207]
v_mfma_f32_16x16x32_bf16 v[188:191], a[144:147], v[88:91], v[188:191]
v_mfma_f32_16x16x32_bf16 v[208:211], a[144:147], v[92:95], v[208:211]
v_mfma_f32_16x16x32_bf16 v[192:195], a[148:151], v[88:91], v[192:195]
v_mfma_f32_16x16x32_bf16 v[212:215], a[148:151], v[92:95], v[212:215]
v_mfma_f32_16x16x32_bf16 v[196:199], a[152:155], v[88:91], v[196:199]
v_mfma_f32_16x16x32_bf16 v[216:219], a[152:155], v[92:95], v[216:219]
v_mfma_f32_16x16x32_bf16 v[200:203], a[156:159], v[88:91], v[200:203]
v_mfma_f32_16x16x32_bf16 v[220:223], a[156:159], v[92:95], v[220:223]
s_waitcnt vmcnt(9)
v_mfma_f32_16x16x32_bf16 v[184:187], a[160:163], v[96:99], v[184:187]
v_mfma_f32_16x16x32_bf16 v[204:207], a[160:163], v[100:103], v[204:207]
v_mfma_f32_16x16x32_bf16 v[188:191], a[164:167], v[96:99], v[188:191]
v_mfma_f32_16x16x32_bf16 v[208:211], a[164:167], v[100:103], v[208:211]
v_mfma_f32_16x16x32_bf16 v[192:195], a[168:171], v[96:99], v[192:195]
v_mfma_f32_16x16x32_bf16 v[212:215], a[168:171], v[100:103], v[212:215]
v_mfma_f32_16x16x32_bf16 v[196:199], a[172:175], v[96:99], v[196:199]
v_mfma_f32_16x16x32_bf16 v[216:219], a[172:175], v[100:103], v[216:219]
v_mfma_f32_16x16x32_bf16 v[200:203], a[176:179], v[96:99], v[200:203]
v_mfma_f32_16x16x32_bf16 v[220:223], a[176:179], v[100:103], v[220:223]
s_waitcnt vmcnt(7)
v_mfma_f32_16x16x32_bf16 v[184:187], a[180:183], v[104:107], v[184:187]
v_mfma_f32_16x16x32_bf16 v[204:207], a[180:183], v[108:111], v[204:207]
v_mfma_f32_16x16x32_bf16 v[188:191], a[184:187], v[104:107], v[188:191]
v_mfma_f32_16x16x32_bf16 v[208:211], a[184:187], v[108:111], v[208:211]
v_mfma_f32_16x16x32_bf16 v[192:195], a[188:191], v[104:107], v[192:195]
v_mfma_f32_16x16x32_bf16 v[212:215], a[188:191], v[108:111], v[212:215]
v_mfma_f32_16x16x32_bf16 v[196:199], a[192:195], v[104:107], v[196:199]
v_mfma_f32_16x16x32_bf16 v[216:219], a[192:195], v[108:111], v[216:219]
v_mfma_f32_16x16x32_bf16 v[200:203], a[196:199], v[104:107], v[200:203]
v_mfma_f32_16x16x32_bf16 v[220:223], a[196:199], v[108:111], v[220:223]
s_lshr_b32 s29, s24, 1
s_add_u32 s29, s29, 16
s_lshl_b32 s29, s29, 7
s_add_u32 s94, s29, 9201664
buffer_load_dword v31, v6, s[8:11], s94 offen sc1
s_waitcnt vmcnt(6)
v_mfma_f32_16x16x32_bf16 v[184:187], a[200:203], v[112:115], v[184:187]
v_mfma_f32_16x16x32_bf16 v[204:207], a[200:203], v[116:119], v[204:207]
v_mfma_f32_16x16x32_bf16 v[188:191], a[204:207], v[112:115], v[188:191]
v_mfma_f32_16x16x32_bf16 v[208:211], a[204:207], v[116:119], v[208:211]
v_mfma_f32_16x16x32_bf16 v[192:195], a[208:211], v[112:115], v[192:195]
v_mfma_f32_16x16x32_bf16 v[212:215], a[208:211], v[116:119], v[212:215]
v_mfma_f32_16x16x32_bf16 v[196:199], a[212:215], v[112:115], v[196:199]
v_mfma_f32_16x16x32_bf16 v[216:219], a[212:215], v[116:119], v[216:219]
v_mfma_f32_16x16x32_bf16 v[200:203], a[216:219], v[112:115], v[200:203]
v_mfma_f32_16x16x32_bf16 v[220:223], a[216:219], v[116:119], v[220:223]
s_waitcnt vmcnt(4)
v_mfma_f32_16x16x32_bf16 v[184:187], a[220:223], v[120:123], v[184:187]
v_mfma_f32_16x16x32_bf16 v[204:207], a[220:223], v[124:127], v[204:207]
v_mfma_f32_16x16x32_bf16 v[188:191], a[224:227], v[120:123], v[188:191]
v_mfma_f32_16x16x32_bf16 v[208:211], a[224:227], v[124:127], v[208:211]
v_mfma_f32_16x16x32_bf16 v[192:195], a[228:231], v[120:123], v[192:195]
v_mfma_f32_16x16x32_bf16 v[212:215], a[228:231], v[124:127], v[212:215]
v_mfma_f32_16x16x32_bf16 v[196:199], a[232:235], v[120:123], v[196:199]
v_mfma_f32_16x16x32_bf16 v[216:219], a[232:235], v[124:127], v[216:219]
v_mfma_f32_16x16x32_bf16 v[200:203], a[236:239], v[120:123], v[200:203]
v_mfma_f32_16x16x32_bf16 v[220:223], a[236:239], v[124:127], v[220:223]
s_waitcnt vmcnt(0)
s_cmp_lg_u32 s16, 0
s_cbranch_scc1 P28
s_movk_i32 s77, 16
P29:
v_cmp_gt_u32 vcc, s77, v31
s_nop 1
s_cbranch_vccz P28
s_add_u32 s76, s76, 1
s_cmp_gt_u32 s76, 400000
s_cbranch_scc1 P28
s_sleep 4
buffer_load_dword v31, v6, s[8:11], s94 offen sc1
s_waitcnt vmcnt(0)
s_branch P29
P28:
s_barrier
s_lshr_b32 s28, s24, 1
s_add_u32 s28, s28, 16
s_mul_i32 s87, s28, 196608
s_add_u32 s87, s87, 25546752
s_mul_i32 s28, s16, 49152
s_add_u32 s87, s87, s28
s_and_b32 s28, s24, 1
s_lshl_b32 s28, s28, 9
s_add_u32 s87, s87, s28
s_and_b32 s28, s16, 1
s_lshl_b32 s28, s28, 8
v_add_u32 v254, s28, v10
s_xor_b32 s28, s28, 256
v_add_u32 v247, s28, v10
buffer_load_dwordx4 v[128:131], v254, s[8:11], s87 offen sc1
buffer_load_dwordx4 v[132:135], v247, s[8:11], s87 offen sc1
s_add_u32 s87, s87, 4096
buffer_load_dwordx4 v[136:139], v254, s[8:11], s87 offen sc1
buffer_load_dwordx4 v[140:143], v247, s[8:11], s87 offen sc1
s_add_u32 s87, s87, 4096
buffer_load_dwordx4 v[144:147], v254, s[8:11], s87 offen sc1
buffer_load_dwordx4 v[148:151], v247, s[8:11], s87 offen sc1
s_add_u32 s87, s87, 4096
buffer_load_dwordx4 v[152:155], v254, s[8:11], s87 offen sc1
buffer_load_dwordx4 v[156:159], v247, s[8:11], s87 offen sc1
s_add_u32 s87, s87, 4096
buffer_load_dwordx4 v[160:163], v254, s[8:11], s87 offen sc1
buffer_load_dwordx4 v[164:167], v247, s[8:11], s87 offen sc1
s_add_u32 s87, s87, 4096
buffer_load_dwordx4 v[168:171], v254, s[8:11], s87 offen sc1
buffer_load_dwordx4 v[172:175], v247, s[8:11], s87 offen sc1
s_add_u32 s87, s87, 4096
buffer_load_dwordx4 v[176:179], v254, s[8:11], s87 offen sc1
buffer_load_dwordx4 v[180:183], v247, s[8:11], s87 offen sc1
s_add_u32 s87, s87, 4096
buffer_load_dwordx4 v[32:35], v254, s[8:11], s87 offen sc1
buffer_load_dwordx4 v[36:39], v247, s[8:11], s87 offen sc1
s_add_u32 s87, s87, 4096
buffer_load_dwordx4 v[40:43], v254, s[8:11], s87 offen sc1
buffer_load_dwordx4 v[44:47], v247, s[8:11], s87 offen sc1
s_add_u32 s87, s87, 4096
buffer_load_dwordx4 v[48:51], v254, s[8:11], s87 offen sc1
buffer_load_dwordx4 v[52:55], v247, s[8:11], s87 offen sc1
s_add_u32 s87, s87, 4096
buffer_load_dwordx4 v[56:59], v254, s[8:11], s87 offen sc1
buffer_load_dwordx4 v[60:63], v247, s[8:11], s87 offen sc1
s_add_u32 s87, s87, 4096
buffer_load_dwordx4 v[64:67], v254, s[8:11], s87 offen sc1
buffer_load_dwordx4 v[68:71], v247, s[8:11], s87 offen sc1
s_add_u32 s87, s87, 4096
s_lshr_b32 s28, s24, 1
s_add_u32 s28, s28, 0
s_mul_i32 s88, s28, 81920
s_mul_i32 s29, s25, 10240
s_add_u32 s88, s88, s29
s_barrier
s_mul_i32 s28, s16, 10240
s_add_u32 s28, s28, 0
s_and_b32 s29, s16, 1
s_mul_i32 s29, s29, 5120
s_add_u32 s90, s28, s29
v_add_u32 v24, s90, v1
s_xor_b32 s29, s29, 5120
s_add_u32 s90, s28, s29
v_add_u32 v25, s90, v1
s_cmp_ge_u32 s16, 2
s_cbranch_scc1 V31
s_nop 1
ds_write_b128 v25, v[204:207] offset:0
ds_write_b128 v25, v[208:211] offset:1024
ds_write_b128 v25, v[212:215] offset:2048
ds_write_b128 v24, v[196:199] offset:3072
ds_write_b128 v25, v[216:219] offset:3072
ds_write_b128 v24, v[200:203] offset:4096
ds_write_b128 v25, v[220:223] offset:4096
s_waitcnt lgkmcnt(0)
s_barrier
s_add_u32 s28, s16, 1
s_and_b32 s28, s28, 3
s_mul_i32 s28, s28, 10240
s_and_b32 s29, s16, 1
s_mul_i32 s29, s29, 5120
s_add_u32 s28, s28, s29
s_add_u32 s28, s28, 0
v_add_u32 v26, s28, v1
ds_read_b128 v[72:75], v26 offset:0
ds_read_b128 v[76:79], v26 offset:1024
ds_read_b128 v[80:83], v26 offset:2048
s_add_u32 s28, s16, 2
s_and_b32 s28, s28, 3
s_mul_i32 s28, s28, 10240
s_and_b32 s29, s16, 1
s_mul_i32 s29, s29, 5120
s_add_u32 s28, s28, s29
s_add_u32 s28, s28, 0
v_add_u32 v26, s28, v1
ds_read_b128 v[84:87], v26 offset:0
ds_read_b128 v[88:91], v26 offset:1024
ds_read_b128 v[92:95], v26 offset:2048
s_add_u32 s28, s16, 3
s_and_b32 s28, s28, 3
s_mul_i32 s28, s28, 10240
s_and_b32 s29, s16, 1
s_mul_i32 s29, s29, 5120
s_add_u32 s28, s28, s29
s_add_u32 s28, s28, 0
v_add_u32 v26, s28, v1
ds_read_b128 v[96:99], v26 offset:0
ds_read_b128 v[100:103], v26 offset:1024
ds_read_b128 v[104:107], v26 offset:2048
s_waitcnt lgkmcnt(6)
v_add_f32 v184, v184, v72
v_add_f32 v185, v185, v73
v_add_f32 v186, v186, v74
v_add_f32 v187, v187, v75
v_add_f32 v188, v188, v76
v_add_f32 v189, v189, v77
v_add_f32 v190, v190, v78
v_add_f32 v191, v191, v79
v_add_f32 v192, v192, v80
v_add_f32 v193, v193, v81
v_add_f32 v194, v194, v82
v_add_f32 v195, v195, v83
s_waitcnt lgkmcnt(3)
v_add_f32 v184, v184, v84
v_add_f32 v185, v185, v85
v_add_f32 v186, v186, v86
v_add_f32 v187, v187, v87
v_add_f32 v188, v188, v88
v_add_f32 v189, v189, v89
v_add_f32 v190, v190, v90
v_add_f32 v191, v191, v91
v_add_f32 v192, v192, v92
v_add_f32 v193, v193, v93
v_add_f32 v194, v194, v94
v_add_f32 v195, v195, v95
s_waitcnt lgkmcnt(0)
v_add_f32 v184, v184, v96
v_add_f32 v185, v185, v97
v_add_f32 v186, v186, v98
v_add_f32 v187, v187, v99
v_add_f32 v188, v188, v100
v_add_f32 v189, v189, v101
v_add_f32 v190, v190, v102
v_add_f32 v191, v191, v103
v_add_f32 v192, v192, v104
v_add_f32 v193, v193, v105
v_add_f32 v194, v194, v106
v_add_f32 v195, v195, v107
v_lshlrev_b32 v26, 16, v248
v_and_b32 v27, 0xffff0000, v248
v_add_f32 v184, v184, v26
v_add_f32 v185, v185, v27
v_cvt_pk_bf16_f32 v248, v184, v185
v_lshlrev_b32 v26, 16, v249
v_and_b32 v27, 0xffff0000, v249
v_add_f32 v186, v186, v26
v_add_f32 v187, v187, v27
v_cvt_pk_bf16_f32 v249, v186, v187
v_lshlrev_b32 v26, 16, v250
v_and_b32 v27, 0xffff0000, v250
v_add_f32 v188, v188, v26
v_add_f32 v189, v189, v27
v_cvt_pk_bf16_f32 v250, v188, v189
v_lshlrev_b32 v26, 16, v251
v_and_b32 v27, 0xffff0000, v251
v_add_f32 v190, v190, v26
v_add_f32 v191, v191, v27
v_cvt_pk_bf16_f32 v251, v190, v191
v_lshlrev_b32 v26, 16, v252
v_and_b32 v27, 0xffff0000, v252
v_add_f32 v192, v192, v26
v_add_f32 v193, v193, v27
v_cvt_pk_bf16_f32 v252, v192, v193
v_lshlrev_b32 v26, 16, v253
v_and_b32 v27, 0xffff0000, v253
v_add_f32 v194, v194, v26
v_add_f32 v195, v195, v27
v_cvt_pk_bf16_f32 v253, v194, v195
v_mov_b32 v28, 0x3f803f80
v_mov_b32 v26, 0
v_mov_b32 v27, 0
v_dot2_f32_bf16 v26, v248, v28, v26
v_dot2_f32_bf16 v27, v248, v248, v27
v_dot2_f32_bf16 v26, v249, v28, v26
v_dot2_f32_bf16 v27, v249, v249, v27
v_dot2_f32_bf16 v26, v250, v28, v26
v_dot2_f32_bf16 v27, v250, v250, v27
v_dot2_f32_bf16 v26, v251, v28, v26
v_dot2_f32_bf16 v27, v251, v251, v27
v_dot2_f32_bf16 v26, v252, v28, v26
v_dot2_f32_bf16 v27, v252, v252, v27
v_dot2_f32_bf16 v26, v253, v28, v26
v_dot2_f32_bf16 v27, v253, v253, v27
s_add_u32 s89, s88, 31838208
s_add_u32 s91, s89, 4096
buffer_store_dwordx2 v[252:253], v245, s[8:11], s91 offen sc1
v_and_b32 v29, 1, v5
v_lshlrev_b32 v29, 1, v29
v_lshrrev_b32 v30, 1, v5
v_add_u32 v29, v29, v30
v_lshlrev_b32 v29, 10, v29
v_lshl_add_u32 v29, v225, 4, v29
v_permlane16_swap_b32 v248, v250
v_permlane16_swap_b32 v249, v251
s_nop 0
buffer_store_dwordx4 v[248:251], v29, s[8:11], s89 offen offset:0 sc1
v_mov_b32 v28, v26
v_mov_b32 v30, v27
s_nop 1
v_permlane16_swap_b32 v26, v28
v_permlane16_swap_b32 v27, v30
s_nop 0
v_add_f32 v26, v26, v28
v_add_f32 v27, v27, v30
v_mov_b32 v28, v26
v_mov_b32 v30, v27
s_nop 1
v_permlane32_swap_b32 v26, v28
v_permlane32_swap_b32 v27, v30
s_nop 0
v_add_f32 v26, v26, v28
v_add_f32 v27, v27, v30
s_lshr_b32 s28, s24, 1
s_add_u32 s28, s28, 0
s_lshl_b32 s28, s28, 6
v_add_u32 v28, s28, v225
v_lshlrev_b32 v28, 4, v28
s_lshl_b32 s28, s25, 15
s_add_u32 s28, s28, 37081088
v_cmp_gt_u32 vcc, 16, v0
s_and_saveexec_b64 s[92:93], vcc
buffer_store_dwordx2 v[26:27], v28, s[8:11], s28 offen sc1
s_mov_b64 exec, -1
s_branch V30
V31:
s_nop 1
ds_write_b128 v24, v[184:187] offset:0
ds_write_b128 v25, v[204:207] offset:0
ds_write_b128 v24, v[188:191] offset:1024
ds_write_b128 v25, v[208:211] offset:1024
ds_write_b128 v24, v[192:195] offset:2048
ds_write_b128 v25, v[212:215] offset:2048
ds_write_b128 v25, v[216:219] offset:3072
ds_write_b128 v25, v[220:223] offset:4096
s_waitcnt lgkmcnt(0)
s_barrier
s_add_u32 s28, s16, 1
s_and_b32 s28, s28, 3
s_mul_i32 s28, s28, 10240
s_and_b32 s29, s16, 1
s_mul_i32 s29, s29, 5120
s_add_u32 s28, s28, s29
s_add_u32 s28, s28, 0
v_add_u32 v26, s28, v1
ds_read_b128 v[72:75], v26 offset:3072
ds_read_b128 v[76:79], v26 offset:4096
s_add_u32 s28, s16, 2
s_and_b32 s28, s28, 3
s_mul_i32 s28, s28, 10240
s_and_b32 s29, s16, 1
s_mul_i32 s29, s29, 5120
s_add_u32 s28, s28, s29
s_add_u32 s28, s28, 0
v_add_u32 v26, s28, v1
ds_read_b128 v[84:87], v26 offset:3072
ds_read_b128 v[88:91], v26 offset:4096
s_add_u32 s28, s16, 3
s_and_b32 s28, s28, 3
s_mul_i32 s28, s28, 10240
s_and_b32 s29, s16, 1
s_mul_i32 s29, s29, 5120
s_add_u32 s28, s28, s29
s_add_u32 s28, s28, 0
v_add_u32 v26, s28, v1
ds_read_b128 v[96:99], v26 offset:3072
ds_read_b128 v[100:103], v26 offset:4096
s_waitcnt lgkmcnt(4)
v_add_f32 v196, v196, v72
v_add_f32 v197, v197, v73
v_add_f32 v198, v198, v74
v_add_f32 v199, v199, v75
v_add_f32 v200, v200, v76
v_add_f32 v201, v201, v77
v_add_f32 v202, v202, v78
v_add_f32 v203, v203, v79
s_waitcnt lgkmcnt(2)
v_add_f32 v196, v196, v84
v_add_f32 v197, v197, v85
v_add_f32 v198, v198, v86
v_add_f32 v199, v199, v87
v_add_f32 v200, v200, v88
v_add_f32 v201, v201, v89
v_add_f32 v202, v202, v90
v_add_f32 v203, v203, v91
s_waitcnt lgkmcnt(0)
v_add_f32 v196, v196, v96
v_add_f32 v197, v197, v97
v_add_f32 v198, v198, v98
v_add_f32 v199, v199, v99
v_add_f32 v200, v200, v100
v_add_f32 v201, v201, v101
v_add_f32 v202, v202, v102
v_add_f32 v203, v203, v103
v_lshlrev_b32 v26, 16, v248
v_and_b32 v27, 0xffff0000, v248
v_add_f32 v196, v196, v26
v_add_f32 v197, v197, v27
v_cvt_pk_bf16_f32 v248, v196, v197
v_lshlrev_b32 v26, 16, v249
v_and_b32 v27, 0xffff0000, v249
v_add_f32 v198, v198, v26
v_add_f32 v199, v199, v27
v_cvt_pk_bf16_f32 v249, v198, v199
v_lshlrev_b32 v26, 16, v250
v_and_b32 v27, 0xffff0000, v250
v_add_f32 v200, v200, v26
v_add_f32 v201, v201, v27
v_cvt_pk_bf16_f32 v250, v200, v201
v_lshlrev_b32 v26, 16, v251
v_and_b32 v27, 0xffff0000, v251
v_add_f32 v202, v202, v26
v_add_f32 v203, v203, v27
v_cvt_pk_bf16_f32 v251, v202, v203
v_mov_b32 v28, 0x3f803f80
v_mov_b32 v26, 0
v_mov_b32 v27, 0
v_dot2_f32_bf16 v26, v248, v28, v26
v_dot2_f32_bf16 v27, v248, v248, v27
v_dot2_f32_bf16 v26, v249, v28, v26
v_dot2_f32_bf16 v27, v249, v249, v27
v_dot2_f32_bf16 v26, v250, v28, v26
v_dot2_f32_bf16 v27, v250, v250, v27
v_dot2_f32_bf16 v26, v251, v28, v26
v_dot2_f32_bf16 v27, v251, v251, v27
s_add_u32 s89, s88, 31838208
v_and_b32 v29, 1, v5
v_lshlrev_b32 v29, 1, v29
v_lshrrev_b32 v30, 1, v5
v_add_u32 v29, v29, v30
v_lshlrev_b32 v29, 10, v29
v_lshl_add_u32 v29, v225, 4, v29
v_permlane16_swap_b32 v248, v250
v_permlane16_swap_b32 v249, v251
s_add_u32 s91, s89, 4096
s_nop 0
buffer_store_dwordx4 v[248:251], v29, s[8:11], s91 offen offset:2048 sc1
v_mov_b32 v28, v26
v_mov_b32 v30, v27
s_nop 1
v_permlane16_swap_b32 v26, v28
v_permlane16_swap_b32 v27, v30
s_nop 0
v_add_f32 v26, v26, v28
v_add_f32 v27, v27, v30
v_mov_b32 v28, v26
v_mov_b32 v30, v27
s_nop 1
v_permlane32_swap_b32 v26, v28
v_permlane32_swap_b32 v27, v30
s_nop 0
v_add_f32 v26, v26, v28
v_add_f32 v27, v27, v30
s_lshr_b32 s28, s24, 1
s_add_u32 s28, s28, 0
s_lshl_b32 s28, s28, 6
v_add_u32 v28, s28, v225
v_lshlrev_b32 v28, 4, v28
s_lshl_b32 s28, s25, 15
s_add_u32 s28, s28, 37081096
v_cmp_gt_u32 vcc, 16, v0
s_and_saveexec_b64 s[92:93], vcc
buffer_store_dwordx2 v[26:27], v28, s[8:11], s28 offen sc1
s_mov_b64 exec, -1
V30:
s_lshr_b32 s28, s24, 1
s_lshl_b32 s28, s28, 7
s_add_u32 s28, s28, 9205760
s_waitcnt vmcnt(0)
s_barrier
s_cmp_lg_u32 s16, 0
s_cbranch_scc1 S32
s_mov_b64 exec, 1
buffer_atomic_add v7, v6, s[8:11], s28 offen sc1
s_mov_b64 exec, -1
S32:
v_mfma_f32_16x16x32_bf16 v[184:187], a[0:3], v[128:131], 0
v_mfma_f32_16x16x32_bf16 v[204:207], a[0:3], v[132:135], 0
v_mfma_f32_16x16x32_bf16 v[188:191], a[4:7], v[128:131], 0
v_mfma_f32_16x16x32_bf16 v[208:211], a[4:7], v[132:135], 0
v_mfma_f32_16x16x32_bf16 v[192:195], a[8:11], v[128:131], 0
v_mfma_f32_16x16x32_bf16 v[212:215], a[8:11], v[132:135], 0
s_mul_i32 s33, s20, 163840
s_lshl_b32 s28, s16, 9
s_add_u32 s33, s33, s28
s_add_u32 s33, s33, 0
buffer_load_dwordx4 a[0:3], v9, s[8:11], s33 offen offset:0
v_mfma_f32_16x16x32_bf16 v[196:199], a[12:15], v[128:131], 0
v_mfma_f32_16x16x32_bf16 v[216:219], a[12:15], v[132:135], 0
v_mfma_f32_16x16x32_bf16 v[200:203], a[16:19], v[128:131], 0
v_mfma_f32_16x16x32_bf16 v[220:223], a[16:19], v[132:135], 0
v_mfma_f32_16x16x32_bf16 v[184:187], a[20:23], v[136:139], v[184:187]
v_mfma_f32_16x16x32_bf16 v[204:207], a[20:23], v[140:143], v[204:207]
s_add_u32 s33, s33, 4096
buffer_load_dwordx4 a[4:7], v9, s[8:11], s33 offen offset:0
v_mfma_f32_16x16x32_bf16 v[188:191], a[24:27], v[136:139], v[188:191]
v_mfma_f32_16x16x32_bf16 v[208:211], a[24:27], v[140:143], v[208:211]
v_mfma_f32_16x16x32_bf16 v[192:195], a[28:31], v[136:139], v[192:195]
v_mfma_f32_16x16x32_bf16 v[212:215], a[28:31], v[140:143], v[212:215]
v_mfma_f32_16x16x32_bf16 v[196:199], a[32:35], v[136:139], v[196:199]
v_mfma_f32_16x16x32_bf16 v[216:219], a[32:35], v[140:143], v[216:219]
s_add_u32 s33, s33, 4096
buffer_load_dwordx4 a[8:11], v9, s[8:11], s33 offen offset:0
v_mfma_f32_16x16x32_bf16 v[200:203], a[36:39], v[136:139], v[200:203]
v_mfma_f32_16x16x32_bf16 v[220:223], a[36:39], v[140:143], v[220:223]
v_mfma_f32_16x16x32_bf16 v[184:187], a[40:43], v[144:147], v[184:187]
v_mfma_f32_16x16x32_bf16 v[204:207], a[40:43], v[148:151], v[204:207]
v_mfma_f32_16x16x32_bf16 v[188:191], a[44:47], v[144:147], v[188:191]
v_mfma_f32_16x16x32_bf16 v[208:211], a[44:47], v[148:151], v[208:211]
s_add_u32 s33, s33, 4096
buffer_load_dwordx4 a[12:15], v9, s[8:11], s33 offen offset:0
v_mfma_f32_16x16x32_bf16 v[192:195], a[48:51], v[144:147], v[192:195]
v_mfma_f32_16x16x32_bf16 v[212:215], a[48:51], v[148:151], v[212:215]
v_mfma_f32_16x16x32_bf16 v[196:199], a[52:55], v[144:147], v[196:199]
v_mfma_f32_16x16x32_bf16 v[216:219], a[52:55], v[148:151], v[216:219]
v_mfma_f32_16x16x32_bf16 v[200:203], a[56:59], v[144:147], v[200:203]
v_mfma_f32_16x16x32_bf16 v[220:223], a[56:59], v[148:151], v[220:223]
s_add_u32 s33, s33, 4096
buffer_load_dwordx4 a[16:19], v9, s[8:11], s33 offen offset:0
v_mfma_f32_16x16x32_bf16 v[184:187], a[60:63], v[152:155], v[184:187]
v_mfma_f32_16x16x32_bf16 v[204:207], a[60:63], v[156:159], v[204:207]
v_mfma_f32_16x16x32_bf16 v[188:191], a[64:67], v[152:155], v[188:191]
v_mfma_f32_16x16x32_bf16 v[208:211], a[64:67], v[156:159], v[208:211]
v_mfma_f32_16x16x32_bf16 v[192:195], a[68:71], v[152:155], v[192:195]
v_mfma_f32_16x16x32_bf16 v[212:215], a[68:71], v[156:159], v[212:215]
s_add_u32 s33, s33, 4096
buffer_load_dwordx4 a[20:23], v9, s[8:11], s33 offen offset:0
v_mfma_f32_16x16x32_bf16 v[196:199], a[72:75], v[152:155], v[196:199]
v_mfma_f32_16x16x32_bf16 v[216:219], a[72:75], v[156:159], v[216:219]
v_mfma_f32_16x16x32_bf16 v[200:203], a[76:79], v[152:155], v[200:203]
v_mfma_f32_16x16x32_bf16 v[220:223], a[76:79], v[156:159], v[220:223]
v_mfma_f32_16x16x32_bf16 v[184:187], a[80:83], v[160:163], v[184:187]
v_mfma_f32_16x16x32_bf16 v[204:207], a[80:83], v[164:167], v[204:207]
s_add_u32 s33, s33, 4096
buffer_load_dwordx4 a[24:27], v9, s[8:11], s33 offen offset:0
v_mfma_f32_16x16x32_bf16 v[188:191], a[84:87], v[160:163], v[188:191]
v_mfma_f32_16x16x32_bf16 v[208:211], a[84:87], v[164:167], v[208:211]
v_mfma_f32_16x16x32_bf16 v[192:195], a[88:91], v[160:163], v[192:195]
v_mfma_f32_16x16x32_bf16 v[212:215], a[88:91], v[164:167], v[212:215]
v_mfma_f32_16x16x32_bf16 v[196:199], a[92:95], v[160:163], v[196:199]
v_mfma_f32_16x16x32_bf16 v[216:219], a[92:95], v[164:167], v[216:219]
s_add_u32 s33, s33, 4096
buffer_load_dwordx4 a[28:31], v9, s[8:11], s33 offen offset:0
v_mfma_f32_16x16x32_bf16 v[200:203], a[96:99], v[160:163], v[200:203]
v_mfma_f32_16x16x32_bf16 v[220:223], a[96:99], v[164:167], v[220:223]
v_mfma_f32_16x16x32_bf16 v[184:187], a[100:103], v[168:171], v[184:187]
v_mfma_f32_16x16x32_bf16 v[204:207], a[100:103], v[172:175], v[204:207]
v_mfma_f32_16x16x32_bf16 v[188:191], a[104:107], v[168:171], v[188:191]
v_mfma_f32_16x16x32_bf16 v[208:211], a[104:107], v[172:175], v[208:211]
s_add_u32 s33, s33, 4096
buffer_load_dwordx4 a[32:35], v9, s[8:11], s33 offen offset:0
v_mfma_f32_16x16x32_bf16 v[192:195], a[108:111], v[168:171], v[192:195]
v_mfma_f32_16x16x32_bf16 v[212:215], a[108:111], v[172:175], v[212:215]
v_mfma_f32_16x16x32_bf16 v[196:199], a[112:115], v[168:171], v[196:199]
v_mfma_f32_16x16x32_bf16 v[216:219], a[112:115], v[172:175], v[216:219]
v_mfma_f32_16x16x32_bf16 v[200:203], a[116:119], v[168:171], v[200:203]
v_mfma_f32_16x16x32_bf16 v[220:223], a[116:119], v[172:175], v[220:223]
s_add_u32 s33, s33, 4096
buffer_load_dwordx4 a[36:39], v9, s[8:11], s33 offen offset:0
v_mfma_f32_16x16x32_bf16 v[184:187], a[120:123], v[176:179], v[184:187]
v_mfma_f32_16x16x32_bf16 v[204:207], a[120:123], v[180:183], v[204:207]
v_mfma_f32_16x16x32_bf16 v[188:191], a[124:127], v[176:179], v[188:191]
v_mfma_f32_16x16x32_bf16 v[208:211], a[124:127], v[180:183], v[208:211]
v_mfma_f32_16x16x32_bf16 v[192:195], a[128:131], v[176:179], v[192:195]
v_mfma_f32_16x16x32_bf16 v[212:215], a[128:131], v[180:183], v[212:215]
s_add_u32 s33, s33, 4096
buffer_load_dwordx4 a[40:43], v9, s[8:11], s33 offen offset:0
v_mfma_f32_16x16x32_bf16 v[196:199], a[132:135], v[176:179], v[196:199]
v_mfma_f32_16x16x32_bf16 v[216:219], a[132:135], v[180:183], v[216:219]
v_mfma_f32_16x16x32_bf16 v[200:203], a[136:139], v[176:179], v[200:203]
v_mfma_f32_16x16x32_bf16 v[220:223], a[136:139], v[180:183], v[220:223]
s_mov_b32 s29, s19
s_lshl_b32 s29, s29, 7
s_add_u32 s94, s29, 9205760
buffer_load_dword v31, v6, s[8:11], s94 offen sc1
v_mfma_f32_16x16x32_bf16 v[184:187], a[140:143], v[32:35], v[184:187]
v_mfma_f32_16x16x32_bf16 v[204:207], a[140:143], v[36:39], v[204:207]
s_add_u32 s33, s33, 4096
buffer_load_dwordx4 a[44:47], v9, s[8:11], s33 offen offset:0
v_mfma_f32_16x16x32_bf16 v[188:191], a[144:147], v[32:35], v[188:191]
v_mfma_f32_16x16x32_bf16 v[208:211], a[144:147], v[36:39], v[208:211]
v_mfma_f32_16x16x32_bf16 v[192:195], a[148:151], v[32:35], v[192:195]
v_mfma_f32_16x16x32_bf16 v[212:215], a[148:151], v[36:39], v[212:215]
v_mfma_f32_16x16x32_bf16 v[196:199], a[152:155], v[32:35], v[196:199]
v_mfma_f32_16x16x32_bf16 v[216:219], a[152:155], v[36:39], v[216:219]
s_add_u32 s33, s33, 4096
buffer_load_dwordx4 a[48:51], v9, s[8:11], s33 offen offset:0
v_mfma_f32_16x16x32_bf16 v[200:203], a[156:159], v[32:35], v[200:203]
v_mfma_f32_16x16x32_bf16 v[220:223], a[156:159], v[36:39], v[220:223]
v_mfma_f32_16x16x32_bf16 v[184:187], a[160:163], v[40:43], v[184:187]
v_mfma_f32_16x16x32_bf16 v[204:207], a[160:163], v[44:47], v[204:207]
v_mfma_f32_16x16x32_bf16 v[188:191], a[164:167], v[40:43], v[188:191]
v_mfma_f32_16x16x32_bf16 v[208:211], a[164:167], v[44:47], v[208:211]
s_add_u32 s33, s33, 4096
buffer_load_dwordx4 a[52:55], v9, s[8:11], s33 offen offset:0
v_mfma_f32_16x16x32_bf16 v[192:195], a[168:171], v[40:43], v[192:195]
v_mfma_f32_16x16x32_bf16 v[212:215], a[168:171], v[44:47], v[212:215]
v_mfma_f32_16x16x32_bf16 v[196:199], a[172:175], v[40:43], v[196:199]
v_mfma_f32_16x16x32_bf16 v[216:219], a[172:175], v[44:47], v[216:219]
v_mfma_f32_16x16x32_bf16 v[200:203], a[176:179], v[40:43], v[200:203]
v_mfma_f32_16x16x32_bf16 v[220:223], a[176:179], v[44:47], v[220:223]
s_add_u32 s33, s33, 4096
buffer_load_dwordx4 a[56:59], v9, s[8:11], s33 offen offset:0
v_mfma_f32_16x16x32_bf16 v[184:187], a[180:183], v[48:51], v[184:187]
v_mfma_f32_16x16x32_bf16 v[204:207], a[180:183], v[52:55], v[204:207]
v_mfma_f32_16x16x32_bf16 v[188:191], a[184:187], v[48:51], v[188:191]
v_mfma_f32_16x16x32_bf16 v[208:211], a[184:187], v[52:55], v[208:211]
v_mfma_f32_16x16x32_bf16 v[192:195], a[188:191], v[48:51], v[192:195]
v_mfma_f32_16x16x32_bf16 v[212:215], a[188:191], v[52:55], v[212:215]
s_add_u32 s33, s33, 4096
buffer_load_dwordx4 a[60:63], v9, s[8:11], s33 offen offset:0
v_mfma_f32_16x16x32_bf16 v[196:199], a[192:195], v[48:51], v[196:199]
v_mfma_f32_16x16x32_bf16 v[216:219], a[192:195], v[52:55], v[216:219]
v_mfma_f32_16x16x32_bf16 v[200:203], a[196:199], v[48:51], v[200:203]
v_mfma_f32_16x16x32_bf16 v[220:223], a[196:199], v[52:55], v[220:223]
v_mfma_f32_16x16x32_bf16 v[184:187], a[200:203], v[56:59], v[184:187]
v_mfma_f32_16x16x32_bf16 v[204:207], a[200:203], v[60:63], v[204:207]
s_add_u32 s33, s33, 4096
buffer_load_dwordx4 a[64:67], v9, s[8:11], s33 offen offset:0
v_mfma_f32_16x16x32_bf16 v[188:191], a[204:207], v[56:59], v[188:191]
v_mfma_f32_16x16x32_bf16 v[208:211], a[204:207], v[60:63], v[208:211]
v_mfma_f32_16x16x32_bf16 v[192:195], a[208:211], v[56:59], v[192:195]
v_mfma_f32_16x16x32_bf16 v[212:215], a[208:211], v[60:63], v[212:215]
v_mfma_f32_16x16x32_bf16 v[196:199], a[212:215], v[56:59], v[196:199]
v_mfma_f32_16x16x32_bf16 v[216:219], a[212:215], v[60:63], v[216:219]
s_add_u32 s33, s33, 4096
buffer_load_dwordx4 a[68:71], v9, s[8:11], s33 offen offset:0
v_mfma_f32_16x16x32_bf16 v[200:203], a[216:219], v[56:59], v[200:203]
v_mfma_f32_16x16x32_bf16 v[220:223], a[216:219], v[60:63], v[220:223]
v_mfma_f32_16x16x32_bf16 v[184:187], a[220:223], v[64:67], v[184:187]
v_mfma_f32_16x16x32_bf16 v[204:207], a[220:223], v[68:71], v[204:207]
v_mfma_f32_16x16x32_bf16 v[188:191], a[224:227], v[64:67], v[188:191]
v_mfma_f32_16x16x32_bf16 v[208:211], a[224:227], v[68:71], v[208:211]
s_add_u32 s33, s33, 4096
buffer_load_dwordx4 a[72:75], v9, s[8:11], s33 offen offset:0
v_mfma_f32_16x16x32_bf16 v[192:195], a[228:231], v[64:67], v[192:195]
v_mfma_f32_16x16x32_bf16 v[212:215], a[228:231], v[68:71], v[212:215]
v_mfma_f32_16x16x32_bf16 v[196:199], a[232:235], v[64:67], v[196:199]
v_mfma_f32_16x16x32_bf16 v[216:219], a[232:235], v[68:71], v[216:219]
v_mfma_f32_16x16x32_bf16 v[200:203], a[236:239], v[64:67], v[200:203]
v_mfma_f32_16x16x32_bf16 v[220:223], a[236:239], v[68:71], v[220:223]
s_add_u32 s33, s33, 4096
buffer_load_dwordx4 a[76:79], v9, s[8:11], s33 offen offset:0
s_waitcnt vmcnt(9)
s_cmp_lg_u32 s16, 0
s_cbranch_scc1 P33
s_movk_i32 s77, 16
P34:
v_cmp_gt_u32 vcc, s77, v31
s_nop 1
s_cbranch_vccz P33
s_add_u32 s76, s76, 1
s_cmp_gt_u32 s76, 400000
s_cbranch_scc1 P33
s_sleep 4
buffer_load_dword v31, v6, s[8:11], s94 offen sc1
s_waitcnt vmcnt(0)
s_branch P34
P33:
s_barrier
s_add_u32 s28, s19, 0
s_lshl_b32 s28, s28, 6
v_add_u32 v29, s28, v0
v_lshlrev_b32 v29, 4, v29
s_mov_b32 s29, 37081088
buffer_load_dwordx4 v[140:143], v29, s[8:11], s29 offen sc1
s_add_u32 s29, s29, 32768
buffer_load_dwordx4 v[144:147], v29, s[8:11], s29 offen sc1
s_add_u32 s29, s29, 32768
buffer_load_dwordx4 v[148:151], v29, s[8:11], s29 offen sc1
s_add_u32 s29, s29, 32768
buffer_load_dwordx4 v[152:155], v29, s[8:11], s29 offen sc1
s_add_u32 s29, s29, 32768
buffer_load_dwordx4 v[156:159], v29, s[8:11], s29 offen sc1
s_add_u32 s29, s29, 32768
buffer_load_dwordx4 v[160:163], v29, s[8:11], s29 offen sc1
s_add_u32 s29, s29, 32768
buffer_load_dwordx4 v[164:167], v29, s[8:11], s29 offen sc1
s_add_u32 s29, s29, 32768
buffer_load_dwordx4 v[168:171], v29, s[8:11], s29 offen sc1
s_lshl_b32 s28, s20, 7
s_lshl_b32 s29, s16, 5
s_add_u32 s28, s28, s29
s_lshl_b32 s28, s28, 2
s_add_u32 s28, s28, 9175040
v_lshlrev_b32 v29, 4, v3
buffer_load_dwordx4 v[124:127], v29, s[8:11], s28 offen offset:0
buffer_load_dwordx4 v[128:131], v29, s[8:11], s28 offen offset:32
buffer_load_dwordx4 v[132:135], v29, s[8:11], s28 offen offset:64
buffer_load_dwordx4 v[136:139], v29, s[8:11], s28 offen offset:96
s_add_u32 s26, s19, 0
s_mul_i32 s26, s26, 81920
s_add_u32 s26, s26, 31838208
s_add_u32 s26, s26, s30
s_add_u32 m0, s30, 40960
s_nop 0
buffer_load_dwordx4 v1, s[8:11], s26 offen sc1 lds
buffer_load_dwordx4 v1, s[8:11], s26 offen offset:1024 sc1 lds
s_add_u32 s26, s26, 8192
s_add_u32 m0, s30, 49152
s_nop 0
buffer_load_dwordx4 v1, s[8:11], s26 offen sc1 lds
buffer_load_dwordx4 v1, s[8:11], s26 offen offset:1024 sc1 lds
s_add_u32 s26, s26, 8192
s_add_u32 m0, s30, 57344
s_nop 0
buffer_load_dwordx4 v1, s[8:11], s26 offen sc1 lds
buffer_load_dwordx4 v1, s[8:11], s26 offen offset:1024 sc1 lds
s_add_u32 s26, s26, 8192
s_lshr_b32 s28, s24, 1
s_add_u32 s28, s28, 16
s_mul_i32 s88, s28, 81920
s_mul_i32 s29, s25, 10240
s_add_u32 s88, s88, s29
s_barrier
s_mul_i32 s28, s16, 10240
s_add_u32 s28, s28, 0
s_and_b32 s29, s16, 1
s_mul_i32 s29, s29, 5120
s_add_u32 s90, s28, s29
v_add_u32 v24, s90, v1
s_xor_b32 s29, s29, 5120
s_add_u32 s90, s28, s29
v_add_u32 v25, s90, v1
s_cmp_ge_u32 s16, 2
s_cbranch_scc1 V36
s_nop 1
ds_write_b128 v25, v[204:207] offset:0
ds_write_b128 v25, v[208:211] offset:1024
ds_write_b128 v25, v[212:215] offset:2048
ds_write_b128 v24, v[196:199] offset:3072
ds_write_b128 v25, v[216:219] offset:3072
ds_write_b128 v24, v[200:203] offset:4096
ds_write_b128 v25, v[220:223] offset:4096
s_waitcnt lgkmcnt(0)
s_barrier
s_add_u32 s28, s16, 1
s_and_b32 s28, s28, 3
s_mul_i32 s28, s28, 10240
s_and_b32 s29, s16, 1
s_mul_i32 s29, s29, 5120
s_add_u32 s28, s28, s29
s_add_u32 s28, s28, 0
v_add_u32 v26, s28, v1
ds_read_b128 v[72:75], v26 offset:0
ds_read_b128 v[76:79], v26 offset:1024
ds_read_b128 v[80:83], v26 offset:2048
s_add_u32 s28, s16, 2
s_and_b32 s28, s28, 3
s_mul_i32 s28, s28, 10240
s_and_b32 s29, s16, 1
s_mul_i32 s29, s29, 5120
s_add_u32 s28, s28, s29
s_add_u32 s28, s28, 0
v_add_u32 v26, s28, v1
ds_read_b128 v[84:87], v26 offset:0
ds_read_b128 v[88:91], v26 offset:1024
ds_read_b128 v[92:95], v26 offset:2048
s_add_u32 s28, s16, 3
s_and_b32 s28, s28, 3
s_mul_i32 s28, s28, 10240
s_and_b32 s29, s16, 1
s_mul_i32 s29, s29, 5120
s_add_u32 s28, s28, s29
s_add_u32 s28, s28, 0
v_add_u32 v26, s28, v1
ds_read_b128 v[96:99], v26 offset:0
ds_read_b128 v[100:103], v26 offset:1024
ds_read_b128 v[104:107], v26 offset:2048
s_waitcnt lgkmcnt(6)
v_add_f32 v184, v184, v72
v_add_f32 v185, v185, v73
v_add_f32 v186, v186, v74
v_add_f32 v187, v187, v75
v_add_f32 v188, v188, v76
v_add_f32 v189, v189, v77
v_add_f32 v190, v190, v78
v_add_f32 v191, v191, v79
v_add_f32 v192, v192, v80
v_add_f32 v193, v193, v81
v_add_f32 v194, v194, v82
v_add_f32 v195, v195, v83
s_waitcnt lgkmcnt(3)
v_add_f32 v184, v184, v84
v_add_f32 v185, v185, v85
v_add_f32 v186, v186, v86
v_add_f32 v187, v187, v87
v_add_f32 v188, v188, v88
v_add_f32 v189, v189, v89
v_add_f32 v190, v190, v90
v_add_f32 v191, v191, v91
v_add_f32 v192, v192, v92
v_add_f32 v193, v193, v93
v_add_f32 v194, v194, v94
v_add_f32 v195, v195, v95
s_waitcnt lgkmcnt(0)
v_add_f32 v184, v184, v96
v_add_f32 v185, v185, v97
v_add_f32 v186, v186, v98
v_add_f32 v187, v187, v99
v_add_f32 v188, v188, v100
v_add_f32 v189, v189, v101
v_add_f32 v190, v190, v102
v_add_f32 v191, v191, v103
v_add_f32 v192, v192, v104
v_add_f32 v193, v193, v105
v_add_f32 v194, v194, v106
v_add_f32 v195, v195, v107
v_lshlrev_b32 v26, 16, v232
v_and_b32 v27, 0xffff0000, v232
v_add_f32 v184, v184, v26
v_add_f32 v185, v185, v27
v_cvt_pk_bf16_f32 v232, v184, v185
v_lshlrev_b32 v26, 16, v233
v_and_b32 v27, 0xffff0000, v233
v_add_f32 v186, v186, v26
v_add_f32 v187, v187, v27
v_cvt_pk_bf16_f32 v233, v186, v187
v_lshlrev_b32 v26, 16, v234
v_and_b32 v27, 0xffff0000, v234
v_add_f32 v188, v188, v26
v_add_f32 v189, v189, v27
v_cvt_pk_bf16_f32 v234, v188, v189
v_lshlrev_b32 v26, 16, v235
v_and_b32 v27, 0xffff0000, v235
v_add_f32 v190, v190, v26
v_add_f32 v191, v191, v27
v_cvt_pk_bf16_f32 v235, v190, v191
v_lshlrev_b32 v26, 16, v236
v_and_b32 v27, 0xffff0000, v236
v_add_f32 v192, v192, v26
v_add_f32 v193, v193, v27
v_cvt_pk_bf16_f32 v236, v192, v193
v_lshlrev_b32 v26, 16, v237
v_and_b32 v27, 0xffff0000, v237
v_add_f32 v194, v194, v26
v_add_f32 v195, v195, v27
v_cvt_pk_bf16_f32 v237, v194, v195
v_mov_b32 v28, 0x3f803f80
v_mov_b32 v26, 0
v_mov_b32 v27, 0
v_dot2_f32_bf16 v26, v232, v28, v26
v_dot2_f32_bf16 v27, v232, v232, v27
v_dot2_f32_bf16 v26, v233, v28, v26
v_dot2_f32_bf16 v27, v233, v233, v27
v_dot2_f32_bf16 v26, v234, v28, v26
v_dot2_f32_bf16 v27, v234, v234, v27
v_dot2_f32_bf16 v26, v235, v28, v26
v_dot2_f32_bf16 v27, v235, v235, v27
v_dot2_f32_bf16 v26, v236, v28, v26
v_dot2_f32_bf16 v27, v236, v236, v27
v_dot2_f32_bf16 v26, v237, v28, v26
v_dot2_f32_bf16 v27, v237, v237, v27
s_add_u32 s89, s88, 31838208
s_add_u32 s91, s89, 4096
buffer_store_dwordx2 v[236:237], v246, s[8:11], s91 offen sc1
v_and_b32 v29, 1, v5
v_lshlrev_b32 v29, 1, v29
v_lshrrev_b32 v30, 1, v5
v_add_u32 v29, v29, v30
v_lshlrev_b32 v29, 10, v29
v_lshl_add_u32 v29, v244, 4, v29
v_permlane16_swap_b32 v232, v234
v_permlane16_swap_b32 v233, v235
s_nop 0
buffer_store_dwordx4 v[232:235], v29, s[8:11], s89 offen offset:0 sc1
v_mov_b32 v28, v26
v_mov_b32 v30, v27
s_nop 1
v_permlane16_swap_b32 v26, v28
v_permlane16_swap_b32 v27, v30
s_nop 0
v_add_f32 v26, v26, v28
v_add_f32 v27, v27, v30
v_mov_b32 v28, v26
v_mov_b32 v30, v27
s_nop 1
v_permlane32_swap_b32 v26, v28
v_permlane32_swap_b32 v27, v30
s_nop 0
v_add_f32 v26, v26, v28
v_add_f32 v27, v27, v30
s_lshr_b32 s28, s24, 1
s_add_u32 s28, s28, 16
s_lshl_b32 s28, s28, 6
v_add_u32 v28, s28, v244
v_lshlrev_b32 v28, 4, v28
s_lshl_b32 s28, s25, 15
s_add_u32 s28, s28, 37081088
v_cmp_gt_u32 vcc, 16, v0
s_and_saveexec_b64 s[92:93], vcc
buffer_store_dwordx2 v[26:27], v28, s[8:11], s28 offen sc1
s_mov_b64 exec, -1
s_branch V35
V36:
s_nop 1
ds_write_b128 v24, v[184:187] offset:0
ds_write_b128 v25, v[204:207] offset:0
ds_write_b128 v24, v[188:191] offset:1024
ds_write_b128 v25, v[208:211] offset:1024
ds_write_b128 v24, v[192:195] offset:2048
ds_write_b128 v25, v[212:215] offset:2048
ds_write_b128 v25, v[216:219] offset:3072
ds_write_b128 v25, v[220:223] offset:4096
s_waitcnt lgkmcnt(0)
s_barrier
s_add_u32 s28, s16, 1
s_and_b32 s28, s28, 3
s_mul_i32 s28, s28, 10240
s_and_b32 s29, s16, 1
s_mul_i32 s29, s29, 5120
s_add_u32 s28, s28, s29
s_add_u32 s28, s28, 0
v_add_u32 v26, s28, v1
ds_read_b128 v[72:75], v26 offset:3072
ds_read_b128 v[76:79], v26 offset:4096
s_add_u32 s28, s16, 2
s_and_b32 s28, s28, 3
s_mul_i32 s28, s28, 10240
s_and_b32 s29, s16, 1
s_mul_i32 s29, s29, 5120
s_add_u32 s28, s28, s29
s_add_u32 s28, s28, 0
v_add_u32 v26, s28, v1
ds_read_b128 v[84:87], v26 offset:3072
ds_read_b128 v[88:91], v26 offset:4096
s_add_u32 s28, s16, 3
s_and_b32 s28, s28, 3
s_mul_i32 s28, s28, 10240
s_and_b32 s29, s16, 1
s_mul_i32 s29, s29, 5120
s_add_u32 s28, s28, s29
s_add_u32 s28, s28, 0
v_add_u32 v26, s28, v1
ds_read_b128 v[96:99], v26 offset:3072
ds_read_b128 v[100:103], v26 offset:4096
s_waitcnt lgkmcnt(4)
v_add_f32 v196, v196, v72
v_add_f32 v197, v197, v73
v_add_f32 v198, v198, v74
v_add_f32 v199, v199, v75
v_add_f32 v200, v200, v76
v_add_f32 v201, v201, v77
v_add_f32 v202, v202, v78
v_add_f32 v203, v203, v79
s_waitcnt lgkmcnt(2)
v_add_f32 v196, v196, v84
v_add_f32 v197, v197, v85
v_add_f32 v198, v198, v86
v_add_f32 v199, v199, v87
v_add_f32 v200, v200, v88
v_add_f32 v201, v201, v89
v_add_f32 v202, v202, v90
v_add_f32 v203, v203, v91
s_waitcnt lgkmcnt(0)
v_add_f32 v196, v196, v96
v_add_f32 v197, v197, v97
v_add_f32 v198, v198, v98
v_add_f32 v199, v199, v99
v_add_f32 v200, v200, v100
v_add_f32 v201, v201, v101
v_add_f32 v202, v202, v102
v_add_f32 v203, v203, v103
v_lshlrev_b32 v26, 16, v232
v_and_b32 v27, 0xffff0000, v232
v_add_f32 v196, v196, v26
v_add_f32 v197, v197, v27
v_cvt_pk_bf16_f32 v232, v196, v197
v_lshlrev_b32 v26, 16, v233
v_and_b32 v27, 0xffff0000, v233
v_add_f32 v198, v198, v26
v_add_f32 v199, v199, v27
v_cvt_pk_bf16_f32 v233, v198, v199
v_lshlrev_b32 v26, 16, v234
v_and_b32 v27, 0xffff0000, v234
v_add_f32 v200, v200, v26
v_add_f32 v201, v201, v27
v_cvt_pk_bf16_f32 v234, v200, v201
v_lshlrev_b32 v26, 16, v235
v_and_b32 v27, 0xffff0000, v235
v_add_f32 v202, v202, v26
v_add_f32 v203, v203, v27
v_cvt_pk_bf16_f32 v235, v202, v203
v_mov_b32 v28, 0x3f803f80
v_mov_b32 v26, 0
v_mov_b32 v27, 0
v_dot2_f32_bf16 v26, v232, v28, v26
v_dot2_f32_bf16 v27, v232, v232, v27
v_dot2_f32_bf16 v26, v233, v28, v26
v_dot2_f32_bf16 v27, v233, v233, v27
v_dot2_f32_bf16 v26, v234, v28, v26
v_dot2_f32_bf16 v27, v234, v234, v27
v_dot2_f32_bf16 v26, v235, v28, v26
v_dot2_f32_bf16 v27, v235, v235, v27
s_add_u32 s89, s88, 31838208
v_and_b32 v29, 1, v5
v_lshlrev_b32 v29, 1, v29
v_lshrrev_b32 v30, 1, v5
v_add_u32 v29, v29, v30
v_lshlrev_b32 v29, 10, v29
v_lshl_add_u32 v29, v244, 4, v29
v_permlane16_swap_b32 v232, v234
v_permlane16_swap_b32 v233, v235
s_add_u32 s91, s89, 4096
s_nop 0
buffer_store_dwordx4 v[232:235], v29, s[8:11], s91 offen offset:2048 sc1
v_mov_b32 v28, v26
v_mov_b32 v30, v27
s_nop 1
v_permlane16_swap_b32 v26, v28
v_permlane16_swap_b32 v27, v30
s_nop 0
v_add_f32 v26, v26, v28
v_add_f32 v27, v27, v30
v_mov_b32 v28, v26
v_mov_b32 v30, v27
s_nop 1
v_permlane32_swap_b32 v26, v28
v_permlane32_swap_b32 v27, v30
s_nop 0
v_add_f32 v26, v26, v28
v_add_f32 v27, v27, v30
s_lshr_b32 s28, s24, 1
s_add_u32 s28, s28, 16
s_lshl_b32 s28, s28, 6
v_add_u32 v28, s28, v244
v_lshlrev_b32 v28, 4, v28
s_lshl_b32 s28, s25, 15
s_add_u32 s28, s28, 37081096
v_cmp_gt_u32 vcc, 16, v0
s_and_saveexec_b64 s[92:93], vcc
buffer_store_dwordx2 v[26:27], v28, s[8:11], s28 offen sc1
s_mov_b64 exec, -1
V35:
s_waitcnt vmcnt(12)
v_add_f32 v140, v140, v156
v_add_f32 v141, v141, v157
v_add_f32 v142, v142, v158
v_add_f32 v143, v143, v159
v_add_f32 v144, v144, v160
v_add_f32 v145, v145, v161
v_add_f32 v146, v146, v162
v_add_f32 v147, v147, v163
v_add_f32 v148, v148, v164
v_add_f32 v149, v149, v165
v_add_f32 v150, v150, v166
v_add_f32 v151, v151, v167
v_add_f32 v152, v152, v168
v_add_f32 v153, v153, v169
v_add_f32 v154, v154, v170
v_add_f32 v155, v155, v171
v_add_f32 v140, v140, v148
v_add_f32 v141, v141, v149
v_add_f32 v142, v142, v150
v_add_f32 v143, v143, v151
v_add_f32 v144, v144, v152
v_add_f32 v145, v145, v153
v_add_f32 v146, v146, v154
v_add_f32 v147, v147, v155
v_add_f32 v140, v140, v144
v_add_f32 v141, v141, v145
v_add_f32 v142, v142, v146
v_add_f32 v143, v143, v147
v_add_f32 v140, v140, v142
v_add_f32 v141, v141, v143
v_mul_f32 v28, 0x3acccccd, v140
v_mul_f32 v26, 0x3acccccd, v141
v_fma_f32 v26, -v28, v28, v26
v_max_f32 v26, 0, v26
v_add_f32 v26, 0x3727c5ac, v26
v_rsq_f32 v27, v26
s_nop 0
v_mov_b32 v172, v28
v_mov_b32 v173, v28
v_mov_b32 v176, v27
v_mov_b32 v177, v27
s_nop 1
v_permlane32_swap_b32 v172, v173
v_permlane32_swap_b32 v176, v177
s_waitcnt vmcnt(8)
v_mul_f32_e64 v32, -v172, v124
v_mul_f32_e64 v33, -v172, v125
v_mul_f32_e64 v34, -v172, v126
v_mul_f32_e64 v35, -v172, v127
v_mul_f32_e64 v36, -v172, v128
v_mul_f32_e64 v37, -v172, v129
v_mul_f32_e64 v38, -v172, v130
v_mul_f32_e64 v39, -v172, v131
v_mul_f32_e64 v40, -v172, v132
v_mul_f32_e64 v41, -v172, v133
v_mul_f32_e64 v42, -v172, v134
v_mul_f32_e64 v43, -v172, v135
v_mul_f32_e64 v44, -v172, v136
v_mul_f32_e64 v45, -v172, v137
v_mul_f32_e64 v46, -v172, v138
v_mul_f32_e64 v47, -v172, v139
v_mul_f32_e64 v48, -v173, v124
v_mul_f32_e64 v49, -v173, v125
v_mul_f32_e64 v50, -v173, v126
v_mul_f32_e64 v51, -v173, v127
v_mul_f32_e64 v52, -v173, v128
v_mul_f32_e64 v53, -v173, v129
v_mul_f32_e64 v54, -v173, v130
v_mul_f32_e64 v55, -v173, v131
v_mul_f32_e64 v56, -v173, v132
v_mul_f32_e64 v57, -v173, v133
v_mul_f32_e64 v58, -v173, v134
v_mul_f32_e64 v59, -v173, v135
v_mul_f32_e64 v60, -v173, v136
v_mul_f32_e64 v61, -v173, v137
v_mul_f32_e64 v62, -v173, v138
v_mul_f32_e64 v63, -v173, v139
s_waitcnt vmcnt(4)
s_barrier
ds_read_b128 v[96:99], v8 offset:40960
ds_read_b128 v[100:103], v8 offset:41472
ds_read_b128 v[104:107], v8 offset:43008
ds_read_b128 v[108:111], v8 offset:43520
s_waitcnt lgkmcnt(2)
v_mfma_f32_32x32x16_bf16 v[32:47], a[0:3], v[96:99], v[32:47]
ds_read_b128 v[112:115], v8 offset:45056
s_add_u32 m0, s30, 0
s_nop 0
buffer_load_dwordx4 v1, s[8:11], s26 offen sc1 lds
buffer_load_dwordx4 v1, s[8:11], s26 offen offset:1024 sc1 lds
s_add_u32 s26, s26, 8192
s_add_u32 s33, s33, 4096
buffer_load_dwordx4 a[80:83], v9, s[8:11], s33 offen offset:0
v_mfma_f32_32x32x16_bf16 v[48:63], a[0:3], v[100:103], v[48:63]
ds_read_b128 v[116:119], v8 offset:45568
s_add_u32 m0, s30, 8192
s_nop 0
buffer_load_dwordx4 v1, s[8:11], s26 offen sc1 lds
buffer_load_dwordx4 v1, s[8:11], s26 offen offset:1024 sc1 lds
s_add_u32 s26, s26, 8192
s_add_u32 s33, s33, 4096
buffer_load_dwordx4 a[84:87], v9, s[8:11], s33 offen offset:0
s_waitcnt lgkmcnt(2)
v_mfma_f32_32x32x16_bf16 v[32:47], a[4:7], v[104:107], v[32:47]
ds_read_b128 v[96:99], v8 offset:47104
s_add_u32 m0, s30, 16384
s_nop 0
buffer_load_dwordx4 v1, s[8:11], s26 offen sc1 lds
buffer_load_dwordx4 v1, s[8:11], s26 offen offset:1024 sc1 lds
s_add_u32 s26, s26, 8192
s_add_u32 s33, s33, 4096
buffer_load_dwordx4 a[88:91], v9, s[8:11], s33 offen offset:0
v_mfma_f32_32x32x16_bf16 v[48:63], a[4:7], v[108:111], v[48:63]
ds_read_b128 v[100:103], v8 offset:47616
s_add_u32 m0, s30, 24576
s_nop 0
buffer_load_dwordx4 v1, s[8:11], s26 offen sc1 lds
buffer_load_dwordx4 v1, s[8:11], s26 offen offset:1024 sc1 lds
s_add_u32 s26, s26, 8192
s_add_u32 s33, s33, 4096
buffer_load_dwordx4 a[92:95], v9, s[8:11], s33 offen offset:0
s_waitcnt lgkmcnt(2)
v_mfma_f32_32x32x16_bf16 v[32:47], a[8:11], v[112:115], v[32:47]
ds_read_b128 v[104:107], v8 offset:49152
s_add_u32 m0, s30, 32768
s_nop 0
buffer_load_dwordx4 v1, s[8:11], s26 offen sc1 lds
buffer_load_dwordx4 v1, s[8:11], s26 offen offset:1024 sc1 lds
s_add_u32 s26, s26, 8192
s_add_u32 s33, s33, 4096
buffer_load_dwordx4 a[96:99], v9, s[8:11], s33 offen offset:0
v_mfma_f32_32x32x16_bf16 v[48:63], a[8:11], v[116:119], v[48:63]
ds_read_b128 v[108:111], v8 offset:49664
s_add_u32 s33, s33, 4096
buffer_load_dwordx4 a[100:103], v9, s[8:11], s33 offen offset:0
s_waitcnt lgkmcnt(2)
v_mfma_f32_32x32x16_bf16 v[32:47], a[12:15], v[96:99], v[32:47]
ds_read_b128 v[112:115], v8 offset:51200
s_add_u32 s33, s33, 4096
buffer_load_dwordx4 a[104:107], v9, s[8:11], s33 offen offset:0
v_mfma_f32_32x32x16_bf16 v[48:63], a[12:15], v[100:103], v[48:63]
ds_read_b128 v[116:119], v8 offset:51712
s_add_u32 s33, s33, 4096
buffer_load_dwordx4 a[108:111], v9, s[8:11], s33 offen offset:0
s_waitcnt lgkmcnt(2)
v_mfma_f32_32x32x16_bf16 v[32:47], a[16:19], v[104:107], v[32:47]
ds_read_b128 v[96:99], v8 offset:53248
s_add_u32 s33, s33, 4096
buffer_load_dwordx4 a[112:115], v9, s[8:11], s33 offen offset:0
v_mfma_f32_32x32x16_bf16 v[48:63], a[16:19], v[108:111], v[48:63]
ds_read_b128 v[100:103], v8 offset:53760
s_add_u32 s33, s33, 4096
buffer_load_dwordx4 a[116:119], v9, s[8:11], s33 offen offset:0
s_waitcnt lgkmcnt(2)
v_mfma_f32_32x32x16_bf16 v[32:47], a[20:23], v[112:115], v[32:47]
ds_read_b128 v[104:107], v8 offset:55296
s_add_u32 s33, s33, 4096
buffer_load_dwordx4 a[120:123], v9, s[8:11], s33 offen offset:0
v_mfma_f32_32x32x16_bf16 v[48:63], a[20:23], v[116:119], v[48:63]
ds_read_b128 v[108:111], v8 offset:55808
s_add_u32 s33, s33, 4096
buffer_load_dwordx4 a[124:127], v9, s[8:11], s33 offen offset:0
s_lshr_b32 s28, s24, 1
s_lshl_b32 s28, s28, 7
s_add_u32 s28, s28, 9207808
s_waitcnt vmcnt(22)
s_barrier
s_cmp_lg_u32 s16, 0
s_cbranch_scc1 S37
s_mov_b64 exec, 1
buffer_atomic_add v7, v6, s[8:11], s28 offen sc1
s_mov_b64 exec, -1
S37:
s_waitcnt vmcnt(20)
s_barrier
s_waitcnt lgkmcnt(2)
v_mfma_f32_32x32x16_bf16 v[32:47], a[24:27], v[96:99], v[32:47]
ds_read_b128 v[112:115], v8 offset:57344
s_add_u32 m0, s30, 40960
s_nop 0
buffer_load_dwordx4 v1, s[8:11], s26 offen sc1 lds
buffer_load_dwordx4 v1, s[8:11], s26 offen offset:1024 sc1 lds
s_add_u32 s26, s26, 8192
s_add_u32 s33, s33, 4096
buffer_load_dwordx4 a[128:131], v9, s[8:11], s33 offen offset:0
v_mfma_f32_32x32x16_bf16 v[48:63], a[24:27], v[100:103], v[48:63]
ds_read_b128 v[116:119], v8 offset:57856
s_add_u32 s33, s33, 4096
buffer_load_dwordx4 a[132:135], v9, s[8:11], s33 offen offset:0
s_waitcnt lgkmcnt(2)
v_mfma_f32_32x32x16_bf16 v[32:47], a[28:31], v[104:107], v[32:47]
ds_read_b128 v[96:99], v8 offset:59392
s_add_u32 s33, s33, 4096
buffer_load_dwordx4 a[136:139], v9, s[8:11], s33 offen offset:0
v_mfma_f32_32x32x16_bf16 v[48:63], a[28:31], v[108:111], v[48:63]
ds_read_b128 v[100:103], v8 offset:59904
s_add_u32 s33, s33, 4096
buffer_load_dwordx4 a[140:143], v9, s[8:11], s33 offen offset:0
s_waitcnt lgkmcnt(2)
v_mfma_f32_32x32x16_bf16 v[32:47], a[32:35], v[112:115], v[32:47]
ds_read_b128 v[104:107], v8 offset:61440
s_add_u32 s33, s33, 4096
buffer_load_dwordx4 a[144:147], v9, s[8:11], s33 offen offset:0
v_mfma_f32_32x32x16_bf16 v[48:63], a[32:35], v[116:119], v[48:63]
ds_read_b128 v[108:111], v8 offset:61952
s_add_u32 s33, s33, 4096
buffer_load_dwordx4 a[148:151], v9, s[8:11], s33 offen offset:0
s_waitcnt lgkmcnt(2)
v_mfma_f32_32x32x16_bf16 v[32:47], a[36:39], v[96:99], v[32:47]
ds_read_b128 v[112:115], v8 offset:63488
s_add_u32 s33, s33, 4096
buffer_load_dwordx4 a[152:155], v9, s[8:11], s33 offen offset:0
v_mfma_f32_32x32x16_bf16 v[48:63], a[36:39], v[100:103], v[48:63]
ds_read_b128 v[116:119], v8 offset:64000
s_add_u32 s33, s33, 4096
buffer_load_dwordx4 a[156:159], v9, s[8:11], s33 offen offset:0
s_waitcnt lgkmcnt(2)
v_mfma_f32_32x32x16_bf16 v[32:47], a[40:43], v[104:107], v[32:47]
ds_read_b128 v[96:99], v8 offset:0
v_mfma_f32_32x32x16_bf16 v[48:63], a[40:43], v[108:111], v[48:63]
ds_read_b128 v[100:103], v8 offset:512
s_waitcnt lgkmcnt(2)
v_mfma_f32_32x32x16_bf16 v[32:47], a[44:47], v[112:115], v[32:47]
ds_read_b128 v[104:107], v8 offset:2048
v_mfma_f32_32x32x16_bf16 v[48:63], a[44:47], v[116:119], v[48:63]
ds_read_b128 v[108:111], v8 offset:2560
s_waitcnt lgkmcnt(2)
v_mfma_f32_32x32x16_bf16 v[32:47], a[48:51], v[96:99], v[32:47]
ds_read_b128 v[112:115], v8 offset:4096
v_mfma_f32_32x32x16_bf16 v[48:63], a[48:51], v[100:103], v[48:63]
ds_read_b128 v[116:119], v8 offset:4608
s_waitcnt lgkmcnt(2)
v_mfma_f32_32x32x16_bf16 v[32:47], a[52:55], v[104:107], v[32:47]
ds_read_b128 v[96:99], v8 offset:6144
v_mfma_f32_32x32x16_bf16 v[48:63], a[52:55], v[108:111], v[48:63]
ds_read_b128 v[100:103], v8 offset:6656
s_waitcnt vmcnt(24)
s_barrier
s_waitcnt lgkmcnt(2)
v_mfma_f32_32x32x16_bf16 v[32:47], a[56:59], v[112:115], v[32:47]
ds_read_b128 v[104:107], v8 offset:8192
s_add_u32 m0, s30, 49152
s_nop 0
buffer_load_dwordx4 v1, s[8:11], s26 offen sc1 lds
buffer_load_dwordx4 v1, s[8:11], s26 offen offset:1024 sc1 lds
s_add_u32 s26, s26, 8192
v_mfma_f32_32x32x16_bf16 v[48:63], a[56:59], v[116:119], v[48:63]
ds_read_b128 v[108:111], v8 offset:8704
s_waitcnt lgkmcnt(2)
v_mfma_f32_32x32x16_bf16 v[32:47], a[60:63], v[96:99], v[32:47]
ds_read_b128 v[112:115], v8 offset:10240
v_mfma_f32_32x32x16_bf16 v[48:63], a[60:63], v[100:103], v[48:63]
ds_read_b128 v[116:119], v8 offset:10752
s_waitcnt lgkmcnt(2)
v_mfma_f32_32x32x16_bf16 v[32:47], a[64:67], v[104:107], v[32:47]
ds_read_b128 v[96:99], v8 offset:12288
v_mfma_f32_32x32x16_bf16 v[48:63], a[64:67], v[108:111], v[48:63]
ds_read_b128 v[100:103], v8 offset:12800
s_waitcnt lgkmcnt(2)
v_mfma_f32_32x32x16_bf16 v[32:47], a[68:71], v[112:115], v[32:47]
ds_read_b128 v[104:107], v8 offset:14336
v_mfma_f32_32x32x16_bf16 v[48:63], a[68:71], v[116:119], v[48:63]
ds_read_b128 v[108:111], v8 offset:14848
s_mov_b32 s29, s19
s_add_u32 s29, s29, 16
s_lshl_b32 s29, s29, 7
s_add_u32 s94, s29, 9205760
buffer_load_dword v31, v6, s[8:11], s94 offen sc1
s_waitcnt lgkmcnt(2)
v_mfma_f32_32x32x16_bf16 v[32:47], a[72:75], v[96:99], v[32:47]
ds_read_b128 v[112:115], v8 offset:16384
v_mfma_f32_32x32x16_bf16 v[48:63], a[72:75], v[100:103], v[48:63]
ds_read_b128 v[116:119], v8 offset:16896
s_waitcnt lgkmcnt(2)
v_mfma_f32_32x32x16_bf16 v[32:47], a[76:79], v[104:107], v[32:47]
ds_read_b128 v[96:99], v8 offset:18432
v_mfma_f32_32x32x16_bf16 v[48:63], a[76:79], v[108:111], v[48:63]
ds_read_b128 v[100:103], v8 offset:18944
s_waitcnt lgkmcnt(2)
v_mfma_f32_32x32x16_bf16 v[32:47], a[80:83], v[112:115], v[32:47]
ds_read_b128 v[104:107], v8 offset:20480
v_mfma_f32_32x32x16_bf16 v[48:63], a[80:83], v[116:119], v[48:63]
ds_read_b128 v[108:111], v8 offset:20992
s_waitcnt lgkmcnt(2)
v_mfma_f32_32x32x16_bf16 v[32:47], a[84:87], v[96:99], v[32:47]
ds_read_b128 v[112:115], v8 offset:22528
v_mfma_f32_32x32x16_bf16 v[48:63], a[84:87], v[100:103], v[48:63]
ds_read_b128 v[116:119], v8 offset:23040
s_waitcnt vmcnt(21)
s_barrier
s_waitcnt lgkmcnt(2)
v_mfma_f32_32x32x16_bf16 v[32:47], a[88:91], v[104:107], v[32:47]
ds_read_b128 v[96:99], v8 offset:24576
v_mfma_f32_32x32x16_bf16 v[48:63], a[88:91], v[108:111], v[48:63]
ds_read_b128 v[100:103], v8 offset:25088
s_waitcnt lgkmcnt(2)
v_mfma_f32_32x32x16_bf16 v[32:47], a[92:95], v[112:115], v[32:47]
ds_read_b128 v[104:107], v8 offset:26624
v_mfma_f32_32x32x16_bf16 v[48:63], a[92:95], v[116:119], v[48:63]
ds_read_b128 v[108:111], v8 offset:27136
s_waitcnt lgkmcnt(2)
s_waitcnt vmcnt(20)
v_mfma_f32_32x32x16_bf16 v[32:47], a[96:99], v[96:99], v[32:47]
ds_read_b128 v[112:115], v8 offset:28672
v_mfma_f32_32x32x16_bf16 v[48:63], a[96:99], v[100:103], v[48:63]
ds_read_b128 v[116:119], v8 offset:29184
s_waitcnt lgkmcnt(2)
s_waitcnt vmcnt(19)
v_mfma_f32_32x32x16_bf16 v[32:47], a[100:103], v[104:107], v[32:47]
ds_read_b128 v[96:99], v8 offset:30720
v_mfma_f32_32x32x16_bf16 v[48:63], a[100:103], v[108:111], v[48:63]
ds_read_b128 v[100:103], v8 offset:31232
s_waitcnt vmcnt(0)
s_cmp_lg_u32 s16, 0
s_cbranch_scc1 P38
s_movk_i32 s77, 16
P39:
v_cmp_gt_u32 vcc, s77, v31
s_nop 1
s_cbranch_vccz P38
s_add_u32 s76, s76, 1
s_cmp_gt_u32 s76, 400000
s_cbranch_scc1 P38
s_sleep 4
buffer_load_dword v31, v6, s[8:11], s94 offen sc1
s_waitcnt vmcnt(0)
s_branch P39
P38:
s_barrier
s_add_u32 s28, s19, 16
s_lshl_b32 s28, s28, 6
v_add_u32 v29, s28, v0
v_lshlrev_b32 v29, 4, v29
s_mov_b32 s29, 37081088
buffer_load_dwordx4 v[140:143], v29, s[8:11], s29 offen sc1
s_add_u32 s29, s29, 32768
buffer_load_dwordx4 v[144:147], v29, s[8:11], s29 offen sc1
s_add_u32 s29, s29, 32768
buffer_load_dwordx4 v[148:151], v29, s[8:11], s29 offen sc1
s_add_u32 s29, s29, 32768
buffer_load_dwordx4 v[152:155], v29, s[8:11], s29 offen sc1
s_add_u32 s29, s29, 32768
buffer_load_dwordx4 v[156:159], v29, s[8:11], s29 offen sc1
s_add_u32 s29, s29, 32768
buffer_load_dwordx4 v[160:163], v29, s[8:11], s29 offen sc1
s_add_u32 s29, s29, 32768
buffer_load_dwordx4 v[164:167], v29, s[8:11], s29 offen sc1
s_add_u32 s29, s29, 32768
buffer_load_dwordx4 v[168:171], v29, s[8:11], s29 offen sc1
s_waitcnt lgkmcnt(2)
v_mfma_f32_32x32x16_bf16 v[32:47], a[104:107], v[112:115], v[32:47]
ds_read_b128 v[104:107], v8 offset:32768
s_add_u32 s26, s19, 16
s_mul_i32 s26, s26, 81920
s_add_u32 s26, s26, 31838208
s_add_u32 s26, s26, s30
s_add_u32 m0, s30, 57344
s_nop 0
buffer_load_dwordx4 v1, s[8:11], s26 offen sc1 lds
buffer_load_dwordx4 v1, s[8:11], s26 offen offset:1024 sc1 lds
s_add_u32 s26, s26, 8192
v_mfma_f32_32x32x16_bf16 v[48:63], a[104:107], v[116:119], v[48:63]
ds_read_b128 v[108:111], v8 offset:33280
s_add_u32 m0, s30, 0
s_nop 0
buffer_load_dwordx4 v1, s[8:11], s26 offen sc1 lds
buffer_load_dwordx4 v1, s[8:11], s26 offen offset:1024 sc1 lds
s_add_u32 s26, s26, 8192
s_waitcnt lgkmcnt(2)
v_mfma_f32_32x32x16_bf16 v[32:47], a[108:111], v[96:99], v[32:47]
ds_read_b128 v[112:115], v8 offset:34816
s_add_u32 m0, s30, 8192
s_nop 0
buffer_load_dwordx4 v1, s[8:11], s26 offen sc1 lds
buffer_load_dwordx4 v1, s[8:11], s26 offen offset:1024 sc1 lds
s_add_u32 s26, s26, 8192
v_mfma_f32_32x32x16_bf16 v[48:63], a[108:111], v[100:103], v[48:63]
ds_read_b128 v[116:119], v8 offset:35328
s_waitcnt lgkmcnt(2)
v_mfma_f32_32x32x16_bf16 v[32:47], a[112:115], v[104:107], v[32:47]
ds_read_b128 v[96:99], v8 offset:36864
v_mfma_f32_32x32x16_bf16 v[48:63], a[112:115], v[108:111], v[48:63]
ds_read_b128 v[100:103], v8 offset:37376
s_waitcnt lgkmcnt(2)
v_mfma_f32_32x32x16_bf16 v[32:47], a[116:119], v[112:115], v[32:47]
ds_read_b128 v[104:107], v8 offset:38912
v_mfma_f32_32x32x16_bf16 v[48:63], a[116:119], v[116:119], v[48:63]
ds_read_b128 v[108:111], v8 offset:39424
s_barrier
s_waitcnt lgkmcnt(2)
v_mfma_f32_32x32x16_bf16 v[32:47], a[120:123], v[96:99], v[32:47]
ds_read_b128 v[112:115], v8 offset:40960
s_add_u32 m0, s30, 16384
s_nop 0
buffer_load_dwordx4 v1, s[8:11], s26 offen sc1 lds
buffer_load_dwordx4 v1, s[8:11], s26 offen offset:1024 sc1 lds
s_add_u32 s26, s26, 8192
s_waitcnt vmcnt(8)
v_add_f32 v140, v140, v156
v_mfma_f32_32x32x16_bf16 v[48:63], a[120:123], v[100:103], v[48:63]
ds_read_b128 v[116:119], v8 offset:41472
s_add_u32 m0, s30, 24576
s_nop 0
buffer_load_dwordx4 v1, s[8:11], s26 offen sc1 lds
buffer_load_dwordx4 v1, s[8:11], s26 offen offset:1024 sc1 lds
s_add_u32 s26, s26, 8192
v_add_f32 v141, v141, v157
v_add_f32 v142, v142, v158
s_waitcnt lgkmcnt(2)
v_mfma_f32_32x32x16_bf16 v[32:47], a[124:127], v[104:107], v[32:47]
ds_read_b128 v[96:99], v8 offset:43008
v_add_f32 v143, v143, v159
v_add_f32 v144, v144, v160
v_mfma_f32_32x32x16_bf16 v[48:63], a[124:127], v[108:111], v[48:63]
ds_read_b128 v[100:103], v8 offset:43520
v_add_f32 v145, v145, v161
v_add_f32 v146, v146, v162
s_waitcnt lgkmcnt(2)
v_mfma_f32_32x32x16_bf16 v[32:47], a[128:131], v[112:115], v[32:47]
ds_read_b128 v[104:107], v8 offset:45056
v_add_f32 v147, v147, v163
v_add_f32 v148, v148, v164
v_mfma_f32_32x32x16_bf16 v[48:63], a[128:131], v[116:119], v[48:63]
ds_read_b128 v[108:111], v8 offset:45568
v_add_f32 v149, v149, v165
v_add_f32 v150, v150, v166
s_waitcnt lgkmcnt(2)
v_mfma_f32_32x32x16_bf16 v[32:47], a[132:135], v[96:99], v[32:47]
ds_read_b128 v[112:115], v8 offset:47104
v_add_f32 v151, v151, v167
v_add_f32 v152, v152, v168
v_mfma_f32_32x32x16_bf16 v[48:63], a[132:135], v[100:103], v[48:63]
ds_read_b128 v[116:119], v8 offset:47616
v_add_f32 v153, v153, v169
v_add_f32 v154, v154, v170
s_waitcnt lgkmcnt(2)
v_mfma_f32_32x32x16_bf16 v[32:47], a[136:139], v[104:107], v[32:47]
ds_read_b128 v[96:99], v8 offset:49152
v_add_f32 v155, v155, v171
v_add_f32 v140, v140, v148
v_mfma_f32_32x32x16_bf16 v[48:63], a[136:139], v[108:111], v[48:63]
ds_read_b128 v[100:103], v8 offset:49664
v_add_f32 v141, v141, v149
v_add_f32 v142, v142, v150
s_waitcnt lgkmcnt(2)
v_mfma_f32_32x32x16_bf16 v[32:47], a[140:143], v[112:115], v[32:47]
ds_read_b128 v[104:107], v8 offset:51200
v_add_f32 v143, v143, v151
v_add_f32 v144, v144, v152
v_mfma_f32_32x32x16_bf16 v[48:63], a[140:143], v[116:119], v[48:63]
ds_read_b128 v[108:111], v8 offset:51712
v_add_f32 v145, v145, v153
v_add_f32 v146, v146, v154
s_waitcnt lgkmcnt(2)
v_mfma_f32_32x32x16_bf16 v[32:47], a[144:147], v[96:99], v[32:47]
ds_read_b128 v[112:115], v8 offset:53248
v_add_f32 v147, v147, v155
v_add_f32 v140, v140, v144
v_mfma_f32_32x32x16_bf16 v[48:63], a[144:147], v[100:103], v[48:63]
ds_read_b128 v[116:119], v8 offset:53760
v_add_f32 v141, v141, v145
v_add_f32 v142, v142, v146
s_waitcnt lgkmcnt(2)
v_mfma_f32_32x32x16_bf16 v[32:47], a[148:151], v[104:107], v[32:47]
ds_read_b128 v[96:99], v8 offset:55296
v_add_f32 v143, v143, v147
v_add_f32 v140, v140, v142
v_mfma_f32_32x32x16_bf16 v[48:63], a[148:151], v[108:111], v[48:63]
ds_read_b128 v[100:103], v8 offset:55808
v_add_f32 v141, v141, v143
v_mul_f32 v28, 0x3acccccd, v140
s_waitcnt vmcnt(6)
s_barrier
s_waitcnt lgkmcnt(2)
v_mfma_f32_32x32x16_bf16 v[32:47], a[152:155], v[112:115], v[32:47]
ds_read_b128 v[104:107], v8 offset:57344
s_add_u32 m0, s30, 32768
s_nop 0
buffer_load_dwordx4 v1, s[8:11], s26 offen sc1 lds
buffer_load_dwordx4 v1, s[8:11], s26 offen offset:1024 sc1 lds
s_add_u32 s26, s26, 8192
v_mul_f32 v26, 0x3acccccd, v141
v_fma_f32 v26, -v28, v28, v26
v_mfma_f32_32x32x16_bf16 v[48:63], a[152:155], v[116:119], v[48:63]
ds_read_b128 v[108:111], v8 offset:57856
s_add_u32 m0, s30, 40960
s_nop 0
buffer_load_dwordx4 v1, s[8:11], s26 offen sc1 lds
buffer_load_dwordx4 v1, s[8:11], s26 offen offset:1024 sc1 lds
s_add_u32 s26, s26, 8192
v_max_f32 v26, 0, v26
v_add_f32 v26, 0x3727c5ac, v26
s_waitcnt lgkmcnt(2)
v_mfma_f32_32x32x16_bf16 v[32:47], a[156:159], v[96:99], v[32:47]
ds_read_b128 v[112:115], v8 offset:59392
v_rsq_f32 v27, v26
s_nop 0
v_mfma_f32_32x32x16_bf16 v[48:63], a[156:159], v[100:103], v[48:63]
ds_read_b128 v[116:119], v8 offset:59904
v_mov_b32 v174, v28
v_mov_b32 v175, v28
v_mov_b32 v178, v27
v_mov_b32 v179, v27
s_nop 1
v_permlane32_swap_b32 v174, v175
v_permlane32_swap_b32 v178, v179
v_mul_f32_e64 v64, -v174, v124
v_mul_f32_e64 v65, -v174, v125
v_mul_f32_e64 v66, -v174, v126
v_mul_f32_e64 v67, -v174, v127
v_mul_f32_e64 v68, -v174, v128
v_mul_f32_e64 v69, -v174, v129
v_mul_f32_e64 v70, -v174, v130
v_mul_f32_e64 v71, -v174, v131
v_mul_f32_e64 v72, -v174, v132
v_mul_f32_e64 v73, -v174, v133
v_mul_f32_e64 v74, -v174, v134
v_mul_f32_e64 v75, -v174, v135
v_mul_f32_e64 v76, -v174, v136
v_mul_f32_e64 v77, -v174, v137
v_mul_f32_e64 v78, -v174, v138
v_mul_f32_e64 v79, -v174, v139
v_mul_f32_e64 v80, -v175, v124
v_mul_f32_e64 v81, -v175, v125
v_mul_f32_e64 v82, -v175, v126
v_mul_f32_e64 v83, -v175, v127
v_mul_f32_e64 v84, -v175, v128
v_mul_f32_e64 v85, -v175, v129
v_mul_f32_e64 v86, -v175, v130
v_mul_f32_e64 v87, -v175, v131
v_mul_f32_e64 v88, -v175, v132
v_mul_f32_e64 v89, -v175, v133
v_mul_f32_e64 v90, -v175, v134
v_mul_f32_e64 v91, -v175, v135
v_mul_f32_e64 v92, -v175, v136
v_mul_f32_e64 v93, -v175, v137
v_mul_f32_e64 v94, -v175, v138
v_mul_f32_e64 v95, -v175, v139
s_waitcnt lgkmcnt(2)
v_mfma_f32_32x32x16_bf16 v[64:79], a[0:3], v[104:107], v[64:79]
ds_read_b128 v[96:99], v8 offset:61440
s_lshl_b32 s37, s20, 4
s_lshl_b32 s28, s16, 2
s_add_u32 s37, s37, s28
s_lshl_b32 s37, s37, 15
s_add_u32 s37, s37, 37605376
s_add_u32 s28, s19, 0
s_lshl_b32 s28, s28, 6
v_add_u32 v25, s28, v2
v_lshlrev_b32 v25, 4, v25
v_lshl_add_u32 v25, v3, 15, v25
v_mul_f32 v32, v32, v176
v_mfma_f32_32x32x16_bf16 v[80:95], a[0:3], v[108:111], v[80:95]
ds_read_b128 v[100:103], v8 offset:61952
v_mul_f32 v33, v33, v176
v_mul_f32 v34, v34, v176
s_waitcnt lgkmcnt(2)
v_mfma_f32_32x32x16_bf16 v[64:79], a[4:7], v[112:115], v[64:79]
ds_read_b128 v[104:107], v8 offset:63488
v_mul_f32 v35, v35, v176
v_cvt_pk_bf16_f32 v16, v32, v33
v_mfma_f32_32x32x16_bf16 v[80:95], a[4:7], v[116:119], v[80:95]
ds_read_b128 v[108:111], v8 offset:64000
v_cvt_pk_bf16_f32 v17, v34, v35
v_mul_f32 v36, v36, v176
s_waitcnt lgkmcnt(2)
v_mfma_f32_32x32x16_bf16 v[64:79], a[8:11], v[96:99], v[64:79]
ds_read_b128 v[112:115], v8 offset:0
v_mul_f32 v37, v37, v176
v_mul_f32 v38, v38, v176
v_mfma_f32_32x32x16_bf16 v[80:95], a[8:11], v[100:103], v[80:95]
ds_read_b128 v[116:119], v8 offset:512
v_mul_f32 v39, v39, v176
v_cvt_pk_bf16_f32 v18, v36, v37
s_waitcnt lgkmcnt(2)
v_mfma_f32_32x32x16_bf16 v[64:79], a[12:15], v[104:107], v[64:79]
ds_read_b128 v[96:99], v8 offset:2048
v_cvt_pk_bf16_f32 v19, v38, v39
s_add_u32 s28, s37, 0
s_nop 0
v_permlane32_swap_b32 v16, v18
v_permlane32_swap_b32 v17, v19
s_nop 0
buffer_store_dwordx4 v[16:19], v25, s[8:11], s28 offen offset:0 sc1
s_nop 0
v_mfma_f32_32x32x16_bf16 v[80:95], a[12:15], v[108:111], v[80:95]
ds_read_b128 v[100:103], v8 offset:2560
v_mul_f32 v40, v40, v176
v_mul_f32 v41, v41, v176
s_waitcnt lgkmcnt(2)
v_mfma_f32_32x32x16_bf16 v[64:79], a[16:19], v[112:115], v[64:79]
ds_read_b128 v[104:107], v8 offset:4096
v_mul_f32 v42, v42, v176
v_mul_f32 v43, v43, v176
v_mfma_f32_32x32x16_bf16 v[80:95], a[16:19], v[116:119], v[80:95]
ds_read_b128 v[108:111], v8 offset:4608
v_cvt_pk_bf16_f32 v20, v40, v41
v_cvt_pk_bf16_f32 v21, v42, v43
s_waitcnt lgkmcnt(2)
v_mfma_f32_32x32x16_bf16 v[64:79], a[20:23], v[96:99], v[64:79]
ds_read_b128 v[112:115], v8 offset:6144
v_mul_f32 v44, v44, v176
v_mul_f32 v45, v45, v176
v_mfma_f32_32x32x16_bf16 v[80:95], a[20:23], v[100:103], v[80:95]
ds_read_b128 v[116:119], v8 offset:6656
v_mul_f32 v46, v46, v176
v_mul_f32 v47, v47, v176
s_waitcnt vmcnt(7)
s_barrier
s_waitcnt lgkmcnt(2)
v_mfma_f32_32x32x16_bf16 v[64:79], a[24:27], v[104:107], v[64:79]
ds_read_b128 v[96:99], v8 offset:8192
s_add_u32 m0, s30, 49152
s_nop 0
buffer_load_dwordx4 v1, s[8:11], s26 offen sc1 lds
buffer_load_dwordx4 v1, s[8:11], s26 offen offset:1024 sc1 lds
s_add_u32 s26, s26, 8192
v_cvt_pk_bf16_f32 v22, v44, v45
v_cvt_pk_bf16_f32 v23, v46, v47
v_mfma_f32_32x32x16_bf16 v[80:95], a[24:27], v[108:111], v[80:95]
ds_read_b128 v[100:103], v8 offset:8704
s_add_u32 m0, s30, 57344
s_nop 0
buffer_load_dwordx4 v1, s[8:11], s26 offen sc1 lds
buffer_load_dwordx4 v1, s[8:11], s26 offen offset:1024 sc1 lds
s_add_u32 s26, s26, 8192
s_add_u32 s28, s37, 65536
s_nop 0
v_permlane32_swap_b32 v20, v22
v_permlane32_swap_b32 v21, v23
s_nop 0
buffer_store_dwordx4 v[20:23], v25, s[8:11], s28 offen offset:0 sc1
s_nop 0
v_mul_f32 v48, v48, v177
s_waitcnt lgkmcnt(2)
v_mfma_f32_32x32x16_bf16 v[64:79], a[28:31], v[112:115], v[64:79]
ds_read_b128 v[104:107], v8 offset:10240
v_mul_f32 v49, v49, v177
v_mul_f32 v50, v50, v177
v_mfma_f32_32x32x16_bf16 v[80:95], a[28:31], v[116:119], v[80:95]
ds_read_b128 v[108:111], v8 offset:10752
v_mul_f32 v51, v51, v177
v_cvt_pk_bf16_f32 v16, v48, v49
s_waitcnt lgkmcnt(2)
v_mfma_f32_32x32x16_bf16 v[64:79], a[32:35], v[96:99], v[64:79]
ds_read_b128 v[112:115], v8 offset:12288
v_cvt_pk_bf16_f32 v17, v50, v51
v_mul_f32 v52, v52, v177
v_mfma_f32_32x32x16_bf16 v[80:95], a[32:35], v[100:103], v[80:95]
ds_read_b128 v[116:119], v8 offset:12800
v_mul_f32 v53, v53, v177
v_mul_f32 v54, v54, v177
s_waitcnt lgkmcnt(2)
v_mfma_f32_32x32x16_bf16 v[64:79], a[36:39], v[104:107], v[64:79]
ds_read_b128 v[96:99], v8 offset:14336
v_mul_f32 v55, v55, v177
v_cvt_pk_bf16_f32 v18, v52, v53
v_mfma_f32_32x32x16_bf16 v[80:95], a[36:39], v[108:111], v[80:95]
ds_read_b128 v[100:103], v8 offset:14848
v_cvt_pk_bf16_f32 v19, v54, v55
s_add_u32 s28, s37, 0
s_nop 0
v_permlane32_swap_b32 v16, v18
v_permlane32_swap_b32 v17, v19
s_nop 0
buffer_store_dwordx4 v[16:19], v25, s[8:11], s28 offen offset:512 sc1
s_nop 0
s_waitcnt lgkmcnt(2)
v_mfma_f32_32x32x16_bf16 v[64:79], a[40:43], v[112:115], v[64:79]
ds_read_b128 v[104:107], v8 offset:16384
v_mul_f32 v56, v56, v177
v_mul_f32 v57, v57, v177
v_mfma_f32_32x32x16_bf16 v[80:95], a[40:43], v[116:119], v[80:95]
ds_read_b128 v[108:111], v8 offset:16896
v_mul_f32 v58, v58, v177
v_mul_f32 v59, v59, v177
s_waitcnt lgkmcnt(2)
v_mfma_f32_32x32x16_bf16 v[64:79], a[44:47], v[96:99], v[64:79]
ds_read_b128 v[112:115], v8 offset:18432
v_cvt_pk_bf16_f32 v20, v56, v57
v_cvt_pk_bf16_f32 v21, v58, v59
v_mfma_f32_32x32x16_bf16 v[80:95], a[44:47], v[100:103], v[80:95]
ds_read_b128 v[116:119], v8 offset:18944
v_mul_f32 v60, v60, v177
v_mul_f32 v61, v61, v177
v_mul_f32 v62, v62, v177
v_mul_f32 v63, v63, v177
v_cvt_pk_bf16_f32 v22, v60, v61
v_cvt_pk_bf16_f32 v23, v62, v63
s_add_u32 s28, s37, 65536
s_nop 0
v_permlane32_swap_b32 v20, v22
v_permlane32_swap_b32 v21, v23
s_nop 0
buffer_store_dwordx4 v[20:23], v25, s[8:11], s28 offen offset:512 sc1
s_nop 0
s_waitcnt lgkmcnt(2)
v_mfma_f32_32x32x16_bf16 v[64:79], a[48:51], v[104:107], v[64:79]
ds_read_b128 v[96:99], v8 offset:20480
v_mfma_f32_32x32x16_bf16 v[80:95], a[48:51], v[108:111], v[80:95]
ds_read_b128 v[100:103], v8 offset:20992
s_waitcnt lgkmcnt(2)
v_mfma_f32_32x32x16_bf16 v[64:79], a[52:55], v[112:115], v[64:79]
ds_read_b128 v[104:107], v8 offset:22528
v_mfma_f32_32x32x16_bf16 v[80:95], a[52:55], v[116:119], v[80:95]
ds_read_b128 v[108:111], v8 offset:23040
s_waitcnt vmcnt(10)
s_barrier
s_waitcnt lgkmcnt(2)
v_mfma_f32_32x32x16_bf16 v[64:79], a[56:59], v[96:99], v[64:79]
ds_read_b128 v[112:115], v8 offset:24576
s_add_u32 m0, s30, 0
s_nop 0
buffer_load_dwordx4 v1, s[8:11], s26 offen sc1 lds
buffer_load_dwordx4 v1, s[8:11], s26 offen offset:1024 sc1 lds
s_add_u32 s26, s26, 8192
v_mfma_f32_32x32x16_bf16 v[80:95], a[56:59], v[100:103], v[80:95]
ds_read_b128 v[116:119], v8 offset:25088
s_waitcnt lgkmcnt(2)
v_mfma_f32_32x32x16_bf16 v[64:79], a[60:63], v[104:107], v[64:79]
ds_read_b128 v[96:99], v8 offset:26624
v_mfma_f32_32x32x16_bf16 v[80:95], a[60:63], v[108:111], v[80:95]
ds_read_b128 v[100:103], v8 offset:27136
s_waitcnt lgkmcnt(2)
v_mfma_f32_32x32x16_bf16 v[64:79], a[64:67], v[112:115], v[64:79]
ds_read_b128 v[104:107], v8 offset:28672
v_mfma_f32_32x32x16_bf16 v[80:95], a[64:67], v[116:119], v[80:95]
ds_read_b128 v[108:111], v8 offset:29184
s_waitcnt lgkmcnt(2)
v_mfma_f32_32x32x16_bf16 v[64:79], a[68:71], v[96:99], v[64:79]
ds_read_b128 v[112:115], v8 offset:30720
v_mfma_f32_32x32x16_bf16 v[80:95], a[68:71], v[100:103], v[80:95]
ds_read_b128 v[116:119], v8 offset:31232
s_add_u32 s28, s19, 0
s_lshl_b32 s28, s28, 7
s_add_u32 s28, s28, 9261056
s_waitcnt vmcnt(2)
s_barrier
s_cmp_lg_u32 s16, 0
s_cbranch_scc1 S40
v_lshlrev_b32 v29, 12, v0
s_mov_b64 exec, 0xff
buffer_atomic_add v7, v29, s[8:11], s28 offen sc1
s_mov_b64 exec, -1
S40:
s_waitcnt lgkmcnt(2)
v_mfma_f32_32x32x16_bf16 v[64:79], a[72:75], v[104:107], v[64:79]
ds_read_b128 v[96:99], v8 offset:32768
v_mfma_f32_32x32x16_bf16 v[80:95], a[72:75], v[108:111], v[80:95]
ds_read_b128 v[100:103], v8 offset:33280
s_waitcnt lgkmcnt(2)
v_mfma_f32_32x32x16_bf16 v[64:79], a[76:79], v[112:115], v[64:79]
ds_read_b128 v[104:107], v8 offset:34816
v_mfma_f32_32x32x16_bf16 v[80:95], a[76:79], v[116:119], v[80:95]
ds_read_b128 v[108:111], v8 offset:35328
s_waitcnt lgkmcnt(2)
v_mfma_f32_32x32x16_bf16 v[64:79], a[80:83], v[96:99], v[64:79]
ds_read_b128 v[112:115], v8 offset:36864
v_mfma_f32_32x32x16_bf16 v[80:95], a[80:83], v[100:103], v[80:95]
ds_read_b128 v[116:119], v8 offset:37376
s_waitcnt lgkmcnt(2)
v_mfma_f32_32x32x16_bf16 v[64:79], a[84:87], v[104:107], v[64:79]
ds_read_b128 v[96:99], v8 offset:38912
v_mfma_f32_32x32x16_bf16 v[80:95], a[84:87], v[108:111], v[80:95]
ds_read_b128 v[100:103], v8 offset:39424
s_barrier
s_waitcnt lgkmcnt(2)
v_mfma_f32_32x32x16_bf16 v[64:79], a[88:91], v[112:115], v[64:79]
ds_read_b128 v[104:107], v8 offset:40960
v_mfma_f32_32x32x16_bf16 v[80:95], a[88:91], v[116:119], v[80:95]
ds_read_b128 v[108:111], v8 offset:41472
s_waitcnt lgkmcnt(2)
v_mfma_f32_32x32x16_bf16 v[64:79], a[92:95], v[96:99], v[64:79]
ds_read_b128 v[112:115], v8 offset:43008
v_mfma_f32_32x32x16_bf16 v[80:95], a[92:95], v[100:103], v[80:95]
ds_read_b128 v[116:119], v8 offset:43520
s_waitcnt lgkmcnt(2)
v_mfma_f32_32x32x16_bf16 v[64:79], a[96:99], v[104:107], v[64:79]
ds_read_b128 v[96:99], v8 offset:45056
v_mfma_f32_32x32x16_bf16 v[80:95], a[96:99], v[108:111], v[80:95]
ds_read_b128 v[100:103], v8 offset:45568
s_waitcnt lgkmcnt(2)
v_mfma_f32_32x32x16_bf16 v[64:79], a[100:103], v[112:115], v[64:79]
ds_read_b128 v[104:107], v8 offset:47104
v_mfma_f32_32x32x16_bf16 v[80:95], a[100:103], v[116:119], v[80:95]
ds_read_b128 v[108:111], v8 offset:47616
s_waitcnt lgkmcnt(2)
v_mfma_f32_32x32x16_bf16 v[64:79], a[104:107], v[96:99], v[64:79]
ds_read_b128 v[112:115], v8 offset:49152
v_mfma_f32_32x32x16_bf16 v[80:95], a[104:107], v[100:103], v[80:95]
ds_read_b128 v[116:119], v8 offset:49664
s_waitcnt lgkmcnt(2)
v_mfma_f32_32x32x16_bf16 v[64:79], a[108:111], v[104:107], v[64:79]
ds_read_b128 v[96:99], v8 offset:51200
v_mfma_f32_32x32x16_bf16 v[80:95], a[108:111], v[108:111], v[80:95]
ds_read_b128 v[100:103], v8 offset:51712
s_waitcnt lgkmcnt(2)
v_mfma_f32_32x32x16_bf16 v[64:79], a[112:115], v[112:115], v[64:79]
ds_read_b128 v[104:107], v8 offset:53248
v_mfma_f32_32x32x16_bf16 v[80:95], a[112:115], v[116:119], v[80:95]
ds_read_b128 v[108:111], v8 offset:53760
s_waitcnt lgkmcnt(2)
v_mfma_f32_32x32x16_bf16 v[64:79], a[116:119], v[96:99], v[64:79]
ds_read_b128 v[112:115], v8 offset:55296
v_mfma_f32_32x32x16_bf16 v[80:95], a[116:119], v[100:103], v[80:95]
ds_read_b128 v[116:119], v8 offset:55808
s_lshl_b32 s28, s23, 1
s_add_u32 s28, s28, 0
s_sub_u32 s28, s28, 4
v_min_u32 v30, 5, v0
v_add_u32 v30, s28, v30
v_max_i32 v30, 0, v30
v_lshlrev_b32 v30, 7, v30
s_lshl_b32 s95, s17, 12
s_add_u32 s95, s95, 9261056
buffer_load_dword v31, v30, s[8:11], s95 offen sc1
s_waitcnt vmcnt(1)
s_barrier
s_waitcnt lgkmcnt(2)
v_mfma_f32_32x32x16_bf16 v[64:79], a[120:123], v[104:107], v[64:79]
ds_read_b128 v[96:99], v8 offset:57344
v_mfma_f32_32x32x16_bf16 v[80:95], a[120:123], v[108:111], v[80:95]
ds_read_b128 v[100:103], v8 offset:57856
s_waitcnt lgkmcnt(2)
v_mfma_f32_32x32x16_bf16 v[64:79], a[124:127], v[112:115], v[64:79]
ds_read_b128 v[104:107], v8 offset:59392
v_mfma_f32_32x32x16_bf16 v[80:95], a[124:127], v[116:119], v[80:95]
ds_read_b128 v[108:111], v8 offset:59904
s_waitcnt lgkmcnt(2)
v_mfma_f32_32x32x16_bf16 v[64:79], a[128:131], v[96:99], v[64:79]
ds_read_b128 v[112:115], v8 offset:61440
v_mfma_f32_32x32x16_bf16 v[80:95], a[128:131], v[100:103], v[80:95]
ds_read_b128 v[116:119], v8 offset:61952
s_waitcnt lgkmcnt(2)
v_mfma_f32_32x32x16_bf16 v[64:79], a[132:135], v[104:107], v[64:79]
ds_read_b128 v[96:99], v8 offset:63488
v_mfma_f32_32x32x16_bf16 v[80:95], a[132:135], v[108:111], v[80:95]
ds_read_b128 v[100:103], v8 offset:64000
s_waitcnt lgkmcnt(2)
v_mfma_f32_32x32x16_bf16 v[64:79], a[136:139], v[112:115], v[64:79]
ds_read_b128 v[104:107], v8 offset:0
v_mfma_f32_32x32x16_bf16 v[80:95], a[136:139], v[116:119], v[80:95]
ds_read_b128 v[108:111], v8 offset:512
s_waitcnt lgkmcnt(2)
v_mfma_f32_32x32x16_bf16 v[64:79], a[140:143], v[96:99], v[64:79]
ds_read_b128 v[112:115], v8 offset:2048
v_mfma_f32_32x32x16_bf16 v[80:95], a[140:143], v[100:103], v[80:95]
ds_read_b128 v[116:119], v8 offset:2560
s_waitcnt lgkmcnt(2)
v_mfma_f32_32x32x16_bf16 v[64:79], a[144:147], v[104:107], v[64:79]
ds_read_b128 v[96:99], v8 offset:4096
v_mfma_f32_32x32x16_bf16 v[80:95], a[144:147], v[108:111], v[80:95]
ds_read_b128 v[100:103], v8 offset:4608
s_waitcnt vmcnt(0)
s_cmp_lg_u32 s16, 0
s_cbranch_scc1 P41
s_movk_i32 s77, 16
P42:
v_cmp_gt_u32 vcc, s77, v31
s_nop 1
s_cbranch_vccz P41
s_add_u32 s76, s76, 1
s_cmp_gt_u32 s76, 400000
s_cbranch_scc1 P41
s_sleep 4
buffer_load_dword v31, v30, s[8:11], s95 offen sc1
s_waitcnt vmcnt(0)
s_branch P42
P41:
s_barrier
s_lshl_b32 s78, s23, 7
s_add_u32 s78, s78, 0
s_lshl_b32 s28, s16, 6
s_add_u32 s79, s78, s28
s_sub_u32 s79, s79, 256
s_max_i32 s79, s79, 0
s_lshl_b32 s79, s79, 4
s_add_u32 s28, s16, 4
s_min_u32 s28, s28, 5
s_lshl_b32 s81, s28, 10
s_lshl_b32 s28, s28, 6
s_add_u32 s80, s78, s28
s_sub_u32 s80, s80, 256
s_max_i32 s80, s80, 0
s_lshl_b32 s80, s80, 4
s_lshl_b32 s82, s16, 10
s_lshl_b32 s83, s39, 15
s_add_u32 s84, s38, 4
s_lshl_b32 s84, s84, 15
s_add_u32 s28, s83, 40226816
s_add_u32 s28, s28, s79
s_add_u32 m0, s82, 65536
s_nop 0
buffer_load_dwordx4 v1, s[8:11], s28 offen sc1 lds
s_add_u32 s28, s83, 40226816
s_add_u32 s28, s28, s80
s_add_u32 m0, s81, 65536
s_nop 0
buffer_load_dwordx4 v1, s[8:11], s28 offen sc1 lds
s_add_u32 s28, s83, 40259584
s_add_u32 s28, s28, s79
s_add_u32 m0, s82, 71744
s_nop 0
buffer_load_dwordx4 v1, s[8:11], s28 offen sc1 lds
s_add_u32 s28, s83, 40259584
s_add_u32 s28, s28, s80
s_add_u32 m0, s81, 71744
s_nop 0
buffer_load_dwordx4 v1, s[8:11], s28 offen sc1 lds
s_add_u32 s28, s84, 40226816
s_add_u32 s28, s28, s79
s_add_u32 m0, s82, 77952
s_nop 0
buffer_load_dwordx4 v1, s[8:11], s28 offen sc1 lds
s_add_u32 s28, s84, 40226816
s_add_u32 s28, s28, s80
s_add_u32 m0, s81, 77952
s_nop 0
buffer_load_dwordx4 v1, s[8:11], s28 offen sc1 lds
s_add_u32 s28, s83, 42848256
s_add_u32 s28, s28, s79
s_add_u32 m0, s82, 84160
s_nop 0
buffer_load_dwordx4 v1, s[8:11], s28 offen sc1 lds
s_add_u32 s28, s83, 42848256
s_add_u32 s28, s28, s80
s_add_u32 m0, s81, 84160
s_nop 0
buffer_load_dwordx4 v1, s[8:11], s28 offen sc1 lds
s_add_u32 s28, s83, 42881024
s_add_u32 s28, s28, s79
s_add_u32 m0, s82, 90368
s_nop 0
buffer_load_dwordx4 v1, s[8:11], s28 offen sc1 lds
s_add_u32 s28, s83, 42881024
s_add_u32 s28, s28, s80
s_add_u32 m0, s81, 90368
s_nop 0
buffer_load_dwordx4 v1, s[8:11], s28 offen sc1 lds
s_add_u32 s28, s84, 42848256
s_add_u32 s28, s28, s79
s_add_u32 m0, s82, 96576
s_nop 0
buffer_load_dwordx4 v1, s[8:11], s28 offen sc1 lds
s_add_u32 s28, s84, 42848256
s_add_u32 s28, s28, s80
s_add_u32 m0, s81, 96576
s_nop 0
buffer_load_dwordx4 v1, s[8:11], s28 offen sc1 lds
s_lshl_b32 s28, s16, 5
s_add_u32 s28, s28, s78
v_add_u32 v29, s28, v2
v_lshlrev_b32 v29, 4, v29
v_lshl_add_u32 v28, v3, 15, v29
s_add_u32 s28, s83, 37605376
buffer_load_dwordx4 v[200:203], v28, s[8:11], s28 offen sc1
v_add_u32 v29, s31, v29
s_add_u32 s28, s84, 37605376
buffer_load_dwordx2 v[204:205], v29, s[8:11], s28 offen sc1
s_waitcnt lgkmcnt(2)
v_mfma_f32_32x32x16_bf16 v[64:79], a[148:151], v[112:115], v[64:79]
ds_read_b128 v[104:107], v8 offset:6144
v_mfma_f32_32x32x16_bf16 v[80:95], a[148:151], v[116:119], v[80:95]
ds_read_b128 v[108:111], v8 offset:6656
s_waitcnt lgkmcnt(2)
v_mfma_f32_32x32x16_bf16 v[64:79], a[152:155], v[96:99], v[64:79]
v_mfma_f32_32x32x16_bf16 v[80:95], a[152:155], v[100:103], v[80:95]
s_waitcnt lgkmcnt(0)
v_mfma_f32_32x32x16_bf16 v[64:79], a[156:159], v[104:107], v[64:79]
v_mfma_f32_32x32x16_bf16 v[80:95], a[156:159], v[108:111], v[80:95]
s_nop 7
s_lshl_b32 s37, s20, 4
s_lshl_b32 s28, s16, 2
s_add_u32 s37, s37, s28
s_lshl_b32 s37, s37, 15
s_add_u32 s37, s37, 37605376
s_add_u32 s28, s19, 16
s_lshl_b32 s28, s28, 6
v_add_u32 v25, s28, v2
v_lshlrev_b32 v25, 4, v25
v_lshl_add_u32 v25, v3, 15, v25
v_mul_f32 v64, v64, v178
v_mul_f32 v65, v65, v178
v_mul_f32 v66, v66, v178
v_mul_f32 v67, v67, v178
v_cvt_pk_bf16_f32 v16, v64, v65
v_cvt_pk_bf16_f32 v17, v66, v67
v_mul_f32 v68, v68, v178
v_mul_f32 v69, v69, v178
v_mul_f32 v70, v70, v178
v_mul_f32 v71, v71, v178
v_cvt_pk_bf16_f32 v18, v68, v69
v_cvt_pk_bf16_f32 v19, v70, v71
s_add_u32 s28, s37, 0
s_nop 0
v_permlane32_swap_b32 v16, v18
v_permlane32_swap_b32 v17, v19
s_nop 0
buffer_store_dwordx4 v[16:19], v25, s[8:11], s28 offen offset:0 sc1
s_nop 0
v_mul_f32 v72, v72, v178
v_mul_f32 v73, v73, v178
v_mul_f32 v74, v74, v178
v_mul_f32 v75, v75, v178
v_cvt_pk_bf16_f32 v20, v72, v73
v_cvt_pk_bf16_f32 v21, v74, v75
v_mul_f32 v76, v76, v178
v_mul_f32 v77, v77, v178
v_mul_f32 v78, v78, v178
v_mul_f32 v79, v79, v178
v_cvt_pk_bf16_f32 v22, v76, v77
v_cvt_pk_bf16_f32 v23, v78, v79
s_add_u32 s28, s37, 65536
s_nop 0
v_permlane32_swap_b32 v20, v22
v_permlane32_swap_b32 v21, v23
s_nop 0
buffer_store_dwordx4 v[20:23], v25, s[8:11], s28 offen offset:0 sc1
s_nop 0
v_mul_f32 v80, v80, v179
v_mul_f32 v81, v81, v179
v_mul_f32 v82, v82, v179
v_mul_f32 v83, v83, v179
v_cvt_pk_bf16_f32 v16, v80, v81
v_cvt_pk_bf16_f32 v17, v82, v83
v_mul_f32 v84, v84, v179
v_mul_f32 v85, v85, v179
v_mul_f32 v86, v86, v179
v_mul_f32 v87, v87, v179
v_cvt_pk_bf16_f32 v18, v84, v85
v_cvt_pk_bf16_f32 v19, v86, v87
s_add_u32 s28, s37, 0
s_nop 0
v_permlane32_swap_b32 v16, v18
v_permlane32_swap_b32 v17, v19
s_nop 0
buffer_store_dwordx4 v[16:19], v25, s[8:11], s28 offen offset:512 sc1
s_nop 0
v_mul_f32 v88, v88, v179
v_mul_f32 v89, v89, v179
v_mul_f32 v90, v90, v179
v_mul_f32 v91, v91, v179
v_cvt_pk_bf16_f32 v20, v88, v89
v_cvt_pk_bf16_f32 v21, v90, v91
v_mul_f32 v92, v92, v179
v_mul_f32 v93, v93, v179
v_mul_f32 v94, v94, v179
v_mul_f32 v95, v95, v179
v_cvt_pk_bf16_f32 v22, v92, v93
v_cvt_pk_bf16_f32 v23, v94, v95
s_add_u32 s28, s37, 65536
s_nop 0
v_permlane32_swap_b32 v20, v22
v_permlane32_swap_b32 v21, v23
s_nop 0
buffer_store_dwordx4 v[20:23], v25, s[8:11], s28 offen offset:512 sc1
s_nop 0
s_lshl_b32 s85, s23, 2
s_add_u32 s85, s85, s16
s_sub_u32 s85, 8, s85
s_max_i32 s85, s85, 0
s_waitcnt vmcnt(4)
v_cndmask_b32 v204, 0, v204, s[74:75]
v_cndmask_b32 v205, 0, v205, s[74:75]
v_mov_b32 v16, 0x3f80
v_cndmask_b32 v206, 0, v16, s[74:75]
v_mov_b32 v207, 0
v_mov_b32 v183, 0
v_mov_b32 v191, 0
v_mov_b32 v199, 0
s_barrier
ds_read_b128 v[176:179], v13 offset:0
ds_read_b64 v[180:181], v14 offset:0
s_cmp_gt_u32 s85, 0
s_cselect_b32 s28, 0xff7f, 0
v_mov_b32 v182, s28
ds_read_b128 v[184:187], v13 offset:4096
ds_read_b64 v[188:189], v14 offset:4096
s_cmp_gt_u32 s85, 8
s_cselect_b32 s28, 0xff7f, 0
v_mov_b32 v190, s28
ds_read_b128 v[192:195], v13 offset:512
ds_read_b64 v[196:197], v14 offset:512
s_cmp_gt_u32 s85, 1
s_cselect_b32 s28, 0xff7f, 0
v_mov_b32 v198, s28
s_waitcnt lgkmcnt(4)
s_nop 0
v_mfma_f32_32x32x16_bf16 v[32:47], v[180:183], v[204:207], 0
s_mul_i32 s34, s25, 102400
s_mul_i32 s28, s16, 25600
s_add_u32 s34, s34, s28
s_add_u32 s34, s34, 6389760
buffer_load_dwordx4 a[160:163], v11, s[8:11], s34 offen offset:0
v_mfma_f32_32x32x16_bf16 v[32:47], v[176:179], v[200:203], v[32:47]
ds_read_b128 v[176:179], v13 offset:1024
ds_read_b64 v[180:181], v14 offset:1024
s_cmp_gt_u32 s85, 2
s_cselect_b32 s28, 0xff7f, 0
v_mov_b32 v182, s28
s_waitcnt lgkmcnt(4)
s_nop 0
v_mfma_f32_32x32x16_bf16 v[160:175], v[188:191], v[204:207], 0
buffer_load_dwordx4 a[164:167], v11, s[8:11], s34 offen offset:256
v_mfma_f32_32x32x16_bf16 v[160:175], v[184:187], v[200:203], v[160:175]
ds_read_b128 v[184:187], v13 offset:1536
ds_read_b64 v[188:189], v14 offset:1536
s_cmp_gt_u32 s85, 3
s_cselect_b32 s28, 0xff7f, 0
v_mov_b32 v190, s28
s_waitcnt lgkmcnt(4)
s_nop 0
v_mfma_f32_32x32x16_bf16 v[48:63], v[196:199], v[204:207], 0
buffer_load_dwordx4 a[168:171], v11, s[8:11], s34 offen offset:512
v_mfma_f32_32x32x16_bf16 v[48:63], v[192:195], v[200:203], v[48:63]
ds_read_b128 v[192:195], v13 offset:2048
ds_read_b64 v[196:197], v14 offset:2048
s_cmp_gt_u32 s85, 4
s_cselect_b32 s28, 0xff7f, 0
v_mov_b32 v198, s28
s_waitcnt lgkmcnt(4)
s_nop 0
v_mfma_f32_32x32x16_bf16 v[64:79], v[180:183], v[204:207], 0
buffer_load_dwordx4 a[172:175], v11, s[8:11], s34 offen offset:768
v_mfma_f32_32x32x16_bf16 v[64:79], v[176:179], v[200:203], v[64:79]
ds_read_b128 v[176:179], v13 offset:2560
ds_read_b64 v[180:181], v14 offset:2560
s_cmp_gt_u32 s85, 5
s_cselect_b32 s28, 0xff7f, 0
v_mov_b32 v182, s28
s_waitcnt lgkmcnt(4)
s_nop 0
v_mfma_f32_32x32x16_bf16 v[80:95], v[188:191], v[204:207], 0
v_cndmask_b32 v32, v32, v160, s[40:41]
v_cndmask_b32 v33, v33, v161, s[42:43]
v_cndmask_b32 v34, v34, v162, s[44:45]
v_cndmask_b32 v35, v35, v163, s[46:47]
buffer_load_dwordx4 a[176:179], v11, s[8:11], s34 offen offset:1024
v_mfma_f32_32x32x16_bf16 v[80:95], v[184:187], v[200:203], v[80:95]
v_cndmask_b32 v36, v36, v164, s[48:49]
v_cndmask_b32 v37, v37, v165, s[50:51]
v_cndmask_b32 v38, v38, v166, s[52:53]
v_cndmask_b32 v39, v39, v167, s[54:55]
ds_read_b128 v[184:187], v13 offset:3072
ds_read_b64 v[188:189], v14 offset:3072
s_cmp_gt_u32 s85, 6
s_cselect_b32 s28, 0xff7f, 0
v_mov_b32 v190, s28
s_waitcnt lgkmcnt(4)
s_nop 0
v_mfma_f32_32x32x16_bf16 v[96:111], v[196:199], v[204:207], 0
v_cndmask_b32 v40, v40, v168, s[56:57]
v_cndmask_b32 v41, v41, v169, s[58:59]
v_cndmask_b32 v42, v42, v170, s[60:61]
v_cndmask_b32 v43, v43, v171, s[62:63]
s_add_u32 s34, s34, 5120
buffer_load_dwordx4 a[180:183], v11, s[8:11], s34 offen offset:0
v_mfma_f32_32x32x16_bf16 v[96:111], v[192:195], v[200:203], v[96:111]
v_cndmask_b32 v44, v44, v172, s[64:65]
v_cndmask_b32 v45, v45, v173, s[66:67]
v_cndmask_b32 v46, v46, v174, s[68:69]
v_cndmask_b32 v47, v47, v175, s[70:71]
ds_read_b128 v[192:195], v13 offset:3584
ds_read_b64 v[196:197], v14 offset:3584
s_cmp_gt_u32 s85, 7
s_cselect_b32 s28, 0xff7f, 0
v_mov_b32 v198, s28
s_waitcnt lgkmcnt(4)
s_nop 0
v_mfma_f32_32x32x16_bf16 v[112:127], v[180:183], v[204:207], 0
v_max_f32 v16, v32, v33
v_max_f32 v17, v34, v35
v_max3_f32 v16, v16, v36, v37
v_max3_f32 v17, v17, v38, v39
buffer_load_dwordx4 a[184:187], v11, s[8:11], s34 offen offset:256
v_mfma_f32_32x32x16_bf16 v[112:127], v[176:179], v[200:203], v[112:127]
v_max3_f32 v16, v16, v40, v41
v_max3_f32 v17, v17, v42, v43
v_max3_f32 v16, v16, v44, v45
v_max3_f32 v17, v17, v46, v47
s_waitcnt lgkmcnt(2)
s_nop 0
v_mfma_f32_32x32x16_bf16 v[128:143], v[188:191], v[204:207], 0
v_max3_f32 v16, v16, v48, v49
v_max3_f32 v17, v17, v50, v51
v_max3_f32 v16, v16, v52, v53
v_max3_f32 v17, v17, v54, v55
buffer_load_dwordx4 a[188:191], v11, s[8:11], s34 offen offset:512
v_mfma_f32_32x32x16_bf16 v[128:143], v[184:187], v[200:203], v[128:143]
v_max3_f32 v16, v16, v56, v57
v_max3_f32 v17, v17, v58, v59
v_max3_f32 v16, v16, v60, v61
v_max3_f32 v17, v17, v62, v63
s_waitcnt lgkmcnt(0)
s_nop 0
v_mfma_f32_32x32x16_bf16 v[144:159], v[196:199], v[204:207], 0
v_max3_f32 v16, v16, v64, v65
v_max3_f32 v17, v17, v66, v67
v_max3_f32 v16, v16, v68, v69
v_max3_f32 v17, v17, v70, v71
buffer_load_dwordx4 a[192:195], v11, s[8:11], s34 offen offset:768
v_mfma_f32_32x32x16_bf16 v[144:159], v[192:195], v[200:203], v[144:159]
v_max3_f32 v16, v16, v72, v73
v_max3_f32 v17, v17, v74, v75
v_max3_f32 v16, v16, v76, v77
v_max3_f32 v17, v17, v78, v79
s_add_u32 s28, s19, 16
s_lshl_b32 s28, s28, 7
s_add_u32 s28, s28, 9261056
s_waitcnt vmcnt(9)
s_barrier
s_cmp_lg_u32 s16, 0
s_cbranch_scc1 S43
v_lshlrev_b32 v29, 12, v0
s_mov_b64 exec, 0xff
buffer_atomic_add v7, v29, s[8:11], s28 offen sc1
s_mov_b64 exec, -1
S43:
s_barrier
ds_read_b64_tr_b16 v[176:177], v15 offset:0
ds_read_b64_tr_b16 v[178:179], v15 offset:128
ds_read_b64_tr_b16 v[180:181], v15 offset:256
ds_read_b64_tr_b16 v[182:183], v15 offset:384
ds_read_b64_tr_b16 v[184:185], v15 offset:4096
ds_read_b64_tr_b16 v[186:187], v15 offset:4224
v_max3_f32 v16, v16, v80, v81
v_max3_f32 v17, v17, v82, v83
v_max3_f32 v16, v16, v84, v85
v_max3_f32 v17, v17, v86, v87
v_max3_f32 v16, v16, v88, v89
v_max3_f32 v17, v17, v90, v91
v_max3_f32 v16, v16, v92, v93
v_max3_f32 v17, v17, v94, v95
v_max3_f32 v16, v16, v96, v97
v_max3_f32 v17, v17, v98, v99
v_max3_f32 v16, v16, v100, v101
v_max3_f32 v17, v17, v102, v103
v_max3_f32 v16, v16, v104, v105
v_max3_f32 v17, v17, v106, v107
v_max3_f32 v16, v16, v108, v109
v_max3_f32 v17, v17, v110, v111
v_max3_f32 v16, v16, v112, v113
v_max3_f32 v17, v17, v114, v115
v_max3_f32 v16, v16, v116, v117
v_max3_f32 v17, v17, v118, v119
v_max3_f32 v16, v16, v120, v121
v_max3_f32 v17, v17, v122, v123
v_max3_f32 v16, v16, v124, v125
v_max3_f32 v17, v17, v126, v127
v_max3_f32 v16, v16, v128, v129
v_max3_f32 v17, v17, v130, v131
v_max3_f32 v16, v16, v132, v133
v_max3_f32 v17, v17, v134, v135
v_max3_f32 v16, v16, v136, v137
v_max3_f32 v17, v17, v138, v139
v_max3_f32 v16, v16, v140, v141
v_max3_f32 v17, v17, v142, v143
v_max3_f32 v16, v16, v144, v145
v_max3_f32 v17, v17, v146, v147
v_max3_f32 v16, v16, v148, v149
v_max3_f32 v17, v17, v150, v151
v_max3_f32 v16, v16, v152, v153
v_max3_f32 v17, v17, v154, v155
v_max3_f32 v16, v16, v156, v157
v_max3_f32 v17, v17, v158, v159
v_max_f32 v16, v16, v17
v_mov_b32 v17, v16
s_nop 1
v_permlane32_swap_b32 v16, v17
s_nop 0
v_max_f32 v16, v16, v17
s_mov_b32 s90, 0x3ea52b5c
s_mov_b32 s91, 0x3ea52b5c
v_mul_f32_e64 v16, s90, -v16
v_mov_b32 v17, v16
v_pk_fma_f32 v[32:33], v[32:33], s[90:91], v[16:17]
v_pk_fma_f32 v[34:35], v[34:35], s[90:91], v[16:17]
v_pk_fma_f32 v[36:37], v[36:37], s[90:91], v[16:17]
v_pk_fma_f32 v[38:39], v[38:39], s[90:91], v[16:17]
v_pk_fma_f32 v[40:41], v[40:41], s[90:91], v[16:17]
v_pk_fma_f32 v[42:43], v[42:43], s[90:91], v[16:17]
v_pk_fma_f32 v[44:45], v[44:45], s[90:91], v[16:17]
v_pk_fma_f32 v[46:47], v[46:47], s[90:91], v[16:17]
buffer_load_dwordx4 a[196:199], v11, s[8:11], s34 offen offset:1024
v_exp_f32 v32, v32
v_exp_f32 v33, v33
v_exp_f32 v34, v34
v_exp_f32 v35, v35
v_exp_f32 v36, v36
v_exp_f32 v37, v37
v_exp_f32 v38, v38
v_exp_f32 v39, v39
v_exp_f32 v40, v40
v_exp_f32 v41, v41
v_exp_f32 v42, v42
v_exp_f32 v43, v43
v_exp_f32 v44, v44
v_exp_f32 v45, v45
v_exp_f32 v46, v46
v_exp_f32 v47, v47
s_add_u32 s34, s34, 5120
buffer_load_dwordx4 a[200:203], v11, s[8:11], s34 offen offset:0
s_nop 0
v_cndmask_b32 v160, 0, v32, s[40:41]
v_cndmask_b32 v32, v32, 0, s[40:41]
v_cndmask_b32 v161, 0, v33, s[42:43]
v_cndmask_b32 v33, v33, 0, s[42:43]
v_cndmask_b32 v162, 0, v34, s[44:45]
v_cndmask_b32 v34, v34, 0, s[44:45]
v_cndmask_b32 v163, 0, v35, s[46:47]
v_cndmask_b32 v35, v35, 0, s[46:47]
v_cndmask_b32 v164, 0, v36, s[48:49]
v_cndmask_b32 v36, v36, 0, s[48:49]
v_cndmask_b32 v165, 0, v37, s[50:51]
v_cndmask_b32 v37, v37, 0, s[50:51]
v_cndmask_b32 v166, 0, v38, s[52:53]
v_cndmask_b32 v38, v38, 0, s[52:53]
v_cndmask_b32 v167, 0, v39, s[54:55]
v_cndmask_b32 v39, v39, 0, s[54:55]
v_cndmask_b32 v168, 0, v40, s[56:57]
v_cndmask_b32 v40, v40, 0, s[56:57]
v_cndmask_b32 v169, 0, v41, s[58:59]
v_cndmask_b32 v41, v41, 0, s[58:59]
v_cndmask_b32 v170, 0, v42, s[60:61]
v_cndmask_b32 v42, v42, 0, s[60:61]
v_cndmask_b32 v171, 0, v43, s[62:63]
v_cndmask_b32 v43, v43, 0, s[62:63]
v_cndmask_b32 v172, 0, v44, s[64:65]
v_cndmask_b32 v44, v44, 0, s[64:65]
v_cndmask_b32 v173, 0, v45, s[66:67]
v_cndmask_b32 v45, v45, 0, s[66:67]
v_cndmask_b32 v174, 0, v46, s[68:69]
v_cndmask_b32 v46, v46, 0, s[68:69]
v_cndmask_b32 v175, 0, v47, s[70:71]
v_cndmask_b32 v47, v47, 0, s[70:71]
v_cvt_pk_bf16_f32 v32, v32, v33
v_cvt_pk_bf16_f32 v33, v34, v35
v_cvt_pk_bf16_f32 v34, v36, v37
v_cvt_pk_bf16_f32 v35, v38, v39
v_cvt_pk_bf16_f32 v36, v40, v41
v_cvt_pk_bf16_f32 v37, v42, v43
v_cvt_pk_bf16_f32 v38, v44, v45
v_cvt_pk_bf16_f32 v39, v46, v47
v_cvt_pk_bf16_f32 v160, v160, v161
v_cvt_pk_bf16_f32 v161, v162, v163
v_cvt_pk_bf16_f32 v162, v164, v165
v_cvt_pk_bf16_f32 v163, v166, v167
v_cvt_pk_bf16_f32 v164, v168, v169
v_cvt_pk_bf16_f32 v165, v170, v171
v_cvt_pk_bf16_f32 v166, v172, v173
v_cvt_pk_bf16_f32 v167, v174, v175
s_nop 1
ds_read_b64_tr_b16 v[188:189], v15 offset:4352
ds_read_b64_tr_b16 v[190:191], v15 offset:4480
s_waitcnt lgkmcnt(6)
v_mfma_f32_32x32x16_bf16 v[208:223], v[176:179], v[32:35], 0
ds_read_b64_tr_b16 v[176:177], v15 offset:512
ds_read_b64_tr_b16 v[178:179], v15 offset:640
s_waitcnt lgkmcnt(6)
v_mfma_f32_32x32x16_bf16 v[208:223], v[180:183], v[36:39], v[208:223]
buffer_load_dwordx4 a[204:207], v11, s[8:11], s34 offen offset:256
s_nop 1
ds_read_b64_tr_b16 v[180:181], v15 offset:768
ds_read_b64_tr_b16 v[182:183], v15 offset:896
s_waitcnt lgkmcnt(6)
v_mfma_f32_32x32x16_bf16 v[208:223], v[184:187], v[160:163], v[208:223]
ds_read_b64_tr_b16 v[184:185], v15 offset:1024
ds_read_b64_tr_b16 v[186:187], v15 offset:1152
s_waitcnt lgkmcnt(6)
v_mfma_f32_32x32x16_bf16 v[208:223], v[188:191], v[164:167], v[208:223]
buffer_load_dwordx4 a[208:211], v11, s[8:11], s34 offen offset:512
v_pk_fma_f32 v[48:49], v[48:49], s[90:91], v[16:17]
v_pk_fma_f32 v[50:51], v[50:51], s[90:91], v[16:17]
v_pk_fma_f32 v[52:53], v[52:53], s[90:91], v[16:17]
v_pk_fma_f32 v[54:55], v[54:55], s[90:91], v[16:17]
v_pk_fma_f32 v[56:57], v[56:57], s[90:91], v[16:17]
v_pk_fma_f32 v[58:59], v[58:59], s[90:91], v[16:17]
v_pk_fma_f32 v[60:61], v[60:61], s[90:91], v[16:17]
v_pk_fma_f32 v[62:63], v[62:63], s[90:91], v[16:17]
buffer_load_dwordx4 a[212:215], v11, s[8:11], s34 offen offset:768
v_exp_f32 v48, v48
v_exp_f32 v49, v49
v_exp_f32 v50, v50
v_exp_f32 v51, v51
v_exp_f32 v52, v52
v_exp_f32 v53, v53
v_exp_f32 v54, v54
v_exp_f32 v55, v55
v_exp_f32 v56, v56
v_exp_f32 v57, v57
v_exp_f32 v58, v58
v_exp_f32 v59, v59
v_exp_f32 v60, v60
v_exp_f32 v61, v61
v_exp_f32 v62, v62
v_exp_f32 v63, v63
buffer_load_dwordx4 a[216:219], v11, s[8:11], s34 offen offset:1024
s_nop 0
v_cvt_pk_bf16_f32 v48, v48, v49
v_cvt_pk_bf16_f32 v49, v50, v51
v_cvt_pk_bf16_f32 v50, v52, v53
v_cvt_pk_bf16_f32 v51, v54, v55
v_cvt_pk_bf16_f32 v52, v56, v57
v_cvt_pk_bf16_f32 v53, v58, v59
v_cvt_pk_bf16_f32 v54, v60, v61
v_cvt_pk_bf16_f32 v55, v62, v63
s_nop 1
ds_read_b64_tr_b16 v[188:189], v15 offset:1280
ds_read_b64_tr_b16 v[190:191], v15 offset:1408
s_waitcnt lgkmcnt(6)
v_mfma_f32_32x32x16_bf16 v[208:223], v[176:179], v[48:51], v[208:223]
ds_read_b64_tr_b16 v[176:177], v15 offset:1536
ds_read_b64_tr_b16 v[178:179], v15 offset:1664
s_waitcnt lgkmcnt(6)
v_mfma_f32_32x32x16_bf16 v[208:223], v[180:183], v[52:55], v[208:223]
s_add_u32 s34, s34, 5120
buffer_load_dwordx4 a[220:223], v11, s[8:11], s34 offen offset:0
s_lshl_b32 s28, s23, 1
s_add_u32 s28, s28, 16
s_sub_u32 s28, s28, 4
v_min_u32 v30, 5, v0
v_add_u32 v30, s28, v30
v_max_i32 v30, 0, v30
v_lshlrev_b32 v30, 7, v30
buffer_load_dword v31, v30, s[8:11], s95 offen sc1
v_pk_fma_f32 v[64:65], v[64:65], s[90:91], v[16:17]
v_pk_fma_f32 v[66:67], v[66:67], s[90:91], v[16:17]
v_pk_fma_f32 v[68:69], v[68:69], s[90:91], v[16:17]
v_pk_fma_f32 v[70:71], v[70:71], s[90:91], v[16:17]
v_pk_fma_f32 v[72:73], v[72:73], s[90:91], v[16:17]
v_pk_fma_f32 v[74:75], v[74:75], s[90:91], v[16:17]
v_pk_fma_f32 v[76:77], v[76:77], s[90:91], v[16:17]
v_pk_fma_f32 v[78:79], v[78:79], s[90:91], v[16:17]
buffer_load_dwordx4 a[224:227], v11, s[8:11], s34 offen offset:256
v_exp_f32 v64, v64
v_exp_f32 v65, v65
v_exp_f32 v66, v66
v_exp_f32 v67, v67
v_exp_f32 v68, v68
v_exp_f32 v69, v69
v_exp_f32 v70, v70
v_exp_f32 v71, v71
v_exp_f32 v72, v72
v_exp_f32 v73, v73
v_exp_f32 v74, v74
v_exp_f32 v75, v75
v_exp_f32 v76, v76
v_exp_f32 v77, v77
v_exp_f32 v78, v78
v_exp_f32 v79, v79
buffer_load_dwordx4 a[228:231], v11, s[8:11], s34 offen offset:512
s_nop 0
v_cvt_pk_bf16_f32 v64, v64, v65
v_cvt_pk_bf16_f32 v65, v66, v67
v_cvt_pk_bf16_f32 v66, v68, v69
v_cvt_pk_bf16_f32 v67, v70, v71
v_cvt_pk_bf16_f32 v68, v72, v73
v_cvt_pk_bf16_f32 v69, v74, v75
v_cvt_pk_bf16_f32 v70, v76, v77
v_cvt_pk_bf16_f32 v71, v78, v79
s_nop 1
ds_read_b64_tr_b16 v[180:181], v15 offset:1792
ds_read_b64_tr_b16 v[182:183], v15 offset:1920
s_waitcnt lgkmcnt(6)
v_mfma_f32_32x32x16_bf16 v[208:223], v[184:187], v[64:67], v[208:223]
ds_read_b64_tr_b16 v[184:185], v15 offset:2048
ds_read_b64_tr_b16 v[186:187], v15 offset:2176
s_waitcnt lgkmcnt(6)
v_mfma_f32_32x32x16_bf16 v[208:223], v[188:191], v[68:71], v[208:223]
buffer_load_dwordx4 a[232:235], v11, s[8:11], s34 offen offset:768
v_pk_fma_f32 v[80:81], v[80:81], s[90:91], v[16:17]
v_pk_fma_f32 v[82:83], v[82:83], s[90:91], v[16:17]
v_pk_fma_f32 v[84:85], v[84:85], s[90:91], v[16:17]
v_pk_fma_f32 v[86:87], v[86:87], s[90:91], v[16:17]
v_pk_fma_f32 v[88:89], v[88:89], s[90:91], v[16:17]
v_pk_fma_f32 v[90:91], v[90:91], s[90:91], v[16:17]
v_pk_fma_f32 v[92:93], v[92:93], s[90:91], v[16:17]
v_pk_fma_f32 v[94:95], v[94:95], s[90:91], v[16:17]
buffer_load_dwordx4 a[236:239], v11, s[8:11], s34 offen offset:1024
v_exp_f32 v80, v80
v_exp_f32 v81, v81
v_exp_f32 v82, v82
v_exp_f32 v83, v83
v_exp_f32 v84, v84
v_exp_f32 v85, v85
v_exp_f32 v86, v86
v_exp_f32 v87, v87
v_exp_f32 v88, v88
v_exp_f32 v89, v89
v_exp_f32 v90, v90
v_exp_f32 v91, v91
v_exp_f32 v92, v92
v_exp_f32 v93, v93
v_exp_f32 v94, v94
v_exp_f32 v95, v95
s_add_u32 s34, s34, 5120
buffer_load_dwordx4 a[240:243], v11, s[8:11], s34 offen offset:0
s_nop 0
v_cvt_pk_bf16_f32 v80, v80, v81
v_cvt_pk_bf16_f32 v81, v82, v83
v_cvt_pk_bf16_f32 v82, v84, v85
v_cvt_pk_bf16_f32 v83, v86, v87
v_cvt_pk_bf16_f32 v84, v88, v89
v_cvt_pk_bf16_f32 v85, v90, v91
v_cvt_pk_bf16_f32 v86, v92, v93
v_cvt_pk_bf16_f32 v87, v94, v95
s_nop 1
ds_read_b64_tr_b16 v[188:189], v15 offset:2304
ds_read_b64_tr_b16 v[190:191], v15 offset:2432
s_waitcnt lgkmcnt(6)
v_mfma_f32_32x32x16_bf16 v[208:223], v[176:179], v[80:83], v[208:223]
ds_read_b64_tr_b16 v[176:177], v15 offset:2560
ds_read_b64_tr_b16 v[178:179], v15 offset:2688
s_waitcnt lgkmcnt(6)
v_mfma_f32_32x32x16_bf16 v[208:223], v[180:183], v[84:87], v[208:223]
buffer_load_dwordx4 a[244:247], v11, s[8:11], s34 offen offset:256
v_pk_fma_f32 v[96:97], v[96:97], s[90:91], v[16:17]
v_pk_fma_f32 v[98:99], v[98:99], s[90:91], v[16:17]
v_pk_fma_f32 v[100:101], v[100:101], s[90:91], v[16:17]
v_pk_fma_f32 v[102:103], v[102:103], s[90:91], v[16:17]
v_pk_fma_f32 v[104:105], v[104:105], s[90:91], v[16:17]
v_pk_fma_f32 v[106:107], v[106:107], s[90:91], v[16:17]
v_pk_fma_f32 v[108:109], v[108:109], s[90:91], v[16:17]
v_pk_fma_f32 v[110:111], v[110:111], s[90:91], v[16:17]
buffer_load_dwordx4 a[248:251], v11, s[8:11], s34 offen offset:512
v_exp_f32 v96, v96
v_exp_f32 v97, v97
v_exp_f32 v98, v98
v_exp_f32 v99, v99
v_exp_f32 v100, v100
v_exp_f32 v101, v101
v_exp_f32 v102, v102
v_exp_f32 v103, v103
v_exp_f32 v104, v104
v_exp_f32 v105, v105
v_exp_f32 v106, v106
v_exp_f32 v107, v107
v_exp_f32 v108, v108
v_exp_f32 v109, v109
v_exp_f32 v110, v110
v_exp_f32 v111, v111
buffer_load_dwordx4 a[252:255], v11, s[8:11], s34 offen offset:768
s_nop 0
v_cvt_pk_bf16_f32 v96, v96, v97
v_cvt_pk_bf16_f32 v97, v98, v99
v_cvt_pk_bf16_f32 v98, v100, v101
v_cvt_pk_bf16_f32 v99, v102, v103
v_cvt_pk_bf16_f32 v100, v104, v105
v_cvt_pk_bf16_f32 v101, v106, v107
v_cvt_pk_bf16_f32 v102, v108, v109
v_cvt_pk_bf16_f32 v103, v110, v111
s_nop 1
ds_read_b64_tr_b16 v[180:181], v15 offset:2816
ds_read_b64_tr_b16 v[182:183], v15 offset:2944
s_waitcnt lgkmcnt(6)
v_mfma_f32_32x32x16_bf16 v[208:223], v[184:187], v[96:99], v[208:223]
ds_read_b64_tr_b16 v[184:185], v15 offset:3072
ds_read_b64_tr_b16 v[186:187], v15 offset:3200
s_waitcnt lgkmcnt(6)
v_mfma_f32_32x32x16_bf16 v[208:223], v[188:191], v[100:103], v[208:223]
buffer_load_dwordx4 v[228:231], v11, s[8:11], s34 offen offset:1024
s_waitcnt vmcnt(9)
s_cmp_lg_u32 s16, 0
s_cbranch_scc1 P44
s_movk_i32 s77, 16
P45:
v_cmp_gt_u32 vcc, s77, v31
s_nop 1
s_cbranch_vccz P44
s_add_u32 s76, s76, 1
s_cmp_gt_u32 s76, 400000
s_cbranch_scc1 P44
s_sleep 4
buffer_load_dword v31, v30, s[8:11], s95 offen sc1
s_waitcnt vmcnt(0)
s_branch P45
P44:
s_barrier
s_lshl_b32 s78, s23, 7
s_add_u32 s78, s78, 1024
s_lshl_b32 s28, s16, 6
s_add_u32 s79, s78, s28
s_sub_u32 s79, s79, 256
s_max_i32 s79, s79, 0
s_lshl_b32 s79, s79, 4
s_add_u32 s28, s16, 4
s_min_u32 s28, s28, 5
s_lshl_b32 s81, s28, 10
s_lshl_b32 s28, s28, 6
s_add_u32 s80, s78, s28
s_sub_u32 s80, s80, 256
s_max_i32 s80, s80, 0
s_lshl_b32 s80, s80, 4
s_lshl_b32 s82, s16, 10
s_lshl_b32 s83, s39, 15
s_add_u32 s84, s38, 4
s_lshl_b32 s84, s84, 15
s_add_u32 s28, s83, 40226816
s_add_u32 s28, s28, s79
s_add_u32 m0, s82, 102784
s_nop 0
buffer_load_dwordx4 v1, s[8:11], s28 offen sc1 lds
s_add_u32 s28, s83, 40226816
s_add_u32 s28, s28, s80
s_add_u32 m0, s81, 102784
s_nop 0
buffer_load_dwordx4 v1, s[8:11], s28 offen sc1 lds
s_add_u32 s28, s83, 40259584
s_add_u32 s28, s28, s79
s_add_u32 m0, s82, 108992
s_nop 0
buffer_load_dwordx4 v1, s[8:11], s28 offen sc1 lds
s_add_u32 s28, s83, 40259584
s_add_u32 s28, s28, s80
s_add_u32 m0, s81, 108992
s_nop 0
buffer_load_dwordx4 v1, s[8:11], s28 offen sc1 lds
s_add_u32 s28, s84, 40226816
s_add_u32 s28, s28, s79
s_add_u32 m0, s82, 115200
s_nop 0
buffer_load_dwordx4 v1, s[8:11], s28 offen sc1 lds
s_add_u32 s28, s84, 40226816
s_add_u32 s28, s28, s80
s_add_u32 m0, s81, 115200
s_nop 0
buffer_load_dwordx4 v1, s[8:11], s28 offen sc1 lds
s_add_u32 s28, s83, 42848256
s_add_u32 s28, s28, s79
s_add_u32 m0, s82, 121408
s_nop 0
buffer_load_dwordx4 v1, s[8:11], s28 offen sc1 lds
s_add_u32 s28, s83, 42848256
s_add_u32 s28, s28, s80
s_add_u32 m0, s81, 121408
s_nop 0
buffer_load_dwordx4 v1, s[8:11], s28 offen sc1 lds
s_add_u32 s28, s83, 42881024
s_add_u32 s28, s28, s79
s_add_u32 m0, s82, 127616
s_nop 0
buffer_load_dwordx4 v1, s[8:11], s28 offen sc1 lds
s_add_u32 s28, s83, 42881024
s_add_u32 s28, s28, s80
s_add_u32 m0, s81, 127616
s_nop 0
buffer_load_dwordx4 v1, s[8:11], s28 offen sc1 lds
s_add_u32 s28, s84, 42848256
s_add_u32 s28, s28, s79
s_add_u32 m0, s82, 133824
s_nop 0
buffer_load_dwordx4 v1, s[8:11], s28 offen sc1 lds
s_add_u32 s28, s84, 42848256
s_add_u32 s28, s28, s80
s_add_u32 m0, s81, 133824
s_nop 0
buffer_load_dwordx4 v1, s[8:11], s28 offen sc1 lds
s_lshl_b32 s28, s16, 5
s_add_u32 s28, s28, s78
v_add_u32 v29, s28, v2
v_lshlrev_b32 v29, 4, v29
v_lshl_add_u32 v28, v3, 15, v29
s_add_u32 s28, s83, 37605376
buffer_load_dwordx4 v[232:235], v28, s[8:11], s28 offen sc1
v_add_u32 v29, s31, v29
s_add_u32 s28, s84, 37605376
buffer_load_dwordx2 v[236:237], v29, s[8:11], s28 offen sc1
v_pk_fma_f32 v[112:113], v[112:113], s[90:91], v[16:17]
v_pk_fma_f32 v[114:115], v[114:115], s[90:91], v[16:17]
v_pk_fma_f32 v[116:117], v[116:117], s[90:91], v[16:17]
v_pk_fma_f32 v[118:119], v[118:119], s[90:91], v[16:17]
v_pk_fma_f32 v[120:121], v[120:121], s[90:91], v[16:17]
v_pk_fma_f32 v[122:123], v[122:123], s[90:91], v[16:17]
v_pk_fma_f32 v[124:125], v[124:125], s[90:91], v[16:17]
v_pk_fma_f32 v[126:127], v[126:127], s[90:91], v[16:17]
s_mul_i32 s35, s21, 245760
s_lshr_b32 s28, s16, 1
s_mul_i32 s28, s28, 1536
s_add_u32 s35, s35, s28
s_and_b32 s28, s16, 1
s_mul_i32 s28, s28, 768
s_add_u32 s35, s35, s28
s_add_u32 s35, s35, 2457600
buffer_load_dwordx4 a[0:3], v12, s[8:11], s35 offen offset:0
v_exp_f32 v112, v112
v_exp_f32 v113, v113
v_exp_f32 v114, v114
v_exp_f32 v115, v115
v_exp_f32 v116, v116
v_exp_f32 v117, v117
v_exp_f32 v118, v118
v_exp_f32 v119, v119
v_exp_f32 v120, v120
v_exp_f32 v121, v121
v_exp_f32 v122, v122
v_exp_f32 v123, v123
v_exp_f32 v124, v124
v_exp_f32 v125, v125
v_exp_f32 v126, v126
v_exp_f32 v127, v127
buffer_load_dwordx4 a[4:7], v12, s[8:11], s35 offen offset:256
s_nop 0
v_cvt_pk_bf16_f32 v112, v112, v113
v_cvt_pk_bf16_f32 v113, v114, v115
v_cvt_pk_bf16_f32 v114, v116, v117
v_cvt_pk_bf16_f32 v115, v118, v119
v_cvt_pk_bf16_f32 v116, v120, v121
v_cvt_pk_bf16_f32 v117, v122, v123
v_cvt_pk_bf16_f32 v118, v124, v125
v_cvt_pk_bf16_f32 v119, v126, v127
s_nop 1
ds_read_b64_tr_b16 v[188:189], v15 offset:3328
ds_read_b64_tr_b16 v[190:191], v15 offset:3456
s_waitcnt lgkmcnt(6)
v_mfma_f32_32x32x16_bf16 v[208:223], v[176:179], v[112:115], v[208:223]
ds_read_b64_tr_b16 v[176:177], v15 offset:3584
ds_read_b64_tr_b16 v[178:179], v15 offset:3712
s_waitcnt lgkmcnt(6)
v_mfma_f32_32x32x16_bf16 v[208:223], v[180:183], v[116:119], v[208:223]
buffer_load_dwordx4 a[8:11], v12, s[8:11], s35 offen offset:512
v_pk_fma_f32 v[128:129], v[128:129], s[90:91], v[16:17]
v_pk_fma_f32 v[130:131], v[130:131], s[90:91], v[16:17]
v_pk_fma_f32 v[132:133], v[132:133], s[90:91], v[16:17]
v_pk_fma_f32 v[134:135], v[134:135], s[90:91], v[16:17]
v_pk_fma_f32 v[136:137], v[136:137], s[90:91], v[16:17]
v_pk_fma_f32 v[138:139], v[138:139], s[90:91], v[16:17]
v_pk_fma_f32 v[140:141], v[140:141], s[90:91], v[16:17]
v_pk_fma_f32 v[142:143], v[142:143], s[90:91], v[16:17]
s_add_u32 s35, s35, 12288
buffer_load_dwordx4 a[12:15], v12, s[8:11], s35 offen offset:0
v_exp_f32 v128, v128
v_exp_f32 v129, v129
v_exp_f32 v130, v130
v_exp_f32 v131, v131
v_exp_f32 v132, v132
v_exp_f32 v133, v133
v_exp_f32 v134, v134
v_exp_f32 v135, v135
v_exp_f32 v136, v136
v_exp_f32 v137, v137
v_exp_f32 v138, v138
v_exp_f32 v139, v139
v_exp_f32 v140, v140
v_exp_f32 v141, v141
v_exp_f32 v142, v142
v_exp_f32 v143, v143
buffer_load_dwordx4 a[16:19], v12, s[8:11], s35 offen offset:256
s_nop 0
v_cvt_pk_bf16_f32 v128, v128, v129
v_cvt_pk_bf16_f32 v129, v130, v131
v_cvt_pk_bf16_f32 v130, v132, v133
v_cvt_pk_bf16_f32 v131, v134, v135
v_cvt_pk_bf16_f32 v132, v136, v137
v_cvt_pk_bf16_f32 v133, v138, v139
v_cvt_pk_bf16_f32 v134, v140, v141
v_cvt_pk_bf16_f32 v135, v142, v143
s_nop 1
ds_read_b64_tr_b16 v[180:181], v15 offset:3840
ds_read_b64_tr_b16 v[182:183], v15 offset:3968
s_waitcnt lgkmcnt(6)
v_mfma_f32_32x32x16_bf16 v[208:223], v[184:187], v[128:131], v[208:223]
s_waitcnt lgkmcnt(4)
v_mfma_f32_32x32x16_bf16 v[208:223], v[188:191], v[132:135], v[208:223]
buffer_load_dwordx4 a[20:23], v12, s[8:11], s35 offen offset:512
v_pk_fma_f32 v[144:145], v[144:145], s[90:91], v[16:17]
v_pk_fma_f32 v[146:147], v[146:147], s[90:91], v[16:17]
v_pk_fma_f32 v[148:149], v[148:149], s[90:91], v[16:17]
v_pk_fma_f32 v[150:151], v[150:151], s[90:91], v[16:17]
v_pk_fma_f32 v[152:153], v[152:153], s[90:91], v[16:17]
v_pk_fma_f32 v[154:155], v[154:155], s[90:91], v[16:17]
v_pk_fma_f32 v[156:157], v[156:157], s[90:91], v[16:17]
v_pk_fma_f32 v[158:159], v[158:159], s[90:91], v[16:17]
s_add_u32 s35, s35, 12288
buffer_load_dwordx4 a[24:27], v12, s[8:11], s35 offen offset:0
v_exp_f32 v144, v144
v_exp_f32 v145, v145
v_exp_f32 v146, v146
v_exp_f32 v147, v147
v_exp_f32 v148, v148
v_exp_f32 v149, v149
v_exp_f32 v150, v150
v_exp_f32 v151, v151
v_exp_f32 v152, v152
v_exp_f32 v153, v153
v_exp_f32 v154, v154
v_exp_f32 v155, v155
v_exp_f32 v156, v156
v_exp_f32 v157, v157
v_exp_f32 v158, v158
v_exp_f32 v159, v159
buffer_load_dwordx4 a[28:31], v12, s[8:11], s35 offen offset:256
s_nop 0
v_cvt_pk_bf16_f32 v144, v144, v145
v_cvt_pk_bf16_f32 v145, v146, v147
v_cvt_pk_bf16_f32 v146, v148, v149
v_cvt_pk_bf16_f32 v147, v150, v151
v_cvt_pk_bf16_f32 v148, v152, v153
v_cvt_pk_bf16_f32 v149, v154, v155
v_cvt_pk_bf16_f32 v150, v156, v157
v_cvt_pk_bf16_f32 v151, v158, v159
s_nop 1
s_waitcnt lgkmcnt(2)
v_mfma_f32_32x32x16_bf16 v[208:223], v[176:179], v[144:147], v[208:223]
s_waitcnt lgkmcnt(0)
v_mfma_f32_32x32x16_bf16 v[208:223], v[180:183], v[148:151], v[208:223]
buffer_load_dwordx4 a[32:35], v12, s[8:11], s35 offen offset:512
s_lshl_b32 s28, s23, 7
s_add_u32 s28, s28, 0
s_lshl_b32 s29, s16, 5
s_add_u32 s28, s28, s29
v_add_u32 v18, s28, v2
v_lshrrev_b32 v19, 6, v18
s_mov_b32 s29, 81920
v_mul_lo_u32 v19, v19, s29
v_and_b32 v18, 63, v18
v_lshl_add_u32 v19, v18, 4, v19
v_add_u32 v18, s39, v3
v_lshl_add_u32 v26, v18, 10, v19
s_add_u32 s29, s38, 4
s_lshl_b32 s29, s29, 10
s_add_u32 s29, s29, s31
v_add_u32 v27, s29, v19
s_nop 5
v_mov_b32 v16, v216
v_mov_b32 v17, v216
s_nop 1
v_permlane32_swap_b32 v16, v17
s_nop 0
v_rcp_f32 v17, v17
s_nop 0
v_mul_f32 v208, v208, v17
v_mul_f32 v209, v209, v17
v_mul_f32 v210, v210, v17
v_mul_f32 v211, v211, v17
v_mul_f32 v212, v212, v17
v_mul_f32 v213, v213, v17
v_mul_f32 v214, v214, v17
v_mul_f32 v215, v215, v17
v_mul_f32 v216, v216, v17
v_mul_f32 v217, v217, v17
v_mul_f32 v218, v218, v17
v_mul_f32 v219, v219, v17
v_cvt_pk_bf16_f32 v20, v208, v209
v_cvt_pk_bf16_f32 v21, v210, v211
v_cvt_pk_bf16_f32 v22, v212, v213
v_cvt_pk_bf16_f32 v23, v214, v215
v_cvt_pk_bf16_f32 v24, v216, v217
v_cvt_pk_bf16_f32 v25, v218, v219
s_mov_b32 s28, 45469696
v_permlane32_swap_b32 v20, v22
v_permlane32_swap_b32 v21, v23
s_nop 0
buffer_store_dwordx4 v[20:23], v26, s[8:11], s28 offen sc1
s_mov_b64 exec, s[74:75]
buffer_store_dwordx2 v[24:25], v27, s[8:11], s28 offen sc1
s_mov_b64 exec, -1
s_mul_i32 s98, s16, 10240
s_mul_i32 s99, s16, 10240
s_add_u32 s99, s99, 40960
s_mul_i32 s28, s16, 10240
s_add_u32 s28, s28, 86400
s_cmp_ge_u32 s16, 2
s_cselect_b32 s99, s28, s99
s_mul_i32 s97, s16, 12288
s_add_u32 s97, s97, 90112
v_lshlrev_b32 v226, 9, v5
v_lshl_add_u32 v226, v4, 4, v226
s_and_b32 s28, s16, 1
s_lshl_b32 s28, s28, 8
v_add_u32 v227, s28, v226
s_xor_b32 s28, s28, 256
v_add_u32 v226, s28, v226
s_mov_b32 s85, 0
s_waitcnt vmcnt(11)
v_cndmask_b32 v236, 0, v236, s[74:75]
v_cndmask_b32 v237, 0, v237, s[74:75]
v_mov_b32 v16, 0x3f80
v_cndmask_b32 v238, 0, v16, s[74:75]
v_mov_b32 v239, 0
v_mov_b32 v183, 0
v_mov_b32 v191, 0
v_mov_b32 v199, 0
s_barrier
ds_read_b128 v[176:179], v13 offset:37248
ds_read_b64 v[180:181], v14 offset:37248
s_cmp_gt_u32 s85, 0
s_cselect_b32 s28, 0xff7f, 0
v_mov_b32 v182, s28
ds_read_b128 v[184:187], v13 offset:41344
ds_read_b64 v[188:189], v14 offset:41344
s_cmp_gt_u32 s85, 8
s_cselect_b32 s28, 0xff7f, 0
v_mov_b32 v190, s28
ds_read_b128 v[192:195], v13 offset:37760
ds_read_b64 v[196:197], v14 offset:37760
s_cmp_gt_u32 s85, 1
s_cselect_b32 s28, 0xff7f, 0
v_mov_b32 v198, s28
s_waitcnt lgkmcnt(4)
s_nop 0
v_mfma_f32_32x32x16_bf16 v[32:47], v[180:183], v[236:239], 0
s_add_u32 s35, s35, 12288
buffer_load_dwordx4 a[36:39], v12, s[8:11], s35 offen offset:0
v_mfma_f32_32x32x16_bf16 v[32:47], v[176:179], v[232:235], v[32:47]
ds_read_b128 v[176:179], v13 offset:38272
ds_read_b64 v[180:181], v14 offset:38272
s_cmp_gt_u32 s85, 2
s_cselect_b32 s28, 0xff7f, 0
v_mov_b32 v182, s28
s_waitcnt lgkmcnt(4)
s_nop 0
v_mfma_f32_32x32x16_bf16 v[160:175], v[188:191], v[236:239], 0
buffer_load_dwordx4 a[40:43], v12, s[8:11], s35 offen offset:256
v_mfma_f32_32x32x16_bf16 v[160:175], v[184:187], v[232:235], v[160:175]
ds_read_b128 v[184:187], v13 offset:38784
ds_read_b64 v[188:189], v14 offset:38784
s_cmp_gt_u32 s85, 3
s_cselect_b32 s28, 0xff7f, 0
v_mov_b32 v190, s28
s_waitcnt lgkmcnt(4)
s_nop 0
v_mfma_f32_32x32x16_bf16 v[48:63], v[196:199], v[236:239], 0
buffer_load_dwordx4 a[44:47], v12, s[8:11], s35 offen offset:512
v_mfma_f32_32x32x16_bf16 v[48:63], v[192:195], v[232:235], v[48:63]
ds_read_b128 v[192:195], v13 offset:39296
ds_read_b64 v[196:197], v14 offset:39296
s_cmp_gt_u32 s85, 4
s_cselect_b32 s28, 0xff7f, 0
v_mov_b32 v198, s28
s_waitcnt lgkmcnt(4)
s_nop 0
v_mfma_f32_32x32x16_bf16 v[64:79], v[180:183], v[236:239], 0
s_add_u32 s35, s35, 12288
buffer_load_dwordx4 a[48:51], v12, s[8:11], s35 offen offset:0
v_mfma_f32_32x32x16_bf16 v[64:79], v[176:179], v[232:235], v[64:79]
ds_read_b128 v[176:179], v13 offset:39808
ds_read_b64 v[180:181], v14 offset:39808
s_cmp_gt_u32 s85, 5
s_cselect_b32 s28, 0xff7f, 0
v_mov_b32 v182, s28
s_waitcnt lgkmcnt(4)
s_nop 0
v_mfma_f32_32x32x16_bf16 v[80:95], v[188:191], v[236:239], 0
v_cndmask_b32 v32, v32, v160, s[40:41]
v_cndmask_b32 v33, v33, v161, s[42:43]
v_cndmask_b32 v34, v34, v162, s[44:45]
v_cndmask_b32 v35, v35, v163, s[46:47]
buffer_load_dwordx4 a[52:55], v12, s[8:11], s35 offen offset:256
v_mfma_f32_32x32x16_bf16 v[80:95], v[184:187], v[232:235], v[80:95]
v_cndmask_b32 v36, v36, v164, s[48:49]
v_cndmask_b32 v37, v37, v165, s[50:51]
v_cndmask_b32 v38, v38, v166, s[52:53]
v_cndmask_b32 v39, v39, v167, s[54:55]
ds_read_b128 v[184:187], v13 offset:40320
ds_read_b64 v[188:189], v14 offset:40320
s_cmp_gt_u32 s85, 6
s_cselect_b32 s28, 0xff7f, 0
v_mov_b32 v190, s28
s_waitcnt lgkmcnt(4)
s_nop 0
v_mfma_f32_32x32x16_bf16 v[96:111], v[196:199], v[236:239], 0
v_cndmask_b32 v40, v40, v168, s[56:57]
v_cndmask_b32 v41, v41, v169, s[58:59]
v_cndmask_b32 v42, v42, v170, s[60:61]
v_cndmask_b32 v43, v43, v171, s[62:63]
buffer_load_dwordx4 a[56:59], v12, s[8:11], s35 offen offset:512
v_mfma_f32_32x32x16_bf16 v[96:111], v[192:195], v[232:235], v[96:111]
v_cndmask_b32 v44, v44, v172, s[64:65]
v_cndmask_b32 v45, v45, v173, s[66:67]
v_cndmask_b32 v46, v46, v174, s[68:69]
v_cndmask_b32 v47, v47, v175, s[70:71]
ds_read_b128 v[192:195], v13 offset:40832
ds_read_b64 v[196:197], v14 offset:40832
s_cmp_gt_u32 s85, 7
s_cselect_b32 s28, 0xff7f, 0
v_mov_b32 v198, s28
s_waitcnt lgkmcnt(4)
s_nop 0
v_mfma_f32_32x32x16_bf16 v[112:127], v[180:183], v[236:239], 0
v_max_f32 v16, v32, v33
v_max_f32 v17, v34, v35
v_max3_f32 v16, v16, v36, v37
v_max3_f32 v17, v17, v38, v39
s_add_u32 s35, s35, 12288
buffer_load_dwordx4 a[60:63], v12, s[8:11], s35 offen offset:0
v_mfma_f32_32x32x16_bf16 v[112:127], v[176:179], v[232:235], v[112:127]
v_max3_f32 v16, v16, v40, v41
v_max3_f32 v17, v17, v42, v43
v_max3_f32 v16, v16, v44, v45
v_max3_f32 v17, v17, v46, v47
s_waitcnt lgkmcnt(2)
s_nop 0
v_mfma_f32_32x32x16_bf16 v[128:143], v[188:191], v[236:239], 0
v_max3_f32 v16, v16, v48, v49
v_max3_f32 v17, v17, v50, v51
v_max3_f32 v16, v16, v52, v53
v_max3_f32 v17, v17, v54, v55
buffer_load_dwordx4 a[64:67], v12, s[8:11], s35 offen offset:256
v_mfma_f32_32x32x16_bf16 v[128:143], v[184:187], v[232:235], v[128:143]
v_max3_f32 v16, v16, v56, v57
v_max3_f32 v17, v17, v58, v59
v_max3_f32 v16, v16, v60, v61
v_max3_f32 v17, v17, v62, v63
s_waitcnt lgkmcnt(0)
s_nop 0
v_mfma_f32_32x32x16_bf16 v[144:159], v[196:199], v[236:239], 0
v_max3_f32 v16, v16, v64, v65
v_max3_f32 v17, v17, v66, v67
v_max3_f32 v16, v16, v68, v69
v_max3_f32 v17, v17, v70, v71
buffer_load_dwordx4 a[68:71], v12, s[8:11], s35 offen offset:512
v_mfma_f32_32x32x16_bf16 v[144:159], v[192:195], v[232:235], v[144:159]
v_max3_f32 v16, v16, v72, v73
v_max3_f32 v17, v17, v74, v75
v_max3_f32 v16, v16, v76, v77
v_max3_f32 v17, v17, v78, v79
s_lshl_b32 s28, s23, 7
s_add_u32 s28, s28, 9244672
s_waitcnt vmcnt(9)
s_barrier
s_cmp_lg_u32 s16, 0
s_cbranch_scc1 S46
s_mov_b64 exec, 1
buffer_atomic_add v7, v6, s[8:11], s28 offen sc1
s_mov_b64 exec, -1
S46:
s_barrier
ds_read_b64_tr_b16 v[176:177], v224 offset:0
ds_read_b64_tr_b16 v[178:179], v224 offset:128
ds_read_b64_tr_b16 v[180:181], v224 offset:256
ds_read_b64_tr_b16 v[182:183], v224 offset:384
ds_read_b64_tr_b16 v[184:185], v224 offset:4096
ds_read_b64_tr_b16 v[186:187], v224 offset:4224
v_max3_f32 v16, v16, v80, v81
v_max3_f32 v17, v17, v82, v83
v_max3_f32 v16, v16, v84, v85
v_max3_f32 v17, v17, v86, v87
v_max3_f32 v16, v16, v88, v89
v_max3_f32 v17, v17, v90, v91
v_max3_f32 v16, v16, v92, v93
v_max3_f32 v17, v17, v94, v95
v_max3_f32 v16, v16, v96, v97
v_max3_f32 v17, v17, v98, v99
v_max3_f32 v16, v16, v100, v101
v_max3_f32 v17, v17, v102, v103
v_max3_f32 v16, v16, v104, v105
v_max3_f32 v17, v17, v106, v107
v_max3_f32 v16, v16, v108, v109
v_max3_f32 v17, v17, v110, v111
v_max3_f32 v16, v16, v112, v113
v_max3_f32 v17, v17, v114, v115
v_max3_f32 v16, v16, v116, v117
v_max3_f32 v17, v17, v118, v119
v_max3_f32 v16, v16, v120, v121
v_max3_f32 v17, v17, v122, v123
v_max3_f32 v16, v16, v124, v125
v_max3_f32 v17, v17, v126, v127
v_max3_f32 v16, v16, v128, v129
v_max3_f32 v17, v17, v130, v131
v_max3_f32 v16, v16, v132, v133
v_max3_f32 v17, v17, v134, v135
v_max3_f32 v16, v16, v136, v137
v_max3_f32 v17, v17, v138, v139
v_max3_f32 v16, v16, v140, v141
v_max3_f32 v17, v17, v142, v143
v_max3_f32 v16, v16, v144, v145
v_max3_f32 v17, v17, v146, v147
v_max3_f32 v16, v16, v148, v149
v_max3_f32 v17, v17, v150, v151
v_max3_f32 v16, v16, v152, v153
v_max3_f32 v17, v17, v154, v155
v_max3_f32 v16, v16, v156, v157
v_max3_f32 v17, v17, v158, v159
v_max_f32 v16, v16, v17
v_mov_b32 v17, v16
s_nop 1
v_permlane32_swap_b32 v16, v17
s_nop 0
v_max_f32 v16, v16, v17
s_mov_b32 s90, 0x3ea52b5c
s_mov_b32 s91, 0x3ea52b5c
v_mul_f32_e64 v16, s90, -v16
v_mov_b32 v17, v16
v_pk_fma_f32 v[32:33], v[32:33], s[90:91], v[16:17]
v_pk_fma_f32 v[34:35], v[34:35], s[90:91], v[16:17]
v_pk_fma_f32 v[36:37], v[36:37], s[90:91], v[16:17]
v_pk_fma_f32 v[38:39], v[38:39], s[90:91], v[16:17]
v_pk_fma_f32 v[40:41], v[40:41], s[90:91], v[16:17]
v_pk_fma_f32 v[42:43], v[42:43], s[90:91], v[16:17]
v_pk_fma_f32 v[44:45], v[44:45], s[90:91], v[16:17]
v_pk_fma_f32 v[46:47], v[46:47], s[90:91], v[16:17]
s_add_u32 s35, s35, 12288
buffer_load_dwordx4 a[72:75], v12, s[8:11], s35 offen offset:0
v_exp_f32 v32, v32
v_exp_f32 v33, v33
v_exp_f32 v34, v34
v_exp_f32 v35, v35
v_exp_f32 v36, v36
v_exp_f32 v37, v37
v_exp_f32 v38, v38
v_exp_f32 v39, v39
v_exp_f32 v40, v40
v_exp_f32 v41, v41
v_exp_f32 v42, v42
v_exp_f32 v43, v43
v_exp_f32 v44, v44
v_exp_f32 v45, v45
v_exp_f32 v46, v46
v_exp_f32 v47, v47
buffer_load_dwordx4 a[76:79], v12, s[8:11], s35 offen offset:256
s_nop 0
v_cndmask_b32 v160, 0, v32, s[40:41]
v_cndmask_b32 v32, v32, 0, s[40:41]
v_cndmask_b32 v161, 0, v33, s[42:43]
v_cndmask_b32 v33, v33, 0, s[42:43]
v_cndmask_b32 v162, 0, v34, s[44:45]
v_cndmask_b32 v34, v34, 0, s[44:45]
v_cndmask_b32 v163, 0, v35, s[46:47]
v_cndmask_b32 v35, v35, 0, s[46:47]
v_cndmask_b32 v164, 0, v36, s[48:49]
v_cndmask_b32 v36, v36, 0, s[48:49]
v_cndmask_b32 v165, 0, v37, s[50:51]
v_cndmask_b32 v37, v37, 0, s[50:51]
v_cndmask_b32 v166, 0, v38, s[52:53]
v_cndmask_b32 v38, v38, 0, s[52:53]
v_cndmask_b32 v167, 0, v39, s[54:55]
v_cndmask_b32 v39, v39, 0, s[54:55]
v_cndmask_b32 v168, 0, v40, s[56:57]
v_cndmask_b32 v40, v40, 0, s[56:57]
v_cndmask_b32 v169, 0, v41, s[58:59]
v_cndmask_b32 v41, v41, 0, s[58:59]
v_cndmask_b32 v170, 0, v42, s[60:61]
v_cndmask_b32 v42, v42, 0, s[60:61]
v_cndmask_b32 v171, 0, v43, s[62:63]
v_cndmask_b32 v43, v43, 0, s[62:63]
v_cndmask_b32 v172, 0, v44, s[64:65]
v_cndmask_b32 v44, v44, 0, s[64:65]
v_cndmask_b32 v173, 0, v45, s[66:67]
v_cndmask_b32 v45, v45, 0, s[66:67]
v_cndmask_b32 v174, 0, v46, s[68:69]
v_cndmask_b32 v46, v46, 0, s[68:69]
v_cndmask_b32 v175, 0, v47, s[70:71]
v_cndmask_b32 v47, v47, 0, s[70:71]
v_cvt_pk_bf16_f32 v32, v32, v33
v_cvt_pk_bf16_f32 v33, v34, v35
v_cvt_pk_bf16_f32 v34, v36, v37
v_cvt_pk_bf16_f32 v35, v38, v39
v_cvt_pk_bf16_f32 v36, v40, v41
v_cvt_pk_bf16_f32 v37, v42, v43
v_cvt_pk_bf16_f32 v38, v44, v45
v_cvt_pk_bf16_f32 v39, v46, v47
v_cvt_pk_bf16_f32 v160, v160, v161
v_cvt_pk_bf16_f32 v161, v162, v163
v_cvt_pk_bf16_f32 v162, v164, v165
v_cvt_pk_bf16_f32 v163, v166, v167
v_cvt_pk_bf16_f32 v164, v168, v169
v_cvt_pk_bf16_f32 v165, v170, v171
v_cvt_pk_bf16_f32 v166, v172, v173
v_cvt_pk_bf16_f32 v167, v174, v175
s_nop 1
ds_read_b64_tr_b16 v[188:189], v224 offset:4352
ds_read_b64_tr_b16 v[190:191], v224 offset:4480
s_waitcnt lgkmcnt(6)
v_mfma_f32_32x32x16_bf16 v[208:223], v[176:179], v[32:35], 0
ds_read_b64_tr_b16 v[176:177], v224 offset:512
ds_read_b64_tr_b16 v[178:179], v224 offset:640
s_waitcnt lgkmcnt(6)
v_mfma_f32_32x32x16_bf16 v[208:223], v[180:183], v[36:39], v[208:223]
buffer_load_dwordx4 a[80:83], v12, s[8:11], s35 offen offset:512
s_and_b32 s28, s24, 1
s_lshl_b32 s28, s28, 5
s_and_b32 s29, s16, 1
s_lshl_b32 s29, s29, 4
s_add_u32 s28, s28, s29
v_add_u32 v225, s28, v4
s_lshr_b32 s28, s24, 1
s_add_u32 s28, s28, 0
s_mul_i32 s28, s28, 81920
s_mul_i32 s29, s25, 10240
s_add_u32 s28, s28, s29
s_add_u32 s28, s28, 31838208
v_lshrrev_b32 v28, 1, v5
v_lshlrev_b32 v28, 10, v28
v_and_b32 v29, 1, v5
v_lshl_add_u32 v28, v29, 3, v28
v_lshl_add_u32 v245, v225, 4, v28
s_lshr_b32 s29, s16, 1
s_mul_i32 s29, s29, 6144
s_add_u32 s28, s28, s29
buffer_load_dwordx2 v[248:249], v245, s[8:11], s28 offen sc1
buffer_load_dwordx2 v[250:251], v245, s[8:11], s28 offen offset:2048 sc1
s_lshr_b32 s29, s16, 1
s_lshl_b32 s29, s29, 11
s_sub_u32 s28, s28, s29
s_add_u32 s28, s28, 4096
buffer_load_dwordx2 v[252:253], v245, s[8:11], s28 offen sc1
s_nop 1
ds_read_b64_tr_b16 v[180:181], v224 offset:768
ds_read_b64_tr_b16 v[182:183], v224 offset:896
s_waitcnt lgkmcnt(6)
v_mfma_f32_32x32x16_bf16 v[208:223], v[184:187], v[160:163], v[208:223]
ds_read_b64_tr_b16 v[184:185], v224 offset:1024
ds_read_b64_tr_b16 v[186:187], v224 offset:1152
s_waitcnt lgkmcnt(6)
v_mfma_f32_32x32x16_bf16 v[208:223], v[188:191], v[164:167], v[208:223]
s_add_u32 s35, s35, 12288
buffer_load_dwordx4 a[84:87], v12, s[8:11], s35 offen offset:0
v_pk_fma_f32 v[48:49], v[48:49], s[90:91], v[16:17]
v_pk_fma_f32 v[50:51], v[50:51], s[90:91], v[16:17]
v_pk_fma_f32 v[52:53], v[52:53], s[90:91], v[16:17]
v_pk_fma_f32 v[54:55], v[54:55], s[90:91], v[16:17]
v_pk_fma_f32 v[56:57], v[56:57], s[90:91], v[16:17]
v_pk_fma_f32 v[58:59], v[58:59], s[90:91], v[16:17]
v_pk_fma_f32 v[60:61], v[60:61], s[90:91], v[16:17]
v_pk_fma_f32 v[62:63], v[62:63], s[90:91], v[16:17]
buffer_load_dwordx4 a[88:91], v12, s[8:11], s35 offen offset:256
v_exp_f32 v48, v48
v_exp_f32 v49, v49
v_exp_f32 v50, v50
v_exp_f32 v51, v51
v_exp_f32 v52, v52
v_exp_f32 v53, v53
v_exp_f32 v54, v54
v_exp_f32 v55, v55
v_exp_f32 v56, v56
v_exp_f32 v57, v57
v_exp_f32 v58, v58
v_exp_f32 v59, v59
v_exp_f32 v60, v60
v_exp_f32 v61, v61
v_exp_f32 v62, v62
v_exp_f32 v63, v63
buffer_load_dwordx4 a[92:95], v12, s[8:11], s35 offen offset:512
s_nop 0
v_cvt_pk_bf16_f32 v48, v48, v49
v_cvt_pk_bf16_f32 v49, v50, v51
v_cvt_pk_bf16_f32 v50, v52, v53
v_cvt_pk_bf16_f32 v51, v54, v55
v_cvt_pk_bf16_f32 v52, v56, v57
v_cvt_pk_bf16_f32 v53, v58, v59
v_cvt_pk_bf16_f32 v54, v60, v61
v_cvt_pk_bf16_f32 v55, v62, v63
s_nop 1
ds_read_b64_tr_b16 v[188:189], v224 offset:1280
ds_read_b64_tr_b16 v[190:191], v224 offset:1408
s_waitcnt lgkmcnt(6)
v_mfma_f32_32x32x16_bf16 v[208:223], v[176:179], v[48:51], v[208:223]
ds_read_b64_tr_b16 v[176:177], v224 offset:1536
ds_read_b64_tr_b16 v[178:179], v224 offset:1664
s_waitcnt lgkmcnt(6)
v_mfma_f32_32x32x16_bf16 v[208:223], v[180:183], v[52:55], v[208:223]
s_add_u32 s35, s35, 12288
buffer_load_dwordx4 a[96:99], v12, s[8:11], s35 offen offset:0
v_pk_fma_f32 v[64:65], v[64:65], s[90:91], v[16:17]
v_pk_fma_f32 v[66:67], v[66:67], s[90:91], v[16:17]
v_pk_fma_f32 v[68:69], v[68:69], s[90:91], v[16:17]
v_pk_fma_f32 v[70:71], v[70:71], s[90:91], v[16:17]
v_pk_fma_f32 v[72:73], v[72:73], s[90:91], v[16:17]
v_pk_fma_f32 v[74:75], v[74:75], s[90:91], v[16:17]
v_pk_fma_f32 v[76:77], v[76:77], s[90:91], v[16:17]
v_pk_fma_f32 v[78:79], v[78:79], s[90:91], v[16:17]
buffer_load_dwordx4 a[100:103], v12, s[8:11], s35 offen offset:256
v_exp_f32 v64, v64
v_exp_f32 v65, v65
v_exp_f32 v66, v66
v_exp_f32 v67, v67
v_exp_f32 v68, v68
v_exp_f32 v69, v69
v_exp_f32 v70, v70
v_exp_f32 v71, v71
v_exp_f32 v72, v72
v_exp_f32 v73, v73
v_exp_f32 v74, v74
v_exp_f32 v75, v75
v_exp_f32 v76, v76
v_exp_f32 v77, v77
v_exp_f32 v78, v78
v_exp_f32 v79, v79
buffer_load_dwordx4 a[104:107], v12, s[8:11], s35 offen offset:512
s_nop 0
v_cvt_pk_bf16_f32 v64, v64, v65
v_cvt_pk_bf16_f32 v65, v66, v67
v_cvt_pk_bf16_f32 v66, v68, v69
v_cvt_pk_bf16_f32 v67, v70, v71
v_cvt_pk_bf16_f32 v68, v72, v73
v_cvt_pk_bf16_f32 v69, v74, v75
v_cvt_pk_bf16_f32 v70, v76, v77
v_cvt_pk_bf16_f32 v71, v78, v79
s_nop 1
ds_read_b64_tr_b16 v[180:181], v224 offset:1792
ds_read_b64_tr_b16 v[182:183], v224 offset:1920
s_waitcnt lgkmcnt(6)
v_mfma_f32_32x32x16_bf16 v[208:223], v[184:187], v[64:67], v[208:223]
ds_read_b64_tr_b16 v[184:185], v224 offset:2048
ds_read_b64_tr_b16 v[186:187], v224 offset:2176
s_waitcnt lgkmcnt(6)
v_mfma_f32_32x32x16_bf16 v[208:223], v[188:191], v[68:71], v[208:223]
s_add_u32 s35, s35, 12288
buffer_load_dwordx4 a[108:111], v12, s[8:11], s35 offen offset:0
s_lshr_b32 s29, s24, 2
s_lshl_b32 s29, s29, 7
s_add_u32 s94, s29, 9244672
buffer_load_dword v31, v6, s[8:11], s94 offen sc1
v_pk_fma_f32 v[80:81], v[80:81], s[90:91], v[16:17]
v_pk_fma_f32 v[82:83], v[82:83], s[90:91], v[16:17]
v_pk_fma_f32 v[84:85], v[84:85], s[90:91], v[16:17]
v_pk_fma_f32 v[86:87], v[86:87], s[90:91], v[16:17]
v_pk_fma_f32 v[88:89], v[88:89], s[90:91], v[16:17]
v_pk_fma_f32 v[90:91], v[90:91], s[90:91], v[16:17]
v_pk_fma_f32 v[92:93], v[92:93], s[90:91], v[16:17]
v_pk_fma_f32 v[94:95], v[94:95], s[90:91], v[16:17]
buffer_load_dwordx4 a[112:115], v12, s[8:11], s35 offen offset:256
v_exp_f32 v80, v80
v_exp_f32 v81, v81
v_exp_f32 v82, v82
v_exp_f32 v83, v83
v_exp_f32 v84, v84
v_exp_f32 v85, v85
v_exp_f32 v86, v86
v_exp_f32 v87, v87
v_exp_f32 v88, v88
v_exp_f32 v89, v89
v_exp_f32 v90, v90
v_exp_f32 v91, v91
v_exp_f32 v92, v92
v_exp_f32 v93, v93
v_exp_f32 v94, v94
v_exp_f32 v95, v95
buffer_load_dwordx4 a[116:119], v12, s[8:11], s35 offen offset:512
s_nop 0
v_cvt_pk_bf16_f32 v80, v80, v81
v_cvt_pk_bf16_f32 v81, v82, v83
v_cvt_pk_bf16_f32 v82, v84, v85
v_cvt_pk_bf16_f32 v83, v86, v87
v_cvt_pk_bf16_f32 v84, v88, v89
v_cvt_pk_bf16_f32 v85, v90, v91
v_cvt_pk_bf16_f32 v86, v92, v93
v_cvt_pk_bf16_f32 v87, v94, v95
s_nop 1
ds_read_b64_tr_b16 v[188:189], v224 offset:2304
ds_read_b64_tr_b16 v[190:191], v224 offset:2432
s_waitcnt lgkmcnt(6)
v_mfma_f32_32x32x16_bf16 v[208:223], v[176:179], v[80:83], v[208:223]
ds_read_b64_tr_b16 v[176:177], v224 offset:2560
ds_read_b64_tr_b16 v[178:179], v224 offset:2688
s_waitcnt lgkmcnt(6)
v_mfma_f32_32x32x16_bf16 v[208:223], v[180:183], v[84:87], v[208:223]
s_add_u32 s35, s35, 12288
buffer_load_dwordx4 a[120:123], v12, s[8:11], s35 offen offset:0
v_pk_fma_f32 v[96:97], v[96:97], s[90:91], v[16:17]
v_pk_fma_f32 v[98:99], v[98:99], s[90:91], v[16:17]
v_pk_fma_f32 v[100:101], v[100:101], s[90:91], v[16:17]
v_pk_fma_f32 v[102:103], v[102:103], s[90:91], v[16:17]
v_pk_fma_f32 v[104:105], v[104:105], s[90:91], v[16:17]
v_pk_fma_f32 v[106:107], v[106:107], s[90:91], v[16:17]
v_pk_fma_f32 v[108:109], v[108:109], s[90:91], v[16:17]
v_pk_fma_f32 v[110:111], v[110:111], s[90:91], v[16:17]
buffer_load_dwordx4 a[124:127], v12, s[8:11], s35 offen offset:256
v_exp_f32 v96, v96
v_exp_f32 v97, v97
v_exp_f32 v98, v98
v_exp_f32 v99, v99
v_exp_f32 v100, v100
v_exp_f32 v101, v101
v_exp_f32 v102, v102
v_exp_f32 v103, v103
v_exp_f32 v104, v104
v_exp_f32 v105, v105
v_exp_f32 v106, v106
v_exp_f32 v107, v107
v_exp_f32 v108, v108
v_exp_f32 v109, v109
v_exp_f32 v110, v110
v_exp_f32 v111, v111
buffer_load_dwordx4 a[128:131], v12, s[8:11], s35 offen offset:512
s_nop 0
v_cvt_pk_bf16_f32 v96, v96, v97
v_cvt_pk_bf16_f32 v97, v98, v99
v_cvt_pk_bf16_f32 v98, v100, v101
v_cvt_pk_bf16_f32 v99, v102, v103
v_cvt_pk_bf16_f32 v100, v104, v105
v_cvt_pk_bf16_f32 v101, v106, v107
v_cvt_pk_bf16_f32 v102, v108, v109
v_cvt_pk_bf16_f32 v103, v110, v111
s_nop 1
ds_read_b64_tr_b16 v[180:181], v224 offset:2816
ds_read_b64_tr_b16 v[182:183], v224 offset:2944
s_waitcnt lgkmcnt(6)
v_mfma_f32_32x32x16_bf16 v[208:223], v[184:187], v[96:99], v[208:223]
ds_read_b64_tr_b16 v[184:185], v224 offset:3072
ds_read_b64_tr_b16 v[186:187], v224 offset:3200
s_waitcnt lgkmcnt(6)
v_mfma_f32_32x32x16_bf16 v[208:223], v[188:191], v[100:103], v[208:223]
s_add_u32 s35, s35, 12288
buffer_load_dwordx4 a[132:135], v12, s[8:11], s35 offen offset:0
v_pk_fma_f32 v[112:113], v[112:113], s[90:91], v[16:17]
v_pk_fma_f32 v[114:115], v[114:115], s[90:91], v[16:17]
v_pk_fma_f32 v[116:117], v[116:117], s[90:91], v[16:17]
v_pk_fma_f32 v[118:119], v[118:119], s[90:91], v[16:17]
v_pk_fma_f32 v[120:121], v[120:121], s[90:91], v[16:17]
v_pk_fma_f32 v[122:123], v[122:123], s[90:91], v[16:17]
v_pk_fma_f32 v[124:125], v[124:125], s[90:91], v[16:17]
v_pk_fma_f32 v[126:127], v[126:127], s[90:91], v[16:17]
buffer_load_dwordx4 a[136:139], v12, s[8:11], s35 offen offset:256
v_exp_f32 v112, v112
v_exp_f32 v113, v113
v_exp_f32 v114, v114
v_exp_f32 v115, v115
v_exp_f32 v116, v116
v_exp_f32 v117, v117
v_exp_f32 v118, v118
v_exp_f32 v119, v119
v_exp_f32 v120, v120
v_exp_f32 v121, v121
v_exp_f32 v122, v122
v_exp_f32 v123, v123
v_exp_f32 v124, v124
v_exp_f32 v125, v125
v_exp_f32 v126, v126
v_exp_f32 v127, v127
buffer_load_dwordx4 a[140:143], v12, s[8:11], s35 offen offset:512
s_nop 0
v_cvt_pk_bf16_f32 v112, v112, v113
v_cvt_pk_bf16_f32 v113, v114, v115
v_cvt_pk_bf16_f32 v114, v116, v117
v_cvt_pk_bf16_f32 v115, v118, v119
v_cvt_pk_bf16_f32 v116, v120, v121
v_cvt_pk_bf16_f32 v117, v122, v123
v_cvt_pk_bf16_f32 v118, v124, v125
v_cvt_pk_bf16_f32 v119, v126, v127
s_nop 1
ds_read_b64_tr_b16 v[188:189], v224 offset:3328
ds_read_b64_tr_b16 v[190:191], v224 offset:3456
s_waitcnt lgkmcnt(6)
v_mfma_f32_32x32x16_bf16 v[208:223], v[176:179], v[112:115], v[208:223]
ds_read_b64_tr_b16 v[176:177], v224 offset:3584
ds_read_b64_tr_b16 v[178:179], v224 offset:3712
s_waitcnt lgkmcnt(6)
v_mfma_f32_32x32x16_bf16 v[208:223], v[180:183], v[116:119], v[208:223]
s_add_u32 s35, s35, 12288
buffer_load_dwordx4 a[144:147], v12, s[8:11], s35 offen offset:0
s_waitcnt vmcnt(9)
s_cmp_lg_u32 s16, 0
s_cbranch_scc1 P47
s_movk_i32 s77, 32
P48:
v_cmp_gt_u32 vcc, s77, v31
s_nop 1
s_cbranch_vccz P47
s_add_u32 s76, s76, 1
s_cmp_gt_u32 s76, 400000
s_cbranch_scc1 P47
s_sleep 4
buffer_load_dword v31, v6, s[8:11], s94 offen sc1
s_waitcnt vmcnt(0)
s_branch P48
P47:
s_barrier
s_lshr_b32 s28, s24, 1
s_add_u32 s28, s28, 0
s_mul_i32 s87, s28, 81920
s_add_u32 s87, s87, 45469696
s_mul_i32 s28, s16, 20480
s_add_u32 s87, s87, s28
s_and_b32 s28, s24, 1
s_lshl_b32 s28, s28, 9
s_add_u32 s87, s87, s28
s_add_u32 m0, s98, 0
s_add_u32 s28, s87, 1024
buffer_load_dwordx4 v8, s[8:11], s87 offen sc1 lds
buffer_load_dwordx4 v8, s[8:11], s28 offen offset:1024 sc1 lds
s_add_u32 s87, s87, 4096
s_add_u32 m0, s98, 2048
s_add_u32 s28, s87, 1024
buffer_load_dwordx4 v8, s[8:11], s87 offen sc1 lds
buffer_load_dwordx4 v8, s[8:11], s28 offen offset:1024 sc1 lds
s_add_u32 s87, s87, 4096
s_add_u32 m0, s98, 4096
s_add_u32 s28, s87, 1024
buffer_load_dwordx4 v8, s[8:11], s87 offen sc1 lds
buffer_load_dwordx4 v8, s[8:11], s28 offen offset:1024 sc1 lds
s_add_u32 s87, s87, 4096
s_add_u32 m0, s98, 6144
s_add_u32 s28, s87, 1024
buffer_load_dwordx4 v8, s[8:11], s87 offen sc1 lds
buffer_load_dwordx4 v8, s[8:11], s28 offen offset:1024 sc1 lds
s_add_u32 s87, s87, 4096
s_add_u32 m0, s98, 8192
s_add_u32 s28, s87, 1024
buffer_load_dwordx4 v8, s[8:11], s87 offen sc1 lds
buffer_load_dwordx4 v8, s[8:11], s28 offen offset:1024 sc1 lds
s_add_u32 s87, s87, 4096
v_pk_fma_f32 v[128:129], v[128:129], s[90:91], v[16:17]
v_pk_fma_f32 v[130:131], v[130:131], s[90:91], v[16:17]
v_pk_fma_f32 v[132:133], v[132:133], s[90:91], v[16:17]
v_pk_fma_f32 v[134:135], v[134:135], s[90:91], v[16:17]
v_pk_fma_f32 v[136:137], v[136:137], s[90:91], v[16:17]
v_pk_fma_f32 v[138:139], v[138:139], s[90:91], v[16:17]
v_pk_fma_f32 v[140:141], v[140:141], s[90:91], v[16:17]
v_pk_fma_f32 v[142:143], v[142:143], s[90:91], v[16:17]
buffer_load_dwordx4 a[148:151], v12, s[8:11], s35 offen offset:256
v_exp_f32 v128, v128
v_exp_f32 v129, v129
v_exp_f32 v130, v130
v_exp_f32 v131, v131
v_exp_f32 v132, v132
v_exp_f32 v133, v133
v_exp_f32 v134, v134
v_exp_f32 v135, v135
v_exp_f32 v136, v136
v_exp_f32 v137, v137
v_exp_f32 v138, v138
v_exp_f32 v139, v139
v_exp_f32 v140, v140
v_exp_f32 v141, v141
v_exp_f32 v142, v142
v_exp_f32 v143, v143
buffer_load_dwordx4 a[152:155], v12, s[8:11], s35 offen offset:512
s_nop 0
v_cvt_pk_bf16_f32 v128, v128, v129
v_cvt_pk_bf16_f32 v129, v130, v131
v_cvt_pk_bf16_f32 v130, v132, v133
v_cvt_pk_bf16_f32 v131, v134, v135
v_cvt_pk_bf16_f32 v132, v136, v137
v_cvt_pk_bf16_f32 v133, v138, v139
v_cvt_pk_bf16_f32 v134, v140, v141
v_cvt_pk_bf16_f32 v135, v142, v143
s_nop 1
ds_read_b64_tr_b16 v[180:181], v224 offset:3840
ds_read_b64_tr_b16 v[182:183], v224 offset:3968
s_waitcnt lgkmcnt(6)
v_mfma_f32_32x32x16_bf16 v[208:223], v[184:187], v[128:131], v[208:223]
s_waitcnt lgkmcnt(4)
v_mfma_f32_32x32x16_bf16 v[208:223], v[188:191], v[132:135], v[208:223]
s_add_u32 s35, s35, 12288
buffer_load_dwordx4 a[156:159], v12, s[8:11], s35 offen offset:0
v_pk_fma_f32 v[144:145], v[144:145], s[90:91], v[16:17]
v_pk_fma_f32 v[146:147], v[146:147], s[90:91], v[16:17]
v_pk_fma_f32 v[148:149], v[148:149], s[90:91], v[16:17]
v_pk_fma_f32 v[150:151], v[150:151], s[90:91], v[16:17]
v_pk_fma_f32 v[152:153], v[152:153], s[90:91], v[16:17]
v_pk_fma_f32 v[154:155], v[154:155], s[90:91], v[16:17]
v_pk_fma_f32 v[156:157], v[156:157], s[90:91], v[16:17]
v_pk_fma_f32 v[158:159], v[158:159], s[90:91], v[16:17]
v_exp_f32 v144, v144
v_exp_f32 v145, v145
v_exp_f32 v146, v146
v_exp_f32 v147, v147
v_exp_f32 v148, v148
v_exp_f32 v149, v149
v_exp_f32 v150, v150
v_exp_f32 v151, v151
v_exp_f32 v152, v152
v_exp_f32 v153, v153
v_exp_f32 v154, v154
v_exp_f32 v155, v155
v_exp_f32 v156, v156
v_exp_f32 v157, v157
v_exp_f32 v158, v158
v_exp_f32 v159, v159
s_nop 0
v_cvt_pk_bf16_f32 v144, v144, v145
v_cvt_pk_bf16_f32 v145, v146, v147
v_cvt_pk_bf16_f32 v146, v148, v149
v_cvt_pk_bf16_f32 v147, v150, v151
v_cvt_pk_bf16_f32 v148, v152, v153
v_cvt_pk_bf16_f32 v149, v154, v155
v_cvt_pk_bf16_f32 v150, v156, v157
v_cvt_pk_bf16_f32 v151, v158, v159
s_nop 1
s_waitcnt lgkmcnt(2)
v_mfma_f32_32x32x16_bf16 v[208:223], v[176:179], v[144:147], v[208:223]
s_waitcnt lgkmcnt(0)
v_mfma_f32_32x32x16_bf16 v[208:223], v[180:183], v[148:151], v[208:223]
s_lshl_b32 s28, s23, 7
s_add_u32 s28, s28, 1024
s_lshl_b32 s29, s16, 5
s_add_u32 s28, s28, s29
v_add_u32 v18, s28, v2
v_lshrrev_b32 v19, 6, v18
s_mov_b32 s29, 81920
v_mul_lo_u32 v19, v19, s29
v_and_b32 v18, 63, v18
v_lshl_add_u32 v19, v18, 4, v19
v_add_u32 v18, s39, v3
v_lshl_add_u32 v26, v18, 10, v19
s_add_u32 s29, s38, 4
s_lshl_b32 s29, s29, 10
s_add_u32 s29, s29, s31
v_add_u32 v27, s29, v19
s_nop 5
v_mov_b32 v16, v216
v_mov_b32 v17, v216
s_nop 1
v_permlane32_swap_b32 v16, v17
s_nop 0
v_rcp_f32 v17, v17
s_nop 0
v_mul_f32 v208, v208, v17
v_mul_f32 v209, v209, v17
v_mul_f32 v210, v210, v17
v_mul_f32 v211, v211, v17
v_mul_f32 v212, v212, v17
v_mul_f32 v213, v213, v17
v_mul_f32 v214, v214, v17
v_mul_f32 v215, v215, v17
v_mul_f32 v216, v216, v17
v_mul_f32 v217, v217, v17
v_mul_f32 v218, v218, v17
v_mul_f32 v219, v219, v17
v_cvt_pk_bf16_f32 v20, v208, v209
v_cvt_pk_bf16_f32 v21, v210, v211
v_cvt_pk_bf16_f32 v22, v212, v213
v_cvt_pk_bf16_f32 v23, v214, v215
v_cvt_pk_bf16_f32 v24, v216, v217
v_cvt_pk_bf16_f32 v25, v218, v219
s_mov_b32 s28, 45469696
v_permlane32_swap_b32 v20, v22
v_permlane32_swap_b32 v21, v23
s_nop 0
buffer_store_dwordx4 v[20:23], v26, s[8:11], s28 offen sc1
s_mov_b64 exec, s[74:75]
buffer_store_dwordx2 v[24:25], v27, s[8:11], s28 offen sc1
s_mov_b64 exec, -1
s_barrier
s_and_b32 s28, s24, 1
s_lshl_b32 s28, s28, 5
s_and_b32 s29, s16, 1
s_lshl_b32 s29, s29, 4
s_add_u32 s28, s28, s29
v_add_u32 v244, s28, v4
s_lshr_b32 s28, s24, 1
s_add_u32 s28, s28, 16
s_mul_i32 s28, s28, 81920
s_mul_i32 s29, s25, 10240
s_add_u32 s28, s28, s29
s_add_u32 s28, s28, 31838208
v_lshrrev_b32 v28, 1, v5
v_lshlrev_b32 v28, 10, v28
v_and_b32 v29, 1, v5
v_lshl_add_u32 v28, v29, 3, v28
v_lshl_add_u32 v246, v244, 4, v28
s_lshr_b32 s29, s16, 1
s_mul_i32 s29, s29, 6144
s_add_u32 s28, s28, s29
buffer_load_dwordx2 v[232:233], v246, s[8:11], s28 offen sc1
buffer_load_dwordx2 v[234:235], v246, s[8:11], s28 offen offset:2048 sc1
s_lshr_b32 s29, s16, 1
s_lshl_b32 s29, s29, 11
s_sub_u32 s28, s28, s29
s_add_u32 s28, s28, 4096
buffer_load_dwordx2 v[236:237], v246, s[8:11], s28 offen sc1
v_add_u32 v238, s98, v227
v_add_u32 v239, s98, v226
s_waitcnt vmcnt(16)
ds_read_b128 v[32:35], v238 offset:0
ds_read_b128 v[36:39], v239 offset:0
s_waitcnt vmcnt(14)
ds_read_b128 v[40:43], v238 offset:2048
ds_read_b128 v[44:47], v239 offset:2048
s_waitcnt lgkmcnt(2)
v_mfma_f32_16x16x32_bf16 v[48:51], a[160:163], v[32:35], 0
v_mfma_f32_16x16x32_bf16 v[68:71], a[160:163], v[36:39], 0
v_mfma_f32_16x16x32_bf16 v[52:55], a[164:167], v[32:35], 0
v_mfma_f32_16x16x32_bf16 v[72:75], a[164:167], v[36:39], 0
v_mfma_f32_16x16x32_bf16 v[56:59], a[168:171], v[32:35], 0
v_mfma_f32_16x16x32_bf16 v[76:79], a[168:171], v[36:39], 0
v_mfma_f32_16x16x32_bf16 v[60:63], a[172:175], v[32:35], 0
v_mfma_f32_16x16x32_bf16 v[80:83], a[172:175], v[36:39], 0
v_mfma_f32_16x16x32_bf16 v[64:67], a[176:179], v[32:35], 0
v_mfma_f32_16x16x32_bf16 v[84:87], a[176:179], v[36:39], 0
s_lshl_b32 s28, s23, 7
s_add_u32 s28, s28, 9245696
s_waitcnt vmcnt(3)
s_barrier
s_cmp_lg_u32 s16, 0
s_cbranch_scc1 S49
s_mov_b64 exec, 1
buffer_atomic_add v7, v6, s[8:11], s28 offen sc1
s_mov_b64 exec, -1
S49:
ds_read_b128 v[32:35], v238 offset:4096
ds_read_b128 v[36:39], v239 offset:4096
s_waitcnt lgkmcnt(2)
v_mfma_f32_16x16x32_bf16 v[48:51], a[180:183], v[40:43], v[48:51]
v_mfma_f32_16x16x32_bf16 v[68:71], a[180:183], v[44:47], v[68:71]
v_mfma_f32_16x16x32_bf16 v[52:55], a[184:187], v[40:43], v[52:55]
v_mfma_f32_16x16x32_bf16 v[72:75], a[184:187], v[44:47], v[72:75]
v_mfma_f32_16x16x32_bf16 v[56:59], a[188:191], v[40:43], v[56:59]
v_mfma_f32_16x16x32_bf16 v[76:79], a[188:191], v[44:47], v[76:79]
v_mfma_f32_16x16x32_bf16 v[60:63], a[192:195], v[40:43], v[60:63]
v_mfma_f32_16x16x32_bf16 v[80:83], a[192:195], v[44:47], v[80:83]
v_mfma_f32_16x16x32_bf16 v[64:67], a[196:199], v[40:43], v[64:67]
v_mfma_f32_16x16x32_bf16 v[84:87], a[196:199], v[44:47], v[84:87]
ds_read_b128 v[40:43], v238 offset:6144
ds_read_b128 v[44:47], v239 offset:6144
s_waitcnt lgkmcnt(2)
v_mfma_f32_16x16x32_bf16 v[48:51], a[200:203], v[32:35], v[48:51]
v_mfma_f32_16x16x32_bf16 v[68:71], a[200:203], v[36:39], v[68:71]
v_mfma_f32_16x16x32_bf16 v[52:55], a[204:207], v[32:35], v[52:55]
v_mfma_f32_16x16x32_bf16 v[72:75], a[204:207], v[36:39], v[72:75]
v_mfma_f32_16x16x32_bf16 v[56:59], a[208:211], v[32:35], v[56:59]
v_mfma_f32_16x16x32_bf16 v[76:79], a[208:211], v[36:39], v[76:79]
v_mfma_f32_16x16x32_bf16 v[60:63], a[212:215], v[32:35], v[60:63]
v_mfma_f32_16x16x32_bf16 v[80:83], a[212:215], v[36:39], v[80:83]
v_mfma_f32_16x16x32_bf16 v[64:67], a[216:219], v[32:35], v[64:67]
v_mfma_f32_16x16x32_bf16 v[84:87], a[216:219], v[36:39], v[84:87]
ds_read_b128 v[32:35], v238 offset:8192
ds_read_b128 v[36:39], v239 offset:8192
s_waitcnt lgkmcnt(2)
v_mfma_f32_16x16x32_bf16 v[48:51], a[220:223], v[40:43], v[48:51]
v_mfma_f32_16x16x32_bf16 v[68:71], a[220:223], v[44:47], v[68:71]
v_mfma_f32_16x16x32_bf16 v[52:55], a[224:227], v[40:43], v[52:55]
v_mfma_f32_16x16x32_bf16 v[72:75], a[224:227], v[44:47], v[72:75]
v_mfma_f32_16x16x32_bf16 v[56:59], a[228:231], v[40:43], v[56:59]
v_mfma_f32_16x16x32_bf16 v[76:79], a[228:231], v[44:47], v[76:79]
v_mfma_f32_16x16x32_bf16 v[60:63], a[232:235], v[40:43], v[60:63]
v_mfma_f32_16x16x32_bf16 v[80:83], a[232:235], v[44:47], v[80:83]
v_mfma_f32_16x16x32_bf16 v[64:67], a[236:239], v[40:43], v[64:67]
v_mfma_f32_16x16x32_bf16 v[84:87], a[236:239], v[44:47], v[84:87]
s_waitcnt lgkmcnt(0)
v_mfma_f32_16x16x32_bf16 v[48:51], a[240:243], v[32:35], v[48:51]
v_mfma_f32_16x16x32_bf16 v[68:71], a[240:243], v[36:39], v[68:71]
v_mfma_f32_16x16x32_bf16 v[52:55], a[244:247], v[32:35], v[52:55]
v_mfma_f32_16x16x32_bf16 v[72:75], a[244:247], v[36:39], v[72:75]
v_mfma_f32_16x16x32_bf16 v[56:59], a[248:251], v[32:35], v[56:59]
v_mfma_f32_16x16x32_bf16 v[76:79], a[248:251], v[36:39], v[76:79]
v_mfma_f32_16x16x32_bf16 v[60:63], a[252:255], v[32:35], v[60:63]
v_mfma_f32_16x16x32_bf16 v[80:83], a[252:255], v[36:39], v[80:83]
v_mfma_f32_16x16x32_bf16 v[64:67], v[228:231], v[32:35], v[64:67]
v_mfma_f32_16x16x32_bf16 v[84:87], v[228:231], v[36:39], v[84:87]
s_lshr_b32 s28, s24, 1
s_add_u32 s28, s28, 0
s_mul_i32 s88, s28, 81920
s_mul_i32 s29, s25, 10240
s_add_u32 s88, s88, s29
s_barrier
s_mul_i32 s28, s16, 10240
s_add_u32 s28, s28, 65536
s_and_b32 s29, s16, 1
s_mul_i32 s29, s29, 5120
s_add_u32 s90, s28, s29
v_add_u32 v24, s90, v1
s_xor_b32 s29, s29, 5120
s_add_u32 s90, s28, s29
v_add_u32 v25, s90, v1
s_cmp_ge_u32 s16, 2
s_cbranch_scc1 V51
s_nop 1
ds_write_b128 v25, v[68:71] offset:0
ds_write_b128 v25, v[72:75] offset:1024
ds_write_b128 v25, v[76:79] offset:2048
ds_write_b128 v24, v[60:63] offset:3072
ds_write_b128 v25, v[80:83] offset:3072
ds_write_b128 v24, v[64:67] offset:4096
ds_write_b128 v25, v[84:87] offset:4096
s_waitcnt lgkmcnt(0)
s_barrier
s_add_u32 s28, s16, 1
s_and_b32 s28, s28, 3
s_mul_i32 s28, s28, 10240
s_and_b32 s29, s16, 1
s_mul_i32 s29, s29, 5120
s_add_u32 s28, s28, s29
s_add_u32 s28, s28, 65536
v_add_u32 v26, s28, v1
ds_read_b128 v[88:91], v26 offset:0
ds_read_b128 v[92:95], v26 offset:1024
ds_read_b128 v[96:99], v26 offset:2048
s_add_u32 s28, s16, 2
s_and_b32 s28, s28, 3
s_mul_i32 s28, s28, 10240
s_and_b32 s29, s16, 1
s_mul_i32 s29, s29, 5120
s_add_u32 s28, s28, s29
s_add_u32 s28, s28, 65536
v_add_u32 v26, s28, v1
ds_read_b128 v[100:103], v26 offset:0
ds_read_b128 v[104:107], v26 offset:1024
ds_read_b128 v[108:111], v26 offset:2048
s_add_u32 s28, s16, 3
s_and_b32 s28, s28, 3
s_mul_i32 s28, s28, 10240
s_and_b32 s29, s16, 1
s_mul_i32 s29, s29, 5120
s_add_u32 s28, s28, s29
s_add_u32 s28, s28, 65536
v_add_u32 v26, s28, v1
ds_read_b128 v[112:115], v26 offset:0
ds_read_b128 v[116:119], v26 offset:1024
ds_read_b128 v[120:123], v26 offset:2048
s_waitcnt lgkmcnt(6)
v_add_f32 v48, v48, v88
v_add_f32 v49, v49, v89
v_add_f32 v50, v50, v90
v_add_f32 v51, v51, v91
v_add_f32 v52, v52, v92
v_add_f32 v53, v53, v93
v_add_f32 v54, v54, v94
v_add_f32 v55, v55, v95
v_add_f32 v56, v56, v96
v_add_f32 v57, v57, v97
v_add_f32 v58, v58, v98
v_add_f32 v59, v59, v99
s_waitcnt lgkmcnt(3)
v_add_f32 v48, v48, v100
v_add_f32 v49, v49, v101
v_add_f32 v50, v50, v102
v_add_f32 v51, v51, v103
v_add_f32 v52, v52, v104
v_add_f32 v53, v53, v105
v_add_f32 v54, v54, v106
v_add_f32 v55, v55, v107
v_add_f32 v56, v56, v108
v_add_f32 v57, v57, v109
v_add_f32 v58, v58, v110
v_add_f32 v59, v59, v111
s_waitcnt lgkmcnt(0)
v_add_f32 v48, v48, v112
v_add_f32 v49, v49, v113
v_add_f32 v50, v50, v114
v_add_f32 v51, v51, v115
v_add_f32 v52, v52, v116
v_add_f32 v53, v53, v117
v_add_f32 v54, v54, v118
v_add_f32 v55, v55, v119
v_add_f32 v56, v56, v120
v_add_f32 v57, v57, v121
v_add_f32 v58, v58, v122
v_add_f32 v59, v59, v123
v_lshlrev_b32 v26, 16, v248
v_and_b32 v27, 0xffff0000, v248
v_add_f32 v48, v48, v26
v_add_f32 v49, v49, v27
v_cvt_pk_bf16_f32 v248, v48, v49
v_lshlrev_b32 v26, 16, v249
v_and_b32 v27, 0xffff0000, v249
v_add_f32 v50, v50, v26
v_add_f32 v51, v51, v27
v_cvt_pk_bf16_f32 v249, v50, v51
v_lshlrev_b32 v26, 16, v250
v_and_b32 v27, 0xffff0000, v250
v_add_f32 v52, v52, v26
v_add_f32 v53, v53, v27
v_cvt_pk_bf16_f32 v250, v52, v53
v_lshlrev_b32 v26, 16, v251
v_and_b32 v27, 0xffff0000, v251
v_add_f32 v54, v54, v26
v_add_f32 v55, v55, v27
v_cvt_pk_bf16_f32 v251, v54, v55
v_lshlrev_b32 v26, 16, v252
v_and_b32 v27, 0xffff0000, v252
v_add_f32 v56, v56, v26
v_add_f32 v57, v57, v27
v_cvt_pk_bf16_f32 v252, v56, v57
v_lshlrev_b32 v26, 16, v253
v_and_b32 v27, 0xffff0000, v253
v_add_f32 v58, v58, v26
v_add_f32 v59, v59, v27
v_cvt_pk_bf16_f32 v253, v58, v59
v_mov_b32 v28, 0x3f803f80
v_mov_b32 v26, 0
v_mov_b32 v27, 0
v_dot2_f32_bf16 v26, v248, v28, v26
v_dot2_f32_bf16 v27, v248, v248, v27
v_dot2_f32_bf16 v26, v249, v28, v26
v_dot2_f32_bf16 v27, v249, v249, v27
v_dot2_f32_bf16 v26, v250, v28, v26
v_dot2_f32_bf16 v27, v250, v250, v27
v_dot2_f32_bf16 v26, v251, v28, v26
v_dot2_f32_bf16 v27, v251, v251, v27
v_dot2_f32_bf16 v26, v252, v28, v26
v_dot2_f32_bf16 v27, v252, v252, v27
v_dot2_f32_bf16 v26, v253, v28, v26
v_dot2_f32_bf16 v27, v253, v253, v27
s_add_u32 s89, s88, 34459648
s_add_u32 s91, s89, 4096
buffer_store_dwordx2 v[252:253], v245, s[8:11], s91 offen sc1
v_and_b32 v29, 1, v5
v_lshlrev_b32 v29, 1, v29
v_lshrrev_b32 v30, 1, v5
v_add_u32 v29, v29, v30
v_lshlrev_b32 v29, 10, v29
v_lshl_add_u32 v29, v225, 4, v29
v_permlane16_swap_b32 v248, v250
v_permlane16_swap_b32 v249, v251
s_nop 0
buffer_store_dwordx4 v[248:251], v29, s[8:11], s89 offen offset:0 sc1
v_mov_b32 v28, v26
v_mov_b32 v30, v27
s_nop 1
v_permlane16_swap_b32 v26, v28
v_permlane16_swap_b32 v27, v30
s_nop 0
v_add_f32 v26, v26, v28
v_add_f32 v27, v27, v30
v_mov_b32 v28, v26
v_mov_b32 v30, v27
s_nop 1
v_permlane32_swap_b32 v26, v28
v_permlane32_swap_b32 v27, v30
s_nop 0
v_add_f32 v26, v26, v28
v_add_f32 v27, v27, v30
s_lshr_b32 s28, s24, 1
s_add_u32 s28, s28, 0
s_lshl_b32 s28, s28, 6
v_add_u32 v28, s28, v225
v_lshlrev_b32 v28, 4, v28
s_lshl_b32 s28, s25, 15
s_add_u32 s28, s28, 37343232
v_cmp_gt_u32 vcc, 16, v0
s_and_saveexec_b64 s[92:93], vcc
buffer_store_dwordx2 v[26:27], v28, s[8:11], s28 offen sc1
s_mov_b64 exec, -1
s_branch V50
V51:
s_nop 1
ds_write_b128 v24, v[48:51] offset:0
ds_write_b128 v25, v[68:71] offset:0
ds_write_b128 v24, v[52:55] offset:1024
ds_write_b128 v25, v[72:75] offset:1024
ds_write_b128 v24, v[56:59] offset:2048
ds_write_b128 v25, v[76:79] offset:2048
ds_write_b128 v25, v[80:83] offset:3072
ds_write_b128 v25, v[84:87] offset:4096
s_waitcnt lgkmcnt(0)
s_barrier
s_add_u32 s28, s16, 1
s_and_b32 s28, s28, 3
s_mul_i32 s28, s28, 10240
s_and_b32 s29, s16, 1
s_mul_i32 s29, s29, 5120
s_add_u32 s28, s28, s29
s_add_u32 s28, s28, 65536
v_add_u32 v26, s28, v1
ds_read_b128 v[88:91], v26 offset:3072
ds_read_b128 v[92:95], v26 offset:4096
s_add_u32 s28, s16, 2
s_and_b32 s28, s28, 3
s_mul_i32 s28, s28, 10240
s_and_b32 s29, s16, 1
s_mul_i32 s29, s29, 5120
s_add_u32 s28, s28, s29
s_add_u32 s28, s28, 65536
v_add_u32 v26, s28, v1
ds_read_b128 v[100:103], v26 offset:3072
ds_read_b128 v[104:107], v26 offset:4096
s_add_u32 s28, s16, 3
s_and_b32 s28, s28, 3
s_mul_i32 s28, s28, 10240
s_and_b32 s29, s16, 1
s_mul_i32 s29, s29, 5120
s_add_u32 s28, s28, s29
s_add_u32 s28, s28, 65536
v_add_u32 v26, s28, v1
ds_read_b128 v[112:115], v26 offset:3072
ds_read_b128 v[116:119], v26 offset:4096
s_waitcnt lgkmcnt(4)
v_add_f32 v60, v60, v88
v_add_f32 v61, v61, v89
v_add_f32 v62, v62, v90
v_add_f32 v63, v63, v91
v_add_f32 v64, v64, v92
v_add_f32 v65, v65, v93
v_add_f32 v66, v66, v94
v_add_f32 v67, v67, v95
s_waitcnt lgkmcnt(2)
v_add_f32 v60, v60, v100
v_add_f32 v61, v61, v101
v_add_f32 v62, v62, v102
v_add_f32 v63, v63, v103
v_add_f32 v64, v64, v104
v_add_f32 v65, v65, v105
v_add_f32 v66, v66, v106
v_add_f32 v67, v67, v107
s_waitcnt lgkmcnt(0)
v_add_f32 v60, v60, v112
v_add_f32 v61, v61, v113
v_add_f32 v62, v62, v114
v_add_f32 v63, v63, v115
v_add_f32 v64, v64, v116
v_add_f32 v65, v65, v117
v_add_f32 v66, v66, v118
v_add_f32 v67, v67, v119
v_lshlrev_b32 v26, 16, v248
v_and_b32 v27, 0xffff0000, v248
v_add_f32 v60, v60, v26
v_add_f32 v61, v61, v27
v_cvt_pk_bf16_f32 v248, v60, v61
v_lshlrev_b32 v26, 16, v249
v_and_b32 v27, 0xffff0000, v249
v_add_f32 v62, v62, v26
v_add_f32 v63, v63, v27
v_cvt_pk_bf16_f32 v249, v62, v63
v_lshlrev_b32 v26, 16, v250
v_and_b32 v27, 0xffff0000, v250
v_add_f32 v64, v64, v26
v_add_f32 v65, v65, v27
v_cvt_pk_bf16_f32 v250, v64, v65
v_lshlrev_b32 v26, 16, v251
v_and_b32 v27, 0xffff0000, v251
v_add_f32 v66, v66, v26
v_add_f32 v67, v67, v27
v_cvt_pk_bf16_f32 v251, v66, v67
v_mov_b32 v28, 0x3f803f80
v_mov_b32 v26, 0
v_mov_b32 v27, 0
v_dot2_f32_bf16 v26, v248, v28, v26
v_dot2_f32_bf16 v27, v248, v248, v27
v_dot2_f32_bf16 v26, v249, v28, v26
v_dot2_f32_bf16 v27, v249, v249, v27
v_dot2_f32_bf16 v26, v250, v28, v26
v_dot2_f32_bf16 v27, v250, v250, v27
v_dot2_f32_bf16 v26, v251, v28, v26
v_dot2_f32_bf16 v27, v251, v251, v27
s_add_u32 s89, s88, 34459648
v_and_b32 v29, 1, v5
v_lshlrev_b32 v29, 1, v29
v_lshrrev_b32 v30, 1, v5
v_add_u32 v29, v29, v30
v_lshlrev_b32 v29, 10, v29
v_lshl_add_u32 v29, v225, 4, v29
v_permlane16_swap_b32 v248, v250
v_permlane16_swap_b32 v249, v251
s_add_u32 s91, s89, 4096
s_nop 0
buffer_store_dwordx4 v[248:251], v29, s[8:11], s91 offen offset:2048 sc1
v_mov_b32 v28, v26
v_mov_b32 v30, v27
s_nop 1
v_permlane16_swap_b32 v26, v28
v_permlane16_swap_b32 v27, v30
s_nop 0
v_add_f32 v26, v26, v28
v_add_f32 v27, v27, v30
v_mov_b32 v28, v26
v_mov_b32 v30, v27
s_nop 1
v_permlane32_swap_b32 v26, v28
v_permlane32_swap_b32 v27, v30
s_nop 0
v_add_f32 v26, v26, v28
v_add_f32 v27, v27, v30
s_lshr_b32 s28, s24, 1
s_add_u32 s28, s28, 0
s_lshl_b32 s28, s28, 6
v_add_u32 v28, s28, v225
v_lshlrev_b32 v28, 4, v28
s_lshl_b32 s28, s25, 15
s_add_u32 s28, s28, 37343240
v_cmp_gt_u32 vcc, 16, v0
s_and_saveexec_b64 s[92:93], vcc
buffer_store_dwordx2 v[26:27], v28, s[8:11], s28 offen sc1
s_mov_b64 exec, -1
V50:
s_lshr_b32 s29, s24, 2
s_lshl_b32 s29, s29, 7
s_add_u32 s94, s29, 9245696
buffer_load_dword v31, v6, s[8:11], s94 offen sc1
s_waitcnt vmcnt(0)
s_cmp_lg_u32 s16, 0
s_cbranch_scc1 P52
s_movk_i32 s77, 32
P53:
v_cmp_gt_u32 vcc, s77, v31
s_nop 1
s_cbranch_vccz P52
s_add_u32 s76, s76, 1
s_cmp_gt_u32 s76, 400000
s_cbranch_scc1 P52
s_sleep 4
buffer_load_dword v31, v6, s[8:11], s94 offen sc1
s_waitcnt vmcnt(0)
s_branch P53
P52:
s_barrier
s_lshr_b32 s28, s24, 1
s_add_u32 s28, s28, 16
s_mul_i32 s87, s28, 81920
s_add_u32 s87, s87, 45469696
s_mul_i32 s28, s16, 20480
s_add_u32 s87, s87, s28
s_and_b32 s28, s24, 1
s_lshl_b32 s28, s28, 9
s_add_u32 s87, s87, s28
s_add_u32 m0, s99, 0
s_add_u32 s28, s87, 1024
buffer_load_dwordx4 v8, s[8:11], s87 offen sc1 lds
buffer_load_dwordx4 v8, s[8:11], s28 offen offset:1024 sc1 lds
s_add_u32 s87, s87, 4096
s_add_u32 m0, s99, 2048
s_add_u32 s28, s87, 1024
buffer_load_dwordx4 v8, s[8:11], s87 offen sc1 lds
buffer_load_dwordx4 v8, s[8:11], s28 offen offset:1024 sc1 lds
s_add_u32 s87, s87, 4096
s_add_u32 m0, s99, 4096
s_add_u32 s28, s87, 1024
buffer_load_dwordx4 v8, s[8:11], s87 offen sc1 lds
buffer_load_dwordx4 v8, s[8:11], s28 offen offset:1024 sc1 lds
s_add_u32 s87, s87, 4096
s_add_u32 m0, s99, 6144
s_add_u32 s28, s87, 1024
buffer_load_dwordx4 v8, s[8:11], s87 offen sc1 lds
buffer_load_dwordx4 v8, s[8:11], s28 offen offset:1024 sc1 lds
s_add_u32 s87, s87, 4096
s_add_u32 m0, s99, 8192
s_add_u32 s28, s87, 1024
buffer_load_dwordx4 v8, s[8:11], s87 offen sc1 lds
buffer_load_dwordx4 v8, s[8:11], s28 offen offset:1024 sc1 lds
s_add_u32 s87, s87, 4096
v_add_u32 v238, s99, v227
v_add_u32 v239, s99, v226
s_waitcnt vmcnt(8)
ds_read_b128 v[32:35], v238 offset:0
ds_read_b128 v[36:39], v239 offset:0
s_lshr_b32 s28, s24, 1
s_lshl_b32 s28, s28, 7
s_add_u32 s28, s28, 9246720
s_barrier
s_cmp_lg_u32 s16, 0
s_cbranch_scc1 S54
s_mov_b64 exec, 1
buffer_atomic_add v7, v6, s[8:11], s28 offen sc1
s_mov_b64 exec, -1
S54:
s_waitcnt vmcnt(6)
ds_read_b128 v[40:43], v238 offset:2048
ds_read_b128 v[44:47], v239 offset:2048
s_waitcnt lgkmcnt(2)
v_mfma_f32_16x16x32_bf16 v[48:51], a[160:163], v[32:35], 0
v_mfma_f32_16x16x32_bf16 v[68:71], a[160:163], v[36:39], 0
buffer_load_dwordx4 a[160:163], v12, s[8:11], s35 offen offset:256
v_mfma_f32_16x16x32_bf16 v[52:55], a[164:167], v[32:35], 0
v_mfma_f32_16x16x32_bf16 v[72:75], a[164:167], v[36:39], 0
buffer_load_dwordx4 a[164:167], v12, s[8:11], s35 offen offset:512
v_mfma_f32_16x16x32_bf16 v[56:59], a[168:171], v[32:35], 0
v_mfma_f32_16x16x32_bf16 v[76:79], a[168:171], v[36:39], 0
s_add_u32 s35, s35, 12288
buffer_load_dwordx4 a[168:171], v12, s[8:11], s35 offen offset:0
v_mfma_f32_16x16x32_bf16 v[60:63], a[172:175], v[32:35], 0
v_mfma_f32_16x16x32_bf16 v[80:83], a[172:175], v[36:39], 0
buffer_load_dwordx4 a[172:175], v12, s[8:11], s35 offen offset:256
v_mfma_f32_16x16x32_bf16 v[64:67], a[176:179], v[32:35], 0
v_mfma_f32_16x16x32_bf16 v[84:87], a[176:179], v[36:39], 0
buffer_load_dwordx4 a[176:179], v12, s[8:11], s35 offen offset:512
s_waitcnt vmcnt(9)
ds_read_b128 v[32:35], v238 offset:4096
ds_read_b128 v[36:39], v239 offset:4096
s_waitcnt lgkmcnt(2)
v_mfma_f32_16x16x32_bf16 v[48:51], a[180:183], v[40:43], v[48:51]
v_mfma_f32_16x16x32_bf16 v[68:71], a[180:183], v[44:47], v[68:71]
s_add_u32 s35, s35, 12288
buffer_load_dwordx4 a[180:183], v12, s[8:11], s35 offen offset:0
v_mfma_f32_16x16x32_bf16 v[52:55], a[184:187], v[40:43], v[52:55]
v_mfma_f32_16x16x32_bf16 v[72:75], a[184:187], v[44:47], v[72:75]
buffer_load_dwordx4 a[184:187], v12, s[8:11], s35 offen offset:256
v_mfma_f32_16x16x32_bf16 v[56:59], a[188:191], v[40:43], v[56:59]
v_mfma_f32_16x16x32_bf16 v[76:79], a[188:191], v[44:47], v[76:79]
buffer_load_dwordx4 a[188:191], v12, s[8:11], s35 offen offset:512
v_mfma_f32_16x16x32_bf16 v[60:63], a[192:195], v[40:43], v[60:63]
v_mfma_f32_16x16x32_bf16 v[80:83], a[192:195], v[44:47], v[80:83]
s_add_u32 s35, s35, 12288
buffer_load_dwordx4 a[192:195], v12, s[8:11], s35 offen offset:0
v_mfma_f32_16x16x32_bf16 v[64:67], a[196:199], v[40:43], v[64:67]
v_mfma_f32_16x16x32_bf16 v[84:87], a[196:199], v[44:47], v[84:87]
buffer_load_dwordx4 a[196:199], v12, s[8:11], s35 offen offset:256
s_waitcnt vmcnt(12)
ds_read_b128 v[40:43], v238 offset:6144
ds_read_b128 v[44:47], v239 offset:6144
s_waitcnt lgkmcnt(2)
v_mfma_f32_16x16x32_bf16 v[48:51], a[200:203], v[32:35], v[48:51]
v_mfma_f32_16x16x32_bf16 v[68:71], a[200:203], v[36:39], v[68:71]
buffer_load_dwordx4 a[200:203], v12, s[8:11], s35 offen offset:512
v_mfma_f32_16x16x32_bf16 v[52:55], a[204:207], v[32:35], v[52:55]
v_mfma_f32_16x16x32_bf16 v[72:75], a[204:207], v[36:39], v[72:75]
s_add_u32 s35, s35, 12288
buffer_load_dwordx4 a[204:207], v12, s[8:11], s35 offen offset:0
v_mfma_f32_16x16x32_bf16 v[56:59], a[208:211], v[32:35], v[56:59]
v_mfma_f32_16x16x32_bf16 v[76:79], a[208:211], v[36:39], v[76:79]
buffer_load_dwordx4 a[208:211], v12, s[8:11], s35 offen offset:256
v_mfma_f32_16x16x32_bf16 v[60:63], a[212:215], v[32:35], v[60:63]
v_mfma_f32_16x16x32_bf16 v[80:83], a[212:215], v[36:39], v[80:83]
buffer_load_dwordx4 a[212:215], v12, s[8:11], s35 offen offset:512
v_mfma_f32_16x16x32_bf16 v[64:67], a[216:219], v[32:35], v[64:67]
v_mfma_f32_16x16x32_bf16 v[84:87], a[216:219], v[36:39], v[84:87]
s_add_u32 s35, s35, 12288
buffer_load_dwordx4 a[216:219], v12, s[8:11], s35 offen offset:0
s_waitcnt vmcnt(15)
ds_read_b128 v[32:35], v238 offset:8192
ds_read_b128 v[36:39], v239 offset:8192
s_waitcnt lgkmcnt(2)
v_mfma_f32_16x16x32_bf16 v[48:51], a[220:223], v[40:43], v[48:51]
v_mfma_f32_16x16x32_bf16 v[68:71], a[220:223], v[44:47], v[68:71]
buffer_load_dwordx4 a[220:223], v12, s[8:11], s35 offen offset:256
v_mfma_f32_16x16x32_bf16 v[52:55], a[224:227], v[40:43], v[52:55]
v_mfma_f32_16x16x32_bf16 v[72:75], a[224:227], v[44:47], v[72:75]
buffer_load_dwordx4 a[224:227], v12, s[8:11], s35 offen offset:512
v_mfma_f32_16x16x32_bf16 v[56:59], a[228:231], v[40:43], v[56:59]
v_mfma_f32_16x16x32_bf16 v[76:79], a[228:231], v[44:47], v[76:79]
s_add_u32 s35, s35, 12288
buffer_load_dwordx4 a[228:231], v12, s[8:11], s35 offen offset:0
v_mfma_f32_16x16x32_bf16 v[60:63], a[232:235], v[40:43], v[60:63]
v_mfma_f32_16x16x32_bf16 v[80:83], a[232:235], v[44:47], v[80:83]
buffer_load_dwordx4 a[232:235], v12, s[8:11], s35 offen offset:256
v_mfma_f32_16x16x32_bf16 v[64:67], a[236:239], v[40:43], v[64:67]
v_mfma_f32_16x16x32_bf16 v[84:87], a[236:239], v[44:47], v[84:87]
buffer_load_dwordx4 a[236:239], v12, s[8:11], s35 offen offset:512
s_waitcnt lgkmcnt(0)
v_mfma_f32_16x16x32_bf16 v[48:51], a[240:243], v[32:35], v[48:51]
v_mfma_f32_16x16x32_bf16 v[68:71], a[240:243], v[36:39], v[68:71]
v_mfma_f32_16x16x32_bf16 v[52:55], a[244:247], v[32:35], v[52:55]
v_mfma_f32_16x16x32_bf16 v[72:75], a[244:247], v[36:39], v[72:75]
v_mfma_f32_16x16x32_bf16 v[56:59], a[248:251], v[32:35], v[56:59]
v_mfma_f32_16x16x32_bf16 v[76:79], a[248:251], v[36:39], v[76:79]
v_mfma_f32_16x16x32_bf16 v[60:63], a[252:255], v[32:35], v[60:63]
v_mfma_f32_16x16x32_bf16 v[80:83], a[252:255], v[36:39], v[80:83]
v_mfma_f32_16x16x32_bf16 v[64:67], v[228:231], v[32:35], v[64:67]
v_mfma_f32_16x16x32_bf16 v[84:87], v[228:231], v[36:39], v[84:87]
s_mov_b32 s29, s19
s_lshl_b32 s29, s29, 7
s_add_u32 s94, s29, 9246720
buffer_load_dword v31, v6, s[8:11], s94 offen sc1
s_lshr_b32 s28, s16, 1
s_lshl_b32 s28, s28, 9
v_add_u32 v188, s28, v10
s_sub_u32 s28, 512, s28
v_add_u32 v189, s28, v10
s_lshr_b32 s29, s16, 1
s_lshl_b32 s29, s29, 7
s_xor_b32 s28, s29, 0
v_lshl_add_u32 v240, v4, 2, s28
s_xor_b32 s28, s29, 64
v_lshl_add_u32 v241, v4, 2, s28
s_xor_b32 s28, s29, 128
v_lshl_add_u32 v242, v4, 2, s28
s_xor_b32 s28, s29, 192
v_lshl_add_u32 v243, v4, 2, s28
s_lshr_b32 s28, s16, 1
s_mul_i32 s28, s28, 1536
s_mul_i32 s29, s21, 96
s_add_u32 s28, s28, s29
s_and_b32 s29, s16, 1
s_mul_i32 s29, s29, 48
s_add_u32 s28, s28, s29
s_lshl_b32 s28, s28, 2
s_add_u32 s28, s28, 9182720
v_lshlrev_b32 v29, 4, v5
buffer_load_dwordx4 v[176:179], v29, s[8:11], s28 offen offset:0
buffer_load_dwordx4 v[180:183], v29, s[8:11], s28 offen offset:64
buffer_load_dwordx4 v[184:187], v29, s[8:11], s28 offen offset:128
s_waitcnt vmcnt(3)
s_cmp_lg_u32 s16, 0
s_cbranch_scc1 P55
s_movk_i32 s77, 16
P56:
v_cmp_gt_u32 vcc, s77, v31
s_nop 1
s_cbranch_vccz P55
s_add_u32 s76, s76, 1
s_cmp_gt_u32 s76, 400000
s_cbranch_scc1 P55
s_sleep 4
buffer_load_dword v31, v6, s[8:11], s94 offen sc1
s_waitcnt vmcnt(0)
s_branch P56
P55:
s_barrier
s_add_u32 s28, s19, 0
s_lshl_b32 s28, s28, 6
v_add_u32 v29, s28, v0
v_lshlrev_b32 v29, 4, v29
s_mov_b32 s29, 37343232
buffer_load_dwordx4 v[192:195], v29, s[8:11], s29 offen sc1
s_add_u32 s29, s29, 32768
buffer_load_dwordx4 v[196:199], v29, s[8:11], s29 offen sc1
s_add_u32 s29, s29, 32768
buffer_load_dwordx4 v[200:203], v29, s[8:11], s29 offen sc1
s_add_u32 s29, s29, 32768
buffer_load_dwordx4 v[204:207], v29, s[8:11], s29 offen sc1
s_add_u32 s29, s29, 32768
buffer_load_dwordx4 v[208:211], v29, s[8:11], s29 offen sc1
s_add_u32 s29, s29, 32768
buffer_load_dwordx4 v[212:215], v29, s[8:11], s29 offen sc1
s_add_u32 s29, s29, 32768
buffer_load_dwordx4 v[216:219], v29, s[8:11], s29 offen sc1
s_add_u32 s29, s29, 32768
buffer_load_dwordx4 v[220:223], v29, s[8:11], s29 offen sc1
s_add_u32 s26, s19, 0
s_mul_i32 s26, s26, 81920
s_add_u32 s26, s26, 34459648
s_add_u32 s26, s26, s30
s_add_u32 m0, s30, 0
s_nop 0
buffer_load_dwordx4 v1, s[8:11], s26 offen sc1 lds
buffer_load_dwordx4 v1, s[8:11], s26 offen offset:1024 sc1 lds
s_add_u32 s26, s26, 8192
s_add_u32 m0, s30, 8192
s_nop 0
buffer_load_dwordx4 v1, s[8:11], s26 offen sc1 lds
buffer_load_dwordx4 v1, s[8:11], s26 offen offset:1024 sc1 lds
s_add_u32 s26, s26, 8192
s_add_u32 m0, s30, 16384
s_nop 0
buffer_load_dwordx4 v1, s[8:11], s26 offen sc1 lds
buffer_load_dwordx4 v1, s[8:11], s26 offen offset:1024 sc1 lds
s_add_u32 s26, s26, 8192
s_add_u32 m0, s30, 24576
s_nop 0
buffer_load_dwordx4 v1, s[8:11], s26 offen sc1 lds
buffer_load_dwordx4 v1, s[8:11], s26 offen offset:1024 sc1 lds
s_add_u32 s26, s26, 8192
s_add_u32 m0, s30, 32768
s_nop 0
buffer_load_dwordx4 v1, s[8:11], s26 offen sc1 lds
buffer_load_dwordx4 v1, s[8:11], s26 offen offset:1024 sc1 lds
s_add_u32 s26, s26, 8192
s_lshr_b32 s28, s24, 1
s_add_u32 s28, s28, 16
s_mul_i32 s88, s28, 81920
s_mul_i32 s29, s25, 10240
s_add_u32 s88, s88, s29
s_barrier
s_mul_i32 s28, s16, 10240
s_add_u32 s28, s28, 65536
s_and_b32 s29, s16, 1
s_mul_i32 s29, s29, 5120
s_add_u32 s90, s28, s29
v_add_u32 v24, s90, v1
s_xor_b32 s29, s29, 5120
s_add_u32 s90, s28, s29
v_add_u32 v25, s90, v1
s_cmp_ge_u32 s16, 2
s_cbranch_scc1 V58
s_nop 1
ds_write_b128 v25, v[68:71] offset:0
ds_write_b128 v25, v[72:75] offset:1024
ds_write_b128 v25, v[76:79] offset:2048
ds_write_b128 v24, v[60:63] offset:3072
ds_write_b128 v25, v[80:83] offset:3072
ds_write_b128 v24, v[64:67] offset:4096
ds_write_b128 v25, v[84:87] offset:4096
s_waitcnt lgkmcnt(0)
s_barrier
s_add_u32 s28, s16, 1
s_and_b32 s28, s28, 3
s_mul_i32 s28, s28, 10240
s_and_b32 s29, s16, 1
s_mul_i32 s29, s29, 5120
s_add_u32 s28, s28, s29
s_add_u32 s28, s28, 65536
v_add_u32 v26, s28, v1
ds_read_b128 v[88:91], v26 offset:0
ds_read_b128 v[92:95], v26 offset:1024
ds_read_b128 v[96:99], v26 offset:2048
s_add_u32 s28, s16, 2
s_and_b32 s28, s28, 3
s_mul_i32 s28, s28, 10240
s_and_b32 s29, s16, 1
s_mul_i32 s29, s29, 5120
s_add_u32 s28, s28, s29
s_add_u32 s28, s28, 65536
v_add_u32 v26, s28, v1
ds_read_b128 v[100:103], v26 offset:0
ds_read_b128 v[104:107], v26 offset:1024
ds_read_b128 v[108:111], v26 offset:2048
s_add_u32 s28, s16, 3
s_and_b32 s28, s28, 3
s_mul_i32 s28, s28, 10240
s_and_b32 s29, s16, 1
s_mul_i32 s29, s29, 5120
s_add_u32 s28, s28, s29
s_add_u32 s28, s28, 65536
v_add_u32 v26, s28, v1
ds_read_b128 v[112:115], v26 offset:0
ds_read_b128 v[116:119], v26 offset:1024
ds_read_b128 v[120:123], v26 offset:2048
s_waitcnt lgkmcnt(6)
v_add_f32 v48, v48, v88
v_add_f32 v49, v49, v89
v_add_f32 v50, v50, v90
v_add_f32 v51, v51, v91
v_add_f32 v52, v52, v92
v_add_f32 v53, v53, v93
v_add_f32 v54, v54, v94
v_add_f32 v55, v55, v95
v_add_f32 v56, v56, v96
v_add_f32 v57, v57, v97
v_add_f32 v58, v58, v98
v_add_f32 v59, v59, v99
s_waitcnt lgkmcnt(3)
v_add_f32 v48, v48, v100
v_add_f32 v49, v49, v101
v_add_f32 v50, v50, v102
v_add_f32 v51, v51, v103
v_add_f32 v52, v52, v104
v_add_f32 v53, v53, v105
v_add_f32 v54, v54, v106
v_add_f32 v55, v55, v107
v_add_f32 v56, v56, v108
v_add_f32 v57, v57, v109
v_add_f32 v58, v58, v110
v_add_f32 v59, v59, v111
s_waitcnt lgkmcnt(0)
v_add_f32 v48, v48, v112
v_add_f32 v49, v49, v113
v_add_f32 v50, v50, v114
v_add_f32 v51, v51, v115
v_add_f32 v52, v52, v116
v_add_f32 v53, v53, v117
v_add_f32 v54, v54, v118
v_add_f32 v55, v55, v119
v_add_f32 v56, v56, v120
v_add_f32 v57, v57, v121
v_add_f32 v58, v58, v122
v_add_f32 v59, v59, v123
v_lshlrev_b32 v26, 16, v232
v_and_b32 v27, 0xffff0000, v232
v_add_f32 v48, v48, v26
v_add_f32 v49, v49, v27
v_cvt_pk_bf16_f32 v232, v48, v49
v_lshlrev_b32 v26, 16, v233
v_and_b32 v27, 0xffff0000, v233
v_add_f32 v50, v50, v26
v_add_f32 v51, v51, v27
v_cvt_pk_bf16_f32 v233, v50, v51
v_lshlrev_b32 v26, 16, v234
v_and_b32 v27, 0xffff0000, v234
v_add_f32 v52, v52, v26
v_add_f32 v53, v53, v27
v_cvt_pk_bf16_f32 v234, v52, v53
v_lshlrev_b32 v26, 16, v235
v_and_b32 v27, 0xffff0000, v235
v_add_f32 v54, v54, v26
v_add_f32 v55, v55, v27
v_cvt_pk_bf16_f32 v235, v54, v55
v_lshlrev_b32 v26, 16, v236
v_and_b32 v27, 0xffff0000, v236
v_add_f32 v56, v56, v26
v_add_f32 v57, v57, v27
v_cvt_pk_bf16_f32 v236, v56, v57
v_lshlrev_b32 v26, 16, v237
v_and_b32 v27, 0xffff0000, v237
v_add_f32 v58, v58, v26
v_add_f32 v59, v59, v27
v_cvt_pk_bf16_f32 v237, v58, v59
v_mov_b32 v28, 0x3f803f80
v_mov_b32 v26, 0
v_mov_b32 v27, 0
v_dot2_f32_bf16 v26, v232, v28, v26
v_dot2_f32_bf16 v27, v232, v232, v27
v_dot2_f32_bf16 v26, v233, v28, v26
v_dot2_f32_bf16 v27, v233, v233, v27
v_dot2_f32_bf16 v26, v234, v28, v26
v_dot2_f32_bf16 v27, v234, v234, v27
v_dot2_f32_bf16 v26, v235, v28, v26
v_dot2_f32_bf16 v27, v235, v235, v27
v_dot2_f32_bf16 v26, v236, v28, v26
v_dot2_f32_bf16 v27, v236, v236, v27
v_dot2_f32_bf16 v26, v237, v28, v26
v_dot2_f32_bf16 v27, v237, v237, v27
s_add_u32 s89, s88, 34459648
s_add_u32 s91, s89, 4096
buffer_store_dwordx2 v[236:237], v246, s[8:11], s91 offen sc1
v_and_b32 v29, 1, v5
v_lshlrev_b32 v29, 1, v29
v_lshrrev_b32 v30, 1, v5
v_add_u32 v29, v29, v30
v_lshlrev_b32 v29, 10, v29
v_lshl_add_u32 v29, v244, 4, v29
v_permlane16_swap_b32 v232, v234
v_permlane16_swap_b32 v233, v235
s_nop 0
buffer_store_dwordx4 v[232:235], v29, s[8:11], s89 offen offset:0 sc1
v_mov_b32 v28, v26
v_mov_b32 v30, v27
s_nop 1
v_permlane16_swap_b32 v26, v28
v_permlane16_swap_b32 v27, v30
s_nop 0
v_add_f32 v26, v26, v28
v_add_f32 v27, v27, v30
v_mov_b32 v28, v26
v_mov_b32 v30, v27
s_nop 1
v_permlane32_swap_b32 v26, v28
v_permlane32_swap_b32 v27, v30
s_nop 0
v_add_f32 v26, v26, v28
v_add_f32 v27, v27, v30
s_lshr_b32 s28, s24, 1
s_add_u32 s28, s28, 16
s_lshl_b32 s28, s28, 6
v_add_u32 v28, s28, v244
v_lshlrev_b32 v28, 4, v28
s_lshl_b32 s28, s25, 15
s_add_u32 s28, s28, 37343232
v_cmp_gt_u32 vcc, 16, v0
s_and_saveexec_b64 s[92:93], vcc
buffer_store_dwordx2 v[26:27], v28, s[8:11], s28 offen sc1
s_mov_b64 exec, -1
s_branch V57
V58:
s_nop 1
ds_write_b128 v24, v[48:51] offset:0
ds_write_b128 v25, v[68:71] offset:0
ds_write_b128 v24, v[52:55] offset:1024
ds_write_b128 v25, v[72:75] offset:1024
ds_write_b128 v24, v[56:59] offset:2048
ds_write_b128 v25, v[76:79] offset:2048
ds_write_b128 v25, v[80:83] offset:3072
ds_write_b128 v25, v[84:87] offset:4096
s_waitcnt lgkmcnt(0)
s_barrier
s_add_u32 s28, s16, 1
s_and_b32 s28, s28, 3
s_mul_i32 s28, s28, 10240
s_and_b32 s29, s16, 1
s_mul_i32 s29, s29, 5120
s_add_u32 s28, s28, s29
s_add_u32 s28, s28, 65536
v_add_u32 v26, s28, v1
ds_read_b128 v[88:91], v26 offset:3072
ds_read_b128 v[92:95], v26 offset:4096
s_add_u32 s28, s16, 2
s_and_b32 s28, s28, 3
s_mul_i32 s28, s28, 10240
s_and_b32 s29, s16, 1
s_mul_i32 s29, s29, 5120
s_add_u32 s28, s28, s29
s_add_u32 s28, s28, 65536
v_add_u32 v26, s28, v1
ds_read_b128 v[100:103], v26 offset:3072
ds_read_b128 v[104:107], v26 offset:4096
s_add_u32 s28, s16, 3
s_and_b32 s28, s28, 3
s_mul_i32 s28, s28, 10240
s_and_b32 s29, s16, 1
s_mul_i32 s29, s29, 5120
s_add_u32 s28, s28, s29
s_add_u32 s28, s28, 65536
v_add_u32 v26, s28, v1
ds_read_b128 v[112:115], v26 offset:3072
ds_read_b128 v[116:119], v26 offset:4096
s_waitcnt lgkmcnt(4)
v_add_f32 v60, v60, v88
v_add_f32 v61, v61, v89
v_add_f32 v62, v62, v90
v_add_f32 v63, v63, v91
v_add_f32 v64, v64, v92
v_add_f32 v65, v65, v93
v_add_f32 v66, v66, v94
v_add_f32 v67, v67, v95
s_waitcnt lgkmcnt(2)
v_add_f32 v60, v60, v100
v_add_f32 v61, v61, v101
v_add_f32 v62, v62, v102
v_add_f32 v63, v63, v103
v_add_f32 v64, v64, v104
v_add_f32 v65, v65, v105
v_add_f32 v66, v66, v106
v_add_f32 v67, v67, v107
s_waitcnt lgkmcnt(0)
v_add_f32 v60, v60, v112
v_add_f32 v61, v61, v113
v_add_f32 v62, v62, v114
v_add_f32 v63, v63, v115
v_add_f32 v64, v64, v116
v_add_f32 v65, v65, v117
v_add_f32 v66, v66, v118
v_add_f32 v67, v67, v119
v_lshlrev_b32 v26, 16, v232
v_and_b32 v27, 0xffff0000, v232
v_add_f32 v60, v60, v26
v_add_f32 v61, v61, v27
v_cvt_pk_bf16_f32 v232, v60, v61
v_lshlrev_b32 v26, 16, v233
v_and_b32 v27, 0xffff0000, v233
v_add_f32 v62, v62, v26
v_add_f32 v63, v63, v27
v_cvt_pk_bf16_f32 v233, v62, v63
v_lshlrev_b32 v26, 16, v234
v_and_b32 v27, 0xffff0000, v234
v_add_f32 v64, v64, v26
v_add_f32 v65, v65, v27
v_cvt_pk_bf16_f32 v234, v64, v65
v_lshlrev_b32 v26, 16, v235
v_and_b32 v27, 0xffff0000, v235
v_add_f32 v66, v66, v26
v_add_f32 v67, v67, v27
v_cvt_pk_bf16_f32 v235, v66, v67
v_mov_b32 v28, 0x3f803f80
v_mov_b32 v26, 0
v_mov_b32 v27, 0
v_dot2_f32_bf16 v26, v232, v28, v26
v_dot2_f32_bf16 v27, v232, v232, v27
v_dot2_f32_bf16 v26, v233, v28, v26
v_dot2_f32_bf16 v27, v233, v233, v27
v_dot2_f32_bf16 v26, v234, v28, v26
v_dot2_f32_bf16 v27, v234, v234, v27
v_dot2_f32_bf16 v26, v235, v28, v26
v_dot2_f32_bf16 v27, v235, v235, v27
s_add_u32 s89, s88, 34459648
v_and_b32 v29, 1, v5
v_lshlrev_b32 v29, 1, v29
v_lshrrev_b32 v30, 1, v5
v_add_u32 v29, v29, v30
v_lshlrev_b32 v29, 10, v29
v_lshl_add_u32 v29, v244, 4, v29
v_permlane16_swap_b32 v232, v234
v_permlane16_swap_b32 v233, v235
s_add_u32 s91, s89, 4096
s_nop 0
buffer_store_dwordx4 v[232:235], v29, s[8:11], s91 offen offset:2048 sc1
v_mov_b32 v28, v26
v_mov_b32 v30, v27
s_nop 1
v_permlane16_swap_b32 v26, v28
v_permlane16_swap_b32 v27, v30
s_nop 0
v_add_f32 v26, v26, v28
v_add_f32 v27, v27, v30
v_mov_b32 v28, v26
v_mov_b32 v30, v27
s_nop 1
v_permlane32_swap_b32 v26, v28
v_permlane32_swap_b32 v27, v30
s_nop 0
v_add_f32 v26, v26, v28
v_add_f32 v27, v27, v30
s_lshr_b32 s28, s24, 1
s_add_u32 s28, s28, 16
s_lshl_b32 s28, s28, 6
v_add_u32 v28, s28, v244
v_lshlrev_b32 v28, 4, v28
s_lshl_b32 s28, s25, 15
s_add_u32 s28, s28, 37343240
v_cmp_gt_u32 vcc, 16, v0
s_and_saveexec_b64 s[92:93], vcc
buffer_store_dwordx2 v[26:27], v28, s[8:11], s28 offen sc1
s_mov_b64 exec, -1
V57:
s_waitcnt vmcnt(12)
v_add_f32 v192, v192, v208
v_add_f32 v193, v193, v209
v_add_f32 v194, v194, v210
v_add_f32 v195, v195, v211
v_add_f32 v196, v196, v212
v_add_f32 v197, v197, v213
v_add_f32 v198, v198, v214
v_add_f32 v199, v199, v215
v_add_f32 v200, v200, v216
v_add_f32 v201, v201, v217
v_add_f32 v202, v202, v218
v_add_f32 v203, v203, v219
v_add_f32 v204, v204, v220
v_add_f32 v205, v205, v221
v_add_f32 v206, v206, v222
v_add_f32 v207, v207, v223
v_add_f32 v192, v192, v200
v_add_f32 v193, v193, v201
v_add_f32 v194, v194, v202
v_add_f32 v195, v195, v203
v_add_f32 v196, v196, v204
v_add_f32 v197, v197, v205
v_add_f32 v198, v198, v206
v_add_f32 v199, v199, v207
v_add_f32 v192, v192, v196
v_add_f32 v193, v193, v197
v_add_f32 v194, v194, v198
v_add_f32 v195, v195, v199
v_add_f32 v192, v192, v194
v_add_f32 v193, v193, v195
v_mul_f32 v28, 0x3acccccd, v192
v_mul_f32 v26, 0x3acccccd, v193
v_fma_f32 v26, -v28, v28, v26
v_max_f32 v26, 0, v26
v_add_f32 v26, 0x3727c5ac, v26
v_rsq_f32 v27, v26
s_nop 0
ds_bpermute_b32 v160, v240, v27
ds_bpermute_b32 v168, v240, v28
ds_bpermute_b32 v161, v241, v27
ds_bpermute_b32 v169, v241, v28
ds_bpermute_b32 v162, v242, v27
ds_bpermute_b32 v170, v242, v28
ds_bpermute_b32 v163, v243, v27
ds_bpermute_b32 v171, v243, v28
s_waitcnt lgkmcnt(0)
v_mul_f32_e64 v32, -v168, v176
v_mul_f32_e64 v33, -v168, v177
v_mul_f32_e64 v34, -v168, v178
v_mul_f32_e64 v35, -v168, v179
v_mul_f32_e64 v36, -v169, v176
v_mul_f32_e64 v37, -v169, v177
v_mul_f32_e64 v38, -v169, v178
v_mul_f32_e64 v39, -v169, v179
v_mul_f32_e64 v40, -v170, v176
v_mul_f32_e64 v41, -v170, v177
v_mul_f32_e64 v42, -v170, v178
v_mul_f32_e64 v43, -v170, v179
v_mul_f32_e64 v44, -v171, v176
v_mul_f32_e64 v45, -v171, v177
v_mul_f32_e64 v46, -v171, v178
v_mul_f32_e64 v47, -v171, v179
v_mul_f32_e64 v48, -v168, v180
v_mul_f32_e64 v49, -v168, v181
v_mul_f32_e64 v50, -v168, v182
v_mul_f32_e64 v51, -v168, v183
v_mul_f32_e64 v52, -v169, v180
v_mul_f32_e64 v53, -v169, v181
v_mul_f32_e64 v54, -v169, v182
v_mul_f32_e64 v55, -v169, v183
v_mul_f32_e64 v56, -v170, v180
v_mul_f32_e64 v57, -v170, v181
v_mul_f32_e64 v58, -v170, v182
v_mul_f32_e64 v59, -v170, v183
v_mul_f32_e64 v60, -v171, v180
v_mul_f32_e64 v61, -v171, v181
v_mul_f32_e64 v62, -v171, v182
v_mul_f32_e64 v63, -v171, v183
v_mul_f32_e64 v64, -v168, v184
v_mul_f32_e64 v65, -v168, v185
v_mul_f32_e64 v66, -v168, v186
v_mul_f32_e64 v67, -v168, v187
v_mul_f32_e64 v68, -v169, v184
v_mul_f32_e64 v69, -v169, v185
v_mul_f32_e64 v70, -v169, v186
v_mul_f32_e64 v71, -v169, v187
v_mul_f32_e64 v72, -v170, v184
v_mul_f32_e64 v73, -v170, v185
v_mul_f32_e64 v74, -v170, v186
v_mul_f32_e64 v75, -v170, v187
v_mul_f32_e64 v76, -v171, v184
v_mul_f32_e64 v77, -v171, v185
v_mul_f32_e64 v78, -v171, v186
v_mul_f32_e64 v79, -v171, v187
s_waitcnt vmcnt(10)
s_barrier
ds_read_b128 v[128:131], v188 offset:0
ds_read_b128 v[132:135], v188 offset:256
ds_read_b128 v[136:139], v189 offset:0
ds_read_b128 v[140:143], v189 offset:256
s_waitcnt lgkmcnt(0)
v_mfma_f32_16x16x32_bf16 v[32:35], a[0:3], v[128:131], v[32:35]
ds_read_b128 v[144:147], v188 offset:4096
v_mfma_f32_16x16x32_bf16 v[36:39], a[0:3], v[132:135], v[36:39]
ds_read_b128 v[148:151], v188 offset:4352
v_mfma_f32_16x16x32_bf16 v[40:43], a[0:3], v[136:139], v[40:43]
ds_read_b128 v[152:155], v189 offset:4096
v_mfma_f32_16x16x32_bf16 v[44:47], a[0:3], v[140:143], v[44:47]
ds_read_b128 v[156:159], v189 offset:4352
v_mfma_f32_16x16x32_bf16 v[48:51], a[4:7], v[128:131], v[48:51]
s_add_u32 m0, s30, 40960
s_nop 0
buffer_load_dwordx4 v1, s[8:11], s26 offen sc1 lds
buffer_load_dwordx4 v1, s[8:11], s26 offen offset:1024 sc1 lds
s_add_u32 s26, s26, 8192
v_mfma_f32_16x16x32_bf16 v[52:55], a[4:7], v[132:135], v[52:55]
v_mfma_f32_16x16x32_bf16 v[56:59], a[4:7], v[136:139], v[56:59]
v_mfma_f32_16x16x32_bf16 v[60:63], a[4:7], v[140:143], v[60:63]
s_add_u32 m0, s30, 49152
s_nop 0
buffer_load_dwordx4 v1, s[8:11], s26 offen sc1 lds
buffer_load_dwordx4 v1, s[8:11], s26 offen offset:1024 sc1 lds
s_add_u32 s26, s26, 8192
v_mfma_f32_16x16x32_bf16 v[64:67], a[8:11], v[128:131], v[64:67]
v_mfma_f32_16x16x32_bf16 v[68:71], a[8:11], v[132:135], v[68:71]
v_mfma_f32_16x16x32_bf16 v[72:75], a[8:11], v[136:139], v[72:75]
s_add_u32 m0, s30, 57344
s_nop 0
buffer_load_dwordx4 v1, s[8:11], s26 offen sc1 lds
buffer_load_dwordx4 v1, s[8:11], s26 offen offset:1024 sc1 lds
s_add_u32 s26, s26, 8192
v_mfma_f32_16x16x32_bf16 v[76:79], a[8:11], v[140:143], v[76:79]
s_waitcnt vmcnt(14)
s_barrier
s_waitcnt lgkmcnt(0)
v_mfma_f32_16x16x32_bf16 v[32:35], a[12:15], v[144:147], v[32:35]
ds_read_b128 v[128:131], v188 offset:8192
v_mfma_f32_16x16x32_bf16 v[36:39], a[12:15], v[148:151], v[36:39]
ds_read_b128 v[132:135], v188 offset:8448
v_mfma_f32_16x16x32_bf16 v[40:43], a[12:15], v[152:155], v[40:43]
ds_read_b128 v[136:139], v189 offset:8192
v_mfma_f32_16x16x32_bf16 v[44:47], a[12:15], v[156:159], v[44:47]
ds_read_b128 v[140:143], v189 offset:8448
v_mfma_f32_16x16x32_bf16 v[48:51], a[16:19], v[144:147], v[48:51]
v_mfma_f32_16x16x32_bf16 v[52:55], a[16:19], v[148:151], v[52:55]
v_mfma_f32_16x16x32_bf16 v[56:59], a[16:19], v[152:155], v[56:59]
v_mfma_f32_16x16x32_bf16 v[60:63], a[16:19], v[156:159], v[60:63]
v_mfma_f32_16x16x32_bf16 v[64:67], a[20:23], v[144:147], v[64:67]
v_mfma_f32_16x16x32_bf16 v[68:71], a[20:23], v[148:151], v[68:71]
v_mfma_f32_16x16x32_bf16 v[72:75], a[20:23], v[152:155], v[72:75]
v_mfma_f32_16x16x32_bf16 v[76:79], a[20:23], v[156:159], v[76:79]
s_lshr_b32 s28, s24, 1
s_lshl_b32 s28, s28, 7
s_add_u32 s28, s28, 9248768
s_waitcnt vmcnt(6)
s_barrier
s_cmp_lg_u32 s16, 0
s_cbranch_scc1 S59
s_mov_b64 exec, 1
buffer_atomic_add v7, v6, s[8:11], s28 offen sc1
s_mov_b64 exec, -1
S59:
s_waitcnt lgkmcnt(0)
v_mfma_f32_16x16x32_bf16 v[32:35], a[24:27], v[128:131], v[32:35]
ds_read_b128 v[144:147], v188 offset:12288
v_mfma_f32_16x16x32_bf16 v[36:39], a[24:27], v[132:135], v[36:39]
ds_read_b128 v[148:151], v188 offset:12544
v_mfma_f32_16x16x32_bf16 v[40:43], a[24:27], v[136:139], v[40:43]
ds_read_b128 v[152:155], v189 offset:12288
v_mfma_f32_16x16x32_bf16 v[44:47], a[24:27], v[140:143], v[44:47]
ds_read_b128 v[156:159], v189 offset:12544
v_mfma_f32_16x16x32_bf16 v[48:51], a[28:31], v[128:131], v[48:51]
v_mfma_f32_16x16x32_bf16 v[52:55], a[28:31], v[132:135], v[52:55]
v_mfma_f32_16x16x32_bf16 v[56:59], a[28:31], v[136:139], v[56:59]
v_mfma_f32_16x16x32_bf16 v[60:63], a[28:31], v[140:143], v[60:63]
v_mfma_f32_16x16x32_bf16 v[64:67], a[32:35], v[128:131], v[64:67]
v_mfma_f32_16x16x32_bf16 v[68:71], a[32:35], v[132:135], v[68:71]
v_mfma_f32_16x16x32_bf16 v[72:75], a[32:35], v[136:139], v[72:75]
v_mfma_f32_16x16x32_bf16 v[76:79], a[32:35], v[140:143], v[76:79]
s_barrier
s_waitcnt lgkmcnt(0)
v_mfma_f32_16x16x32_bf16 v[32:35], a[36:39], v[144:147], v[32:35]
ds_read_b128 v[128:131], v188 offset:16384
v_mfma_f32_16x16x32_bf16 v[36:39], a[36:39], v[148:151], v[36:39]
ds_read_b128 v[132:135], v188 offset:16640
v_mfma_f32_16x16x32_bf16 v[40:43], a[36:39], v[152:155], v[40:43]
ds_read_b128 v[136:139], v189 offset:16384
v_mfma_f32_16x16x32_bf16 v[44:47], a[36:39], v[156:159], v[44:47]
ds_read_b128 v[140:143], v189 offset:16640
v_mfma_f32_16x16x32_bf16 v[48:51], a[40:43], v[144:147], v[48:51]
s_add_u32 m0, s30, 0
s_nop 0
buffer_load_dwordx4 v1, s[8:11], s26 offen sc1 lds
buffer_load_dwordx4 v1, s[8:11], s26 offen offset:1024 sc1 lds
s_add_u32 s26, s26, 8192
v_mfma_f32_16x16x32_bf16 v[52:55], a[40:43], v[148:151], v[52:55]
v_mfma_f32_16x16x32_bf16 v[56:59], a[40:43], v[152:155], v[56:59]
v_mfma_f32_16x16x32_bf16 v[60:63], a[40:43], v[156:159], v[60:63]
v_mfma_f32_16x16x32_bf16 v[64:67], a[44:47], v[144:147], v[64:67]
v_mfma_f32_16x16x32_bf16 v[68:71], a[44:47], v[148:151], v[68:71]
v_mfma_f32_16x16x32_bf16 v[72:75], a[44:47], v[152:155], v[72:75]
v_mfma_f32_16x16x32_bf16 v[76:79], a[44:47], v[156:159], v[76:79]
s_waitcnt lgkmcnt(0)
v_mfma_f32_16x16x32_bf16 v[32:35], a[48:51], v[128:131], v[32:35]
ds_read_b128 v[144:147], v188 offset:20480
v_mfma_f32_16x16x32_bf16 v[36:39], a[48:51], v[132:135], v[36:39]
ds_read_b128 v[148:151], v188 offset:20736
v_mfma_f32_16x16x32_bf16 v[40:43], a[48:51], v[136:139], v[40:43]
ds_read_b128 v[152:155], v189 offset:20480
v_mfma_f32_16x16x32_bf16 v[44:47], a[48:51], v[140:143], v[44:47]
ds_read_b128 v[156:159], v189 offset:20736
v_mfma_f32_16x16x32_bf16 v[48:51], a[52:55], v[128:131], v[48:51]
v_mfma_f32_16x16x32_bf16 v[52:55], a[52:55], v[132:135], v[52:55]
v_mfma_f32_16x16x32_bf16 v[56:59], a[52:55], v[136:139], v[56:59]
v_mfma_f32_16x16x32_bf16 v[60:63], a[52:55], v[140:143], v[60:63]
v_mfma_f32_16x16x32_bf16 v[64:67], a[56:59], v[128:131], v[64:67]
v_mfma_f32_16x16x32_bf16 v[68:71], a[56:59], v[132:135], v[68:71]
v_mfma_f32_16x16x32_bf16 v[72:75], a[56:59], v[136:139], v[72:75]
v_mfma_f32_16x16x32_bf16 v[76:79], a[56:59], v[140:143], v[76:79]
s_barrier
s_waitcnt lgkmcnt(0)
v_mfma_f32_16x16x32_bf16 v[32:35], a[60:63], v[144:147], v[32:35]
ds_read_b128 v[128:131], v188 offset:24576
v_mfma_f32_16x16x32_bf16 v[36:39], a[60:63], v[148:151], v[36:39]
ds_read_b128 v[132:135], v188 offset:24832
v_mfma_f32_16x16x32_bf16 v[40:43], a[60:63], v[152:155], v[40:43]
ds_read_b128 v[136:139], v189 offset:24576
v_mfma_f32_16x16x32_bf16 v[44:47], a[60:63], v[156:159], v[44:47]
ds_read_b128 v[140:143], v189 offset:24832
v_mfma_f32_16x16x32_bf16 v[48:51], a[64:67], v[144:147], v[48:51]
s_add_u32 m0, s30, 8192
s_nop 0
buffer_load_dwordx4 v1, s[8:11], s26 offen sc1 lds
buffer_load_dwordx4 v1, s[8:11], s26 offen offset:1024 sc1 lds
s_add_u32 s26, s26, 8192
v_mfma_f32_16x16x32_bf16 v[52:55], a[64:67], v[148:151], v[52:55]
v_mfma_f32_16x16x32_bf16 v[56:59], a[64:67], v[152:155], v[56:59]
v_mfma_f32_16x16x32_bf16 v[60:63], a[64:67], v[156:159], v[60:63]
v_mfma_f32_16x16x32_bf16 v[64:67], a[68:71], v[144:147], v[64:67]
v_mfma_f32_16x16x32_bf16 v[68:71], a[68:71], v[148:151], v[68:71]
v_mfma_f32_16x16x32_bf16 v[72:75], a[68:71], v[152:155], v[72:75]
v_mfma_f32_16x16x32_bf16 v[76:79], a[68:71], v[156:159], v[76:79]
s_waitcnt lgkmcnt(0)
v_mfma_f32_16x16x32_bf16 v[32:35], a[72:75], v[128:131], v[32:35]
ds_read_b128 v[144:147], v188 offset:28672
v_mfma_f32_16x16x32_bf16 v[36:39], a[72:75], v[132:135], v[36:39]
ds_read_b128 v[148:151], v188 offset:28928
v_mfma_f32_16x16x32_bf16 v[40:43], a[72:75], v[136:139], v[40:43]
ds_read_b128 v[152:155], v189 offset:28672
v_mfma_f32_16x16x32_bf16 v[44:47], a[72:75], v[140:143], v[44:47]
ds_read_b128 v[156:159], v189 offset:28928
v_mfma_f32_16x16x32_bf16 v[48:51], a[76:79], v[128:131], v[48:51]
v_mfma_f32_16x16x32_bf16 v[52:55], a[76:79], v[132:135], v[52:55]
v_mfma_f32_16x16x32_bf16 v[56:59], a[76:79], v[136:139], v[56:59]
v_mfma_f32_16x16x32_bf16 v[60:63], a[76:79], v[140:143], v[60:63]
v_mfma_f32_16x16x32_bf16 v[64:67], a[80:83], v[128:131], v[64:67]
v_mfma_f32_16x16x32_bf16 v[68:71], a[80:83], v[132:135], v[68:71]
v_mfma_f32_16x16x32_bf16 v[72:75], a[80:83], v[136:139], v[72:75]
v_mfma_f32_16x16x32_bf16 v[76:79], a[80:83], v[140:143], v[76:79]
s_barrier
s_waitcnt lgkmcnt(0)
v_mfma_f32_16x16x32_bf16 v[32:35], a[84:87], v[144:147], v[32:35]
ds_read_b128 v[128:131], v188 offset:32768
v_mfma_f32_16x16x32_bf16 v[36:39], a[84:87], v[148:151], v[36:39]
ds_read_b128 v[132:135], v188 offset:33024
v_mfma_f32_16x16x32_bf16 v[40:43], a[84:87], v[152:155], v[40:43]
ds_read_b128 v[136:139], v189 offset:32768
v_mfma_f32_16x16x32_bf16 v[44:47], a[84:87], v[156:159], v[44:47]
ds_read_b128 v[140:143], v189 offset:33024
v_mfma_f32_16x16x32_bf16 v[48:51], a[88:91], v[144:147], v[48:51]
v_mfma_f32_16x16x32_bf16 v[52:55], a[88:91], v[148:151], v[52:55]
v_mfma_f32_16x16x32_bf16 v[56:59], a[88:91], v[152:155], v[56:59]
v_mfma_f32_16x16x32_bf16 v[60:63], a[88:91], v[156:159], v[60:63]
v_mfma_f32_16x16x32_bf16 v[64:67], a[92:95], v[144:147], v[64:67]
v_mfma_f32_16x16x32_bf16 v[68:71], a[92:95], v[148:151], v[68:71]
v_mfma_f32_16x16x32_bf16 v[72:75], a[92:95], v[152:155], v[72:75]
v_mfma_f32_16x16x32_bf16 v[76:79], a[92:95], v[156:159], v[76:79]
s_waitcnt lgkmcnt(0)
v_mfma_f32_16x16x32_bf16 v[32:35], a[96:99], v[128:131], v[32:35]
ds_read_b128 v[144:147], v188 offset:36864
v_mfma_f32_16x16x32_bf16 v[36:39], a[96:99], v[132:135], v[36:39]
ds_read_b128 v[148:151], v188 offset:37120
v_mfma_f32_16x16x32_bf16 v[40:43], a[96:99], v[136:139], v[40:43]
ds_read_b128 v[152:155], v189 offset:36864
v_mfma_f32_16x16x32_bf16 v[44:47], a[96:99], v[140:143], v[44:47]
ds_read_b128 v[156:159], v189 offset:37120
v_mfma_f32_16x16x32_bf16 v[48:51], a[100:103], v[128:131], v[48:51]
v_mfma_f32_16x16x32_bf16 v[52:55], a[100:103], v[132:135], v[52:55]
v_mfma_f32_16x16x32_bf16 v[56:59], a[100:103], v[136:139], v[56:59]
v_mfma_f32_16x16x32_bf16 v[60:63], a[100:103], v[140:143], v[60:63]
v_mfma_f32_16x16x32_bf16 v[64:67], a[104:107], v[128:131], v[64:67]
v_mfma_f32_16x16x32_bf16 v[68:71], a[104:107], v[132:135], v[68:71]
v_mfma_f32_16x16x32_bf16 v[72:75], a[104:107], v[136:139], v[72:75]
v_mfma_f32_16x16x32_bf16 v[76:79], a[104:107], v[140:143], v[76:79]
s_mov_b32 s29, s19
s_add_u32 s29, s29, 16
s_lshl_b32 s29, s29, 7
s_add_u32 s94, s29, 9246720
buffer_load_dword v31, v6, s[8:11], s94 offen sc1
s_waitcnt vmcnt(9)
s_barrier
s_waitcnt lgkmcnt(0)
v_mfma_f32_16x16x32_bf16 v[32:35], a[108:111], v[144:147], v[32:35]
ds_read_b128 v[128:131], v188 offset:40960
v_mfma_f32_16x16x32_bf16 v[36:39], a[108:111], v[148:151], v[36:39]
ds_read_b128 v[132:135], v188 offset:41216
v_mfma_f32_16x16x32_bf16 v[40:43], a[108:111], v[152:155], v[40:43]
ds_read_b128 v[136:139], v189 offset:40960
v_mfma_f32_16x16x32_bf16 v[44:47], a[108:111], v[156:159], v[44:47]
ds_read_b128 v[140:143], v189 offset:41216
v_mfma_f32_16x16x32_bf16 v[48:51], a[112:115], v[144:147], v[48:51]
v_mfma_f32_16x16x32_bf16 v[52:55], a[112:115], v[148:151], v[52:55]
v_mfma_f32_16x16x32_bf16 v[56:59], a[112:115], v[152:155], v[56:59]
v_mfma_f32_16x16x32_bf16 v[60:63], a[112:115], v[156:159], v[60:63]
v_mfma_f32_16x16x32_bf16 v[64:67], a[116:119], v[144:147], v[64:67]
v_mfma_f32_16x16x32_bf16 v[68:71], a[116:119], v[148:151], v[68:71]
v_mfma_f32_16x16x32_bf16 v[72:75], a[116:119], v[152:155], v[72:75]
v_mfma_f32_16x16x32_bf16 v[76:79], a[116:119], v[156:159], v[76:79]
s_waitcnt lgkmcnt(0)
v_mfma_f32_16x16x32_bf16 v[32:35], a[120:123], v[128:131], v[32:35]
ds_read_b128 v[144:147], v188 offset:45056
v_mfma_f32_16x16x32_bf16 v[36:39], a[120:123], v[132:135], v[36:39]
ds_read_b128 v[148:151], v188 offset:45312
v_mfma_f32_16x16x32_bf16 v[40:43], a[120:123], v[136:139], v[40:43]
ds_read_b128 v[152:155], v189 offset:45056
v_mfma_f32_16x16x32_bf16 v[44:47], a[120:123], v[140:143], v[44:47]
ds_read_b128 v[156:159], v189 offset:45312
v_mfma_f32_16x16x32_bf16 v[48:51], a[124:127], v[128:131], v[48:51]
v_mfma_f32_16x16x32_bf16 v[52:55], a[124:127], v[132:135], v[52:55]
v_mfma_f32_16x16x32_bf16 v[56:59], a[124:127], v[136:139], v[56:59]
v_mfma_f32_16x16x32_bf16 v[60:63], a[124:127], v[140:143], v[60:63]
v_mfma_f32_16x16x32_bf16 v[64:67], a[128:131], v[128:131], v[64:67]
v_mfma_f32_16x16x32_bf16 v[68:71], a[128:131], v[132:135], v[68:71]
v_mfma_f32_16x16x32_bf16 v[72:75], a[128:131], v[136:139], v[72:75]
v_mfma_f32_16x16x32_bf16 v[76:79], a[128:131], v[140:143], v[76:79]
s_waitcnt vmcnt(7)
s_barrier
s_waitcnt lgkmcnt(0)
v_mfma_f32_16x16x32_bf16 v[32:35], a[132:135], v[144:147], v[32:35]
ds_read_b128 v[128:131], v188 offset:49152
v_mfma_f32_16x16x32_bf16 v[36:39], a[132:135], v[148:151], v[36:39]
ds_read_b128 v[132:135], v188 offset:49408
v_mfma_f32_16x16x32_bf16 v[40:43], a[132:135], v[152:155], v[40:43]
ds_read_b128 v[136:139], v189 offset:49152
v_mfma_f32_16x16x32_bf16 v[44:47], a[132:135], v[156:159], v[44:47]
ds_read_b128 v[140:143], v189 offset:49408
v_mfma_f32_16x16x32_bf16 v[48:51], a[136:139], v[144:147], v[48:51]
v_mfma_f32_16x16x32_bf16 v[52:55], a[136:139], v[148:151], v[52:55]
v_mfma_f32_16x16x32_bf16 v[56:59], a[136:139], v[152:155], v[56:59]
v_mfma_f32_16x16x32_bf16 v[60:63], a[136:139], v[156:159], v[60:63]
v_mfma_f32_16x16x32_bf16 v[64:67], a[140:143], v[144:147], v[64:67]
v_mfma_f32_16x16x32_bf16 v[68:71], a[140:143], v[148:151], v[68:71]
v_mfma_f32_16x16x32_bf16 v[72:75], a[140:143], v[152:155], v[72:75]
v_mfma_f32_16x16x32_bf16 v[76:79], a[140:143], v[156:159], v[76:79]
s_waitcnt vmcnt(0)
s_cmp_lg_u32 s16, 0
s_cbranch_scc1 P60
s_movk_i32 s77, 16
P61:
v_cmp_gt_u32 vcc, s77, v31
s_nop 1
s_cbranch_vccz P60
s_add_u32 s76, s76, 1
s_cmp_gt_u32 s76, 400000
s_cbranch_scc1 P60
s_sleep 4
buffer_load_dword v31, v6, s[8:11], s94 offen sc1
s_waitcnt vmcnt(0)
s_branch P61
P60:
s_barrier
s_add_u32 s28, s19, 16
s_lshl_b32 s28, s28, 6
v_add_u32 v29, s28, v0
v_lshlrev_b32 v29, 4, v29
s_mov_b32 s29, 37343232
buffer_load_dwordx4 v[192:195], v29, s[8:11], s29 offen sc1
s_add_u32 s29, s29, 32768
buffer_load_dwordx4 v[196:199], v29, s[8:11], s29 offen sc1
s_add_u32 s29, s29, 32768
buffer_load_dwordx4 v[200:203], v29, s[8:11], s29 offen sc1
s_add_u32 s29, s29, 32768
buffer_load_dwordx4 v[204:207], v29, s[8:11], s29 offen sc1
s_add_u32 s29, s29, 32768
buffer_load_dwordx4 v[208:211], v29, s[8:11], s29 offen sc1
s_add_u32 s29, s29, 32768
buffer_load_dwordx4 v[212:215], v29, s[8:11], s29 offen sc1
s_add_u32 s29, s29, 32768
buffer_load_dwordx4 v[216:219], v29, s[8:11], s29 offen sc1
s_add_u32 s29, s29, 32768
buffer_load_dwordx4 v[220:223], v29, s[8:11], s29 offen sc1
s_waitcnt lgkmcnt(0)
v_mfma_f32_16x16x32_bf16 v[32:35], a[144:147], v[128:131], v[32:35]
ds_read_b128 v[144:147], v188 offset:53248
v_mfma_f32_16x16x32_bf16 v[36:39], a[144:147], v[132:135], v[36:39]
ds_read_b128 v[148:151], v188 offset:53504
v_mfma_f32_16x16x32_bf16 v[40:43], a[144:147], v[136:139], v[40:43]
ds_read_b128 v[152:155], v189 offset:53248
v_mfma_f32_16x16x32_bf16 v[44:47], a[144:147], v[140:143], v[44:47]
ds_read_b128 v[156:159], v189 offset:53504
v_mfma_f32_16x16x32_bf16 v[48:51], a[148:151], v[128:131], v[48:51]
s_add_u32 s26, s19, 16
s_mul_i32 s26, s26, 81920
s_add_u32 s26, s26, 34459648
s_add_u32 s26, s26, s30
s_add_u32 m0, s30, 16384
s_nop 0
buffer_load_dwordx4 v1, s[8:11], s26 offen sc1 lds
buffer_load_dwordx4 v1, s[8:11], s26 offen offset:1024 sc1 lds
s_add_u32 s26, s26, 8192
v_mfma_f32_16x16x32_bf16 v[52:55], a[148:151], v[132:135], v[52:55]
v_mfma_f32_16x16x32_bf16 v[56:59], a[148:151], v[136:139], v[56:59]
v_mfma_f32_16x16x32_bf16 v[60:63], a[148:151], v[140:143], v[60:63]
s_add_u32 m0, s30, 24576
s_nop 0
buffer_load_dwordx4 v1, s[8:11], s26 offen sc1 lds
buffer_load_dwordx4 v1, s[8:11], s26 offen offset:1024 sc1 lds
s_add_u32 s26, s26, 8192
v_mfma_f32_16x16x32_bf16 v[64:67], a[152:155], v[128:131], v[64:67]
v_mfma_f32_16x16x32_bf16 v[68:71], a[152:155], v[132:135], v[68:71]
v_mfma_f32_16x16x32_bf16 v[72:75], a[152:155], v[136:139], v[72:75]
s_add_u32 m0, s30, 32768
s_nop 0
buffer_load_dwordx4 v1, s[8:11], s26 offen sc1 lds
buffer_load_dwordx4 v1, s[8:11], s26 offen offset:1024 sc1 lds
s_add_u32 s26, s26, 8192
v_mfma_f32_16x16x32_bf16 v[76:79], a[152:155], v[140:143], v[76:79]
s_barrier
s_waitcnt lgkmcnt(0)
v_mfma_f32_16x16x32_bf16 v[32:35], a[156:159], v[144:147], v[32:35]
ds_read_b128 v[128:131], v188 offset:57344
v_mfma_f32_16x16x32_bf16 v[36:39], a[156:159], v[148:151], v[36:39]
ds_read_b128 v[132:135], v188 offset:57600
v_mfma_f32_16x16x32_bf16 v[40:43], a[156:159], v[152:155], v[40:43]
ds_read_b128 v[136:139], v189 offset:57344
v_mfma_f32_16x16x32_bf16 v[44:47], a[156:159], v[156:159], v[44:47]
ds_read_b128 v[140:143], v189 offset:57600
v_mfma_f32_16x16x32_bf16 v[48:51], a[160:163], v[144:147], v[48:51]
s_add_u32 m0, s30, 40960
s_nop 0
buffer_load_dwordx4 v1, s[8:11], s26 offen sc1 lds
buffer_load_dwordx4 v1, s[8:11], s26 offen offset:1024 sc1 lds
s_add_u32 s26, s26, 8192
v_mfma_f32_16x16x32_bf16 v[52:55], a[160:163], v[148:151], v[52:55]
v_mfma_f32_16x16x32_bf16 v[56:59], a[160:163], v[152:155], v[56:59]
v_mfma_f32_16x16x32_bf16 v[60:63], a[160:163], v[156:159], v[60:63]
v_mfma_f32_16x16x32_bf16 v[64:67], a[164:167], v[144:147], v[64:67]
v_mfma_f32_16x16x32_bf16 v[68:71], a[164:167], v[148:151], v[68:71]
v_mfma_f32_16x16x32_bf16 v[72:75], a[164:167], v[152:155], v[72:75]
v_mfma_f32_16x16x32_bf16 v[76:79], a[164:167], v[156:159], v[76:79]
s_waitcnt lgkmcnt(0)
v_mfma_f32_16x16x32_bf16 v[32:35], a[168:171], v[128:131], v[32:35]
ds_read_b128 v[144:147], v188 offset:61440
v_mfma_f32_16x16x32_bf16 v[36:39], a[168:171], v[132:135], v[36:39]
ds_read_b128 v[148:151], v188 offset:61696
v_mfma_f32_16x16x32_bf16 v[40:43], a[168:171], v[136:139], v[40:43]
ds_read_b128 v[152:155], v189 offset:61440
v_mfma_f32_16x16x32_bf16 v[44:47], a[168:171], v[140:143], v[44:47]
ds_read_b128 v[156:159], v189 offset:61696
v_mfma_f32_16x16x32_bf16 v[48:51], a[172:175], v[128:131], v[48:51]
v_mfma_f32_16x16x32_bf16 v[52:55], a[172:175], v[132:135], v[52:55]
v_mfma_f32_16x16x32_bf16 v[56:59], a[172:175], v[136:139], v[56:59]
v_mfma_f32_16x16x32_bf16 v[60:63], a[172:175], v[140:143], v[60:63]
v_mfma_f32_16x16x32_bf16 v[64:67], a[176:179], v[128:131], v[64:67]
v_mfma_f32_16x16x32_bf16 v[68:71], a[176:179], v[132:135], v[68:71]
v_mfma_f32_16x16x32_bf16 v[72:75], a[176:179], v[136:139], v[72:75]
v_mfma_f32_16x16x32_bf16 v[76:79], a[176:179], v[140:143], v[76:79]
s_barrier
s_waitcnt lgkmcnt(0)
v_mfma_f32_16x16x32_bf16 v[32:35], a[180:183], v[144:147], v[32:35]
ds_read_b128 v[128:131], v188 offset:0
v_mfma_f32_16x16x32_bf16 v[36:39], a[180:183], v[148:151], v[36:39]
ds_read_b128 v[132:135], v188 offset:256
v_mfma_f32_16x16x32_bf16 v[40:43], a[180:183], v[152:155], v[40:43]
ds_read_b128 v[136:139], v189 offset:0
v_mfma_f32_16x16x32_bf16 v[44:47], a[180:183], v[156:159], v[44:47]
ds_read_b128 v[140:143], v189 offset:256
v_mfma_f32_16x16x32_bf16 v[48:51], a[184:187], v[144:147], v[48:51]
s_add_u32 m0, s30, 49152
s_nop 0
buffer_load_dwordx4 v1, s[8:11], s26 offen sc1 lds
buffer_load_dwordx4 v1, s[8:11], s26 offen offset:1024 sc1 lds
s_add_u32 s26, s26, 8192
v_mfma_f32_16x16x32_bf16 v[52:55], a[184:187], v[148:151], v[52:55]
s_waitcnt vmcnt(10)
v_mfma_f32_16x16x32_bf16 v[56:59], a[184:187], v[152:155], v[56:59]
v_add_f32 v192, v192, v208
v_mfma_f32_16x16x32_bf16 v[60:63], a[184:187], v[156:159], v[60:63]
v_mfma_f32_16x16x32_bf16 v[64:67], a[188:191], v[144:147], v[64:67]
v_add_f32 v193, v193, v209
v_mfma_f32_16x16x32_bf16 v[68:71], a[188:191], v[148:151], v[68:71]
v_add_f32 v194, v194, v210
v_mfma_f32_16x16x32_bf16 v[72:75], a[188:191], v[152:155], v[72:75]
v_mfma_f32_16x16x32_bf16 v[76:79], a[188:191], v[156:159], v[76:79]
v_add_f32 v195, v195, v211
s_waitcnt lgkmcnt(0)
v_mfma_f32_16x16x32_bf16 v[32:35], a[192:195], v[128:131], v[32:35]
ds_read_b128 v[144:147], v188 offset:4096
v_mfma_f32_16x16x32_bf16 v[36:39], a[192:195], v[132:135], v[36:39]
ds_read_b128 v[148:151], v188 offset:4352
v_mfma_f32_16x16x32_bf16 v[40:43], a[192:195], v[136:139], v[40:43]
ds_read_b128 v[152:155], v189 offset:4096
v_mfma_f32_16x16x32_bf16 v[44:47], a[192:195], v[140:143], v[44:47]
ds_read_b128 v[156:159], v189 offset:4352
v_mfma_f32_16x16x32_bf16 v[48:51], a[196:199], v[128:131], v[48:51]
v_mfma_f32_16x16x32_bf16 v[52:55], a[196:199], v[132:135], v[52:55]
v_add_f32 v196, v196, v212
v_mfma_f32_16x16x32_bf16 v[56:59], a[196:199], v[136:139], v[56:59]
v_add_f32 v197, v197, v213
v_mfma_f32_16x16x32_bf16 v[60:63], a[196:199], v[140:143], v[60:63]
v_mfma_f32_16x16x32_bf16 v[64:67], a[200:203], v[128:131], v[64:67]
v_add_f32 v198, v198, v214
v_mfma_f32_16x16x32_bf16 v[68:71], a[200:203], v[132:135], v[68:71]
v_add_f32 v199, v199, v215
v_mfma_f32_16x16x32_bf16 v[72:75], a[200:203], v[136:139], v[72:75]
v_mfma_f32_16x16x32_bf16 v[76:79], a[200:203], v[140:143], v[76:79]
v_add_f32 v200, v200, v216
s_barrier
s_waitcnt lgkmcnt(0)
v_mfma_f32_16x16x32_bf16 v[32:35], a[204:207], v[144:147], v[32:35]
ds_read_b128 v[128:131], v188 offset:8192
v_mfma_f32_16x16x32_bf16 v[36:39], a[204:207], v[148:151], v[36:39]
ds_read_b128 v[132:135], v188 offset:8448
v_mfma_f32_16x16x32_bf16 v[40:43], a[204:207], v[152:155], v[40:43]
ds_read_b128 v[136:139], v189 offset:8192
v_mfma_f32_16x16x32_bf16 v[44:47], a[204:207], v[156:159], v[44:47]
ds_read_b128 v[140:143], v189 offset:8448
v_mfma_f32_16x16x32_bf16 v[48:51], a[208:211], v[144:147], v[48:51]
s_add_u32 m0, s30, 57344
s_nop 0
buffer_load_dwordx4 v1, s[8:11], s26 offen sc1 lds
buffer_load_dwordx4 v1, s[8:11], s26 offen offset:1024 sc1 lds
s_add_u32 s26, s26, 8192
v_mfma_f32_16x16x32_bf16 v[52:55], a[208:211], v[148:151], v[52:55]
v_add_f32 v201, v201, v217
v_mfma_f32_16x16x32_bf16 v[56:59], a[208:211], v[152:155], v[56:59]
v_add_f32 v202, v202, v218
v_mfma_f32_16x16x32_bf16 v[60:63], a[208:211], v[156:159], v[60:63]
v_mfma_f32_16x16x32_bf16 v[64:67], a[212:215], v[144:147], v[64:67]
v_add_f32 v203, v203, v219
v_mfma_f32_16x16x32_bf16 v[68:71], a[212:215], v[148:151], v[68:71]
v_add_f32 v204, v204, v220
v_mfma_f32_16x16x32_bf16 v[72:75], a[212:215], v[152:155], v[72:75]
v_mfma_f32_16x16x32_bf16 v[76:79], a[212:215], v[156:159], v[76:79]
v_add_f32 v205, v205, v221
s_waitcnt lgkmcnt(0)
v_mfma_f32_16x16x32_bf16 v[32:35], a[216:219], v[128:131], v[32:35]
ds_read_b128 v[144:147], v188 offset:12288
v_mfma_f32_16x16x32_bf16 v[36:39], a[216:219], v[132:135], v[36:39]
ds_read_b128 v[148:151], v188 offset:12544
v_mfma_f32_16x16x32_bf16 v[40:43], a[216:219], v[136:139], v[40:43]
ds_read_b128 v[152:155], v189 offset:12288
v_mfma_f32_16x16x32_bf16 v[44:47], a[216:219], v[140:143], v[44:47]
ds_read_b128 v[156:159], v189 offset:12544
v_mfma_f32_16x16x32_bf16 v[48:51], a[220:223], v[128:131], v[48:51]
v_mfma_f32_16x16x32_bf16 v[52:55], a[220:223], v[132:135], v[52:55]
v_add_f32 v206, v206, v222
v_mfma_f32_16x16x32_bf16 v[56:59], a[220:223], v[136:139], v[56:59]
v_add_f32 v207, v207, v223
v_mfma_f32_16x16x32_bf16 v[60:63], a[220:223], v[140:143], v[60:63]
v_mfma_f32_16x16x32_bf16 v[64:67], a[224:227], v[128:131], v[64:67]
v_add_f32 v192, v192, v200
v_mfma_f32_16x16x32_bf16 v[68:71], a[224:227], v[132:135], v[68:71]
v_add_f32 v193, v193, v201
v_mfma_f32_16x16x32_bf16 v[72:75], a[224:227], v[136:139], v[72:75]
v_mfma_f32_16x16x32_bf16 v[76:79], a[224:227], v[140:143], v[76:79]
v_add_f32 v194, v194, v202
s_waitcnt vmcnt(10)
s_barrier
s_waitcnt lgkmcnt(0)
v_mfma_f32_16x16x32_bf16 v[32:35], a[228:231], v[144:147], v[32:35]
ds_read_b128 v[128:131], v188 offset:16384
v_mfma_f32_16x16x32_bf16 v[36:39], a[228:231], v[148:151], v[36:39]
ds_read_b128 v[132:135], v188 offset:16640
v_mfma_f32_16x16x32_bf16 v[40:43], a[228:231], v[152:155], v[40:43]
ds_read_b128 v[136:139], v189 offset:16384
v_mfma_f32_16x16x32_bf16 v[44:47], a[228:231], v[156:159], v[44:47]
ds_read_b128 v[140:143], v189 offset:16640
v_mfma_f32_16x16x32_bf16 v[48:51], a[232:235], v[144:147], v[48:51]
s_add_u32 m0, s30, 0
s_nop 0
buffer_load_dwordx4 v1, s[8:11], s26 offen sc1 lds
buffer_load_dwordx4 v1, s[8:11], s26 offen offset:1024 sc1 lds
s_add_u32 s26, s26, 8192
v_mfma_f32_16x16x32_bf16 v[52:55], a[232:235], v[148:151], v[52:55]
v_add_f32 v195, v195, v203
v_mfma_f32_16x16x32_bf16 v[56:59], a[232:235], v[152:155], v[56:59]
v_add_f32 v196, v196, v204
v_mfma_f32_16x16x32_bf16 v[60:63], a[232:235], v[156:159], v[60:63]
v_mfma_f32_16x16x32_bf16 v[64:67], a[236:239], v[144:147], v[64:67]
v_add_f32 v197, v197, v205
v_mfma_f32_16x16x32_bf16 v[68:71], a[236:239], v[148:151], v[68:71]
v_add_f32 v198, v198, v206
v_mfma_f32_16x16x32_bf16 v[72:75], a[236:239], v[152:155], v[72:75]
v_mfma_f32_16x16x32_bf16 v[76:79], a[236:239], v[156:159], v[76:79]
v_add_f32 v199, v199, v207
v_add_f32 v192, v192, v196
v_add_f32 v193, v193, v197
v_add_f32 v194, v194, v198
v_add_f32 v195, v195, v199
v_add_f32 v192, v192, v194
v_add_f32 v193, v193, v195
v_mul_f32 v28, 0x3acccccd, v192
v_mul_f32 v26, 0x3acccccd, v193
v_fma_f32 v26, -v28, v28, v26
v_max_f32 v26, 0, v26
v_add_f32 v26, 0x3727c5ac, v26
v_rsq_f32 v27, v26
s_nop 0
ds_bpermute_b32 v164, v240, v27
ds_bpermute_b32 v172, v240, v28
ds_bpermute_b32 v165, v241, v27
ds_bpermute_b32 v173, v241, v28
ds_bpermute_b32 v166, v242, v27
ds_bpermute_b32 v174, v242, v28
ds_bpermute_b32 v167, v243, v27
ds_bpermute_b32 v175, v243, v28
s_waitcnt lgkmcnt(0)
v_mul_f32_e64 v80, -v172, v176
v_mul_f32_e64 v81, -v172, v177
v_mul_f32_e64 v82, -v172, v178
v_mul_f32_e64 v83, -v172, v179
v_mul_f32_e64 v84, -v173, v176
v_mul_f32_e64 v85, -v173, v177
v_mul_f32_e64 v86, -v173, v178
v_mul_f32_e64 v87, -v173, v179
v_mul_f32_e64 v88, -v174, v176
v_mul_f32_e64 v89, -v174, v177
v_mul_f32_e64 v90, -v174, v178
v_mul_f32_e64 v91, -v174, v179
v_mul_f32_e64 v92, -v175, v176
v_mul_f32_e64 v93, -v175, v177
v_mul_f32_e64 v94, -v175, v178
v_mul_f32_e64 v95, -v175, v179
v_mul_f32_e64 v96, -v172, v180
v_mul_f32_e64 v97, -v172, v181
v_mul_f32_e64 v98, -v172, v182
v_mul_f32_e64 v99, -v172, v183
v_mul_f32_e64 v100, -v173, v180
v_mul_f32_e64 v101, -v173, v181
v_mul_f32_e64 v102, -v173, v182
v_mul_f32_e64 v103, -v173, v183
v_mul_f32_e64 v104, -v174, v180
v_mul_f32_e64 v105, -v174, v181
v_mul_f32_e64 v106, -v174, v182
v_mul_f32_e64 v107, -v174, v183
v_mul_f32_e64 v108, -v175, v180
v_mul_f32_e64 v109, -v175, v181
v_mul_f32_e64 v110, -v175, v182
v_mul_f32_e64 v111, -v175, v183
v_mul_f32_e64 v112, -v172, v184
v_mul_f32_e64 v113, -v172, v185
v_mul_f32_e64 v114, -v172, v186
v_mul_f32_e64 v115, -v172, v187
v_mul_f32_e64 v116, -v173, v184
v_mul_f32_e64 v117, -v173, v185
v_mul_f32_e64 v118, -v173, v186
v_mul_f32_e64 v119, -v173, v187
v_mul_f32_e64 v120, -v174, v184
v_mul_f32_e64 v121, -v174, v185
v_mul_f32_e64 v122, -v174, v186
v_mul_f32_e64 v123, -v174, v187
v_mul_f32_e64 v124, -v175, v184
v_mul_f32_e64 v125, -v175, v185
v_mul_f32_e64 v126, -v175, v186
v_mul_f32_e64 v127, -v175, v187
s_nop 3
v_mfma_f32_16x16x32_bf16 v[80:83], a[0:3], v[128:131], v[80:83]
ds_read_b128 v[144:147], v188 offset:20480
v_mfma_f32_16x16x32_bf16 v[84:87], a[0:3], v[132:135], v[84:87]
ds_read_b128 v[148:151], v188 offset:20736
v_mfma_f32_16x16x32_bf16 v[88:91], a[0:3], v[136:139], v[88:91]
ds_read_b128 v[152:155], v189 offset:20480
v_mfma_f32_16x16x32_bf16 v[92:95], a[0:3], v[140:143], v[92:95]
ds_read_b128 v[156:159], v189 offset:20736
s_mul_i32 s36, s25, 245760
s_mul_i32 s28, s16, 61440
s_add_u32 s36, s36, s28
s_add_u32 s36, s36, 7208960
buffer_load_dwordx4 a[0:3], v11, s[8:11], s36 offen offset:0
v_mfma_f32_16x16x32_bf16 v[96:99], a[4:7], v[128:131], v[96:99]
v_mfma_f32_16x16x32_bf16 v[100:103], a[4:7], v[132:135], v[100:103]
v_mul_f32 v32, v32, v160
v_mfma_f32_16x16x32_bf16 v[104:107], a[4:7], v[136:139], v[104:107]
v_mul_f32 v33, v33, v160
v_mfma_f32_16x16x32_bf16 v[108:111], a[4:7], v[140:143], v[108:111]
buffer_load_dwordx4 a[4:7], v11, s[8:11], s36 offen offset:256
v_mfma_f32_16x16x32_bf16 v[112:115], a[8:11], v[128:131], v[112:115]
v_mul_f32 v34, v34, v160
v_mfma_f32_16x16x32_bf16 v[116:119], a[8:11], v[132:135], v[116:119]
v_mul_f32 v35, v35, v160
v_mfma_f32_16x16x32_bf16 v[120:123], a[8:11], v[136:139], v[120:123]
v_mfma_f32_16x16x32_bf16 v[124:127], a[8:11], v[140:143], v[124:127]
v_mul_f32 v36, v36, v161
buffer_load_dwordx4 a[8:11], v11, s[8:11], s36 offen offset:512
s_waitcnt vmcnt(13)
s_barrier
s_waitcnt lgkmcnt(0)
v_mfma_f32_16x16x32_bf16 v[80:83], a[12:15], v[144:147], v[80:83]
ds_read_b128 v[128:131], v188 offset:24576
v_mfma_f32_16x16x32_bf16 v[84:87], a[12:15], v[148:151], v[84:87]
ds_read_b128 v[132:135], v188 offset:24832
v_mfma_f32_16x16x32_bf16 v[88:91], a[12:15], v[152:155], v[88:91]
ds_read_b128 v[136:139], v189 offset:24576
v_mfma_f32_16x16x32_bf16 v[92:95], a[12:15], v[156:159], v[92:95]
ds_read_b128 v[140:143], v189 offset:24832
buffer_load_dwordx4 a[12:15], v11, s[8:11], s36 offen offset:768
v_mfma_f32_16x16x32_bf16 v[96:99], a[16:19], v[144:147], v[96:99]
s_add_u32 m0, s30, 8192
s_nop 0
buffer_load_dwordx4 v1, s[8:11], s26 offen sc1 lds
buffer_load_dwordx4 v1, s[8:11], s26 offen offset:1024 sc1 lds
s_add_u32 s26, s26, 8192
v_mfma_f32_16x16x32_bf16 v[100:103], a[16:19], v[148:151], v[100:103]
v_mul_f32 v37, v37, v161
v_mfma_f32_16x16x32_bf16 v[104:107], a[16:19], v[152:155], v[104:107]
v_mul_f32 v38, v38, v161
v_mfma_f32_16x16x32_bf16 v[108:111], a[16:19], v[156:159], v[108:111]
buffer_load_dwordx4 a[16:19], v11, s[8:11], s36 offen offset:1024
v_mfma_f32_16x16x32_bf16 v[112:115], a[20:23], v[144:147], v[112:115]
v_mul_f32 v39, v39, v161
v_mfma_f32_16x16x32_bf16 v[116:119], a[20:23], v[148:151], v[116:119]
v_mul_f32 v40, v40, v162
v_mfma_f32_16x16x32_bf16 v[120:123], a[20:23], v[152:155], v[120:123]
v_mfma_f32_16x16x32_bf16 v[124:127], a[20:23], v[156:159], v[124:127]
v_mul_f32 v41, v41, v162
s_add_u32 s36, s36, 5120
buffer_load_dwordx4 a[20:23], v11, s[8:11], s36 offen offset:0
s_waitcnt lgkmcnt(0)
v_mfma_f32_16x16x32_bf16 v[80:83], a[24:27], v[128:131], v[80:83]
ds_read_b128 v[144:147], v188 offset:28672
v_mfma_f32_16x16x32_bf16 v[84:87], a[24:27], v[132:135], v[84:87]
ds_read_b128 v[148:151], v188 offset:28928
v_mfma_f32_16x16x32_bf16 v[88:91], a[24:27], v[136:139], v[88:91]
ds_read_b128 v[152:155], v189 offset:28672
v_mfma_f32_16x16x32_bf16 v[92:95], a[24:27], v[140:143], v[92:95]
ds_read_b128 v[156:159], v189 offset:28928
buffer_load_dwordx4 a[24:27], v11, s[8:11], s36 offen offset:256
v_mfma_f32_16x16x32_bf16 v[96:99], a[28:31], v[128:131], v[96:99]
v_mfma_f32_16x16x32_bf16 v[100:103], a[28:31], v[132:135], v[100:103]
v_mul_f32 v42, v42, v162
v_mfma_f32_16x16x32_bf16 v[104:107], a[28:31], v[136:139], v[104:107]
v_mul_f32 v43, v43, v162
v_mfma_f32_16x16x32_bf16 v[108:111], a[28:31], v[140:143], v[108:111]
buffer_load_dwordx4 a[28:31], v11, s[8:11], s36 offen offset:512
v_mfma_f32_16x16x32_bf16 v[112:115], a[32:35], v[128:131], v[112:115]
v_mul_f32 v44, v44, v163
v_mfma_f32_16x16x32_bf16 v[116:119], a[32:35], v[132:135], v[116:119]
v_mul_f32 v45, v45, v163
v_mfma_f32_16x16x32_bf16 v[120:123], a[32:35], v[136:139], v[120:123]
v_mfma_f32_16x16x32_bf16 v[124:127], a[32:35], v[140:143], v[124:127]
v_mul_f32 v46, v46, v163
buffer_load_dwordx4 a[32:35], v11, s[8:11], s36 offen offset:768
s_waitcnt vmcnt(19)
s_barrier
s_waitcnt lgkmcnt(0)
v_mfma_f32_16x16x32_bf16 v[80:83], a[36:39], v[144:147], v[80:83]
ds_read_b128 v[128:131], v188 offset:32768
v_mfma_f32_16x16x32_bf16 v[84:87], a[36:39], v[148:151], v[84:87]
ds_read_b128 v[132:135], v188 offset:33024
v_mfma_f32_16x16x32_bf16 v[88:91], a[36:39], v[152:155], v[88:91]
ds_read_b128 v[136:139], v189 offset:32768
v_mfma_f32_16x16x32_bf16 v[92:95], a[36:39], v[156:159], v[92:95]
ds_read_b128 v[140:143], v189 offset:33024
buffer_load_dwordx4 a[36:39], v11, s[8:11], s36 offen offset:1024
v_mfma_f32_16x16x32_bf16 v[96:99], a[40:43], v[144:147], v[96:99]
s_add_u32 m0, s30, 16384
s_nop 0
buffer_load_dwordx4 v1, s[8:11], s26 offen sc1 lds
buffer_load_dwordx4 v1, s[8:11], s26 offen offset:1024 sc1 lds
s_add_u32 s26, s26, 8192
v_mfma_f32_16x16x32_bf16 v[100:103], a[40:43], v[148:151], v[100:103]
v_mul_f32 v47, v47, v163
v_mfma_f32_16x16x32_bf16 v[104:107], a[40:43], v[152:155], v[104:107]
v_mul_f32 v48, v48, v160
v_mfma_f32_16x16x32_bf16 v[108:111], a[40:43], v[156:159], v[108:111]
s_add_u32 s36, s36, 5120
buffer_load_dwordx4 a[40:43], v11, s[8:11], s36 offen offset:0
v_mfma_f32_16x16x32_bf16 v[112:115], a[44:47], v[144:147], v[112:115]
v_mul_f32 v49, v49, v160
v_mfma_f32_16x16x32_bf16 v[116:119], a[44:47], v[148:151], v[116:119]
v_mul_f32 v50, v50, v160
v_mfma_f32_16x16x32_bf16 v[120:123], a[44:47], v[152:155], v[120:123]
v_mfma_f32_16x16x32_bf16 v[124:127], a[44:47], v[156:159], v[124:127]
v_mul_f32 v51, v51, v160
buffer_load_dwordx4 a[44:47], v11, s[8:11], s36 offen offset:256
s_waitcnt lgkmcnt(0)
v_mfma_f32_16x16x32_bf16 v[80:83], a[48:51], v[128:131], v[80:83]
ds_read_b128 v[144:147], v188 offset:36864
v_mfma_f32_16x16x32_bf16 v[84:87], a[48:51], v[132:135], v[84:87]
ds_read_b128 v[148:151], v188 offset:37120
v_mfma_f32_16x16x32_bf16 v[88:91], a[48:51], v[136:139], v[88:91]
ds_read_b128 v[152:155], v189 offset:36864
v_mfma_f32_16x16x32_bf16 v[92:95], a[48:51], v[140:143], v[92:95]
ds_read_b128 v[156:159], v189 offset:37120
buffer_load_dwordx4 a[48:51], v11, s[8:11], s36 offen offset:512
v_mfma_f32_16x16x32_bf16 v[96:99], a[52:55], v[128:131], v[96:99]
v_mfma_f32_16x16x32_bf16 v[100:103], a[52:55], v[132:135], v[100:103]
v_mul_f32 v52, v52, v161
v_mfma_f32_16x16x32_bf16 v[104:107], a[52:55], v[136:139], v[104:107]
v_mul_f32 v53, v53, v161
v_mfma_f32_16x16x32_bf16 v[108:111], a[52:55], v[140:143], v[108:111]
buffer_load_dwordx4 a[52:55], v11, s[8:11], s36 offen offset:768
v_mfma_f32_16x16x32_bf16 v[112:115], a[56:59], v[128:131], v[112:115]
v_mul_f32 v54, v54, v161
v_mfma_f32_16x16x32_bf16 v[116:119], a[56:59], v[132:135], v[116:119]
v_mul_f32 v55, v55, v161
v_mfma_f32_16x16x32_bf16 v[120:123], a[56:59], v[136:139], v[120:123]
v_mfma_f32_16x16x32_bf16 v[124:127], a[56:59], v[140:143], v[124:127]
v_mul_f32 v56, v56, v162
buffer_load_dwordx4 a[56:59], v11, s[8:11], s36 offen offset:1024
v_mul_f32 v57, v57, v162
v_mul_f32 v58, v58, v162
v_mul_f32 v59, v59, v162
v_mul_f32 v60, v60, v163
v_mul_f32 v61, v61, v163
v_mul_f32 v62, v62, v163
v_mul_f32 v63, v63, v163
v_mul_f32 v64, v64, v160
v_mul_f32 v65, v65, v160
v_mul_f32 v66, v66, v160
v_mul_f32 v67, v67, v160
v_mul_f32 v68, v68, v161
v_mul_f32 v69, v69, v161
v_mul_f32 v70, v70, v161
v_mul_f32 v71, v71, v161
v_mul_f32 v72, v72, v162
v_mul_f32 v73, v73, v162
v_mul_f32 v74, v74, v162
v_mul_f32 v75, v75, v162
v_mul_f32 v76, v76, v163
v_mul_f32 v77, v77, v163
v_mul_f32 v78, v78, v163
v_mul_f32 v79, v79, v163
s_mul_i32 s28, s16, 6144
s_add_u32 s28, s28, 65536
v_add_u32 v29, s28, v1
s_nop 0
ds_write_b128 v29, v[40:43] offset:0
ds_write_b128 v29, v[44:47] offset:1024
ds_write_b128 v29, v[56:59] offset:2048
ds_write_b128 v29, v[60:63] offset:3072
ds_write_b128 v29, v[72:75] offset:4096
ds_write_b128 v29, v[76:79] offset:5120
s_waitcnt lgkmcnt(0)
s_waitcnt vmcnt(25)
s_barrier
v_mfma_f32_16x16x32_bf16 v[80:83], a[60:63], v[144:147], v[80:83]
ds_read_b128 v[128:131], v188 offset:40960
v_mfma_f32_16x16x32_bf16 v[84:87], a[60:63], v[148:151], v[84:87]
ds_read_b128 v[132:135], v188 offset:41216
v_mfma_f32_16x16x32_bf16 v[88:91], a[60:63], v[152:155], v[88:91]
ds_read_b128 v[136:139], v189 offset:40960
v_mfma_f32_16x16x32_bf16 v[92:95], a[60:63], v[156:159], v[92:95]
ds_read_b128 v[140:143], v189 offset:41216
s_add_u32 s36, s36, 5120
buffer_load_dwordx4 a[60:63], v11, s[8:11], s36 offen offset:0
v_mfma_f32_16x16x32_bf16 v[96:99], a[64:67], v[144:147], v[96:99]
s_add_u32 m0, s30, 24576
s_nop 0
buffer_load_dwordx4 v1, s[8:11], s26 offen sc1 lds
buffer_load_dwordx4 v1, s[8:11], s26 offen offset:1024 sc1 lds
s_add_u32 s26, s26, 8192
v_mfma_f32_16x16x32_bf16 v[100:103], a[64:67], v[148:151], v[100:103]
s_xor_b32 s28, s16, 2
s_mul_i32 s28, s28, 6144
s_add_u32 s28, s28, 65536
v_add_u32 v29, s28, v1
s_nop 0
ds_read_b128 v[192:195], v29 offset:0
ds_read_b128 v[196:199], v29 offset:1024
ds_read_b128 v[200:203], v29 offset:2048
ds_read_b128 v[204:207], v29 offset:3072
ds_read_b128 v[208:211], v29 offset:4096
ds_read_b128 v[212:215], v29 offset:5120
v_lshrrev_b32 v28, 1, v5
v_lshlrev_b32 v28, 10, v28
v_and_b32 v27, 1, v5
v_lshl_add_u32 v28, v27, 8, v28
v_lshl_add_u32 v28, v4, 4, v28
s_lshr_b32 s28, s16, 1
s_lshl_b32 s28, s28, 9
v_add_u32 v28, s28, v28
s_add_u32 s28, s19, 0
s_mul_i32 s37, s28, 196608
s_mul_i32 s28, s21, 96
s_and_b32 s29, s16, 1
s_mul_i32 s29, s29, 48
s_add_u32 s28, s28, s29
s_lshl_b32 s28, s28, 7
s_add_u32 s37, s37, s28
s_add_u32 s37, s37, 48091136
s_waitcnt lgkmcnt(0)
v_mfma_f32_16x16x32_bf16 v[104:107], a[64:67], v[152:155], v[104:107]
v_mul_f32 v32, v32, v192
v_mfma_f32_16x16x32_bf16 v[108:111], a[64:67], v[156:159], v[108:111]
buffer_load_dwordx4 a[64:67], v11, s[8:11], s36 offen offset:256
v_mfma_f32_16x16x32_bf16 v[112:115], a[68:71], v[144:147], v[112:115]
v_mul_f32 v33, v33, v193
v_mfma_f32_16x16x32_bf16 v[116:119], a[68:71], v[148:151], v[116:119]
v_mul_f32 v34, v34, v194
v_mfma_f32_16x16x32_bf16 v[120:123], a[68:71], v[152:155], v[120:123]
v_mfma_f32_16x16x32_bf16 v[124:127], a[68:71], v[156:159], v[124:127]
v_mul_f32 v35, v35, v195
buffer_load_dwordx4 a[68:71], v11, s[8:11], s36 offen offset:512
v_mfma_f32_16x16x32_bf16 v[80:83], a[72:75], v[128:131], v[80:83]
ds_read_b128 v[144:147], v188 offset:45056
v_mfma_f32_16x16x32_bf16 v[84:87], a[72:75], v[132:135], v[84:87]
ds_read_b128 v[148:151], v188 offset:45312
v_mfma_f32_16x16x32_bf16 v[88:91], a[72:75], v[136:139], v[88:91]
ds_read_b128 v[152:155], v189 offset:45056
v_mfma_f32_16x16x32_bf16 v[92:95], a[72:75], v[140:143], v[92:95]
ds_read_b128 v[156:159], v189 offset:45312
buffer_load_dwordx4 a[72:75], v11, s[8:11], s36 offen offset:768
v_mfma_f32_16x16x32_bf16 v[96:99], a[76:79], v[128:131], v[96:99]
v_mfma_f32_16x16x32_bf16 v[100:103], a[76:79], v[132:135], v[100:103]
v_cvt_pk_bf16_f32 v16, v32, v33
v_mfma_f32_16x16x32_bf16 v[104:107], a[76:79], v[136:139], v[104:107]
v_cvt_pk_bf16_f32 v17, v34, v35
v_mfma_f32_16x16x32_bf16 v[108:111], a[76:79], v[140:143], v[108:111]
buffer_load_dwordx4 a[76:79], v11, s[8:11], s36 offen offset:1024
v_mfma_f32_16x16x32_bf16 v[112:115], a[80:83], v[128:131], v[112:115]
v_mul_f32 v36, v36, v196
v_mfma_f32_16x16x32_bf16 v[116:119], a[80:83], v[132:135], v[116:119]
v_mul_f32 v37, v37, v197
v_mfma_f32_16x16x32_bf16 v[120:123], a[80:83], v[136:139], v[120:123]
v_mfma_f32_16x16x32_bf16 v[124:127], a[80:83], v[140:143], v[124:127]
v_mul_f32 v38, v38, v198
s_add_u32 s36, s36, 5120
buffer_load_dwordx4 a[80:83], v11, s[8:11], s36 offen offset:0
s_waitcnt vmcnt(31)
s_barrier
s_waitcnt lgkmcnt(0)
v_mfma_f32_16x16x32_bf16 v[80:83], a[84:87], v[144:147], v[80:83]
ds_read_b128 v[128:131], v188 offset:49152
v_mfma_f32_16x16x32_bf16 v[84:87], a[84:87], v[148:151], v[84:87]
ds_read_b128 v[132:135], v188 offset:49408
v_mfma_f32_16x16x32_bf16 v[88:91], a[84:87], v[152:155], v[88:91]
ds_read_b128 v[136:139], v189 offset:49152
v_mfma_f32_16x16x32_bf16 v[92:95], a[84:87], v[156:159], v[92:95]
ds_read_b128 v[140:143], v189 offset:49408
buffer_load_dwordx4 a[84:87], v11, s[8:11], s36 offen offset:256
v_mfma_f32_16x16x32_bf16 v[96:99], a[88:91], v[144:147], v[96:99]
v_mfma_f32_16x16x32_bf16 v[100:103], a[88:91], v[148:151], v[100:103]
v_mul_f32 v39, v39, v199
v_mfma_f32_16x16x32_bf16 v[104:107], a[88:91], v[152:155], v[104:107]
v_cvt_pk_bf16_f32 v18, v36, v37
v_mfma_f32_16x16x32_bf16 v[108:111], a[88:91], v[156:159], v[108:111]
buffer_load_dwordx4 a[88:91], v11, s[8:11], s36 offen offset:512
v_mfma_f32_16x16x32_bf16 v[112:115], a[92:95], v[144:147], v[112:115]
v_cvt_pk_bf16_f32 v19, v38, v39
v_mfma_f32_16x16x32_bf16 v[116:119], a[92:95], v[148:151], v[116:119]
s_nop 0
s_nop 0
v_permlane16_swap_b32 v16, v18
v_permlane16_swap_b32 v17, v19
s_nop 0
buffer_store_dwordx4 v[16:19], v28, s[8:11], s37 offen offset:0 sc1
s_nop 0
v_mfma_f32_16x16x32_bf16 v[120:123], a[92:95], v[152:155], v[120:123]
v_mfma_f32_16x16x32_bf16 v[124:127], a[92:95], v[156:159], v[124:127]
v_mul_f32 v48, v48, v200
buffer_load_dwordx4 a[92:95], v11, s[8:11], s36 offen offset:768
s_waitcnt lgkmcnt(0)
v_mfma_f32_16x16x32_bf16 v[80:83], a[96:99], v[128:131], v[80:83]
ds_read_b128 v[144:147], v188 offset:53248
v_mfma_f32_16x16x32_bf16 v[84:87], a[96:99], v[132:135], v[84:87]
ds_read_b128 v[148:151], v188 offset:53504
v_mfma_f32_16x16x32_bf16 v[88:91], a[96:99], v[136:139], v[88:91]
ds_read_b128 v[152:155], v189 offset:53248
v_mfma_f32_16x16x32_bf16 v[92:95], a[96:99], v[140:143], v[92:95]
ds_read_b128 v[156:159], v189 offset:53504
buffer_load_dwordx4 a[96:99], v11, s[8:11], s36 offen offset:1024
v_mfma_f32_16x16x32_bf16 v[96:99], a[100:103], v[128:131], v[96:99]
v_mfma_f32_16x16x32_bf16 v[100:103], a[100:103], v[132:135], v[100:103]
v_mul_f32 v49, v49, v201
v_mfma_f32_16x16x32_bf16 v[104:107], a[100:103], v[136:139], v[104:107]
v_mul_f32 v50, v50, v202
v_mfma_f32_16x16x32_bf16 v[108:111], a[100:103], v[140:143], v[108:111]
s_add_u32 s36, s36, 5120
buffer_load_dwordx4 a[100:103], v11, s[8:11], s36 offen offset:0
v_mfma_f32_16x16x32_bf16 v[112:115], a[104:107], v[128:131], v[112:115]
v_mul_f32 v51, v51, v203
v_mfma_f32_16x16x32_bf16 v[116:119], a[104:107], v[132:135], v[116:119]
v_cvt_pk_bf16_f32 v20, v48, v49
v_mfma_f32_16x16x32_bf16 v[120:123], a[104:107], v[136:139], v[120:123]
v_mfma_f32_16x16x32_bf16 v[124:127], a[104:107], v[140:143], v[124:127]
v_cvt_pk_bf16_f32 v21, v50, v51
buffer_load_dwordx4 a[104:107], v11, s[8:11], s36 offen offset:256
v_mul_f32 v52, v52, v204
v_mul_f32 v53, v53, v205
v_mul_f32 v54, v54, v206
v_mul_f32 v55, v55, v207
v_cvt_pk_bf16_f32 v22, v52, v53
v_cvt_pk_bf16_f32 v23, v54, v55
s_nop 0
s_nop 0
v_permlane16_swap_b32 v20, v22
v_permlane16_swap_b32 v21, v23
s_nop 0
buffer_store_dwordx4 v[20:23], v28, s[8:11], s37 offen offset:2048 sc1
s_nop 0
v_mul_f32 v64, v64, v208
v_mul_f32 v65, v65, v209
v_mul_f32 v66, v66, v210
v_mul_f32 v67, v67, v211
v_cvt_pk_bf16_f32 v16, v64, v65
v_cvt_pk_bf16_f32 v17, v66, v67
v_mul_f32 v68, v68, v212
v_mul_f32 v69, v69, v213
v_mul_f32 v70, v70, v214
v_mul_f32 v71, v71, v215
v_cvt_pk_bf16_f32 v18, v68, v69
v_cvt_pk_bf16_f32 v19, v70, v71
s_add_u32 s37, s37, 4096
s_nop 0
v_permlane16_swap_b32 v16, v18
v_permlane16_swap_b32 v17, v19
s_nop 0
buffer_store_dwordx4 v[16:19], v28, s[8:11], s37 offen offset:0 sc1
s_nop 0
s_waitcnt vmcnt(38)
s_barrier
s_waitcnt lgkmcnt(0)
v_mfma_f32_16x16x32_bf16 v[80:83], a[108:111], v[144:147], v[80:83]
ds_read_b128 v[128:131], v188 offset:57344
v_mfma_f32_16x16x32_bf16 v[84:87], a[108:111], v[148:151], v[84:87]
ds_read_b128 v[132:135], v188 offset:57600
v_mfma_f32_16x16x32_bf16 v[88:91], a[108:111], v[152:155], v[88:91]
ds_read_b128 v[136:139], v189 offset:57344
v_mfma_f32_16x16x32_bf16 v[92:95], a[108:111], v[156:159], v[92:95]
ds_read_b128 v[140:143], v189 offset:57600
buffer_load_dwordx4 a[108:111], v11, s[8:11], s36 offen offset:512
v_mfma_f32_16x16x32_bf16 v[96:99], a[112:115], v[144:147], v[96:99]
v_mfma_f32_16x16x32_bf16 v[100:103], a[112:115], v[148:151], v[100:103]
v_mfma_f32_16x16x32_bf16 v[104:107], a[112:115], v[152:155], v[104:107]
v_mfma_f32_16x16x32_bf16 v[108:111], a[112:115], v[156:159], v[108:111]
buffer_load_dwordx4 a[112:115], v11, s[8:11], s36 offen offset:768
v_mfma_f32_16x16x32_bf16 v[112:115], a[116:119], v[144:147], v[112:115]
v_mfma_f32_16x16x32_bf16 v[116:119], a[116:119], v[148:151], v[116:119]
v_mfma_f32_16x16x32_bf16 v[120:123], a[116:119], v[152:155], v[120:123]
v_mfma_f32_16x16x32_bf16 v[124:127], a[116:119], v[156:159], v[124:127]
buffer_load_dwordx4 a[116:119], v11, s[8:11], s36 offen offset:1024
s_waitcnt lgkmcnt(0)
v_mfma_f32_16x16x32_bf16 v[80:83], a[120:123], v[128:131], v[80:83]
ds_read_b128 v[144:147], v188 offset:61440
v_mfma_f32_16x16x32_bf16 v[84:87], a[120:123], v[132:135], v[84:87]
ds_read_b128 v[148:151], v188 offset:61696
v_mfma_f32_16x16x32_bf16 v[88:91], a[120:123], v[136:139], v[88:91]
ds_read_b128 v[152:155], v189 offset:61440
v_mfma_f32_16x16x32_bf16 v[92:95], a[120:123], v[140:143], v[92:95]
ds_read_b128 v[156:159], v189 offset:61696
s_add_u32 s36, s36, 5120
buffer_load_dwordx4 a[120:123], v11, s[8:11], s36 offen offset:0
v_mfma_f32_16x16x32_bf16 v[96:99], a[124:127], v[128:131], v[96:99]
v_mfma_f32_16x16x32_bf16 v[100:103], a[124:127], v[132:135], v[100:103]
v_mfma_f32_16x16x32_bf16 v[104:107], a[124:127], v[136:139], v[104:107]
v_mfma_f32_16x16x32_bf16 v[108:111], a[124:127], v[140:143], v[108:111]
buffer_load_dwordx4 a[124:127], v11, s[8:11], s36 offen offset:256
v_mfma_f32_16x16x32_bf16 v[112:115], a[128:131], v[128:131], v[112:115]
v_mfma_f32_16x16x32_bf16 v[116:119], a[128:131], v[132:135], v[116:119]
v_mfma_f32_16x16x32_bf16 v[120:123], a[128:131], v[136:139], v[120:123]
v_mfma_f32_16x16x32_bf16 v[124:127], a[128:131], v[140:143], v[124:127]
buffer_load_dwordx4 a[128:131], v11, s[8:11], s36 offen offset:512
s_add_u32 s28, s19, 0
s_lshl_b32 s28, s28, 7
s_add_u32 s28, s28, 9250816
s_waitcnt vmcnt(6)
s_barrier
s_cmp_lg_u32 s16, 0
s_cbranch_scc1 S62
s_mov_b64 exec, 1
buffer_atomic_add v7, v6, s[8:11], s28 offen sc1
s_mov_b64 exec, -1
S62:
s_barrier
s_waitcnt lgkmcnt(0)
v_mfma_f32_16x16x32_bf16 v[80:83], a[132:135], v[144:147], v[80:83]
ds_read_b128 v[128:131], v188 offset:0
v_mfma_f32_16x16x32_bf16 v[84:87], a[132:135], v[148:151], v[84:87]
ds_read_b128 v[132:135], v188 offset:256
v_mfma_f32_16x16x32_bf16 v[88:91], a[132:135], v[152:155], v[88:91]
ds_read_b128 v[136:139], v189 offset:0
v_mfma_f32_16x16x32_bf16 v[92:95], a[132:135], v[156:159], v[92:95]
ds_read_b128 v[140:143], v189 offset:256
buffer_load_dwordx4 a[132:135], v11, s[8:11], s36 offen offset:768
v_mfma_f32_16x16x32_bf16 v[96:99], a[136:139], v[144:147], v[96:99]
v_mfma_f32_16x16x32_bf16 v[100:103], a[136:139], v[148:151], v[100:103]
v_mfma_f32_16x16x32_bf16 v[104:107], a[136:139], v[152:155], v[104:107]
v_mfma_f32_16x16x32_bf16 v[108:111], a[136:139], v[156:159], v[108:111]
buffer_load_dwordx4 a[136:139], v11, s[8:11], s36 offen offset:1024
v_mfma_f32_16x16x32_bf16 v[112:115], a[140:143], v[144:147], v[112:115]
v_mfma_f32_16x16x32_bf16 v[116:119], a[140:143], v[148:151], v[116:119]
v_mfma_f32_16x16x32_bf16 v[120:123], a[140:143], v[152:155], v[120:123]
v_mfma_f32_16x16x32_bf16 v[124:127], a[140:143], v[156:159], v[124:127]
s_add_u32 s36, s36, 5120
buffer_load_dwordx4 a[140:143], v11, s[8:11], s36 offen offset:0
s_waitcnt lgkmcnt(0)
v_mfma_f32_16x16x32_bf16 v[80:83], a[144:147], v[128:131], v[80:83]
ds_read_b128 v[144:147], v188 offset:4096
v_mfma_f32_16x16x32_bf16 v[84:87], a[144:147], v[132:135], v[84:87]
ds_read_b128 v[148:151], v188 offset:4352
v_mfma_f32_16x16x32_bf16 v[88:91], a[144:147], v[136:139], v[88:91]
ds_read_b128 v[152:155], v189 offset:4096
v_mfma_f32_16x16x32_bf16 v[92:95], a[144:147], v[140:143], v[92:95]
ds_read_b128 v[156:159], v189 offset:4352
buffer_load_dwordx4 a[144:147], v11, s[8:11], s36 offen offset:256
v_mfma_f32_16x16x32_bf16 v[96:99], a[148:151], v[128:131], v[96:99]
v_mfma_f32_16x16x32_bf16 v[100:103], a[148:151], v[132:135], v[100:103]
v_mfma_f32_16x16x32_bf16 v[104:107], a[148:151], v[136:139], v[104:107]
v_mfma_f32_16x16x32_bf16 v[108:111], a[148:151], v[140:143], v[108:111]
buffer_load_dwordx4 a[148:151], v11, s[8:11], s36 offen offset:512
v_mfma_f32_16x16x32_bf16 v[112:115], a[152:155], v[128:131], v[112:115]
v_mfma_f32_16x16x32_bf16 v[116:119], a[152:155], v[132:135], v[116:119]
v_mfma_f32_16x16x32_bf16 v[120:123], a[152:155], v[136:139], v[120:123]
v_mfma_f32_16x16x32_bf16 v[124:127], a[152:155], v[140:143], v[124:127]
buffer_load_dwordx4 a[152:155], v11, s[8:11], s36 offen offset:768
s_barrier
s_waitcnt lgkmcnt(0)
v_mfma_f32_16x16x32_bf16 v[80:83], a[156:159], v[144:147], v[80:83]
ds_read_b128 v[128:131], v188 offset:8192
v_mfma_f32_16x16x32_bf16 v[84:87], a[156:159], v[148:151], v[84:87]
ds_read_b128 v[132:135], v188 offset:8448
v_mfma_f32_16x16x32_bf16 v[88:91], a[156:159], v[152:155], v[88:91]
ds_read_b128 v[136:139], v189 offset:8192
v_mfma_f32_16x16x32_bf16 v[92:95], a[156:159], v[156:159], v[92:95]
ds_read_b128 v[140:143], v189 offset:8448
buffer_load_dwordx4 a[156:159], v11, s[8:11], s36 offen offset:1024
v_mfma_f32_16x16x32_bf16 v[96:99], a[160:163], v[144:147], v[96:99]
v_mfma_f32_16x16x32_bf16 v[100:103], a[160:163], v[148:151], v[100:103]
v_mfma_f32_16x16x32_bf16 v[104:107], a[160:163], v[152:155], v[104:107]
v_mfma_f32_16x16x32_bf16 v[108:111], a[160:163], v[156:159], v[108:111]
s_add_u32 s36, s36, 5120
buffer_load_dwordx4 a[160:163], v11, s[8:11], s36 offen offset:0
v_mfma_f32_16x16x32_bf16 v[112:115], a[164:167], v[144:147], v[112:115]
v_mfma_f32_16x16x32_bf16 v[116:119], a[164:167], v[148:151], v[116:119]
v_mfma_f32_16x16x32_bf16 v[120:123], a[164:167], v[152:155], v[120:123]
v_mfma_f32_16x16x32_bf16 v[124:127], a[164:167], v[156:159], v[124:127]
buffer_load_dwordx4 a[164:167], v11, s[8:11], s36 offen offset:256
s_and_b32 s28, s24, 1
s_lshl_b32 s28, s28, 5
s_and_b32 s29, s16, 1
s_lshl_b32 s29, s29, 4
s_add_u32 s28, s28, s29
v_add_u32 v225, s28, v4
s_lshr_b32 s28, s24, 1
s_add_u32 s28, s28, 0
s_mul_i32 s28, s28, 81920
s_mul_i32 s29, s25, 10240
s_add_u32 s28, s28, s29
s_add_u32 s28, s28, 34459648
v_lshrrev_b32 v28, 1, v5
v_lshlrev_b32 v28, 10, v28
v_and_b32 v29, 1, v5
v_lshl_add_u32 v28, v29, 3, v28
v_lshl_add_u32 v245, v225, 4, v28
s_lshr_b32 s29, s16, 1
s_mul_i32 s29, s29, 6144
s_add_u32 s28, s28, s29
buffer_load_dwordx2 v[248:249], v245, s[8:11], s28 offen sc1
buffer_load_dwordx2 v[250:251], v245, s[8:11], s28 offen offset:2048 sc1
s_lshr_b32 s29, s16, 1
s_lshl_b32 s29, s29, 11
s_sub_u32 s28, s28, s29
s_add_u32 s28, s28, 4096
buffer_load_dwordx2 v[252:253], v245, s[8:11], s28 offen sc1
s_waitcnt lgkmcnt(0)
v_mfma_f32_16x16x32_bf16 v[80:83], a[168:171], v[128:131], v[80:83]
ds_read_b128 v[144:147], v188 offset:12288
v_mfma_f32_16x16x32_bf16 v[84:87], a[168:171], v[132:135], v[84:87]
ds_read_b128 v[148:151], v188 offset:12544
v_mfma_f32_16x16x32_bf16 v[88:91], a[168:171], v[136:139], v[88:91]
ds_read_b128 v[152:155], v189 offset:12288
v_mfma_f32_16x16x32_bf16 v[92:95], a[168:171], v[140:143], v[92:95]
ds_read_b128 v[156:159], v189 offset:12544
buffer_load_dwordx4 a[168:171], v11, s[8:11], s36 offen offset:512
v_mfma_f32_16x16x32_bf16 v[96:99], a[172:175], v[128:131], v[96:99]
v_mfma_f32_16x16x32_bf16 v[100:103], a[172:175], v[132:135], v[100:103]
v_mfma_f32_16x16x32_bf16 v[104:107], a[172:175], v[136:139], v[104:107]
v_mfma_f32_16x16x32_bf16 v[108:111], a[172:175], v[140:143], v[108:111]
buffer_load_dwordx4 a[172:175], v11, s[8:11], s36 offen offset:768
v_mfma_f32_16x16x32_bf16 v[112:115], a[176:179], v[128:131], v[112:115]
v_mfma_f32_16x16x32_bf16 v[116:119], a[176:179], v[132:135], v[116:119]
v_mfma_f32_16x16x32_bf16 v[120:123], a[176:179], v[136:139], v[120:123]
v_mfma_f32_16x16x32_bf16 v[124:127], a[176:179], v[140:143], v[124:127]
buffer_load_dwordx4 a[176:179], v11, s[8:11], s36 offen offset:1024
s_barrier
s_waitcnt lgkmcnt(0)
v_mfma_f32_16x16x32_bf16 v[80:83], a[180:183], v[144:147], v[80:83]
ds_read_b128 v[128:131], v188 offset:16384
v_mfma_f32_16x16x32_bf16 v[84:87], a[180:183], v[148:151], v[84:87]
ds_read_b128 v[132:135], v188 offset:16640
v_mfma_f32_16x16x32_bf16 v[88:91], a[180:183], v[152:155], v[88:91]
ds_read_b128 v[136:139], v189 offset:16384
v_mfma_f32_16x16x32_bf16 v[92:95], a[180:183], v[156:159], v[92:95]
ds_read_b128 v[140:143], v189 offset:16640
s_add_u32 s36, s36, 5120
buffer_load_dwordx4 a[180:183], v11, s[8:11], s36 offen offset:0
v_mfma_f32_16x16x32_bf16 v[96:99], a[184:187], v[144:147], v[96:99]
v_mfma_f32_16x16x32_bf16 v[100:103], a[184:187], v[148:151], v[100:103]
v_mfma_f32_16x16x32_bf16 v[104:107], a[184:187], v[152:155], v[104:107]
v_mfma_f32_16x16x32_bf16 v[108:111], a[184:187], v[156:159], v[108:111]
buffer_load_dwordx4 a[184:187], v11, s[8:11], s36 offen offset:256
v_mfma_f32_16x16x32_bf16 v[112:115], a[188:191], v[144:147], v[112:115]
v_mfma_f32_16x16x32_bf16 v[116:119], a[188:191], v[148:151], v[116:119]
v_mfma_f32_16x16x32_bf16 v[120:123], a[188:191], v[152:155], v[120:123]
v_mfma_f32_16x16x32_bf16 v[124:127], a[188:191], v[156:159], v[124:127]
buffer_load_dwordx4 a[188:191], v11, s[8:11], s36 offen offset:512
s_lshr_b32 s29, s24, 1
s_lshl_b32 s29, s29, 7
s_add_u32 s94, s29, 9250816
buffer_load_dword v31, v6, s[8:11], s94 offen sc1
s_waitcnt lgkmcnt(0)
v_mfma_f32_16x16x32_bf16 v[80:83], a[192:195], v[128:131], v[80:83]
ds_read_b128 v[144:147], v188 offset:20480
v_mfma_f32_16x16x32_bf16 v[84:87], a[192:195], v[132:135], v[84:87]
ds_read_b128 v[148:151], v188 offset:20736
v_mfma_f32_16x16x32_bf16 v[88:91], a[192:195], v[136:139], v[88:91]
ds_read_b128 v[152:155], v189 offset:20480
v_mfma_f32_16x16x32_bf16 v[92:95], a[192:195], v[140:143], v[92:95]
ds_read_b128 v[156:159], v189 offset:20736
buffer_load_dwordx4 a[192:195], v11, s[8:11], s36 offen offset:768
v_mfma_f32_16x16x32_bf16 v[96:99], a[196:199], v[128:131], v[96:99]
v_mfma_f32_16x16x32_bf16 v[100:103], a[196:199], v[132:135], v[100:103]
v_mfma_f32_16x16x32_bf16 v[104:107], a[196:199], v[136:139], v[104:107]
v_mfma_f32_16x16x32_bf16 v[108:111], a[196:199], v[140:143], v[108:111]
buffer_load_dwordx4 a[196:199], v11, s[8:11], s36 offen offset:1024
v_mfma_f32_16x16x32_bf16 v[112:115], a[200:203], v[128:131], v[112:115]
v_mfma_f32_16x16x32_bf16 v[116:119], a[200:203], v[132:135], v[116:119]
v_mfma_f32_16x16x32_bf16 v[120:123], a[200:203], v[136:139], v[120:123]
v_mfma_f32_16x16x32_bf16 v[124:127], a[200:203], v[140:143], v[124:127]
s_add_u32 s36, s36, 5120
buffer_load_dwordx4 a[200:203], v11, s[8:11], s36 offen offset:0
s_barrier
s_waitcnt lgkmcnt(0)
v_mfma_f32_16x16x32_bf16 v[80:83], a[204:207], v[144:147], v[80:83]
ds_read_b128 v[128:131], v188 offset:24576
v_mfma_f32_16x16x32_bf16 v[84:87], a[204:207], v[148:151], v[84:87]
ds_read_b128 v[132:135], v188 offset:24832
v_mfma_f32_16x16x32_bf16 v[88:91], a[204:207], v[152:155], v[88:91]
ds_read_b128 v[136:139], v189 offset:24576
v_mfma_f32_16x16x32_bf16 v[92:95], a[204:207], v[156:159], v[92:95]
ds_read_b128 v[140:143], v189 offset:24832
buffer_load_dwordx4 a[204:207], v11, s[8:11], s36 offen offset:256
v_mfma_f32_16x16x32_bf16 v[96:99], a[208:211], v[144:147], v[96:99]
v_mfma_f32_16x16x32_bf16 v[100:103], a[208:211], v[148:151], v[100:103]
v_mfma_f32_16x16x32_bf16 v[104:107], a[208:211], v[152:155], v[104:107]
v_mfma_f32_16x16x32_bf16 v[108:111], a[208:211], v[156:159], v[108:111]
buffer_load_dwordx4 a[208:211], v11, s[8:11], s36 offen offset:512
v_mfma_f32_16x16x32_bf16 v[112:115], a[212:215], v[144:147], v[112:115]
v_mfma_f32_16x16x32_bf16 v[116:119], a[212:215], v[148:151], v[116:119]
v_mfma_f32_16x16x32_bf16 v[120:123], a[212:215], v[152:155], v[120:123]
v_mfma_f32_16x16x32_bf16 v[124:127], a[212:215], v[156:159], v[124:127]
buffer_load_dwordx4 a[212:215], v11, s[8:11], s36 offen offset:768
s_waitcnt lgkmcnt(0)
v_mfma_f32_16x16x32_bf16 v[80:83], a[216:219], v[128:131], v[80:83]
ds_read_b128 v[144:147], v188 offset:28672
v_mfma_f32_16x16x32_bf16 v[84:87], a[216:219], v[132:135], v[84:87]
ds_read_b128 v[148:151], v188 offset:28928
v_mfma_f32_16x16x32_bf16 v[88:91], a[216:219], v[136:139], v[88:91]
ds_read_b128 v[152:155], v189 offset:28672
v_mfma_f32_16x16x32_bf16 v[92:95], a[216:219], v[140:143], v[92:95]
ds_read_b128 v[156:159], v189 offset:28928
buffer_load_dwordx4 a[216:219], v11, s[8:11], s36 offen offset:1024
v_mfma_f32_16x16x32_bf16 v[96:99], a[220:223], v[128:131], v[96:99]
v_mfma_f32_16x16x32_bf16 v[100:103], a[220:223], v[132:135], v[100:103]
v_mfma_f32_16x16x32_bf16 v[104:107], a[220:223], v[136:139], v[104:107]
v_mfma_f32_16x16x32_bf16 v[108:111], a[220:223], v[140:143], v[108:111]
s_add_u32 s36, s36, 5120
buffer_load_dwordx4 a[220:223], v11, s[8:11], s36 offen offset:0
v_mfma_f32_16x16x32_bf16 v[112:115], a[224:227], v[128:131], v[112:115]
v_mfma_f32_16x16x32_bf16 v[116:119], a[224:227], v[132:135], v[116:119]
v_mfma_f32_16x16x32_bf16 v[120:123], a[224:227], v[136:139], v[120:123]
v_mfma_f32_16x16x32_bf16 v[124:127], a[224:227], v[140:143], v[124:127]
buffer_load_dwordx4 a[224:227], v11, s[8:11], s36 offen offset:256
s_waitcnt vmcnt(9)
s_cmp_lg_u32 s16, 0
s_cbranch_scc1 P63
s_movk_i32 s77, 16
P64:
v_cmp_gt_u32 vcc, s77, v31
s_nop 1
s_cbranch_vccz P63
s_add_u32 s76, s76, 1
s_cmp_gt_u32 s76, 400000
s_cbranch_scc1 P63
s_sleep 4
buffer_load_dword v31, v6, s[8:11], s94 offen sc1
s_waitcnt vmcnt(0)
s_branch P64
P63:
s_barrier
s_lshr_b32 s28, s24, 1
s_add_u32 s28, s28, 0
s_mul_i32 s87, s28, 196608
s_add_u32 s87, s87, 48091136
s_mul_i32 s28, s16, 49152
s_add_u32 s87, s87, s28
s_and_b32 s28, s24, 1
s_lshl_b32 s28, s28, 9
s_add_u32 s87, s87, s28
s_and_b32 s28, s16, 1
s_lshl_b32 s28, s28, 8
v_add_u32 v254, s28, v10
s_xor_b32 s28, s28, 256
v_add_u32 v247, s28, v10
buffer_load_dwordx4 v[32:35], v254, s[8:11], s87 offen sc1
buffer_load_dwordx4 v[36:39], v247, s[8:11], s87 offen sc1
s_add_u32 s87, s87, 4096
buffer_load_dwordx4 v[40:43], v254, s[8:11], s87 offen sc1
buffer_load_dwordx4 v[44:47], v247, s[8:11], s87 offen sc1
s_add_u32 s87, s87, 4096
buffer_load_dwordx4 v[48:51], v254, s[8:11], s87 offen sc1
buffer_load_dwordx4 v[52:55], v247, s[8:11], s87 offen sc1
s_add_u32 s87, s87, 4096
buffer_load_dwordx4 v[56:59], v254, s[8:11], s87 offen sc1
buffer_load_dwordx4 v[60:63], v247, s[8:11], s87 offen sc1
s_add_u32 s87, s87, 4096
buffer_load_dwordx4 v[64:67], v254, s[8:11], s87 offen sc1
buffer_load_dwordx4 v[68:71], v247, s[8:11], s87 offen sc1
s_add_u32 s87, s87, 4096
buffer_load_dwordx4 v[72:75], v254, s[8:11], s87 offen sc1
buffer_load_dwordx4 v[76:79], v247, s[8:11], s87 offen sc1
s_add_u32 s87, s87, 4096
s_waitcnt lgkmcnt(0)
v_mfma_f32_16x16x32_bf16 v[80:83], a[228:231], v[144:147], v[80:83]
v_mfma_f32_16x16x32_bf16 v[84:87], a[228:231], v[148:151], v[84:87]
v_mfma_f32_16x16x32_bf16 v[88:91], a[228:231], v[152:155], v[88:91]
v_mfma_f32_16x16x32_bf16 v[92:95], a[228:231], v[156:159], v[92:95]
buffer_load_dwordx4 a[228:231], v11, s[8:11], s36 offen offset:512
v_mfma_f32_16x16x32_bf16 v[96:99], a[232:235], v[144:147], v[96:99]
v_mfma_f32_16x16x32_bf16 v[100:103], a[232:235], v[148:151], v[100:103]
v_mfma_f32_16x16x32_bf16 v[104:107], a[232:235], v[152:155], v[104:107]
v_mfma_f32_16x16x32_bf16 v[108:111], a[232:235], v[156:159], v[108:111]
buffer_load_dwordx4 a[232:235], v11, s[8:11], s36 offen offset:768
v_mfma_f32_16x16x32_bf16 v[112:115], a[236:239], v[144:147], v[112:115]
v_mfma_f32_16x16x32_bf16 v[116:119], a[236:239], v[148:151], v[116:119]
v_mfma_f32_16x16x32_bf16 v[120:123], a[236:239], v[152:155], v[120:123]
v_mfma_f32_16x16x32_bf16 v[124:127], a[236:239], v[156:159], v[124:127]
buffer_load_dwordx4 a[236:239], v11, s[8:11], s36 offen offset:1024
s_nop 5
v_mul_f32 v80, v80, v164
v_mul_f32 v81, v81, v164
v_mul_f32 v82, v82, v164
v_mul_f32 v83, v83, v164
v_mul_f32 v84, v84, v165
v_mul_f32 v85, v85, v165
v_mul_f32 v86, v86, v165
v_mul_f32 v87, v87, v165
v_mul_f32 v88, v88, v166
v_mul_f32 v89, v89, v166
v_mul_f32 v90, v90, v166
v_mul_f32 v91, v91, v166
v_mul_f32 v92, v92, v167
v_mul_f32 v93, v93, v167
v_mul_f32 v94, v94, v167
v_mul_f32 v95, v95, v167
v_mul_f32 v96, v96, v164
v_mul_f32 v97, v97, v164
v_mul_f32 v98, v98, v164
v_mul_f32 v99, v99, v164
v_mul_f32 v100, v100, v165
v_mul_f32 v101, v101, v165
v_mul_f32 v102, v102, v165
v_mul_f32 v103, v103, v165
v_mul_f32 v104, v104, v166
v_mul_f32 v105, v105, v166
v_mul_f32 v106, v106, v166
v_mul_f32 v107, v107, v166
v_mul_f32 v108, v108, v167
v_mul_f32 v109, v109, v167
v_mul_f32 v110, v110, v167
v_mul_f32 v111, v111, v167
v_mul_f32 v112, v112, v164
v_mul_f32 v113, v113, v164
v_mul_f32 v114, v114, v164
v_mul_f32 v115, v115, v164
v_mul_f32 v116, v116, v165
v_mul_f32 v117, v117, v165
v_mul_f32 v118, v118, v165
v_mul_f32 v119, v119, v165
v_mul_f32 v120, v120, v166
v_mul_f32 v121, v121, v166
v_mul_f32 v122, v122, v166
v_mul_f32 v123, v123, v166
v_mul_f32 v124, v124, v167
v_mul_f32 v125, v125, v167
v_mul_f32 v126, v126, v167
v_mul_f32 v127, v127, v167
s_mul_i32 s28, s16, 6144
s_add_u32 s28, s28, 65536
v_add_u32 v29, s28, v1
s_nop 0
ds_write_b128 v29, v[88:91] offset:0
ds_write_b128 v29, v[92:95] offset:1024
ds_write_b128 v29, v[104:107] offset:2048
ds_write_b128 v29, v[108:111] offset:3072
ds_write_b128 v29, v[120:123] offset:4096
ds_write_b128 v29, v[124:127] offset:5120
s_waitcnt lgkmcnt(0)
s_barrier
s_xor_b32 s28, s16, 2
s_mul_i32 s28, s28, 6144
s_add_u32 s28, s28, 65536
v_add_u32 v29, s28, v1
s_nop 0
ds_read_b128 v[192:195], v29 offset:0
ds_read_b128 v[196:199], v29 offset:1024
ds_read_b128 v[200:203], v29 offset:2048
ds_read_b128 v[204:207], v29 offset:3072
ds_read_b128 v[208:211], v29 offset:4096
ds_read_b128 v[212:215], v29 offset:5120
v_lshrrev_b32 v28, 1, v5
v_lshlrev_b32 v28, 10, v28
v_and_b32 v27, 1, v5
v_lshl_add_u32 v28, v27, 8, v28
v_lshl_add_u32 v28, v4, 4, v28
s_lshr_b32 s28, s16, 1
s_lshl_b32 s28, s28, 9
v_add_u32 v28, s28, v28
s_add_u32 s28, s19, 16
s_mul_i32 s37, s28, 196608
s_mul_i32 s28, s21, 96
s_and_b32 s29, s16, 1
s_mul_i32 s29, s29, 48
s_add_u32 s28, s28, s29
s_lshl_b32 s28, s28, 7
s_add_u32 s37, s37, s28
s_add_u32 s37, s37, 48091136
s_waitcnt lgkmcnt(0)
v_mul_f32 v80, v80, v192
v_mul_f32 v81, v81, v193
v_mul_f32 v82, v82, v194
v_mul_f32 v83, v83, v195
v_cvt_pk_bf16_f32 v16, v80, v81
v_cvt_pk_bf16_f32 v17, v82, v83
v_mul_f32 v84, v84, v196
v_mul_f32 v85, v85, v197
v_mul_f32 v86, v86, v198
v_mul_f32 v87, v87, v199
v_cvt_pk_bf16_f32 v18, v84, v85
v_cvt_pk_bf16_f32 v19, v86, v87
s_nop 0
s_nop 0
v_permlane16_swap_b32 v16, v18
v_permlane16_swap_b32 v17, v19
s_nop 0
buffer_store_dwordx4 v[16:19], v28, s[8:11], s37 offen offset:0 sc1
s_nop 0
v_mul_f32 v96, v96, v200
v_mul_f32 v97, v97, v201
v_mul_f32 v98, v98, v202
v_mul_f32 v99, v99, v203
v_cvt_pk_bf16_f32 v20, v96, v97
v_cvt_pk_bf16_f32 v21, v98, v99
v_mul_f32 v100, v100, v204
v_mul_f32 v101, v101, v205
v_mul_f32 v102, v102, v206
v_mul_f32 v103, v103, v207
v_cvt_pk_bf16_f32 v22, v100, v101
v_cvt_pk_bf16_f32 v23, v102, v103
s_nop 0
s_nop 0
v_permlane16_swap_b32 v20, v22
v_permlane16_swap_b32 v21, v23
s_nop 0
buffer_store_dwordx4 v[20:23], v28, s[8:11], s37 offen offset:2048 sc1
s_nop 0
v_mul_f32 v112, v112, v208
v_mul_f32 v113, v113, v209
v_mul_f32 v114, v114, v210
v_mul_f32 v115, v115, v211
v_cvt_pk_bf16_f32 v16, v112, v113
v_cvt_pk_bf16_f32 v17, v114, v115
v_mul_f32 v116, v116, v212
v_mul_f32 v117, v117, v213
v_mul_f32 v118, v118, v214
v_mul_f32 v119, v119, v215
v_cvt_pk_bf16_f32 v18, v116, v117
v_cvt_pk_bf16_f32 v19, v118, v119
s_add_u32 s37, s37, 4096
s_nop 0
v_permlane16_swap_b32 v16, v18
v_permlane16_swap_b32 v17, v19
s_nop 0
buffer_store_dwordx4 v[16:19], v28, s[8:11], s37 offen offset:0 sc1
s_nop 0
buffer_load_dwordx4 v[80:83], v254, s[8:11], s87 offen sc1
buffer_load_dwordx4 v[84:87], v247, s[8:11], s87 offen sc1
s_add_u32 s87, s87, 4096
buffer_load_dwordx4 v[88:91], v254, s[8:11], s87 offen sc1
buffer_load_dwordx4 v[92:95], v247, s[8:11], s87 offen sc1
s_add_u32 s87, s87, 4096
buffer_load_dwordx4 v[96:99], v254, s[8:11], s87 offen sc1
buffer_load_dwordx4 v[100:103], v247, s[8:11], s87 offen sc1
s_add_u32 s87, s87, 4096
buffer_load_dwordx4 v[104:107], v254, s[8:11], s87 offen sc1
buffer_load_dwordx4 v[108:111], v247, s[8:11], s87 offen sc1
s_add_u32 s87, s87, 4096
buffer_load_dwordx4 v[112:115], v254, s[8:11], s87 offen sc1
buffer_load_dwordx4 v[116:119], v247, s[8:11], s87 offen sc1
s_add_u32 s87, s87, 4096
buffer_load_dwordx4 v[120:123], v254, s[8:11], s87 offen sc1
buffer_load_dwordx4 v[124:127], v247, s[8:11], s87 offen sc1
s_add_u32 s87, s87, 4096
s_and_b32 s28, s24, 1
s_lshl_b32 s28, s28, 5
s_and_b32 s29, s16, 1
s_lshl_b32 s29, s29, 4
s_add_u32 s28, s28, s29
v_add_u32 v244, s28, v4
s_lshr_b32 s28, s24, 1
s_add_u32 s28, s28, 16
s_mul_i32 s28, s28, 81920
s_mul_i32 s29, s25, 10240
s_add_u32 s28, s28, s29
s_add_u32 s28, s28, 34459648
v_lshrrev_b32 v28, 1, v5
v_lshlrev_b32 v28, 10, v28
v_and_b32 v29, 1, v5
v_lshl_add_u32 v28, v29, 3, v28
v_lshl_add_u32 v246, v244, 4, v28
s_lshr_b32 s29, s16, 1
s_mul_i32 s29, s29, 6144
s_add_u32 s28, s28, s29
buffer_load_dwordx2 v[232:233], v246, s[8:11], s28 offen sc1
buffer_load_dwordx2 v[234:235], v246, s[8:11], s28 offen offset:2048 sc1
s_lshr_b32 s29, s16, 1
s_lshl_b32 s29, s29, 11
s_sub_u32 s28, s28, s29
s_add_u32 s28, s28, 4096
buffer_load_dwordx2 v[236:237], v246, s[8:11], s28 offen sc1
s_waitcnt vmcnt(31)
v_mfma_f32_16x16x32_bf16 v[184:187], a[0:3], v[32:35], 0
v_mfma_f32_16x16x32_bf16 v[204:207], a[0:3], v[36:39], 0
v_mfma_f32_16x16x32_bf16 v[188:191], a[4:7], v[32:35], 0
v_mfma_f32_16x16x32_bf16 v[208:211], a[4:7], v[36:39], 0
v_mfma_f32_16x16x32_bf16 v[192:195], a[8:11], v[32:35], 0
v_mfma_f32_16x16x32_bf16 v[212:215], a[8:11], v[36:39], 0
v_mfma_f32_16x16x32_bf16 v[196:199], a[12:15], v[32:35], 0
v_mfma_f32_16x16x32_bf16 v[216:219], a[12:15], v[36:39], 0
v_mfma_f32_16x16x32_bf16 v[200:203], a[16:19], v[32:35], 0
v_mfma_f32_16x16x32_bf16 v[220:223], a[16:19], v[36:39], 0
s_add_u32 s28, s19, 16
s_lshl_b32 s28, s28, 7
s_add_u32 s28, s28, 9250816
s_waitcnt vmcnt(15)
s_barrier
s_cmp_lg_u32 s16, 0
s_cbranch_scc1 S65
s_mov_b64 exec, 1
buffer_atomic_add v7, v6, s[8:11], s28 offen sc1
s_mov_b64 exec, -1
S65:
v_mfma_f32_16x16x32_bf16 v[184:187], a[20:23], v[40:43], v[184:187]
v_mfma_f32_16x16x32_bf16 v[204:207], a[20:23], v[44:47], v[204:207]
v_mfma_f32_16x16x32_bf16 v[188:191], a[24:27], v[40:43], v[188:191]
v_mfma_f32_16x16x32_bf16 v[208:211], a[24:27], v[44:47], v[208:211]
v_mfma_f32_16x16x32_bf16 v[192:195], a[28:31], v[40:43], v[192:195]
v_mfma_f32_16x16x32_bf16 v[212:215], a[28:31], v[44:47], v[212:215]
v_mfma_f32_16x16x32_bf16 v[196:199], a[32:35], v[40:43], v[196:199]
v_mfma_f32_16x16x32_bf16 v[216:219], a[32:35], v[44:47], v[216:219]
v_mfma_f32_16x16x32_bf16 v[200:203], a[36:39], v[40:43], v[200:203]
v_mfma_f32_16x16x32_bf16 v[220:223], a[36:39], v[44:47], v[220:223]
v_mfma_f32_16x16x32_bf16 v[184:187], a[40:43], v[48:51], v[184:187]
v_mfma_f32_16x16x32_bf16 v[204:207], a[40:43], v[52:55], v[204:207]
v_mfma_f32_16x16x32_bf16 v[188:191], a[44:47], v[48:51], v[188:191]
v_mfma_f32_16x16x32_bf16 v[208:211], a[44:47], v[52:55], v[208:211]
v_mfma_f32_16x16x32_bf16 v[192:195], a[48:51], v[48:51], v[192:195]
v_mfma_f32_16x16x32_bf16 v[212:215], a[48:51], v[52:55], v[212:215]
v_mfma_f32_16x16x32_bf16 v[196:199], a[52:55], v[48:51], v[196:199]
v_mfma_f32_16x16x32_bf16 v[216:219], a[52:55], v[52:55], v[216:219]
v_mfma_f32_16x16x32_bf16 v[200:203], a[56:59], v[48:51], v[200:203]
v_mfma_f32_16x16x32_bf16 v[220:223], a[56:59], v[52:55], v[220:223]
v_mfma_f32_16x16x32_bf16 v[184:187], a[60:63], v[56:59], v[184:187]
v_mfma_f32_16x16x32_bf16 v[204:207], a[60:63], v[60:63], v[204:207]
v_mfma_f32_16x16x32_bf16 v[188:191], a[64:67], v[56:59], v[188:191]
v_mfma_f32_16x16x32_bf16 v[208:211], a[64:67], v[60:63], v[208:211]
v_mfma_f32_16x16x32_bf16 v[192:195], a[68:71], v[56:59], v[192:195]
v_mfma_f32_16x16x32_bf16 v[212:215], a[68:71], v[60:63], v[212:215]
v_mfma_f32_16x16x32_bf16 v[196:199], a[72:75], v[56:59], v[196:199]
v_mfma_f32_16x16x32_bf16 v[216:219], a[72:75], v[60:63], v[216:219]
v_mfma_f32_16x16x32_bf16 v[200:203], a[76:79], v[56:59], v[200:203]
v_mfma_f32_16x16x32_bf16 v[220:223], a[76:79], v[60:63], v[220:223]
v_mfma_f32_16x16x32_bf16 v[184:187], a[80:83], v[64:67], v[184:187]
v_mfma_f32_16x16x32_bf16 v[204:207], a[80:83], v[68:71], v[204:207]
v_mfma_f32_16x16x32_bf16 v[188:191], a[84:87], v[64:67], v[188:191]
v_mfma_f32_16x16x32_bf16 v[208:211], a[84:87], v[68:71], v[208:211]
v_mfma_f32_16x16x32_bf16 v[192:195], a[88:91], v[64:67], v[192:195]
v_mfma_f32_16x16x32_bf16 v[212:215], a[88:91], v[68:71], v[212:215]
v_mfma_f32_16x16x32_bf16 v[196:199], a[92:95], v[64:67], v[196:199]
v_mfma_f32_16x16x32_bf16 v[216:219], a[92:95], v[68:71], v[216:219]
v_mfma_f32_16x16x32_bf16 v[200:203], a[96:99], v[64:67], v[200:203]
v_mfma_f32_16x16x32_bf16 v[220:223], a[96:99], v[68:71], v[220:223]
v_mfma_f32_16x16x32_bf16 v[184:187], a[100:103], v[72:75], v[184:187]
v_mfma_f32_16x16x32_bf16 v[204:207], a[100:103], v[76:79], v[204:207]
v_mfma_f32_16x16x32_bf16 v[188:191], a[104:107], v[72:75], v[188:191]
v_mfma_f32_16x16x32_bf16 v[208:211], a[104:107], v[76:79], v[208:211]
v_mfma_f32_16x16x32_bf16 v[192:195], a[108:111], v[72:75], v[192:195]
v_mfma_f32_16x16x32_bf16 v[212:215], a[108:111], v[76:79], v[212:215]
v_mfma_f32_16x16x32_bf16 v[196:199], a[112:115], v[72:75], v[196:199]
v_mfma_f32_16x16x32_bf16 v[216:219], a[112:115], v[76:79], v[216:219]
v_mfma_f32_16x16x32_bf16 v[200:203], a[116:119], v[72:75], v[200:203]
v_mfma_f32_16x16x32_bf16 v[220:223], a[116:119], v[76:79], v[220:223]
s_waitcnt vmcnt(13)
v_mfma_f32_16x16x32_bf16 v[184:187], a[120:123], v[80:83], v[184:187]
v_mfma_f32_16x16x32_bf16 v[204:207], a[120:123], v[84:87], v[204:207]
v_mfma_f32_16x16x32_bf16 v[188:191], a[124:127], v[80:83], v[188:191]
v_mfma_f32_16x16x32_bf16 v[208:211], a[124:127], v[84:87], v[208:211]
v_mfma_f32_16x16x32_bf16 v[192:195], a[128:131], v[80:83], v[192:195]
v_mfma_f32_16x16x32_bf16 v[212:215], a[128:131], v[84:87], v[212:215]
v_mfma_f32_16x16x32_bf16 v[196:199], a[132:135], v[80:83], v[196:199]
v_mfma_f32_16x16x32_bf16 v[216:219], a[132:135], v[84:87], v[216:219]
v_mfma_f32_16x16x32_bf16 v[200:203], a[136:139], v[80:83], v[200:203]
v_mfma_f32_16x16x32_bf16 v[220:223], a[136:139], v[84:87], v[220:223]
s_waitcnt vmcnt(11)
v_mfma_f32_16x16x32_bf16 v[184:187], a[140:143], v[88:91], v[184:187]
v_mfma_f32_16x16x32_bf16 v[204:207], a[140:143], v[92:95], v[204:207]
v_mfma_f32_16x16x32_bf16 v[188:191], a[144:147], v[88:91], v[188:191]
v_mfma_f32_16x16x32_bf16 v[208:211], a[144:147], v[92:95], v[208:211]
v_mfma_f32_16x16x32_bf16 v[192:195], a[148:151], v[88:91], v[192:195]
v_mfma_f32_16x16x32_bf16 v[212:215], a[148:151], v[92:95], v[212:215]
v_mfma_f32_16x16x32_bf16 v[196:199], a[152:155], v[88:91], v[196:199]
v_mfma_f32_16x16x32_bf16 v[216:219], a[152:155], v[92:95], v[216:219]
v_mfma_f32_16x16x32_bf16 v[200:203], a[156:159], v[88:91], v[200:203]
v_mfma_f32_16x16x32_bf16 v[220:223], a[156:159], v[92:95], v[220:223]
s_waitcnt vmcnt(9)
v_mfma_f32_16x16x32_bf16 v[184:187], a[160:163], v[96:99], v[184:187]
v_mfma_f32_16x16x32_bf16 v[204:207], a[160:163], v[100:103], v[204:207]
v_mfma_f32_16x16x32_bf16 v[188:191], a[164:167], v[96:99], v[188:191]
v_mfma_f32_16x16x32_bf16 v[208:211], a[164:167], v[100:103], v[208:211]
v_mfma_f32_16x16x32_bf16 v[192:195], a[168:171], v[96:99], v[192:195]
v_mfma_f32_16x16x32_bf16 v[212:215], a[168:171], v[100:103], v[212:215]
v_mfma_f32_16x16x32_bf16 v[196:199], a[172:175], v[96:99], v[196:199]
v_mfma_f32_16x16x32_bf16 v[216:219], a[172:175], v[100:103], v[216:219]
v_mfma_f32_16x16x32_bf16 v[200:203], a[176:179], v[96:99], v[200:203]
v_mfma_f32_16x16x32_bf16 v[220:223], a[176:179], v[100:103], v[220:223]
s_waitcnt vmcnt(7)
v_mfma_f32_16x16x32_bf16 v[184:187], a[180:183], v[104:107], v[184:187]
v_mfma_f32_16x16x32_bf16 v[204:207], a[180:183], v[108:111], v[204:207]
v_mfma_f32_16x16x32_bf16 v[188:191], a[184:187], v[104:107], v[188:191]
v_mfma_f32_16x16x32_bf16 v[208:211], a[184:187], v[108:111], v[208:211]
v_mfma_f32_16x16x32_bf16 v[192:195], a[188:191], v[104:107], v[192:195]
v_mfma_f32_16x16x32_bf16 v[212:215], a[188:191], v[108:111], v[212:215]
v_mfma_f32_16x16x32_bf16 v[196:199], a[192:195], v[104:107], v[196:199]
v_mfma_f32_16x16x32_bf16 v[216:219], a[192:195], v[108:111], v[216:219]
v_mfma_f32_16x16x32_bf16 v[200:203], a[196:199], v[104:107], v[200:203]
v_mfma_f32_16x16x32_bf16 v[220:223], a[196:199], v[108:111], v[220:223]
s_lshr_b32 s29, s24, 1
s_add_u32 s29, s29, 16
s_lshl_b32 s29, s29, 7
s_add_u32 s94, s29, 9250816
buffer_load_dword v31, v6, s[8:11], s94 offen sc1
s_waitcnt vmcnt(6)
v_mfma_f32_16x16x32_bf16 v[184:187], a[200:203], v[112:115], v[184:187]
v_mfma_f32_16x16x32_bf16 v[204:207], a[200:203], v[116:119], v[204:207]
v_mfma_f32_16x16x32_bf16 v[188:191], a[204:207], v[112:115], v[188:191]
v_mfma_f32_16x16x32_bf16 v[208:211], a[204:207], v[116:119], v[208:211]
v_mfma_f32_16x16x32_bf16 v[192:195], a[208:211], v[112:115], v[192:195]
v_mfma_f32_16x16x32_bf16 v[212:215], a[208:211], v[116:119], v[212:215]
v_mfma_f32_16x16x32_bf16 v[196:199], a[212:215], v[112:115], v[196:199]
v_mfma_f32_16x16x32_bf16 v[216:219], a[212:215], v[116:119], v[216:219]
v_mfma_f32_16x16x32_bf16 v[200:203], a[216:219], v[112:115], v[200:203]
v_mfma_f32_16x16x32_bf16 v[220:223], a[216:219], v[116:119], v[220:223]
s_waitcnt vmcnt(4)
v_mfma_f32_16x16x32_bf16 v[184:187], a[220:223], v[120:123], v[184:187]
v_mfma_f32_16x16x32_bf16 v[204:207], a[220:223], v[124:127], v[204:207]
v_mfma_f32_16x16x32_bf16 v[188:191], a[224:227], v[120:123], v[188:191]
v_mfma_f32_16x16x32_bf16 v[208:211], a[224:227], v[124:127], v[208:211]
v_mfma_f32_16x16x32_bf16 v[192:195], a[228:231], v[120:123], v[192:195]
v_mfma_f32_16x16x32_bf16 v[212:215], a[228:231], v[124:127], v[212:215]
v_mfma_f32_16x16x32_bf16 v[196:199], a[232:235], v[120:123], v[196:199]
v_mfma_f32_16x16x32_bf16 v[216:219], a[232:235], v[124:127], v[216:219]
v_mfma_f32_16x16x32_bf16 v[200:203], a[236:239], v[120:123], v[200:203]
v_mfma_f32_16x16x32_bf16 v[220:223], a[236:239], v[124:127], v[220:223]
s_waitcnt vmcnt(0)
s_cmp_lg_u32 s16, 0
s_cbranch_scc1 P66
s_movk_i32 s77, 16
P67:
v_cmp_gt_u32 vcc, s77, v31
s_nop 1
s_cbranch_vccz P66
s_add_u32 s76, s76, 1
s_cmp_gt_u32 s76, 400000
s_cbranch_scc1 P66
s_sleep 4
buffer_load_dword v31, v6, s[8:11], s94 offen sc1
s_waitcnt vmcnt(0)
s_branch P67
P66:
s_barrier
s_lshr_b32 s28, s24, 1
s_add_u32 s28, s28, 16
s_mul_i32 s87, s28, 196608
s_add_u32 s87, s87, 48091136
s_mul_i32 s28, s16, 49152
s_add_u32 s87, s87, s28
s_and_b32 s28, s24, 1
s_lshl_b32 s28, s28, 9
s_add_u32 s87, s87, s28
s_and_b32 s28, s16, 1
s_lshl_b32 s28, s28, 8
v_add_u32 v254, s28, v10
s_xor_b32 s28, s28, 256
v_add_u32 v247, s28, v10
buffer_load_dwordx4 v[128:131], v254, s[8:11], s87 offen sc1
buffer_load_dwordx4 v[132:135], v247, s[8:11], s87 offen sc1
s_add_u32 s87, s87, 4096
buffer_load_dwordx4 v[136:139], v254, s[8:11], s87 offen sc1
buffer_load_dwordx4 v[140:143], v247, s[8:11], s87 offen sc1
s_add_u32 s87, s87, 4096
buffer_load_dwordx4 v[144:147], v254, s[8:11], s87 offen sc1
buffer_load_dwordx4 v[148:151], v247, s[8:11], s87 offen sc1
s_add_u32 s87, s87, 4096
buffer_load_dwordx4 v[152:155], v254, s[8:11], s87 offen sc1
buffer_load_dwordx4 v[156:159], v247, s[8:11], s87 offen sc1
s_add_u32 s87, s87, 4096
buffer_load_dwordx4 v[160:163], v254, s[8:11], s87 offen sc1
buffer_load_dwordx4 v[164:167], v247, s[8:11], s87 offen sc1
s_add_u32 s87, s87, 4096
buffer_load_dwordx4 v[168:171], v254, s[8:11], s87 offen sc1
buffer_load_dwordx4 v[172:175], v247, s[8:11], s87 offen sc1
s_add_u32 s87, s87, 4096
buffer_load_dwordx4 v[176:179], v254, s[8:11], s87 offen sc1
buffer_load_dwordx4 v[180:183], v247, s[8:11], s87 offen sc1
s_add_u32 s87, s87, 4096
buffer_load_dwordx4 v[32:35], v254, s[8:11], s87 offen sc1
buffer_load_dwordx4 v[36:39], v247, s[8:11], s87 offen sc1
s_add_u32 s87, s87, 4096
buffer_load_dwordx4 v[40:43], v254, s[8:11], s87 offen sc1
buffer_load_dwordx4 v[44:47], v247, s[8:11], s87 offen sc1
s_add_u32 s87, s87, 4096
buffer_load_dwordx4 v[48:51], v254, s[8:11], s87 offen sc1
buffer_load_dwordx4 v[52:55], v247, s[8:11], s87 offen sc1
s_add_u32 s87, s87, 4096
buffer_load_dwordx4 v[56:59], v254, s[8:11], s87 offen sc1
buffer_load_dwordx4 v[60:63], v247, s[8:11], s87 offen sc1
s_add_u32 s87, s87, 4096
buffer_load_dwordx4 v[64:67], v254, s[8:11], s87 offen sc1
buffer_load_dwordx4 v[68:71], v247, s[8:11], s87 offen sc1
s_add_u32 s87, s87, 4096
s_lshr_b32 s28, s24, 1
s_add_u32 s28, s28, 0
s_mul_i32 s88, s28, 81920
s_mul_i32 s29, s25, 10240
s_add_u32 s88, s88, s29
s_barrier
s_mul_i32 s28, s16, 10240
s_add_u32 s28, s28, 0
s_and_b32 s29, s16, 1
s_mul_i32 s29, s29, 5120
s_add_u32 s90, s28, s29
v_add_u32 v24, s90, v1
s_xor_b32 s29, s29, 5120
s_add_u32 s90, s28, s29
v_add_u32 v25, s90, v1
s_cmp_ge_u32 s16, 2
s_cbranch_scc1 V69
s_nop 1
ds_write_b128 v25, v[204:207] offset:0
ds_write_b128 v25, v[208:211] offset:1024
ds_write_b128 v25, v[212:215] offset:2048
ds_write_b128 v24, v[196:199] offset:3072
ds_write_b128 v25, v[216:219] offset:3072
ds_write_b128 v24, v[200:203] offset:4096
ds_write_b128 v25, v[220:223] offset:4096
s_waitcnt lgkmcnt(0)
s_barrier
s_add_u32 s28, s16, 1
s_and_b32 s28, s28, 3
s_mul_i32 s28, s28, 10240
s_and_b32 s29, s16, 1
s_mul_i32 s29, s29, 5120
s_add_u32 s28, s28, s29
s_add_u32 s28, s28, 0
v_add_u32 v26, s28, v1
ds_read_b128 v[72:75], v26 offset:0
ds_read_b128 v[76:79], v26 offset:1024
ds_read_b128 v[80:83], v26 offset:2048
s_add_u32 s28, s16, 2
s_and_b32 s28, s28, 3
s_mul_i32 s28, s28, 10240
s_and_b32 s29, s16, 1
s_mul_i32 s29, s29, 5120
s_add_u32 s28, s28, s29
s_add_u32 s28, s28, 0
v_add_u32 v26, s28, v1
ds_read_b128 v[84:87], v26 offset:0
ds_read_b128 v[88:91], v26 offset:1024
ds_read_b128 v[92:95], v26 offset:2048
s_add_u32 s28, s16, 3
s_and_b32 s28, s28, 3
s_mul_i32 s28, s28, 10240
s_and_b32 s29, s16, 1
s_mul_i32 s29, s29, 5120
s_add_u32 s28, s28, s29
s_add_u32 s28, s28, 0
v_add_u32 v26, s28, v1
ds_read_b128 v[96:99], v26 offset:0
ds_read_b128 v[100:103], v26 offset:1024
ds_read_b128 v[104:107], v26 offset:2048
s_waitcnt lgkmcnt(6)
v_add_f32 v184, v184, v72
v_add_f32 v185, v185, v73
v_add_f32 v186, v186, v74
v_add_f32 v187, v187, v75
v_add_f32 v188, v188, v76
v_add_f32 v189, v189, v77
v_add_f32 v190, v190, v78
v_add_f32 v191, v191, v79
v_add_f32 v192, v192, v80
v_add_f32 v193, v193, v81
v_add_f32 v194, v194, v82
v_add_f32 v195, v195, v83
s_waitcnt lgkmcnt(3)
v_add_f32 v184, v184, v84
v_add_f32 v185, v185, v85
v_add_f32 v186, v186, v86
v_add_f32 v187, v187, v87
v_add_f32 v188, v188, v88
v_add_f32 v189, v189, v89
v_add_f32 v190, v190, v90
v_add_f32 v191, v191, v91
v_add_f32 v192, v192, v92
v_add_f32 v193, v193, v93
v_add_f32 v194, v194, v94
v_add_f32 v195, v195, v95
s_waitcnt lgkmcnt(0)
v_add_f32 v184, v184, v96
v_add_f32 v185, v185, v97
v_add_f32 v186, v186, v98
v_add_f32 v187, v187, v99
v_add_f32 v188, v188, v100
v_add_f32 v189, v189, v101
v_add_f32 v190, v190, v102
v_add_f32 v191, v191, v103
v_add_f32 v192, v192, v104
v_add_f32 v193, v193, v105
v_add_f32 v194, v194, v106
v_add_f32 v195, v195, v107
v_lshlrev_b32 v26, 16, v248
v_and_b32 v27, 0xffff0000, v248
v_add_f32 v184, v184, v26
v_add_f32 v185, v185, v27
v_cvt_pk_bf16_f32 v248, v184, v185
v_lshlrev_b32 v26, 16, v249
v_and_b32 v27, 0xffff0000, v249
v_add_f32 v186, v186, v26
v_add_f32 v187, v187, v27
v_cvt_pk_bf16_f32 v249, v186, v187
v_lshlrev_b32 v26, 16, v250
v_and_b32 v27, 0xffff0000, v250
v_add_f32 v188, v188, v26
v_add_f32 v189, v189, v27
v_cvt_pk_bf16_f32 v250, v188, v189
v_lshlrev_b32 v26, 16, v251
v_and_b32 v27, 0xffff0000, v251
v_add_f32 v190, v190, v26
v_add_f32 v191, v191, v27
v_cvt_pk_bf16_f32 v251, v190, v191
v_lshlrev_b32 v26, 16, v252
v_and_b32 v27, 0xffff0000, v252
v_add_f32 v192, v192, v26
v_add_f32 v193, v193, v27
v_cvt_pk_bf16_f32 v252, v192, v193
v_lshlrev_b32 v26, 16, v253
v_and_b32 v27, 0xffff0000, v253
v_add_f32 v194, v194, v26
v_add_f32 v195, v195, v27
v_cvt_pk_bf16_f32 v253, v194, v195
s_lshr_b32 s28, s24, 1
s_add_u32 s28, s28, 0
s_lshl_b32 s28, s28, 6
v_add_u32 v28, s28, v225
s_movk_i32 s29, 1280
v_mul_lo_u32 v28, v28, s29
s_mul_i32 s91, s25, 160
v_lshl_add_u32 v29, v5, 3, v28
buffer_store_dwordx2 v[252:253], v29, s[12:15], s91 offen offset:64
v_and_b32 v29, 1, v5
v_lshlrev_b32 v29, 1, v29
v_lshrrev_b32 v30, 1, v5
v_add_u32 v29, v29, v30
v_lshl_add_u32 v29, v29, 4, v28
v_permlane16_swap_b32 v248, v250
v_permlane16_swap_b32 v249, v251
s_nop 0
buffer_store_dwordx4 v[248:251], v29, s[12:15], s91 offen offset:0
s_branch V68
V69:
s_nop 1
ds_write_b128 v24, v[184:187] offset:0
ds_write_b128 v25, v[204:207] offset:0
ds_write_b128 v24, v[188:191] offset:1024
ds_write_b128 v25, v[208:211] offset:1024
ds_write_b128 v24, v[192:195] offset:2048
ds_write_b128 v25, v[212:215] offset:2048
ds_write_b128 v25, v[216:219] offset:3072
ds_write_b128 v25, v[220:223] offset:4096
s_waitcnt lgkmcnt(0)
s_barrier
s_add_u32 s28, s16, 1
s_and_b32 s28, s28, 3
s_mul_i32 s28, s28, 10240
s_and_b32 s29, s16, 1
s_mul_i32 s29, s29, 5120
s_add_u32 s28, s28, s29
s_add_u32 s28, s28, 0
v_add_u32 v26, s28, v1
ds_read_b128 v[72:75], v26 offset:3072
ds_read_b128 v[76:79], v26 offset:4096
s_add_u32 s28, s16, 2
s_and_b32 s28, s28, 3
s_mul_i32 s28, s28, 10240
s_and_b32 s29, s16, 1
s_mul_i32 s29, s29, 5120
s_add_u32 s28, s28, s29
s_add_u32 s28, s28, 0
v_add_u32 v26, s28, v1
ds_read_b128 v[84:87], v26 offset:3072
ds_read_b128 v[88:91], v26 offset:4096
s_add_u32 s28, s16, 3
s_and_b32 s28, s28, 3
s_mul_i32 s28, s28, 10240
s_and_b32 s29, s16, 1
s_mul_i32 s29, s29, 5120
s_add_u32 s28, s28, s29
s_add_u32 s28, s28, 0
v_add_u32 v26, s28, v1
ds_read_b128 v[96:99], v26 offset:3072
ds_read_b128 v[100:103], v26 offset:4096
s_waitcnt lgkmcnt(4)
v_add_f32 v196, v196, v72
v_add_f32 v197, v197, v73
v_add_f32 v198, v198, v74
v_add_f32 v199, v199, v75
v_add_f32 v200, v200, v76
v_add_f32 v201, v201, v77
v_add_f32 v202, v202, v78
v_add_f32 v203, v203, v79
s_waitcnt lgkmcnt(2)
v_add_f32 v196, v196, v84
v_add_f32 v197, v197, v85
v_add_f32 v198, v198, v86
v_add_f32 v199, v199, v87
v_add_f32 v200, v200, v88
v_add_f32 v201, v201, v89
v_add_f32 v202, v202, v90
v_add_f32 v203, v203, v91
s_waitcnt lgkmcnt(0)
v_add_f32 v196, v196, v96
v_add_f32 v197, v197, v97
v_add_f32 v198, v198, v98
v_add_f32 v199, v199, v99
v_add_f32 v200, v200, v100
v_add_f32 v201, v201, v101
v_add_f32 v202, v202, v102
v_add_f32 v203, v203, v103
v_lshlrev_b32 v26, 16, v248
v_and_b32 v27, 0xffff0000, v248
v_add_f32 v196, v196, v26
v_add_f32 v197, v197, v27
v_cvt_pk_bf16_f32 v248, v196, v197
v_lshlrev_b32 v26, 16, v249
v_and_b32 v27, 0xffff0000, v249
v_add_f32 v198, v198, v26
v_add_f32 v199, v199, v27
v_cvt_pk_bf16_f32 v249, v198, v199
v_lshlrev_b32 v26, 16, v250
v_and_b32 v27, 0xffff0000, v250
v_add_f32 v200, v200, v26
v_add_f32 v201, v201, v27
v_cvt_pk_bf16_f32 v250, v200, v201
v_lshlrev_b32 v26, 16, v251
v_and_b32 v27, 0xffff0000, v251
v_add_f32 v202, v202, v26
v_add_f32 v203, v203, v27
v_cvt_pk_bf16_f32 v251, v202, v203
s_lshr_b32 s28, s24, 1
s_add_u32 s28, s28, 0
s_lshl_b32 s28, s28, 6
v_add_u32 v28, s28, v225
s_movk_i32 s29, 1280
v_mul_lo_u32 v28, v28, s29
s_mul_i32 s91, s25, 160
v_and_b32 v29, 1, v5
v_lshlrev_b32 v29, 1, v29
v_lshrrev_b32 v30, 1, v5
v_add_u32 v29, v29, v30
v_lshl_add_u32 v29, v29, 4, v28
v_permlane16_swap_b32 v248, v250
v_permlane16_swap_b32 v249, v251
s_nop 0
buffer_store_dwordx4 v[248:251], v29, s[12:15], s91 offen offset:96
V68:
s_waitcnt vmcnt(23)
v_mfma_f32_16x16x32_bf16 v[184:187], a[0:3], v[128:131], 0
v_mfma_f32_16x16x32_bf16 v[204:207], a[0:3], v[132:135], 0
v_mfma_f32_16x16x32_bf16 v[188:191], a[4:7], v[128:131], 0
v_mfma_f32_16x16x32_bf16 v[208:211], a[4:7], v[132:135], 0
v_mfma_f32_16x16x32_bf16 v[192:195], a[8:11], v[128:131], 0
v_mfma_f32_16x16x32_bf16 v[212:215], a[8:11], v[132:135], 0
v_mfma_f32_16x16x32_bf16 v[196:199], a[12:15], v[128:131], 0
v_mfma_f32_16x16x32_bf16 v[216:219], a[12:15], v[132:135], 0
v_mfma_f32_16x16x32_bf16 v[200:203], a[16:19], v[128:131], 0
v_mfma_f32_16x16x32_bf16 v[220:223], a[16:19], v[132:135], 0
s_waitcnt vmcnt(21)
v_mfma_f32_16x16x32_bf16 v[184:187], a[20:23], v[136:139], v[184:187]
v_mfma_f32_16x16x32_bf16 v[204:207], a[20:23], v[140:143], v[204:207]
v_mfma_f32_16x16x32_bf16 v[188:191], a[24:27], v[136:139], v[188:191]
v_mfma_f32_16x16x32_bf16 v[208:211], a[24:27], v[140:143], v[208:211]
v_mfma_f32_16x16x32_bf16 v[192:195], a[28:31], v[136:139], v[192:195]
v_mfma_f32_16x16x32_bf16 v[212:215], a[28:31], v[140:143], v[212:215]
v_mfma_f32_16x16x32_bf16 v[196:199], a[32:35], v[136:139], v[196:199]
v_mfma_f32_16x16x32_bf16 v[216:219], a[32:35], v[140:143], v[216:219]
v_mfma_f32_16x16x32_bf16 v[200:203], a[36:39], v[136:139], v[200:203]
v_mfma_f32_16x16x32_bf16 v[220:223], a[36:39], v[140:143], v[220:223]
s_waitcnt vmcnt(19)
v_mfma_f32_16x16x32_bf16 v[184:187], a[40:43], v[144:147], v[184:187]
v_mfma_f32_16x16x32_bf16 v[204:207], a[40:43], v[148:151], v[204:207]
v_mfma_f32_16x16x32_bf16 v[188:191], a[44:47], v[144:147], v[188:191]
v_mfma_f32_16x16x32_bf16 v[208:211], a[44:47], v[148:151], v[208:211]
v_mfma_f32_16x16x32_bf16 v[192:195], a[48:51], v[144:147], v[192:195]
v_mfma_f32_16x16x32_bf16 v[212:215], a[48:51], v[148:151], v[212:215]
v_mfma_f32_16x16x32_bf16 v[196:199], a[52:55], v[144:147], v[196:199]
v_mfma_f32_16x16x32_bf16 v[216:219], a[52:55], v[148:151], v[216:219]
v_mfma_f32_16x16x32_bf16 v[200:203], a[56:59], v[144:147], v[200:203]
v_mfma_f32_16x16x32_bf16 v[220:223], a[56:59], v[148:151], v[220:223]
s_waitcnt vmcnt(17)
v_mfma_f32_16x16x32_bf16 v[184:187], a[60:63], v[152:155], v[184:187]
v_mfma_f32_16x16x32_bf16 v[204:207], a[60:63], v[156:159], v[204:207]
v_mfma_f32_16x16x32_bf16 v[188:191], a[64:67], v[152:155], v[188:191]
v_mfma_f32_16x16x32_bf16 v[208:211], a[64:67], v[156:159], v[208:211]
v_mfma_f32_16x16x32_bf16 v[192:195], a[68:71], v[152:155], v[192:195]
v_mfma_f32_16x16x32_bf16 v[212:215], a[68:71], v[156:159], v[212:215]
v_mfma_f32_16x16x32_bf16 v[196:199], a[72:75], v[152:155], v[196:199]
v_mfma_f32_16x16x32_bf16 v[216:219], a[72:75], v[156:159], v[216:219]
v_mfma_f32_16x16x32_bf16 v[200:203], a[76:79], v[152:155], v[200:203]
v_mfma_f32_16x16x32_bf16 v[220:223], a[76:79], v[156:159], v[220:223]
s_waitcnt vmcnt(15)
v_mfma_f32_16x16x32_bf16 v[184:187], a[80:83], v[160:163], v[184:187]
v_mfma_f32_16x16x32_bf16 v[204:207], a[80:83], v[164:167], v[204:207]
v_mfma_f32_16x16x32_bf16 v[188:191], a[84:87], v[160:163], v[188:191]
v_mfma_f32_16x16x32_bf16 v[208:211], a[84:87], v[164:167], v[208:211]
v_mfma_f32_16x16x32_bf16 v[192:195], a[88:91], v[160:163], v[192:195]
v_mfma_f32_16x16x32_bf16 v[212:215], a[88:91], v[164:167], v[212:215]
v_mfma_f32_16x16x32_bf16 v[196:199], a[92:95], v[160:163], v[196:199]
v_mfma_f32_16x16x32_bf16 v[216:219], a[92:95], v[164:167], v[216:219]
v_mfma_f32_16x16x32_bf16 v[200:203], a[96:99], v[160:163], v[200:203]
v_mfma_f32_16x16x32_bf16 v[220:223], a[96:99], v[164:167], v[220:223]
s_waitcnt vmcnt(13)
v_mfma_f32_16x16x32_bf16 v[184:187], a[100:103], v[168:171], v[184:187]
v_mfma_f32_16x16x32_bf16 v[204:207], a[100:103], v[172:175], v[204:207]
v_mfma_f32_16x16x32_bf16 v[188:191], a[104:107], v[168:171], v[188:191]
v_mfma_f32_16x16x32_bf16 v[208:211], a[104:107], v[172:175], v[208:211]
v_mfma_f32_16x16x32_bf16 v[192:195], a[108:111], v[168:171], v[192:195]
v_mfma_f32_16x16x32_bf16 v[212:215], a[108:111], v[172:175], v[212:215]
v_mfma_f32_16x16x32_bf16 v[196:199], a[112:115], v[168:171], v[196:199]
v_mfma_f32_16x16x32_bf16 v[216:219], a[112:115], v[172:175], v[216:219]
v_mfma_f32_16x16x32_bf16 v[200:203], a[116:119], v[168:171], v[200:203]
v_mfma_f32_16x16x32_bf16 v[220:223], a[116:119], v[172:175], v[220:223]
s_waitcnt vmcnt(11)
v_mfma_f32_16x16x32_bf16 v[184:187], a[120:123], v[176:179], v[184:187]
v_mfma_f32_16x16x32_bf16 v[204:207], a[120:123], v[180:183], v[204:207]
v_mfma_f32_16x16x32_bf16 v[188:191], a[124:127], v[176:179], v[188:191]
v_mfma_f32_16x16x32_bf16 v[208:211], a[124:127], v[180:183], v[208:211]
v_mfma_f32_16x16x32_bf16 v[192:195], a[128:131], v[176:179], v[192:195]
v_mfma_f32_16x16x32_bf16 v[212:215], a[128:131], v[180:183], v[212:215]
v_mfma_f32_16x16x32_bf16 v[196:199], a[132:135], v[176:179], v[196:199]
v_mfma_f32_16x16x32_bf16 v[216:219], a[132:135], v[180:183], v[216:219]
v_mfma_f32_16x16x32_bf16 v[200:203], a[136:139], v[176:179], v[200:203]
v_mfma_f32_16x16x32_bf16 v[220:223], a[136:139], v[180:183], v[220:223]
s_waitcnt vmcnt(9)
v_mfma_f32_16x16x32_bf16 v[184:187], a[140:143], v[32:35], v[184:187]
v_mfma_f32_16x16x32_bf16 v[204:207], a[140:143], v[36:39], v[204:207]
v_mfma_f32_16x16x32_bf16 v[188:191], a[144:147], v[32:35], v[188:191]
v_mfma_f32_16x16x32_bf16 v[208:211], a[144:147], v[36:39], v[208:211]
v_mfma_f32_16x16x32_bf16 v[192:195], a[148:151], v[32:35], v[192:195]
v_mfma_f32_16x16x32_bf16 v[212:215], a[148:151], v[36:39], v[212:215]
v_mfma_f32_16x16x32_bf16 v[196:199], a[152:155], v[32:35], v[196:199]
v_mfma_f32_16x16x32_bf16 v[216:219], a[152:155], v[36:39], v[216:219]
v_mfma_f32_16x16x32_bf16 v[200:203], a[156:159], v[32:35], v[200:203]
v_mfma_f32_16x16x32_bf16 v[220:223], a[156:159], v[36:39], v[220:223]
s_waitcnt vmcnt(7)
v_mfma_f32_16x16x32_bf16 v[184:187], a[160:163], v[40:43], v[184:187]
v_mfma_f32_16x16x32_bf16 v[204:207], a[160:163], v[44:47], v[204:207]
v_mfma_f32_16x16x32_bf16 v[188:191], a[164:167], v[40:43], v[188:191]
v_mfma_f32_16x16x32_bf16 v[208:211], a[164:167], v[44:47], v[208:211]
v_mfma_f32_16x16x32_bf16 v[192:195], a[168:171], v[40:43], v[192:195]
v_mfma_f32_16x16x32_bf16 v[212:215], a[168:171], v[44:47], v[212:215]
v_mfma_f32_16x16x32_bf16 v[196:199], a[172:175], v[40:43], v[196:199]
v_mfma_f32_16x16x32_bf16 v[216:219], a[172:175], v[44:47], v[216:219]
v_mfma_f32_16x16x32_bf16 v[200:203], a[176:179], v[40:43], v[200:203]
v_mfma_f32_16x16x32_bf16 v[220:223], a[176:179], v[44:47], v[220:223]
s_waitcnt vmcnt(5)
v_mfma_f32_16x16x32_bf16 v[184:187], a[180:183], v[48:51], v[184:187]
v_mfma_f32_16x16x32_bf16 v[204:207], a[180:183], v[52:55], v[204:207]
v_mfma_f32_16x16x32_bf16 v[188:191], a[184:187], v[48:51], v[188:191]
v_mfma_f32_16x16x32_bf16 v[208:211], a[184:187], v[52:55], v[208:211]
v_mfma_f32_16x16x32_bf16 v[192:195], a[188:191], v[48:51], v[192:195]
v_mfma_f32_16x16x32_bf16 v[212:215], a[188:191], v[52:55], v[212:215]
v_mfma_f32_16x16x32_bf16 v[196:199], a[192:195], v[48:51], v[196:199]
v_mfma_f32_16x16x32_bf16 v[216:219], a[192:195], v[52:55], v[216:219]
v_mfma_f32_16x16x32_bf16 v[200:203], a[196:199], v[48:51], v[200:203]
v_mfma_f32_16x16x32_bf16 v[220:223], a[196:199], v[52:55], v[220:223]
s_waitcnt vmcnt(3)
v_mfma_f32_16x16x32_bf16 v[184:187], a[200:203], v[56:59], v[184:187]
v_mfma_f32_16x16x32_bf16 v[204:207], a[200:203], v[60:63], v[204:207]
v_mfma_f32_16x16x32_bf16 v[188:191], a[204:207], v[56:59], v[188:191]
v_mfma_f32_16x16x32_bf16 v[208:211], a[204:207], v[60:63], v[208:211]
v_mfma_f32_16x16x32_bf16 v[192:195], a[208:211], v[56:59], v[192:195]
v_mfma_f32_16x16x32_bf16 v[212:215], a[208:211], v[60:63], v[212:215]
v_mfma_f32_16x16x32_bf16 v[196:199], a[212:215], v[56:59], v[196:199]
v_mfma_f32_16x16x32_bf16 v[216:219], a[212:215], v[60:63], v[216:219]
v_mfma_f32_16x16x32_bf16 v[200:203], a[216:219], v[56:59], v[200:203]
v_mfma_f32_16x16x32_bf16 v[220:223], a[216:219], v[60:63], v[220:223]
s_waitcnt vmcnt(1)
v_mfma_f32_16x16x32_bf16 v[184:187], a[220:223], v[64:67], v[184:187]
v_mfma_f32_16x16x32_bf16 v[204:207], a[220:223], v[68:71], v[204:207]
v_mfma_f32_16x16x32_bf16 v[188:191], a[224:227], v[64:67], v[188:191]
v_mfma_f32_16x16x32_bf16 v[208:211], a[224:227], v[68:71], v[208:211]
v_mfma_f32_16x16x32_bf16 v[192:195], a[228:231], v[64:67], v[192:195]
v_mfma_f32_16x16x32_bf16 v[212:215], a[228:231], v[68:71], v[212:215]
v_mfma_f32_16x16x32_bf16 v[196:199], a[232:235], v[64:67], v[196:199]
v_mfma_f32_16x16x32_bf16 v[216:219], a[232:235], v[68:71], v[216:219]
v_mfma_f32_16x16x32_bf16 v[200:203], a[236:239], v[64:67], v[200:203]
v_mfma_f32_16x16x32_bf16 v[220:223], a[236:239], v[68:71], v[220:223]
s_lshr_b32 s28, s24, 1
s_add_u32 s28, s28, 16
s_mul_i32 s88, s28, 81920
s_mul_i32 s29, s25, 10240
s_add_u32 s88, s88, s29
s_barrier
s_mul_i32 s28, s16, 10240
s_add_u32 s28, s28, 0
s_and_b32 s29, s16, 1
s_mul_i32 s29, s29, 5120
s_add_u32 s90, s28, s29
v_add_u32 v24, s90, v1
s_xor_b32 s29, s29, 5120
s_add_u32 s90, s28, s29
v_add_u32 v25, s90, v1
s_cmp_ge_u32 s16, 2
s_cbranch_scc1 V71
s_nop 1
ds_write_b128 v25, v[204:207] offset:0
ds_write_b128 v25, v[208:211] offset:1024
ds_write_b128 v25, v[212:215] offset:2048
ds_write_b128 v24, v[196:199] offset:3072
ds_write_b128 v25, v[216:219] offset:3072
ds_write_b128 v24, v[200:203] offset:4096
ds_write_b128 v25, v[220:223] offset:4096
s_waitcnt lgkmcnt(0)
s_barrier
s_add_u32 s28, s16, 1
s_and_b32 s28, s28, 3
s_mul_i32 s28, s28, 10240
s_and_b32 s29, s16, 1
s_mul_i32 s29, s29, 5120
s_add_u32 s28, s28, s29
s_add_u32 s28, s28, 0
v_add_u32 v26, s28, v1
ds_read_b128 v[72:75], v26 offset:0
ds_read_b128 v[76:79], v26 offset:1024
ds_read_b128 v[80:83], v26 offset:2048
s_add_u32 s28, s16, 2
s_and_b32 s28, s28, 3
s_mul_i32 s28, s28, 10240
s_and_b32 s29, s16, 1
s_mul_i32 s29, s29, 5120
s_add_u32 s28, s28, s29
s_add_u32 s28, s28, 0
v_add_u32 v26, s28, v1
ds_read_b128 v[84:87], v26 offset:0
ds_read_b128 v[88:91], v26 offset:1024
ds_read_b128 v[92:95], v26 offset:2048
s_add_u32 s28, s16, 3
s_and_b32 s28, s28, 3
s_mul_i32 s28, s28, 10240
s_and_b32 s29, s16, 1
s_mul_i32 s29, s29, 5120
s_add_u32 s28, s28, s29
s_add_u32 s28, s28, 0
v_add_u32 v26, s28, v1
ds_read_b128 v[96:99], v26 offset:0
ds_read_b128 v[100:103], v26 offset:1024
ds_read_b128 v[104:107], v26 offset:2048
s_waitcnt lgkmcnt(6)
v_add_f32 v184, v184, v72
v_add_f32 v185, v185, v73
v_add_f32 v186, v186, v74
v_add_f32 v187, v187, v75
v_add_f32 v188, v188, v76
v_add_f32 v189, v189, v77
v_add_f32 v190, v190, v78
v_add_f32 v191, v191, v79
v_add_f32 v192, v192, v80
v_add_f32 v193, v193, v81
v_add_f32 v194, v194, v82
v_add_f32 v195, v195, v83
s_waitcnt lgkmcnt(3)
v_add_f32 v184, v184, v84
v_add_f32 v185, v185, v85
v_add_f32 v186, v186, v86
v_add_f32 v187, v187, v87
v_add_f32 v188, v188, v88
v_add_f32 v189, v189, v89
v_add_f32 v190, v190, v90
v_add_f32 v191, v191, v91
v_add_f32 v192, v192, v92
v_add_f32 v193, v193, v93
v_add_f32 v194, v194, v94
v_add_f32 v195, v195, v95
s_waitcnt lgkmcnt(0)
v_add_f32 v184, v184, v96
v_add_f32 v185, v185, v97
v_add_f32 v186, v186, v98
v_add_f32 v187, v187, v99
v_add_f32 v188, v188, v100
v_add_f32 v189, v189, v101
v_add_f32 v190, v190, v102
v_add_f32 v191, v191, v103
v_add_f32 v192, v192, v104
v_add_f32 v193, v193, v105
v_add_f32 v194, v194, v106
v_add_f32 v195, v195, v107
v_lshlrev_b32 v26, 16, v232
v_and_b32 v27, 0xffff0000, v232
v_add_f32 v184, v184, v26
v_add_f32 v185, v185, v27
v_cvt_pk_bf16_f32 v232, v184, v185
v_lshlrev_b32 v26, 16, v233
v_and_b32 v27, 0xffff0000, v233
v_add_f32 v186, v186, v26
v_add_f32 v187, v187, v27
v_cvt_pk_bf16_f32 v233, v186, v187
v_lshlrev_b32 v26, 16, v234
v_and_b32 v27, 0xffff0000, v234
v_add_f32 v188, v188, v26
v_add_f32 v189, v189, v27
v_cvt_pk_bf16_f32 v234, v188, v189
v_lshlrev_b32 v26, 16, v235
v_and_b32 v27, 0xffff0000, v235
v_add_f32 v190, v190, v26
v_add_f32 v191, v191, v27
v_cvt_pk_bf16_f32 v235, v190, v191
v_lshlrev_b32 v26, 16, v236
v_and_b32 v27, 0xffff0000, v236
v_add_f32 v192, v192, v26
v_add_f32 v193, v193, v27
v_cvt_pk_bf16_f32 v236, v192, v193
v_lshlrev_b32 v26, 16, v237
v_and_b32 v27, 0xffff0000, v237
v_add_f32 v194, v194, v26
v_add_f32 v195, v195, v27
v_cvt_pk_bf16_f32 v237, v194, v195
s_lshr_b32 s28, s24, 1
s_add_u32 s28, s28, 16
s_lshl_b32 s28, s28, 6
v_add_u32 v28, s28, v244
s_movk_i32 s29, 1280
v_mul_lo_u32 v28, v28, s29
s_mul_i32 s91, s25, 160
v_lshl_add_u32 v29, v5, 3, v28
buffer_store_dwordx2 v[236:237], v29, s[12:15], s91 offen offset:64
v_and_b32 v29, 1, v5
v_lshlrev_b32 v29, 1, v29
v_lshrrev_b32 v30, 1, v5
v_add_u32 v29, v29, v30
v_lshl_add_u32 v29, v29, 4, v28
v_permlane16_swap_b32 v232, v234
v_permlane16_swap_b32 v233, v235
s_nop 0
buffer_store_dwordx4 v[232:235], v29, s[12:15], s91 offen offset:0
s_branch V70
V71:
s_nop 1
ds_write_b128 v24, v[184:187] offset:0
ds_write_b128 v25, v[204:207] offset:0
ds_write_b128 v24, v[188:191] offset:1024
ds_write_b128 v25, v[208:211] offset:1024
ds_write_b128 v24, v[192:195] offset:2048
ds_write_b128 v25, v[212:215] offset:2048
ds_write_b128 v25, v[216:219] offset:3072
ds_write_b128 v25, v[220:223] offset:4096
s_waitcnt lgkmcnt(0)
s_barrier
s_add_u32 s28, s16, 1
s_and_b32 s28, s28, 3
s_mul_i32 s28, s28, 10240
s_and_b32 s29, s16, 1
s_mul_i32 s29, s29, 5120
s_add_u32 s28, s28, s29
s_add_u32 s28, s28, 0
v_add_u32 v26, s28, v1
ds_read_b128 v[72:75], v26 offset:3072
ds_read_b128 v[76:79], v26 offset:4096
s_add_u32 s28, s16, 2
s_and_b32 s28, s28, 3
s_mul_i32 s28, s28, 10240
s_and_b32 s29, s16, 1
s_mul_i32 s29, s29, 5120
s_add_u32 s28, s28, s29
s_add_u32 s28, s28, 0
v_add_u32 v26, s28, v1
ds_read_b128 v[84:87], v26 offset:3072
ds_read_b128 v[88:91], v26 offset:4096
s_add_u32 s28, s16, 3
s_and_b32 s28, s28, 3
s_mul_i32 s28, s28, 10240
s_and_b32 s29, s16, 1
s_mul_i32 s29, s29, 5120
s_add_u32 s28, s28, s29
s_add_u32 s28, s28, 0
v_add_u32 v26, s28, v1
ds_read_b128 v[96:99], v26 offset:3072
ds_read_b128 v[100:103], v26 offset:4096
s_waitcnt lgkmcnt(4)
v_add_f32 v196, v196, v72
v_add_f32 v197, v197, v73
v_add_f32 v198, v198, v74
v_add_f32 v199, v199, v75
v_add_f32 v200, v200, v76
v_add_f32 v201, v201, v77
v_add_f32 v202, v202, v78
v_add_f32 v203, v203, v79
s_waitcnt lgkmcnt(2)
v_add_f32 v196, v196, v84
v_add_f32 v197, v197, v85
v_add_f32 v198, v198, v86
v_add_f32 v199, v199, v87
v_add_f32 v200, v200, v88
v_add_f32 v201, v201, v89
v_add_f32 v202, v202, v90
v_add_f32 v203, v203, v91
s_waitcnt lgkmcnt(0)
v_add_f32 v196, v196, v96
v_add_f32 v197, v197, v97
v_add_f32 v198, v198, v98
v_add_f32 v199, v199, v99
v_add_f32 v200, v200, v100
v_add_f32 v201, v201, v101
v_add_f32 v202, v202, v102
v_add_f32 v203, v203, v103
v_lshlrev_b32 v26, 16, v232
v_and_b32 v27, 0xffff0000, v232
v_add_f32 v196, v196, v26
v_add_f32 v197, v197, v27
v_cvt_pk_bf16_f32 v232, v196, v197
v_lshlrev_b32 v26, 16, v233
v_and_b32 v27, 0xffff0000, v233
v_add_f32 v198, v198, v26
v_add_f32 v199, v199, v27
v_cvt_pk_bf16_f32 v233, v198, v199
v_lshlrev_b32 v26, 16, v234
v_and_b32 v27, 0xffff0000, v234
v_add_f32 v200, v200, v26
v_add_f32 v201, v201, v27
v_cvt_pk_bf16_f32 v234, v200, v201
v_lshlrev_b32 v26, 16, v235
v_and_b32 v27, 0xffff0000, v235
v_add_f32 v202, v202, v26
v_add_f32 v203, v203, v27
v_cvt_pk_bf16_f32 v235, v202, v203
s_lshr_b32 s28, s24, 1
s_add_u32 s28, s28, 16
s_lshl_b32 s28, s28, 6
v_add_u32 v28, s28, v244
s_movk_i32 s29, 1280
v_mul_lo_u32 v28, v28, s29
s_mul_i32 s91, s25, 160
v_and_b32 v29, 1, v5
v_lshlrev_b32 v29, 1, v29
v_lshrrev_b32 v30, 1, v5
v_add_u32 v29, v29, v30
v_lshl_add_u32 v29, v29, 4, v28
v_permlane16_swap_b32 v232, v234
v_permlane16_swap_b32 v233, v235
s_nop 0
buffer_store_dwordx4 v[232:235], v29, s[12:15], s91 offen offset:96
V70:
s_waitcnt vmcnt(0)
s_endpgm
mega_end:
s_endpgm
.section .rodata,"a"
.p2align 6
.amdhsa_kernel prep_kernel
  .amdhsa_next_free_vgpr 96
  .amdhsa_next_free_sgpr 56
  .amdhsa_accum_offset 96
  .amdhsa_group_segment_fixed_size 0
  .amdhsa_kernarg_size 80
  .amdhsa_user_sgpr_count 2
  .amdhsa_user_sgpr_kernarg_segment_ptr 1
  .amdhsa_system_sgpr_workgroup_id_x 1
.end_amdhsa_kernel
.p2align 6
.amdhsa_kernel mega_kernel
  .amdhsa_next_free_vgpr 512
  .amdhsa_next_free_sgpr 100
  .amdhsa_accum_offset 256
  .amdhsa_group_segment_fixed_size 0
  .amdhsa_kernarg_size 80
  .amdhsa_user_sgpr_count 2
  .amdhsa_user_sgpr_kernarg_segment_ptr 1
  .amdhsa_system_sgpr_workgroup_id_x 1
.end_amdhsa_kernel
```
